```python
import torch

def _softmax(x, axis=-1):
    return torch.softmax(x, dim=axis)

def _gelu(x):
    return torch.nn.functional.gelu(x, approximate='tanh')

def _silu(x):
    return torch.nn.functional.silu(x)

def _sigmoid(x):
    return torch.sigmoid(x)

def _layernorm(x, axis=-1, eps=1e-05):
    m = x.mean(dim=axis, keepdim=True)
    v = x.var(dim=axis, keepdim=True, unbiased=False)
    return (x - m) / torch.sqrt(v + eps)

def _scatter_add(tgt, idx, src, axis=0):
    return tgt.clone().index_add_(axis, idx, src)

def _segment_sum(src, seg, n):
    out = torch.zeros((n,) + src.shape[1:], dtype=src.dtype)
    return out.index_add_(0, seg, src)

def _pad(x, pw):
    flat = tuple((v for pair in reversed(pw) for v in pair))
    return torch.nn.functional.pad(x, flat)
kernel_name = 'recurrent_scan__memory_aug_recurrent_mem_tr__dense_activation_squared_relu__prompt'

def setup_inputs():

    _w = lambda a: (lambda t: t.to(torch.bfloat16) if t.is_floating_point() else t)(torch.as_tensor(a))

    def _A_setup():
        B, S, Dm = (1, 2048, 640)
        H, Dh = (32, 128)
        M, seg = (8, 32)
        seg = min(seg, S)
        S = S // seg * seg
        return {'x': _w((lambda *s: torch.randn(*s, dtype=torch.bfloat16) * 0.05)(B, S, Dm)), 'mem0': _w((lambda *s: torch.randn(*s, dtype=torch.bfloat16) * 0.05)(B, M, Dm)), 'Wq': _w((lambda *s: torch.randn(*s, dtype=torch.bfloat16) * 1.6)(Dm, H, Dh) * Dm ** (-0.5)), 'Wk': _w((lambda *s: torch.randn(*s, dtype=torch.bfloat16) * 1.6)(Dm, H, Dh) * Dm ** (-0.5)), 'Wv': _w((lambda *s: torch.randn(*s, dtype=torch.bfloat16) * 0.05)(Dm, H, Dh) * Dm ** (-0.5)), 'Wo': _w((lambda *s: torch.randn(*s, dtype=torch.bfloat16) * 0.05)(H, Dh, Dm) * (H * Dh) ** (-0.5)), 'seg_len': seg}
    _A_in = _A_setup()

    def _B_setup():
        B, S, D, F = (1, 2048, 640, 1728)
        return {'x': _w((lambda *s: torch.randn(*s, dtype=torch.bfloat16) * 0.05)(B, S, D)), 'w1': _w((lambda *s: torch.randn(*s, dtype=torch.bfloat16) * 0.05)(D, F)), 'b1': _w((lambda *s: torch.randn(*s, dtype=torch.bfloat16) * 0.4)(F)), 'w2': _w((lambda *s: torch.randn(*s, dtype=torch.bfloat16) * 0.05)(F, D)), 'b2': _w((lambda *s: torch.randn(*s, dtype=torch.bfloat16) * 3.2)(D))}
    _B_in = _B_setup()
    return {'A_x': _A_in['x'], 'A_mem0': _A_in['mem0'], 'A_Wq': _A_in['Wq'], 'A_Wk': _A_in['Wk'], 'A_Wv': _A_in['Wv'], 'A_Wo': _A_in['Wo'], 'A_seg_len': _A_in['seg_len'], 'B_x': _B_in['x'], 'B_w1': _B_in['w1'], 'B_b1': _B_in['b1'], 'B_w2': _B_in['w2'], 'B_b2': _B_in['b2']}

def reference(A_x, A_mem0, A_Wq, A_Wk, A_Wv, A_Wo, A_seg_len, B_x, B_w1, B_b1, B_w2, B_b2):

    def _A_ref(x, mem0, Wq, Wk, Wv, Wo, seg_len):
        B, S, Dm = x.shape
        H, Dh = (Wq.shape[1], Wq.shape[2])
        M = mem0.shape[1]
        scale = Dh ** (-0.5)
        n_seg = S // seg_len
        L = M + seg_len
        idx = torch.arange(L)
        mask = (idx[:, None] < M) | (idx[:, None] >= idx[None, :])
        mem = mem0
        outs = []
        for s in range(n_seg):
            xs = x[:, s * seg_len:(s + 1) * seg_len, :].clone()
            h = torch.concatenate([mem, xs], axis=1)
            q = torch.einsum('btd,dhe->bhte', h, Wq)
            k = torch.einsum('btd,dhe->bhte', h, Wk)
            v = torch.einsum('btd,dhe->bhte', h, Wv)
            scores = torch.einsum('bhqe,bhke->bhqk', q, k) * scale
            scores = torch.where(mask[None, None], scores, -1000000000.0)
            p = _softmax(scores, axis=-1)
            o = torch.einsum('bhqk,bhke->bhqe', p, v)
            o = torch.einsum('bhte,hed->btd', o, Wo)
            mem = o[:, :M, :].clone()
            outs.append(o[:, M:, :])
        return torch.concatenate(outs, axis=1)

    def _B_ref(x, w1, b1, w2, b2):
        h = torch.einsum('bsd,df->bsf', x, w1) + b1
        zero = torch.zeros_like(h)
        r = torch.where(h > zero, h, zero)
        h = r * r
        out = torch.einsum('bsf,fd->bsd', h, w2) + b2
        return out
    x = A_x
    xn = _layernorm(x, axis=-1)
    s = _A_ref(xn, A_mem0, A_Wq, A_Wk, A_Wv, A_Wo, A_seg_len)
    g = _silu(_B_ref(xn, B_w1, B_b1, B_w2, B_b2))
    return x + s * g
```

```asm
; @launch grid=(256,1,1) block=(256,1,1) lds=163840
.amdgcn_target "amdgcn-amd-amdhsa--gfx950"
.text
.globl recurrent_scan__memory_aug_recurrent_mem_tr__dense_activation_squared_relu__prompt_kernel
.type recurrent_scan__memory_aug_recurrent_mem_tr__dense_activation_squared_relu__prompt_kernel,@function
.p2align 8
recurrent_scan__memory_aug_recurrent_mem_tr__dense_activation_squared_relu__prompt_kernel:
    s_cmp_ge_u32 s2, 256
    s_cbranch_scc1 L_end
    s_load_dwordx2 s[8:9], s[0:1], 0
    s_load_dwordx2 s[12:13], s[0:1], 8
    s_load_dwordx2 s[16:17], s[0:1], 16
    s_load_dwordx2 s[20:21], s[0:1], 24
    s_load_dwordx2 s[24:25], s[0:1], 32
    s_load_dwordx2 s[28:29], s[0:1], 40
    s_load_dwordx2 s[32:33], s[0:1], 64
    s_load_dwordx2 s[36:37], s[0:1], 72
    s_load_dwordx2 s[40:41], s[0:1], 80
    s_load_dwordx2 s[44:45], s[0:1], 88
    s_load_dwordx2 s[48:49], s[0:1], 96
    s_load_dwordx2 s[52:53], s[0:1], 104
    s_load_dwordx2 s[56:57], s[0:1], 112
    s_waitcnt lgkmcnt(0)
    s_and_b32 s9, s9, 0xffff
    s_mov_b32 s10, 2621440
    s_mov_b32 s11, 0x00020000
    s_and_b32 s13, s13, 0xffff
    s_mov_b32 s14, 10240
    s_mov_b32 s15, 0x00020000
    s_and_b32 s17, s17, 0xffff
    s_mov_b32 s18, 5242880
    s_mov_b32 s19, 0x00020000
    s_and_b32 s21, s21, 0xffff
    s_mov_b32 s22, 5242880
    s_mov_b32 s23, 0x00020000
    s_and_b32 s25, s25, 0xffff
    s_mov_b32 s26, 5242880
    s_mov_b32 s27, 0x00020000
    s_and_b32 s29, s29, 0xffff
    s_mov_b32 s30, 5242880
    s_mov_b32 s31, 0x00020000
    s_and_b32 s33, s33, 0xffff
    s_mov_b32 s34, 2211840
    s_mov_b32 s35, 0x00020000
    s_and_b32 s37, s37, 0xffff
    s_mov_b32 s38, 3456
    s_mov_b32 s39, 0x00020000
    s_and_b32 s41, s41, 0xffff
    s_mov_b32 s42, 2211840
    s_mov_b32 s43, 0x00020000
    s_and_b32 s45, s45, 0xffff
    s_mov_b32 s46, 1280
    s_mov_b32 s47, 0x00020000
    s_and_b32 s49, s49, 0xffff
    s_mov_b32 s50, 2621440
    s_mov_b32 s51, 0x00020000
    s_and_b32 s53, s53, 0xffff
    s_mov_b32 s54, 256
    s_mov_b32 s55, 0x00020000
    s_and_b32 s57, s57, 0xffff
    s_mov_b32 s58, 268435456
    s_mov_b32 s59, 0x00020000
    s_mov_b32 s101, 0
    s_getreg_b32 s3, hwreg(HW_REG_XCC_ID)
    s_and_b32 s3, s3, 15
    v_and_b32 v24, 63, v0
    v_lshrrev_b32 v12, 6, v0
    s_nop 0
    v_readfirstlane_b32 s61, v12
    v_lshlrev_b32 v1, 4, v24
    v_lshrrev_b32 v25, 4, v24
    v_and_b32 v26, 15, v24
    s_lshl_b32 s74, s61, 15
    v_lshrrev_b32 v12, 2, v24
    v_and_b32 v13, 7, v12
    v_and_b32 v14, 3, v24
    v_lshlrev_b32 v12, 8, v12
    v_lshl_add_u32 v12, v13, 5, v12
    v_lshl_add_u32 v12, v14, 3, v12
    v_xor_b32 v13, 0, v12
    v_add_u32 v4, s74, v13
    v_xor_b32 v13, 32, v12
    v_add_u32 v5, s74, v13
    v_xor_b32 v13, 64, v12
    v_add_u32 v6, s74, v13
    v_xor_b32 v13, 96, v12
    v_add_u32 v7, s74, v13
    v_xor_b32 v13, 128, v12
    v_add_u32 v8, s74, v13
    v_xor_b32 v13, 160, v12
    v_add_u32 v9, s74, v13
    v_xor_b32 v13, 192, v12
    v_add_u32 v10, s74, v13
    v_xor_b32 v13, 224, v12
    v_add_u32 v11, s74, v13
    s_cmp_lg_u32 s2, 0
    s_cbranch_scc1 L_nz
    v_mov_b32 v12, 0
    v_mov_b32 v13, 0
    v_mov_b32 v14, 0
    v_mov_b32 v15, 0
    v_lshlrev_b32 v16, 4, v0
    s_mov_b32 s62, 94371840
    buffer_store_dwordx4 v[12:15], v16, s[56:59], s62 offen sc1
    s_add_u32 s62, s62, 4096
    buffer_store_dwordx4 v[12:15], v16, s[56:59], s62 offen sc1
    s_add_u32 s62, s62, 4096
    buffer_store_dwordx4 v[12:15], v16, s[56:59], s62 offen sc1
    s_add_u32 s62, s62, 4096
    buffer_store_dwordx4 v[12:15], v16, s[56:59], s62 offen sc1
    s_add_u32 s62, s62, 4096
    s_waitcnt vmcnt(0)
    s_barrier
    v_mov_b32 v12, 1
    v_mov_b32 v13, 128
    buffer_store_dword v12, v13, s[52:55], 0 offen sc1
L_nz:
    s_mov_b32 s7, 99
    s_mov_b32 s100, 0
    s_cmp_lg_u32 s3, 0
    s_cbranch_scc1 L_ln
    v_mov_b32 v12, 1
    v_mov_b32 v13, 0
    v_cmp_eq_u32 vcc, 0, v0
    s_and_saveexec_b64 s[4:5], vcc
    s_cbranch_execz L_ba118
    buffer_atomic_add v12, v13, s[52:55], 0 offen sc0 sc1
    s_waitcnt vmcnt(0)
    v_mov_b32 v13, 163832
    ds_write_b32 v13, v12
L_ba118:
    s_mov_b64 exec, s[4:5]
    s_waitcnt lgkmcnt(0)
    s_barrier
    v_mov_b32 v13, 163832
    ds_read_b32 v12, v13
    s_waitcnt lgkmcnt(0)
    v_readfirstlane_b32 s7, v12
    s_barrier
L_ln:
    s_mov_b32 s76, s2
    v_lshlrev_b32 v78, 3, v24
    v_cmp_gt_u32 s[90:91], 32, v24
    s_lshl_b32 s62, s76, 3
    s_lshl_b32 s63, s61, 1
    s_add_u32 s75, s62, s63
    s_mul_i32 s62, s75, 1280
    v_mov_b64 v[64:65], 0
    buffer_load_dwordx2 v[60:61], v78, s[8:11], s62 offen
    buffer_load_dwordx2 v[62:63], v78, s[8:11], s62 offen offset:512
    v_mov_b64 v[70:71], 0
    buffer_load_dwordx2 v[66:67], v78, s[8:11], s62 offen offset:1280
    buffer_load_dwordx2 v[68:69], v78, s[8:11], s62 offen offset:1792
    s_mov_b64 exec, s[90:91]
    buffer_load_dwordx2 v[64:65], v78, s[8:11], s62 offen offset:1024
    buffer_load_dwordx2 v[70:71], v78, s[8:11], s62 offen offset:2304
    s_mov_b64 exec, -1
    v_add_u32 v73, 0, v24
    v_lshrrev_b32 v79, 3, v73
    v_lshlrev_b32 v79, 10, v79
    v_and_b32 v72, 3, v73
    v_lshl_add_u32 v79, v72, 8, v79
    v_bfe_u32 v72, v73, 2, 1
    v_lshl_add_u32 v79, v72, 3, v79
    v_add_u32 v73, 64, v24
    v_lshrrev_b32 v80, 3, v73
    v_lshlrev_b32 v80, 10, v80
    v_and_b32 v72, 3, v73
    v_lshl_add_u32 v80, v72, 8, v80
    v_bfe_u32 v72, v73, 2, 1
    v_lshl_add_u32 v80, v72, 3, v80
    v_add_u32 v73, 128, v24
    v_lshrrev_b32 v81, 3, v73
    v_lshlrev_b32 v81, 10, v81
    v_and_b32 v72, 3, v73
    v_lshl_add_u32 v81, v72, 8, v81
    v_bfe_u32 v72, v73, 2, 1
    v_lshl_add_u32 v81, v72, 3, v81
    s_lshr_b32 s62, s75, 4
    s_mul_i32 s62, s62, 20480
    s_and_b32 s63, s75, 15
    s_lshl_b32 s63, s63, 4
    s_add_u32 s62, s62, s63
    s_add_u32 s71, s62, 0
    s_waitcnt vmcnt(5)
    v_lshlrev_b32 v28, 16, v60
    v_and_b32 v29, 0xffff0000, v60
    v_lshlrev_b32 v30, 16, v61
    v_and_b32 v31, 0xffff0000, v61
    s_waitcnt vmcnt(4)
    v_lshlrev_b32 v32, 16, v62
    v_and_b32 v33, 0xffff0000, v62
    v_lshlrev_b32 v34, 16, v63
    v_and_b32 v35, 0xffff0000, v63
    s_waitcnt vmcnt(1)
    v_lshlrev_b32 v36, 16, v64
    v_and_b32 v37, 0xffff0000, v64
    v_lshlrev_b32 v38, 16, v65
    v_and_b32 v39, 0xffff0000, v65
    v_add_f32 v72, v28, v29
    v_add_f32 v72, v72, v30
    v_add_f32 v72, v72, v31
    v_add_f32 v72, v72, v32
    v_add_f32 v72, v72, v33
    v_add_f32 v72, v72, v34
    v_add_f32 v72, v72, v35
    v_add_f32 v72, v72, v36
    v_add_f32 v72, v72, v37
    v_add_f32 v72, v72, v38
    v_add_f32 v72, v72, v39
    s_nop 1
    v_add_f32 v72, v72, v72 row_ror:8 row_mask:0xf bank_mask:0xf
    s_nop 1
    v_add_f32 v72, v72, v72 row_ror:4 row_mask:0xf bank_mask:0xf
    s_nop 1
    v_add_f32 v72, v72, v72 row_ror:2 row_mask:0xf bank_mask:0xf
    s_nop 1
    v_add_f32 v72, v72, v72 row_ror:1 row_mask:0xf bank_mask:0xf
    v_mov_b32 v73, v72
    s_nop 1
    v_permlane32_swap_b32 v72, v73
    v_add_f32 v72, v72, v73
    v_mov_b32 v73, v72
    s_nop 1
    v_permlane16_swap_b32 v72, v73
    v_add_f32 v72, v72, v73
    v_mul_f32 v74, 0x3acccccd, v72
    v_sub_f32 v73, v28, v74
    v_mul_f32 v72, v73, v73
    v_sub_f32 v73, v29, v74
    v_fmac_f32 v72, v73, v73
    v_sub_f32 v73, v30, v74
    v_fmac_f32 v72, v73, v73
    v_sub_f32 v73, v31, v74
    v_fmac_f32 v72, v73, v73
    v_sub_f32 v73, v32, v74
    v_fmac_f32 v72, v73, v73
    v_sub_f32 v73, v33, v74
    v_fmac_f32 v72, v73, v73
    v_sub_f32 v73, v34, v74
    v_fmac_f32 v72, v73, v73
    v_sub_f32 v73, v35, v74
    v_fmac_f32 v72, v73, v73
    v_mov_b32 v83, 0
    v_sub_f32 v73, v36, v74
    v_fmac_f32 v83, v73, v73
    v_sub_f32 v73, v37, v74
    v_fmac_f32 v83, v73, v73
    v_sub_f32 v73, v38, v74
    v_fmac_f32 v83, v73, v73
    v_sub_f32 v73, v39, v74
    v_fmac_f32 v83, v73, v73
    v_cndmask_b32 v83, 0, v83, s[90:91]
    v_add_f32 v72, v72, v83
    s_nop 1
    v_add_f32 v72, v72, v72 row_ror:8 row_mask:0xf bank_mask:0xf
    s_nop 1
    v_add_f32 v72, v72, v72 row_ror:4 row_mask:0xf bank_mask:0xf
    s_nop 1
    v_add_f32 v72, v72, v72 row_ror:2 row_mask:0xf bank_mask:0xf
    s_nop 1
    v_add_f32 v72, v72, v72 row_ror:1 row_mask:0xf bank_mask:0xf
    v_mov_b32 v73, v72
    s_nop 1
    v_permlane32_swap_b32 v72, v73
    v_add_f32 v72, v72, v73
    v_mov_b32 v73, v72
    s_nop 1
    v_permlane16_swap_b32 v72, v73
    v_add_f32 v72, v72, v73
    v_mul_f32 v72, 0x3acccccd, v72
    v_cvt_pk_bf16_f32 v73, v74, v72
    v_lshlrev_b32 v82, 16, v73
    v_and_b32 v72, 0xffff0000, v73
    v_add_f32 v72, 0x3727c5ac, v72
    v_cvt_pk_bf16_f32 v73, v72, v72
    v_lshlrev_b32 v72, 16, v73
    v_sqrt_f32 v72, v72
    s_nop 0
    v_cvt_pk_bf16_f32 v73, v72, v72
    v_lshlrev_b32 v72, 16, v73
    v_rcp_f32 v83, v72
    v_sub_f32 v28, v28, v82
    v_sub_f32 v29, v29, v82
    v_sub_f32 v30, v30, v82
    v_sub_f32 v31, v31, v82
    v_cvt_pk_bf16_f32 v73, v28, v29
    v_lshlrev_b32 v28, 16, v73
    v_and_b32 v29, 0xffff0000, v73
    v_cvt_pk_bf16_f32 v73, v30, v31
    v_lshlrev_b32 v30, 16, v73
    v_and_b32 v31, 0xffff0000, v73
    v_mul_f32 v74, v28, v83
    v_fma_f32 v28, -v74, v72, v28
    v_fma_f32 v28, v28, v83, v74
    v_mul_f32 v74, v29, v83
    v_fma_f32 v29, -v74, v72, v29
    v_fma_f32 v29, v29, v83, v74
    v_mul_f32 v74, v30, v83
    v_fma_f32 v30, -v74, v72, v30
    v_fma_f32 v30, v30, v83, v74
    v_mul_f32 v74, v31, v83
    v_fma_f32 v31, -v74, v72, v31
    v_fma_f32 v31, v31, v83, v74
    v_cvt_pk_bf16_f32 v76, v28, v29
    v_cvt_pk_bf16_f32 v77, v30, v31
    buffer_store_dwordx2 v[76:77], v79, s[56:59], s71 offen sc1
    v_sub_f32 v32, v32, v82
    v_sub_f32 v33, v33, v82
    v_sub_f32 v34, v34, v82
    v_sub_f32 v35, v35, v82
    v_cvt_pk_bf16_f32 v73, v32, v33
    v_lshlrev_b32 v32, 16, v73
    v_and_b32 v33, 0xffff0000, v73
    v_cvt_pk_bf16_f32 v73, v34, v35
    v_lshlrev_b32 v34, 16, v73
    v_and_b32 v35, 0xffff0000, v73
    v_mul_f32 v74, v32, v83
    v_fma_f32 v32, -v74, v72, v32
    v_fma_f32 v32, v32, v83, v74
    v_mul_f32 v74, v33, v83
    v_fma_f32 v33, -v74, v72, v33
    v_fma_f32 v33, v33, v83, v74
    v_mul_f32 v74, v34, v83
    v_fma_f32 v34, -v74, v72, v34
    v_fma_f32 v34, v34, v83, v74
    v_mul_f32 v74, v35, v83
    v_fma_f32 v35, -v74, v72, v35
    v_fma_f32 v35, v35, v83, v74
    v_cvt_pk_bf16_f32 v76, v32, v33
    v_cvt_pk_bf16_f32 v77, v34, v35
    buffer_store_dwordx2 v[76:77], v80, s[56:59], s71 offen sc1
    v_sub_f32 v36, v36, v82
    v_sub_f32 v37, v37, v82
    v_sub_f32 v38, v38, v82
    v_sub_f32 v39, v39, v82
    v_cvt_pk_bf16_f32 v73, v36, v37
    v_lshlrev_b32 v36, 16, v73
    v_and_b32 v37, 0xffff0000, v73
    v_cvt_pk_bf16_f32 v73, v38, v39
    v_lshlrev_b32 v38, 16, v73
    v_and_b32 v39, 0xffff0000, v73
    v_mul_f32 v74, v36, v83
    v_fma_f32 v36, -v74, v72, v36
    v_fma_f32 v36, v36, v83, v74
    v_mul_f32 v74, v37, v83
    v_fma_f32 v37, -v74, v72, v37
    v_fma_f32 v37, v37, v83, v74
    v_mul_f32 v74, v38, v83
    v_fma_f32 v38, -v74, v72, v38
    v_fma_f32 v38, v38, v83, v74
    v_mul_f32 v74, v39, v83
    v_fma_f32 v39, -v74, v72, v39
    v_fma_f32 v39, v39, v83, v74
    v_cvt_pk_bf16_f32 v76, v36, v37
    v_cvt_pk_bf16_f32 v77, v38, v39
    s_mov_b64 exec, s[90:91]
    buffer_store_dwordx2 v[76:77], v81, s[56:59], s71 offen sc1
    s_mov_b64 exec, -1
    v_lshlrev_b32 v44, 16, v66
    v_and_b32 v45, 0xffff0000, v66
    v_lshlrev_b32 v46, 16, v67
    v_and_b32 v47, 0xffff0000, v67
    v_lshlrev_b32 v48, 16, v68
    v_and_b32 v49, 0xffff0000, v68
    v_lshlrev_b32 v50, 16, v69
    v_and_b32 v51, 0xffff0000, v69
    s_waitcnt vmcnt(3)
    v_lshlrev_b32 v52, 16, v70
    v_and_b32 v53, 0xffff0000, v70
    v_lshlrev_b32 v54, 16, v71
    v_and_b32 v55, 0xffff0000, v71
    v_add_f32 v72, v44, v45
    v_add_f32 v72, v72, v46
    v_add_f32 v72, v72, v47
    v_add_f32 v72, v72, v48
    v_add_f32 v72, v72, v49
    v_add_f32 v72, v72, v50
    v_add_f32 v72, v72, v51
    v_add_f32 v72, v72, v52
    v_add_f32 v72, v72, v53
    v_add_f32 v72, v72, v54
    v_add_f32 v72, v72, v55
    s_nop 1
    v_add_f32 v72, v72, v72 row_ror:8 row_mask:0xf bank_mask:0xf
    s_nop 1
    v_add_f32 v72, v72, v72 row_ror:4 row_mask:0xf bank_mask:0xf
    s_nop 1
    v_add_f32 v72, v72, v72 row_ror:2 row_mask:0xf bank_mask:0xf
    s_nop 1
    v_add_f32 v72, v72, v72 row_ror:1 row_mask:0xf bank_mask:0xf
    v_mov_b32 v73, v72
    s_nop 1
    v_permlane32_swap_b32 v72, v73
    v_add_f32 v72, v72, v73
    v_mov_b32 v73, v72
    s_nop 1
    v_permlane16_swap_b32 v72, v73
    v_add_f32 v72, v72, v73
    v_mul_f32 v74, 0x3acccccd, v72
    v_sub_f32 v73, v44, v74
    v_mul_f32 v72, v73, v73
    v_sub_f32 v73, v45, v74
    v_fmac_f32 v72, v73, v73
    v_sub_f32 v73, v46, v74
    v_fmac_f32 v72, v73, v73
    v_sub_f32 v73, v47, v74
    v_fmac_f32 v72, v73, v73
    v_sub_f32 v73, v48, v74
    v_fmac_f32 v72, v73, v73
    v_sub_f32 v73, v49, v74
    v_fmac_f32 v72, v73, v73
    v_sub_f32 v73, v50, v74
    v_fmac_f32 v72, v73, v73
    v_sub_f32 v73, v51, v74
    v_fmac_f32 v72, v73, v73
    v_mov_b32 v83, 0
    v_sub_f32 v73, v52, v74
    v_fmac_f32 v83, v73, v73
    v_sub_f32 v73, v53, v74
    v_fmac_f32 v83, v73, v73
    v_sub_f32 v73, v54, v74
    v_fmac_f32 v83, v73, v73
    v_sub_f32 v73, v55, v74
    v_fmac_f32 v83, v73, v73
    v_cndmask_b32 v83, 0, v83, s[90:91]
    v_add_f32 v72, v72, v83
    s_nop 1
    v_add_f32 v72, v72, v72 row_ror:8 row_mask:0xf bank_mask:0xf
    s_nop 1
    v_add_f32 v72, v72, v72 row_ror:4 row_mask:0xf bank_mask:0xf
    s_nop 1
    v_add_f32 v72, v72, v72 row_ror:2 row_mask:0xf bank_mask:0xf
    s_nop 1
    v_add_f32 v72, v72, v72 row_ror:1 row_mask:0xf bank_mask:0xf
    v_mov_b32 v73, v72
    s_nop 1
    v_permlane32_swap_b32 v72, v73
    v_add_f32 v72, v72, v73
    v_mov_b32 v73, v72
    s_nop 1
    v_permlane16_swap_b32 v72, v73
    v_add_f32 v72, v72, v73
    v_mul_f32 v72, 0x3acccccd, v72
    v_cvt_pk_bf16_f32 v73, v74, v72
    v_lshlrev_b32 v82, 16, v73
    v_and_b32 v72, 0xffff0000, v73
    v_add_f32 v72, 0x3727c5ac, v72
    v_cvt_pk_bf16_f32 v73, v72, v72
    v_lshlrev_b32 v72, 16, v73
    v_sqrt_f32 v72, v72
    s_nop 0
    v_cvt_pk_bf16_f32 v73, v72, v72
    v_lshlrev_b32 v72, 16, v73
    v_rcp_f32 v83, v72
    v_sub_f32 v44, v44, v82
    v_sub_f32 v45, v45, v82
    v_sub_f32 v46, v46, v82
    v_sub_f32 v47, v47, v82
    v_cvt_pk_bf16_f32 v73, v44, v45
    v_lshlrev_b32 v44, 16, v73
    v_and_b32 v45, 0xffff0000, v73
    v_cvt_pk_bf16_f32 v73, v46, v47
    v_lshlrev_b32 v46, 16, v73
    v_and_b32 v47, 0xffff0000, v73
    v_mul_f32 v74, v44, v83
    v_fma_f32 v44, -v74, v72, v44
    v_fma_f32 v44, v44, v83, v74
    v_mul_f32 v74, v45, v83
    v_fma_f32 v45, -v74, v72, v45
    v_fma_f32 v45, v45, v83, v74
    v_mul_f32 v74, v46, v83
    v_fma_f32 v46, -v74, v72, v46
    v_fma_f32 v46, v46, v83, v74
    v_mul_f32 v74, v47, v83
    v_fma_f32 v47, -v74, v72, v47
    v_fma_f32 v47, v47, v83, v74
    v_cvt_pk_bf16_f32 v76, v44, v45
    v_cvt_pk_bf16_f32 v77, v46, v47
    buffer_store_dwordx2 v[76:77], v79, s[56:59], s71 offen offset:16 sc1
    v_sub_f32 v48, v48, v82
    v_sub_f32 v49, v49, v82
    v_sub_f32 v50, v50, v82
    v_sub_f32 v51, v51, v82
    v_cvt_pk_bf16_f32 v73, v48, v49
    v_lshlrev_b32 v48, 16, v73
    v_and_b32 v49, 0xffff0000, v73
    v_cvt_pk_bf16_f32 v73, v50, v51
    v_lshlrev_b32 v50, 16, v73
    v_and_b32 v51, 0xffff0000, v73
    v_mul_f32 v74, v48, v83
    v_fma_f32 v48, -v74, v72, v48
    v_fma_f32 v48, v48, v83, v74
    v_mul_f32 v74, v49, v83
    v_fma_f32 v49, -v74, v72, v49
    v_fma_f32 v49, v49, v83, v74
    v_mul_f32 v74, v50, v83
    v_fma_f32 v50, -v74, v72, v50
    v_fma_f32 v50, v50, v83, v74
    v_mul_f32 v74, v51, v83
    v_fma_f32 v51, -v74, v72, v51
    v_fma_f32 v51, v51, v83, v74
    v_cvt_pk_bf16_f32 v76, v48, v49
    v_cvt_pk_bf16_f32 v77, v50, v51
    buffer_store_dwordx2 v[76:77], v80, s[56:59], s71 offen offset:16 sc1
    v_sub_f32 v52, v52, v82
    v_sub_f32 v53, v53, v82
    v_sub_f32 v54, v54, v82
    v_sub_f32 v55, v55, v82
    v_cvt_pk_bf16_f32 v73, v52, v53
    v_lshlrev_b32 v52, 16, v73
    v_and_b32 v53, 0xffff0000, v73
    v_cvt_pk_bf16_f32 v73, v54, v55
    v_lshlrev_b32 v54, 16, v73
    v_and_b32 v55, 0xffff0000, v73
    v_mul_f32 v74, v52, v83
    v_fma_f32 v52, -v74, v72, v52
    v_fma_f32 v52, v52, v83, v74
    v_mul_f32 v74, v53, v83
    v_fma_f32 v53, -v74, v72, v53
    v_fma_f32 v53, v53, v83, v74
    v_mul_f32 v74, v54, v83
    v_fma_f32 v54, -v74, v72, v54
    v_fma_f32 v54, v54, v83, v74
    v_mul_f32 v74, v55, v83
    v_fma_f32 v55, -v74, v72, v55
    v_fma_f32 v55, v55, v83, v74
    v_cvt_pk_bf16_f32 v76, v52, v53
    v_cvt_pk_bf16_f32 v77, v54, v55
    s_mov_b64 exec, s[90:91]
    buffer_store_dwordx2 v[76:77], v81, s[56:59], s71 offen offset:16 sc1
    s_mov_b64 exec, -1
    s_cmp_lg_u32 s61, 0
    s_cbranch_scc1 L_fr1
    v_mov_b32 v13, 128
L_fr:
    buffer_load_dword v12, v13, s[52:55], 0 offen sc1
    s_waitcnt vmcnt(0)
    v_cmp_eq_u32 vcc, 0, v12
    s_cbranch_vccnz L_fr
L_fr1:
    s_lshr_b32 s72, s2, 4
    s_lshl_b32 s65, s72, 7
    s_add_u32 s65, s65, 94372864
    s_waitcnt vmcnt(0)
    s_barrier
    s_cmp_lg_u32 s61, 0
    s_cbranch_scc1 L_sig1
    v_mov_b32 v12, 1
    v_mov_b32 v13, 0
    s_mov_b64 exec, 1
    buffer_atomic_add v12, v13, s[56:59], s65 offen sc1
    s_mov_b64 exec, -1
L_sig1:
    s_barrier
    s_mov_b32 s60, s7
    s_cmp_lt_u32 s60, 32
    s_cbranch_scc1 L_chain
L_par:
    v_and_b32 v24, 63, v0
    v_lshrrev_b32 v12, 6, v0
    s_nop 0
    v_readfirstlane_b32 s61, v12
    v_lshlrev_b32 v1, 4, v24
    v_lshrrev_b32 v25, 4, v24
    v_and_b32 v26, 15, v24
    s_lshl_b32 s74, s61, 15
    v_lshrrev_b32 v12, 2, v24
    v_and_b32 v13, 7, v12
    v_and_b32 v14, 3, v24
    v_lshlrev_b32 v12, 8, v12
    v_lshl_add_u32 v12, v13, 5, v12
    v_lshl_add_u32 v12, v14, 3, v12
    v_xor_b32 v13, 0, v12
    v_add_u32 v4, s74, v13
    v_xor_b32 v13, 32, v12
    v_add_u32 v5, s74, v13
    v_xor_b32 v13, 64, v12
    v_add_u32 v6, s74, v13
    v_xor_b32 v13, 96, v12
    v_add_u32 v7, s74, v13
    v_xor_b32 v13, 128, v12
    v_add_u32 v8, s74, v13
    v_xor_b32 v13, 160, v12
    v_add_u32 v9, s74, v13
    v_xor_b32 v13, 192, v12
    v_add_u32 v10, s74, v13
    v_xor_b32 v13, 224, v12
    v_add_u32 v11, s74, v13
    s_add_u32 s96, s3, 6
    s_mul_hi_u32 s62, s96, 0x24924925
    s_mul_i32 s62, s62, 7
    s_sub_u32 s96, s96, s62
    s_mov_b32 s97, 0
    s_branch L_deq
L_next:
    v_mov_b32 v13, 0
    s_cmp_lg_u32 s61, 0
    s_cbranch_scc1 L_fb0
    buffer_load_dword v12, v13, s[52:55], 0 offen sc1
    v_mov_b32 v13, 163828
    s_waitcnt vmcnt(0)
    ds_write_b32 v13, v12
L_fb0:
    s_waitcnt lgkmcnt(0)
    s_barrier
    v_mov_b32 v13, 163828
    ds_read_b32 v12, v13
    s_waitcnt lgkmcnt(0)
    v_readfirstlane_b32 s62, v12
    s_cmp_ge_u32 s62, 32
    s_cbranch_scc1 L_deq
    v_mov_b32 v12, 1
    v_mov_b32 v13, 0
    v_cmp_eq_u32 vcc, 0, v0
    s_and_saveexec_b64 s[4:5], vcc
    s_cbranch_execz L_ba576
    buffer_atomic_add v12, v13, s[52:55], 0 offen sc0 sc1
    s_waitcnt vmcnt(0)
    v_mov_b32 v13, 163832
    ds_write_b32 v13, v12
L_ba576:
    s_mov_b64 exec, s[4:5]
    s_waitcnt lgkmcnt(0)
    s_barrier
    v_mov_b32 v13, 163832
    ds_read_b32 v12, v13
    s_waitcnt lgkmcnt(0)
    v_readfirstlane_b32 s60, v12
    s_barrier
    s_cmp_lt_u32 s60, 32
    s_cbranch_scc1 L_chain
    v_and_b32 v24, 63, v0
    v_lshrrev_b32 v12, 6, v0
    s_nop 0
    v_readfirstlane_b32 s61, v12
    v_lshlrev_b32 v1, 4, v24
    v_lshrrev_b32 v25, 4, v24
    v_and_b32 v26, 15, v24
    s_lshl_b32 s74, s61, 15
    v_lshrrev_b32 v12, 2, v24
    v_and_b32 v13, 7, v12
    v_and_b32 v14, 3, v24
    v_lshlrev_b32 v12, 8, v12
    v_lshl_add_u32 v12, v13, 5, v12
    v_lshl_add_u32 v12, v14, 3, v12
    v_xor_b32 v13, 0, v12
    v_add_u32 v4, s74, v13
    v_xor_b32 v13, 32, v12
    v_add_u32 v5, s74, v13
    v_xor_b32 v13, 64, v12
    v_add_u32 v6, s74, v13
    v_xor_b32 v13, 96, v12
    v_add_u32 v7, s74, v13
    v_xor_b32 v13, 128, v12
    v_add_u32 v8, s74, v13
    v_xor_b32 v13, 160, v12
    v_add_u32 v9, s74, v13
    v_xor_b32 v13, 192, v12
    v_add_u32 v10, s74, v13
    v_xor_b32 v13, 224, v12
    v_add_u32 v11, s74, v13
L_deq:
    s_cmp_lg_u32 s97, 0
    s_cbranch_scc1 L_phB
L_qtry:
    s_lshl_b32 s62, s96, 7
    s_add_u32 s62, s62, 94384128
    v_mov_b32 v12, 1
    v_mov_b32 v13, s62
    v_cmp_eq_u32 vcc, 0, v0
    s_and_saveexec_b64 s[4:5], vcc
    s_cbranch_execz L_ba631
    buffer_atomic_add v12, v13, s[56:59], 0 offen sc0 sc1
    s_waitcnt vmcnt(0)
    v_mov_b32 v13, 163832
    ds_write_b32 v13, v12
L_ba631:
    s_mov_b64 exec, s[4:5]
    s_waitcnt lgkmcnt(0)
    s_barrier
    v_mov_b32 v13, 163832
    ds_read_b32 v12, v13
    s_waitcnt lgkmcnt(0)
    v_readfirstlane_b32 s60, v12
    s_barrier
    s_cmp_lt_u32 s60, 64
    s_cbranch_scc1 L_qgot
    v_lshlrev_b32 v13, 7, v24
    v_mov_b32 v12, 64
    s_mov_b32 s62, 94384128
    s_mov_b64 exec, 127
    buffer_load_dword v12, v13, s[56:59], s62 offen sc1
    s_mov_b64 exec, -1
    s_waitcnt vmcnt(0)
    v_cmp_gt_u32 vcc, 64, v12
    s_and_b32 s62, vcc_lo, 127
    v_mov_b32 v12, s62
    v_mov_b32 v13, 163828
    s_cmp_lg_u32 s61, 0
    s_cbranch_scc1 L_q1
    ds_write_b32 v13, v12
L_q1:
    s_waitcnt lgkmcnt(0)
    s_barrier
    ds_read_b32 v12, v13
    s_waitcnt lgkmcnt(0)
    v_readfirstlane_b32 s62, v12
    s_barrier
    s_cmp_eq_u32 s62, 0
    s_cbranch_scc1 L_toB
    s_ff1_i32_b32 s96, s62
    s_branch L_qtry
L_toB:
    s_mov_b32 s97, 1
    s_branch L_phB
L_qgot:
    s_cmp_lt_u32 s96, 2
    s_cbranch_scc0 L_d2
    s_cmp_lt_u32 s60, 48
    s_cbranch_scc0 L_d1o
    s_mul_hi_u32 s72, s60, 0x55555556
    s_mul_i32 s63, s72, 3
    s_sub_u32 s63, s60, s63
    s_branch L_dkv
L_d1o:
    s_sub_u32 s72, s60, 48
    s_mov_b32 s62, s96
    s_branch L_doth
L_d2:
    s_cmp_lt_u32 s60, 32
    s_cbranch_scc0 L_d2o
    s_lshr_b32 s72, s60, 1
    s_and_b32 s63, s60, 1
    s_branch L_dkv
L_d2o:
    s_sub_u32 s63, s60, 32
    s_lshr_b32 s72, s63, 1
    s_and_b32 s63, s63, 1
    s_lshl_b32 s62, s96, 1
    s_sub_u32 s62, s62, 2
    s_add_u32 s62, s62, s63
    s_branch L_doth
L_dkv:
    s_mul_i32 s62, s63, 7
    s_add_u32 s62, s62, s96
    s_and_b32 s63, s62, 7
    s_lshl_b32 s63, s63, 2
    s_add_u32 s77, s63, s61
    s_cmp_ge_u32 s62, 8
    s_cbranch_scc1 L_tv
    s_mov_b32 s62, 8192
    v_mul_lo_u32 v12, v25, s62
    v_lshlrev_b32 v13, 1, v25
    v_xor_b32 v13, v13, v26
    v_lshl_add_u32 v2, v13, 4, v12
    v_lshlrev_b32 v13, 1, v25
    v_add_u32 v13, 8, v13
    v_xor_b32 v13, v13, v26
    v_lshl_add_u32 v3, v13, 4, v12
    s_lshl_b32 s65, s72, 7
    s_add_u32 s65, s65, 94372864
    s_cmp_lg_u32 s61, 0
    s_cbranch_scc1 L_wf2d
    v_mov_b32 v13, 0
L_wf2:
    buffer_load_dword v12, v13, s[56:59], s65 offen sc1
    s_waitcnt vmcnt(0)
    v_lshrrev_b32 v12, 0, v12
    v_and_b32 v12, 31, v12
    v_cmp_le_u32 vcc, 16, v12
    s_cbranch_vccnz L_wf2d
    s_sleep 2
    s_branch L_wf2
L_wf2d:
    s_barrier
    s_lshl_b32 s68, s77, 8
    s_mul_i32 s69, s72, 163840
    s_add_u32 s69, s69, 0
    s_mov_b32 s79, 20480
    s_mov_b32 s64, 20
    v_accvgpr_write_b32 a0, 0
    v_accvgpr_write_b32 a1, 0
    v_accvgpr_write_b32 a2, 0
    v_accvgpr_write_b32 a3, 0
    v_accvgpr_write_b32 a4, 0
    v_accvgpr_write_b32 a5, 0
    v_accvgpr_write_b32 a6, 0
    v_accvgpr_write_b32 a7, 0
    v_accvgpr_write_b32 a8, 0
    v_accvgpr_write_b32 a9, 0
    v_accvgpr_write_b32 a10, 0
    v_accvgpr_write_b32 a11, 0
    v_accvgpr_write_b32 a12, 0
    v_accvgpr_write_b32 a13, 0
    v_accvgpr_write_b32 a14, 0
    v_accvgpr_write_b32 a15, 0
    v_accvgpr_write_b32 a16, 0
    v_accvgpr_write_b32 a17, 0
    v_accvgpr_write_b32 a18, 0
    v_accvgpr_write_b32 a19, 0
    v_accvgpr_write_b32 a20, 0
    v_accvgpr_write_b32 a21, 0
    v_accvgpr_write_b32 a22, 0
    v_accvgpr_write_b32 a23, 0
    v_accvgpr_write_b32 a24, 0
    v_accvgpr_write_b32 a25, 0
    v_accvgpr_write_b32 a26, 0
    v_accvgpr_write_b32 a27, 0
    v_accvgpr_write_b32 a28, 0
    v_accvgpr_write_b32 a29, 0
    v_accvgpr_write_b32 a30, 0
    v_accvgpr_write_b32 a31, 0
    v_accvgpr_write_b32 a32, 0
    v_accvgpr_write_b32 a33, 0
    v_accvgpr_write_b32 a34, 0
    v_accvgpr_write_b32 a35, 0
    v_accvgpr_write_b32 a36, 0
    v_accvgpr_write_b32 a37, 0
    v_accvgpr_write_b32 a38, 0
    v_accvgpr_write_b32 a39, 0
    v_accvgpr_write_b32 a40, 0
    v_accvgpr_write_b32 a41, 0
    v_accvgpr_write_b32 a42, 0
    v_accvgpr_write_b32 a43, 0
    v_accvgpr_write_b32 a44, 0
    v_accvgpr_write_b32 a45, 0
    v_accvgpr_write_b32 a46, 0
    v_accvgpr_write_b32 a47, 0
    v_accvgpr_write_b32 a48, 0
    v_accvgpr_write_b32 a49, 0
    v_accvgpr_write_b32 a50, 0
    v_accvgpr_write_b32 a51, 0
    v_accvgpr_write_b32 a52, 0
    v_accvgpr_write_b32 a53, 0
    v_accvgpr_write_b32 a54, 0
    v_accvgpr_write_b32 a55, 0
    v_accvgpr_write_b32 a56, 0
    v_accvgpr_write_b32 a57, 0
    v_accvgpr_write_b32 a58, 0
    v_accvgpr_write_b32 a59, 0
    v_accvgpr_write_b32 a60, 0
    v_accvgpr_write_b32 a61, 0
    v_accvgpr_write_b32 a62, 0
    v_accvgpr_write_b32 a63, 0
    v_accvgpr_write_b32 a64, 0
    v_accvgpr_write_b32 a65, 0
    v_accvgpr_write_b32 a66, 0
    v_accvgpr_write_b32 a67, 0
    v_accvgpr_write_b32 a68, 0
    v_accvgpr_write_b32 a69, 0
    v_accvgpr_write_b32 a70, 0
    v_accvgpr_write_b32 a71, 0
    v_accvgpr_write_b32 a72, 0
    v_accvgpr_write_b32 a73, 0
    v_accvgpr_write_b32 a74, 0
    v_accvgpr_write_b32 a75, 0
    v_accvgpr_write_b32 a76, 0
    v_accvgpr_write_b32 a77, 0
    v_accvgpr_write_b32 a78, 0
    v_accvgpr_write_b32 a79, 0
    v_accvgpr_write_b32 a80, 0
    v_accvgpr_write_b32 a81, 0
    v_accvgpr_write_b32 a82, 0
    v_accvgpr_write_b32 a83, 0
    v_accvgpr_write_b32 a84, 0
    v_accvgpr_write_b32 a85, 0
    v_accvgpr_write_b32 a86, 0
    v_accvgpr_write_b32 a87, 0
    v_accvgpr_write_b32 a88, 0
    v_accvgpr_write_b32 a89, 0
    v_accvgpr_write_b32 a90, 0
    v_accvgpr_write_b32 a91, 0
    v_accvgpr_write_b32 a92, 0
    v_accvgpr_write_b32 a93, 0
    v_accvgpr_write_b32 a94, 0
    v_accvgpr_write_b32 a95, 0
    v_accvgpr_write_b32 a96, 0
    v_accvgpr_write_b32 a97, 0
    v_accvgpr_write_b32 a98, 0
    v_accvgpr_write_b32 a99, 0
    v_accvgpr_write_b32 a100, 0
    v_accvgpr_write_b32 a101, 0
    v_accvgpr_write_b32 a102, 0
    v_accvgpr_write_b32 a103, 0
    v_accvgpr_write_b32 a104, 0
    v_accvgpr_write_b32 a105, 0
    v_accvgpr_write_b32 a106, 0
    v_accvgpr_write_b32 a107, 0
    v_accvgpr_write_b32 a108, 0
    v_accvgpr_write_b32 a109, 0
    v_accvgpr_write_b32 a110, 0
    v_accvgpr_write_b32 a111, 0
    v_accvgpr_write_b32 a112, 0
    v_accvgpr_write_b32 a113, 0
    v_accvgpr_write_b32 a114, 0
    v_accvgpr_write_b32 a115, 0
    v_accvgpr_write_b32 a116, 0
    v_accvgpr_write_b32 a117, 0
    v_accvgpr_write_b32 a118, 0
    v_accvgpr_write_b32 a119, 0
    v_accvgpr_write_b32 a120, 0
    v_accvgpr_write_b32 a121, 0
    v_accvgpr_write_b32 a122, 0
    v_accvgpr_write_b32 a123, 0
    v_accvgpr_write_b32 a124, 0
    v_accvgpr_write_b32 a125, 0
    v_accvgpr_write_b32 a126, 0
    v_accvgpr_write_b32 a127, 0
    v_accvgpr_write_b32 a128, 0
    v_accvgpr_write_b32 a129, 0
    v_accvgpr_write_b32 a130, 0
    v_accvgpr_write_b32 a131, 0
    v_accvgpr_write_b32 a132, 0
    v_accvgpr_write_b32 a133, 0
    v_accvgpr_write_b32 a134, 0
    v_accvgpr_write_b32 a135, 0
    v_accvgpr_write_b32 a136, 0
    v_accvgpr_write_b32 a137, 0
    v_accvgpr_write_b32 a138, 0
    v_accvgpr_write_b32 a139, 0
    v_accvgpr_write_b32 a140, 0
    v_accvgpr_write_b32 a141, 0
    v_accvgpr_write_b32 a142, 0
    v_accvgpr_write_b32 a143, 0
    v_accvgpr_write_b32 a144, 0
    v_accvgpr_write_b32 a145, 0
    v_accvgpr_write_b32 a146, 0
    v_accvgpr_write_b32 a147, 0
    v_accvgpr_write_b32 a148, 0
    v_accvgpr_write_b32 a149, 0
    v_accvgpr_write_b32 a150, 0
    v_accvgpr_write_b32 a151, 0
    v_accvgpr_write_b32 a152, 0
    v_accvgpr_write_b32 a153, 0
    v_accvgpr_write_b32 a154, 0
    v_accvgpr_write_b32 a155, 0
    v_accvgpr_write_b32 a156, 0
    v_accvgpr_write_b32 a157, 0
    v_accvgpr_write_b32 a158, 0
    v_accvgpr_write_b32 a159, 0
    v_accvgpr_write_b32 a160, 0
    v_accvgpr_write_b32 a161, 0
    v_accvgpr_write_b32 a162, 0
    v_accvgpr_write_b32 a163, 0
    v_accvgpr_write_b32 a164, 0
    v_accvgpr_write_b32 a165, 0
    v_accvgpr_write_b32 a166, 0
    v_accvgpr_write_b32 a167, 0
    v_accvgpr_write_b32 a168, 0
    v_accvgpr_write_b32 a169, 0
    v_accvgpr_write_b32 a170, 0
    v_accvgpr_write_b32 a171, 0
    v_accvgpr_write_b32 a172, 0
    v_accvgpr_write_b32 a173, 0
    v_accvgpr_write_b32 a174, 0
    v_accvgpr_write_b32 a175, 0
    v_accvgpr_write_b32 a176, 0
    v_accvgpr_write_b32 a177, 0
    v_accvgpr_write_b32 a178, 0
    v_accvgpr_write_b32 a179, 0
    v_accvgpr_write_b32 a180, 0
    v_accvgpr_write_b32 a181, 0
    v_accvgpr_write_b32 a182, 0
    v_accvgpr_write_b32 a183, 0
    v_accvgpr_write_b32 a184, 0
    v_accvgpr_write_b32 a185, 0
    v_accvgpr_write_b32 a186, 0
    v_accvgpr_write_b32 a187, 0
    v_accvgpr_write_b32 a188, 0
    v_accvgpr_write_b32 a189, 0
    v_accvgpr_write_b32 a190, 0
    v_accvgpr_write_b32 a191, 0
    v_accvgpr_write_b32 a192, 0
    v_accvgpr_write_b32 a193, 0
    v_accvgpr_write_b32 a194, 0
    v_accvgpr_write_b32 a195, 0
    v_accvgpr_write_b32 a196, 0
    v_accvgpr_write_b32 a197, 0
    v_accvgpr_write_b32 a198, 0
    v_accvgpr_write_b32 a199, 0
    v_accvgpr_write_b32 a200, 0
    v_accvgpr_write_b32 a201, 0
    v_accvgpr_write_b32 a202, 0
    v_accvgpr_write_b32 a203, 0
    v_accvgpr_write_b32 a204, 0
    v_accvgpr_write_b32 a205, 0
    v_accvgpr_write_b32 a206, 0
    v_accvgpr_write_b32 a207, 0
    v_accvgpr_write_b32 a208, 0
    v_accvgpr_write_b32 a209, 0
    v_accvgpr_write_b32 a210, 0
    v_accvgpr_write_b32 a211, 0
    v_accvgpr_write_b32 a212, 0
    v_accvgpr_write_b32 a213, 0
    v_accvgpr_write_b32 a214, 0
    v_accvgpr_write_b32 a215, 0
    v_accvgpr_write_b32 a216, 0
    v_accvgpr_write_b32 a217, 0
    v_accvgpr_write_b32 a218, 0
    v_accvgpr_write_b32 a219, 0
    v_accvgpr_write_b32 a220, 0
    v_accvgpr_write_b32 a221, 0
    v_accvgpr_write_b32 a222, 0
    v_accvgpr_write_b32 a223, 0
    v_accvgpr_write_b32 a224, 0
    v_accvgpr_write_b32 a225, 0
    v_accvgpr_write_b32 a226, 0
    v_accvgpr_write_b32 a227, 0
    v_accvgpr_write_b32 a228, 0
    v_accvgpr_write_b32 a229, 0
    v_accvgpr_write_b32 a230, 0
    v_accvgpr_write_b32 a231, 0
    v_accvgpr_write_b32 a232, 0
    v_accvgpr_write_b32 a233, 0
    v_accvgpr_write_b32 a234, 0
    v_accvgpr_write_b32 a235, 0
    v_accvgpr_write_b32 a236, 0
    v_accvgpr_write_b32 a237, 0
    v_accvgpr_write_b32 a238, 0
    v_accvgpr_write_b32 a239, 0
    v_accvgpr_write_b32 a240, 0
    v_accvgpr_write_b32 a241, 0
    v_accvgpr_write_b32 a242, 0
    v_accvgpr_write_b32 a243, 0
    v_accvgpr_write_b32 a244, 0
    v_accvgpr_write_b32 a245, 0
    v_accvgpr_write_b32 a246, 0
    v_accvgpr_write_b32 a247, 0
    v_accvgpr_write_b32 a248, 0
    v_accvgpr_write_b32 a249, 0
    v_accvgpr_write_b32 a250, 0
    v_accvgpr_write_b32 a251, 0
    v_accvgpr_write_b32 a252, 0
    v_accvgpr_write_b32 a253, 0
    v_accvgpr_write_b32 a254, 0
    v_accvgpr_write_b32 a255, 0
    s_add_u32 m0, s74, 0
    s_add_u32 s62, s68, 0
    buffer_load_dwordx4 v2, s[20:23], s62 offen lds
    s_add_u32 m0, s74, 1024
    s_add_u32 s62, s68, 32768
    buffer_load_dwordx4 v3, s[20:23], s62 offen lds
    s_add_u32 m0, s74, 2048
    s_add_u32 s62, s68, 65536
    buffer_load_dwordx4 v2, s[20:23], s62 offen lds
    s_add_u32 m0, s74, 3072
    s_add_u32 s62, s68, 98304
    buffer_load_dwordx4 v3, s[20:23], s62 offen lds
    s_add_u32 m0, s74, 4096
    s_add_u32 s62, s68, 131072
    buffer_load_dwordx4 v2, s[20:23], s62 offen lds
    s_add_u32 m0, s74, 5120
    s_add_u32 s62, s68, 163840
    buffer_load_dwordx4 v3, s[20:23], s62 offen lds
    s_add_u32 m0, s74, 6144
    s_add_u32 s62, s68, 196608
    buffer_load_dwordx4 v2, s[20:23], s62 offen lds
    s_add_u32 m0, s74, 7168
    s_add_u32 s62, s68, 229376
    buffer_load_dwordx4 v3, s[20:23], s62 offen lds
    s_add_u32 s68, s68, 262144
    s_mov_b32 s63, s69
    buffer_load_dwordx4 v[92:95], v1, s[56:59], s63 offen sc1
    s_add_u32 s63, s63, s79
    buffer_load_dwordx4 v[96:99], v1, s[56:59], s63 offen sc1
    s_add_u32 s63, s63, s79
    buffer_load_dwordx4 v[100:103], v1, s[56:59], s63 offen sc1
    s_add_u32 s63, s63, s79
    buffer_load_dwordx4 v[104:107], v1, s[56:59], s63 offen sc1
    s_add_u32 s63, s63, s79
    buffer_load_dwordx4 v[108:111], v1, s[56:59], s63 offen sc1
    s_add_u32 s63, s63, s79
    buffer_load_dwordx4 v[112:115], v1, s[56:59], s63 offen sc1
    s_add_u32 s63, s63, s79
    buffer_load_dwordx4 v[116:119], v1, s[56:59], s63 offen sc1
    s_add_u32 s63, s63, s79
    buffer_load_dwordx4 v[120:123], v1, s[56:59], s63 offen sc1
    s_add_u32 s69, s69, 1024
    s_add_u32 m0, s74, 8192
    s_add_u32 s62, s68, 0
    buffer_load_dwordx4 v2, s[20:23], s62 offen lds
    s_add_u32 m0, s74, 9216
    s_add_u32 s62, s68, 32768
    buffer_load_dwordx4 v3, s[20:23], s62 offen lds
    s_add_u32 m0, s74, 10240
    s_add_u32 s62, s68, 65536
    buffer_load_dwordx4 v2, s[20:23], s62 offen lds
    s_add_u32 m0, s74, 11264
    s_add_u32 s62, s68, 98304
    buffer_load_dwordx4 v3, s[20:23], s62 offen lds
    s_add_u32 m0, s74, 12288
    s_add_u32 s62, s68, 131072
    buffer_load_dwordx4 v2, s[20:23], s62 offen lds
    s_add_u32 m0, s74, 13312
    s_add_u32 s62, s68, 163840
    buffer_load_dwordx4 v3, s[20:23], s62 offen lds
    s_add_u32 m0, s74, 14336
    s_add_u32 s62, s68, 196608
    buffer_load_dwordx4 v2, s[20:23], s62 offen lds
    s_add_u32 m0, s74, 15360
    s_add_u32 s62, s68, 229376
    buffer_load_dwordx4 v3, s[20:23], s62 offen lds
    s_add_u32 s68, s68, 262144
    s_mov_b32 s63, s69
    buffer_load_dwordx4 v[124:127], v1, s[56:59], s63 offen sc1
    s_add_u32 s63, s63, s79
    buffer_load_dwordx4 v[128:131], v1, s[56:59], s63 offen sc1
    s_add_u32 s63, s63, s79
    buffer_load_dwordx4 v[132:135], v1, s[56:59], s63 offen sc1
    s_add_u32 s63, s63, s79
    buffer_load_dwordx4 v[136:139], v1, s[56:59], s63 offen sc1
    s_add_u32 s63, s63, s79
    buffer_load_dwordx4 v[140:143], v1, s[56:59], s63 offen sc1
    s_add_u32 s63, s63, s79
    buffer_load_dwordx4 v[144:147], v1, s[56:59], s63 offen sc1
    s_add_u32 s63, s63, s79
    buffer_load_dwordx4 v[148:151], v1, s[56:59], s63 offen sc1
    s_add_u32 s63, s63, s79
    buffer_load_dwordx4 v[152:155], v1, s[56:59], s63 offen sc1
    s_add_u32 s69, s69, 1024
    s_add_u32 m0, s74, 16384
    s_add_u32 s62, s68, 0
    buffer_load_dwordx4 v2, s[20:23], s62 offen lds
    s_add_u32 m0, s74, 17408
    s_add_u32 s62, s68, 32768
    buffer_load_dwordx4 v3, s[20:23], s62 offen lds
    s_add_u32 m0, s74, 18432
    s_add_u32 s62, s68, 65536
    buffer_load_dwordx4 v2, s[20:23], s62 offen lds
    s_add_u32 m0, s74, 19456
    s_add_u32 s62, s68, 98304
    buffer_load_dwordx4 v3, s[20:23], s62 offen lds
    s_add_u32 m0, s74, 20480
    s_add_u32 s62, s68, 131072
    buffer_load_dwordx4 v2, s[20:23], s62 offen lds
    s_add_u32 m0, s74, 21504
    s_add_u32 s62, s68, 163840
    buffer_load_dwordx4 v3, s[20:23], s62 offen lds
    s_add_u32 m0, s74, 22528
    s_add_u32 s62, s68, 196608
    buffer_load_dwordx4 v2, s[20:23], s62 offen lds
    s_add_u32 m0, s74, 23552
    s_add_u32 s62, s68, 229376
    buffer_load_dwordx4 v3, s[20:23], s62 offen lds
    s_add_u32 s68, s68, 262144
    s_waitcnt vmcnt(32)
    ds_read_b64_tr_b16 v[28:29], v4
    ds_read_b64_tr_b16 v[30:31], v4 offset:4096
    ds_read_b64_tr_b16 v[32:33], v5
    ds_read_b64_tr_b16 v[34:35], v5 offset:4096
    ds_read_b64_tr_b16 v[36:37], v6
    ds_read_b64_tr_b16 v[38:39], v6 offset:4096
    ds_read_b64_tr_b16 v[40:41], v7
    ds_read_b64_tr_b16 v[42:43], v7 offset:4096
    ds_read_b64_tr_b16 v[44:45], v8
    ds_read_b64_tr_b16 v[46:47], v8 offset:4096
    ds_read_b64_tr_b16 v[48:49], v9
    ds_read_b64_tr_b16 v[50:51], v9 offset:4096
    ds_read_b64_tr_b16 v[52:53], v10
    ds_read_b64_tr_b16 v[54:55], v10 offset:4096
    ds_read_b64_tr_b16 v[56:57], v11
    ds_read_b64_tr_b16 v[58:59], v11 offset:4096
    s_mov_b32 s70, 0
L_gk_loop:
    s_waitcnt vmcnt(16) lgkmcnt(0)
    v_mfma_f32_16x16x32_bf16 a[0:3], v[28:31], v[92:95], a[0:3]
    ds_read_b64_tr_b16 v[60:61], v4 offset:8192
    v_mfma_f32_16x16x32_bf16 a[4:7], v[28:31], v[96:99], a[4:7]
    ds_read_b64_tr_b16 v[62:63], v4 offset:12288
    v_mfma_f32_16x16x32_bf16 a[8:11], v[28:31], v[100:103], a[8:11]
    ds_read_b64_tr_b16 v[64:65], v5 offset:8192
    v_mfma_f32_16x16x32_bf16 a[12:15], v[28:31], v[104:107], a[12:15]
    ds_read_b64_tr_b16 v[66:67], v5 offset:12288
    v_mfma_f32_16x16x32_bf16 a[16:19], v[28:31], v[108:111], a[16:19]
    ds_read_b64_tr_b16 v[68:69], v6 offset:8192
    v_mfma_f32_16x16x32_bf16 a[20:23], v[28:31], v[112:115], a[20:23]
    ds_read_b64_tr_b16 v[70:71], v6 offset:12288
    v_mfma_f32_16x16x32_bf16 a[24:27], v[28:31], v[116:119], a[24:27]
    ds_read_b64_tr_b16 v[72:73], v7 offset:8192
    v_mfma_f32_16x16x32_bf16 a[28:31], v[28:31], v[120:123], a[28:31]
    ds_read_b64_tr_b16 v[74:75], v7 offset:12288
    v_mfma_f32_16x16x32_bf16 a[32:35], v[32:35], v[92:95], a[32:35]
    ds_read_b64_tr_b16 v[76:77], v8 offset:8192
    v_mfma_f32_16x16x32_bf16 a[36:39], v[32:35], v[96:99], a[36:39]
    ds_read_b64_tr_b16 v[78:79], v8 offset:12288
    v_mfma_f32_16x16x32_bf16 a[40:43], v[32:35], v[100:103], a[40:43]
    ds_read_b64_tr_b16 v[80:81], v9 offset:8192
    v_mfma_f32_16x16x32_bf16 a[44:47], v[32:35], v[104:107], a[44:47]
    ds_read_b64_tr_b16 v[82:83], v9 offset:12288
    v_mfma_f32_16x16x32_bf16 a[48:51], v[32:35], v[108:111], a[48:51]
    ds_read_b64_tr_b16 v[84:85], v10 offset:8192
    v_mfma_f32_16x16x32_bf16 a[52:55], v[32:35], v[112:115], a[52:55]
    ds_read_b64_tr_b16 v[86:87], v10 offset:12288
    v_mfma_f32_16x16x32_bf16 a[56:59], v[32:35], v[116:119], a[56:59]
    ds_read_b64_tr_b16 v[88:89], v11 offset:8192
    v_mfma_f32_16x16x32_bf16 a[60:63], v[32:35], v[120:123], a[60:63]
    ds_read_b64_tr_b16 v[90:91], v11 offset:12288
    v_mfma_f32_16x16x32_bf16 a[64:67], v[36:39], v[92:95], a[64:67]
    s_mov_b32 s63, s69
    v_mfma_f32_16x16x32_bf16 a[68:71], v[36:39], v[96:99], a[68:71]
    buffer_load_dwordx4 v[156:159], v1, s[56:59], s63 offen sc1
    v_mfma_f32_16x16x32_bf16 a[72:75], v[36:39], v[100:103], a[72:75]
    s_add_u32 s63, s63, s79
    v_mfma_f32_16x16x32_bf16 a[76:79], v[36:39], v[104:107], a[76:79]
    buffer_load_dwordx4 v[160:163], v1, s[56:59], s63 offen sc1
    v_mfma_f32_16x16x32_bf16 a[80:83], v[36:39], v[108:111], a[80:83]
    s_add_u32 s63, s63, s79
    v_mfma_f32_16x16x32_bf16 a[84:87], v[36:39], v[112:115], a[84:87]
    buffer_load_dwordx4 v[164:167], v1, s[56:59], s63 offen sc1
    v_mfma_f32_16x16x32_bf16 a[88:91], v[36:39], v[116:119], a[88:91]
    s_add_u32 s63, s63, s79
    v_mfma_f32_16x16x32_bf16 a[92:95], v[36:39], v[120:123], a[92:95]
    buffer_load_dwordx4 v[168:171], v1, s[56:59], s63 offen sc1
    v_mfma_f32_16x16x32_bf16 a[96:99], v[40:43], v[92:95], a[96:99]
    s_add_u32 s63, s63, s79
    v_mfma_f32_16x16x32_bf16 a[100:103], v[40:43], v[96:99], a[100:103]
    buffer_load_dwordx4 v[172:175], v1, s[56:59], s63 offen sc1
    v_mfma_f32_16x16x32_bf16 a[104:107], v[40:43], v[100:103], a[104:107]
    s_add_u32 s63, s63, s79
    v_mfma_f32_16x16x32_bf16 a[108:111], v[40:43], v[104:107], a[108:111]
    buffer_load_dwordx4 v[176:179], v1, s[56:59], s63 offen sc1
    v_mfma_f32_16x16x32_bf16 a[112:115], v[40:43], v[108:111], a[112:115]
    s_add_u32 s63, s63, s79
    v_mfma_f32_16x16x32_bf16 a[116:119], v[40:43], v[112:115], a[116:119]
    buffer_load_dwordx4 v[180:183], v1, s[56:59], s63 offen sc1
    v_mfma_f32_16x16x32_bf16 a[120:123], v[40:43], v[116:119], a[120:123]
    s_add_u32 s63, s63, s79
    v_mfma_f32_16x16x32_bf16 a[124:127], v[40:43], v[120:123], a[124:127]
    buffer_load_dwordx4 v[184:187], v1, s[56:59], s63 offen sc1
    v_mfma_f32_16x16x32_bf16 a[128:131], v[44:47], v[92:95], a[128:131]
    s_add_u32 s69, s69, 1024
    v_mfma_f32_16x16x32_bf16 a[132:135], v[44:47], v[96:99], a[132:135]
    s_add_u32 m0, s74, 24576
    v_mfma_f32_16x16x32_bf16 a[136:139], v[44:47], v[100:103], a[136:139]
    s_add_u32 s62, s68, 0
    v_mfma_f32_16x16x32_bf16 a[140:143], v[44:47], v[104:107], a[140:143]
    buffer_load_dwordx4 v2, s[20:23], s62 offen lds
    v_mfma_f32_16x16x32_bf16 a[144:147], v[44:47], v[108:111], a[144:147]
    s_add_u32 m0, s74, 25600
    v_mfma_f32_16x16x32_bf16 a[148:151], v[44:47], v[112:115], a[148:151]
    s_add_u32 s62, s68, 32768
    v_mfma_f32_16x16x32_bf16 a[152:155], v[44:47], v[116:119], a[152:155]
    buffer_load_dwordx4 v3, s[20:23], s62 offen lds
    v_mfma_f32_16x16x32_bf16 a[156:159], v[44:47], v[120:123], a[156:159]
    s_add_u32 m0, s74, 26624
    v_mfma_f32_16x16x32_bf16 a[160:163], v[48:51], v[92:95], a[160:163]
    s_add_u32 s62, s68, 65536
    v_mfma_f32_16x16x32_bf16 a[164:167], v[48:51], v[96:99], a[164:167]
    buffer_load_dwordx4 v2, s[20:23], s62 offen lds
    v_mfma_f32_16x16x32_bf16 a[168:171], v[48:51], v[100:103], a[168:171]
    s_add_u32 m0, s74, 27648
    v_mfma_f32_16x16x32_bf16 a[172:175], v[48:51], v[104:107], a[172:175]
    s_add_u32 s62, s68, 98304
    v_mfma_f32_16x16x32_bf16 a[176:179], v[48:51], v[108:111], a[176:179]
    buffer_load_dwordx4 v3, s[20:23], s62 offen lds
    v_mfma_f32_16x16x32_bf16 a[180:183], v[48:51], v[112:115], a[180:183]
    s_add_u32 m0, s74, 28672
    v_mfma_f32_16x16x32_bf16 a[184:187], v[48:51], v[116:119], a[184:187]
    s_add_u32 s62, s68, 131072
    v_mfma_f32_16x16x32_bf16 a[188:191], v[48:51], v[120:123], a[188:191]
    buffer_load_dwordx4 v2, s[20:23], s62 offen lds
    v_mfma_f32_16x16x32_bf16 a[192:195], v[52:55], v[92:95], a[192:195]
    s_add_u32 m0, s74, 29696
    v_mfma_f32_16x16x32_bf16 a[196:199], v[52:55], v[96:99], a[196:199]
    s_add_u32 s62, s68, 163840
    v_mfma_f32_16x16x32_bf16 a[200:203], v[52:55], v[100:103], a[200:203]
    buffer_load_dwordx4 v3, s[20:23], s62 offen lds
    v_mfma_f32_16x16x32_bf16 a[204:207], v[52:55], v[104:107], a[204:207]
    s_add_u32 m0, s74, 30720
    v_mfma_f32_16x16x32_bf16 a[208:211], v[52:55], v[108:111], a[208:211]
    s_add_u32 s62, s68, 196608
    v_mfma_f32_16x16x32_bf16 a[212:215], v[52:55], v[112:115], a[212:215]
    buffer_load_dwordx4 v2, s[20:23], s62 offen lds
    v_mfma_f32_16x16x32_bf16 a[216:219], v[52:55], v[116:119], a[216:219]
    s_add_u32 m0, s74, 31744
    v_mfma_f32_16x16x32_bf16 a[220:223], v[52:55], v[120:123], a[220:223]
    s_add_u32 s62, s68, 229376
    v_mfma_f32_16x16x32_bf16 a[224:227], v[56:59], v[92:95], a[224:227]
    buffer_load_dwordx4 v3, s[20:23], s62 offen lds
    v_mfma_f32_16x16x32_bf16 a[228:231], v[56:59], v[96:99], a[228:231]
    s_add_u32 s68, s68, 262144
    v_mfma_f32_16x16x32_bf16 a[232:235], v[56:59], v[100:103], a[232:235]
    v_mfma_f32_16x16x32_bf16 a[236:239], v[56:59], v[104:107], a[236:239]
    v_mfma_f32_16x16x32_bf16 a[240:243], v[56:59], v[108:111], a[240:243]
    v_mfma_f32_16x16x32_bf16 a[244:247], v[56:59], v[112:115], a[244:247]
    v_mfma_f32_16x16x32_bf16 a[248:251], v[56:59], v[116:119], a[248:251]
    v_mfma_f32_16x16x32_bf16 a[252:255], v[56:59], v[120:123], a[252:255]
    s_waitcnt vmcnt(16) lgkmcnt(0)
    v_mfma_f32_16x16x32_bf16 a[0:3], v[60:63], v[124:127], a[0:3]
    ds_read_b64_tr_b16 v[28:29], v4 offset:16384
    v_mfma_f32_16x16x32_bf16 a[4:7], v[60:63], v[128:131], a[4:7]
    ds_read_b64_tr_b16 v[30:31], v4 offset:20480
    v_mfma_f32_16x16x32_bf16 a[8:11], v[60:63], v[132:135], a[8:11]
    ds_read_b64_tr_b16 v[32:33], v5 offset:16384
    v_mfma_f32_16x16x32_bf16 a[12:15], v[60:63], v[136:139], a[12:15]
    ds_read_b64_tr_b16 v[34:35], v5 offset:20480
    v_mfma_f32_16x16x32_bf16 a[16:19], v[60:63], v[140:143], a[16:19]
    ds_read_b64_tr_b16 v[36:37], v6 offset:16384
    v_mfma_f32_16x16x32_bf16 a[20:23], v[60:63], v[144:147], a[20:23]
    ds_read_b64_tr_b16 v[38:39], v6 offset:20480
    v_mfma_f32_16x16x32_bf16 a[24:27], v[60:63], v[148:151], a[24:27]
    ds_read_b64_tr_b16 v[40:41], v7 offset:16384
    v_mfma_f32_16x16x32_bf16 a[28:31], v[60:63], v[152:155], a[28:31]
    ds_read_b64_tr_b16 v[42:43], v7 offset:20480
    v_mfma_f32_16x16x32_bf16 a[32:35], v[64:67], v[124:127], a[32:35]
    ds_read_b64_tr_b16 v[44:45], v8 offset:16384
    v_mfma_f32_16x16x32_bf16 a[36:39], v[64:67], v[128:131], a[36:39]
    ds_read_b64_tr_b16 v[46:47], v8 offset:20480
    v_mfma_f32_16x16x32_bf16 a[40:43], v[64:67], v[132:135], a[40:43]
    ds_read_b64_tr_b16 v[48:49], v9 offset:16384
    v_mfma_f32_16x16x32_bf16 a[44:47], v[64:67], v[136:139], a[44:47]
    ds_read_b64_tr_b16 v[50:51], v9 offset:20480
    v_mfma_f32_16x16x32_bf16 a[48:51], v[64:67], v[140:143], a[48:51]
    ds_read_b64_tr_b16 v[52:53], v10 offset:16384
    v_mfma_f32_16x16x32_bf16 a[52:55], v[64:67], v[144:147], a[52:55]
    ds_read_b64_tr_b16 v[54:55], v10 offset:20480
    v_mfma_f32_16x16x32_bf16 a[56:59], v[64:67], v[148:151], a[56:59]
    ds_read_b64_tr_b16 v[56:57], v11 offset:16384
    v_mfma_f32_16x16x32_bf16 a[60:63], v[64:67], v[152:155], a[60:63]
    ds_read_b64_tr_b16 v[58:59], v11 offset:20480
    v_mfma_f32_16x16x32_bf16 a[64:67], v[68:71], v[124:127], a[64:67]
    s_mov_b32 s63, s69
    v_mfma_f32_16x16x32_bf16 a[68:71], v[68:71], v[128:131], a[68:71]
    buffer_load_dwordx4 v[188:191], v1, s[56:59], s63 offen sc1
    v_mfma_f32_16x16x32_bf16 a[72:75], v[68:71], v[132:135], a[72:75]
    s_add_u32 s63, s63, s79
    v_mfma_f32_16x16x32_bf16 a[76:79], v[68:71], v[136:139], a[76:79]
    buffer_load_dwordx4 v[192:195], v1, s[56:59], s63 offen sc1
    v_mfma_f32_16x16x32_bf16 a[80:83], v[68:71], v[140:143], a[80:83]
    s_add_u32 s63, s63, s79
    v_mfma_f32_16x16x32_bf16 a[84:87], v[68:71], v[144:147], a[84:87]
    buffer_load_dwordx4 v[196:199], v1, s[56:59], s63 offen sc1
    v_mfma_f32_16x16x32_bf16 a[88:91], v[68:71], v[148:151], a[88:91]
    s_add_u32 s63, s63, s79
    v_mfma_f32_16x16x32_bf16 a[92:95], v[68:71], v[152:155], a[92:95]
    buffer_load_dwordx4 v[200:203], v1, s[56:59], s63 offen sc1
    v_mfma_f32_16x16x32_bf16 a[96:99], v[72:75], v[124:127], a[96:99]
    s_add_u32 s63, s63, s79
    v_mfma_f32_16x16x32_bf16 a[100:103], v[72:75], v[128:131], a[100:103]
    buffer_load_dwordx4 v[204:207], v1, s[56:59], s63 offen sc1
    v_mfma_f32_16x16x32_bf16 a[104:107], v[72:75], v[132:135], a[104:107]
    s_add_u32 s63, s63, s79
    v_mfma_f32_16x16x32_bf16 a[108:111], v[72:75], v[136:139], a[108:111]
    buffer_load_dwordx4 v[208:211], v1, s[56:59], s63 offen sc1
    v_mfma_f32_16x16x32_bf16 a[112:115], v[72:75], v[140:143], a[112:115]
    s_add_u32 s63, s63, s79
    v_mfma_f32_16x16x32_bf16 a[116:119], v[72:75], v[144:147], a[116:119]
    buffer_load_dwordx4 v[212:215], v1, s[56:59], s63 offen sc1
    v_mfma_f32_16x16x32_bf16 a[120:123], v[72:75], v[148:151], a[120:123]
    s_add_u32 s63, s63, s79
    v_mfma_f32_16x16x32_bf16 a[124:127], v[72:75], v[152:155], a[124:127]
    buffer_load_dwordx4 v[216:219], v1, s[56:59], s63 offen sc1
    v_mfma_f32_16x16x32_bf16 a[128:131], v[76:79], v[124:127], a[128:131]
    s_add_u32 s69, s69, 1024
    v_mfma_f32_16x16x32_bf16 a[132:135], v[76:79], v[128:131], a[132:135]
    s_add_u32 m0, s74, 0
    v_mfma_f32_16x16x32_bf16 a[136:139], v[76:79], v[132:135], a[136:139]
    s_add_u32 s62, s68, 0
    v_mfma_f32_16x16x32_bf16 a[140:143], v[76:79], v[136:139], a[140:143]
    buffer_load_dwordx4 v2, s[20:23], s62 offen lds
    v_mfma_f32_16x16x32_bf16 a[144:147], v[76:79], v[140:143], a[144:147]
    s_add_u32 m0, s74, 1024
    v_mfma_f32_16x16x32_bf16 a[148:151], v[76:79], v[144:147], a[148:151]
    s_add_u32 s62, s68, 32768
    v_mfma_f32_16x16x32_bf16 a[152:155], v[76:79], v[148:151], a[152:155]
    buffer_load_dwordx4 v3, s[20:23], s62 offen lds
    v_mfma_f32_16x16x32_bf16 a[156:159], v[76:79], v[152:155], a[156:159]
    s_add_u32 m0, s74, 2048
    v_mfma_f32_16x16x32_bf16 a[160:163], v[80:83], v[124:127], a[160:163]
    s_add_u32 s62, s68, 65536
    v_mfma_f32_16x16x32_bf16 a[164:167], v[80:83], v[128:131], a[164:167]
    buffer_load_dwordx4 v2, s[20:23], s62 offen lds
    v_mfma_f32_16x16x32_bf16 a[168:171], v[80:83], v[132:135], a[168:171]
    s_add_u32 m0, s74, 3072
    v_mfma_f32_16x16x32_bf16 a[172:175], v[80:83], v[136:139], a[172:175]
    s_add_u32 s62, s68, 98304
    v_mfma_f32_16x16x32_bf16 a[176:179], v[80:83], v[140:143], a[176:179]
    buffer_load_dwordx4 v3, s[20:23], s62 offen lds
    v_mfma_f32_16x16x32_bf16 a[180:183], v[80:83], v[144:147], a[180:183]
    s_add_u32 m0, s74, 4096
    v_mfma_f32_16x16x32_bf16 a[184:187], v[80:83], v[148:151], a[184:187]
    s_add_u32 s62, s68, 131072
    v_mfma_f32_16x16x32_bf16 a[188:191], v[80:83], v[152:155], a[188:191]
    buffer_load_dwordx4 v2, s[20:23], s62 offen lds
    v_mfma_f32_16x16x32_bf16 a[192:195], v[84:87], v[124:127], a[192:195]
    s_add_u32 m0, s74, 5120
    v_mfma_f32_16x16x32_bf16 a[196:199], v[84:87], v[128:131], a[196:199]
    s_add_u32 s62, s68, 163840
    v_mfma_f32_16x16x32_bf16 a[200:203], v[84:87], v[132:135], a[200:203]
    buffer_load_dwordx4 v3, s[20:23], s62 offen lds
    v_mfma_f32_16x16x32_bf16 a[204:207], v[84:87], v[136:139], a[204:207]
    s_add_u32 m0, s74, 6144
    v_mfma_f32_16x16x32_bf16 a[208:211], v[84:87], v[140:143], a[208:211]
    s_add_u32 s62, s68, 196608
    v_mfma_f32_16x16x32_bf16 a[212:215], v[84:87], v[144:147], a[212:215]
    buffer_load_dwordx4 v2, s[20:23], s62 offen lds
    v_mfma_f32_16x16x32_bf16 a[216:219], v[84:87], v[148:151], a[216:219]
    s_add_u32 m0, s74, 7168
    v_mfma_f32_16x16x32_bf16 a[220:223], v[84:87], v[152:155], a[220:223]
    s_add_u32 s62, s68, 229376
    v_mfma_f32_16x16x32_bf16 a[224:227], v[88:91], v[124:127], a[224:227]
    buffer_load_dwordx4 v3, s[20:23], s62 offen lds
    v_mfma_f32_16x16x32_bf16 a[228:231], v[88:91], v[128:131], a[228:231]
    s_add_u32 s68, s68, 262144
    v_mfma_f32_16x16x32_bf16 a[232:235], v[88:91], v[132:135], a[232:235]
    v_mfma_f32_16x16x32_bf16 a[236:239], v[88:91], v[136:139], a[236:239]
    v_mfma_f32_16x16x32_bf16 a[240:243], v[88:91], v[140:143], a[240:243]
    v_mfma_f32_16x16x32_bf16 a[244:247], v[88:91], v[144:147], a[244:247]
    v_mfma_f32_16x16x32_bf16 a[248:251], v[88:91], v[148:151], a[248:251]
    v_mfma_f32_16x16x32_bf16 a[252:255], v[88:91], v[152:155], a[252:255]
    s_waitcnt vmcnt(16) lgkmcnt(0)
    v_mfma_f32_16x16x32_bf16 a[0:3], v[28:31], v[156:159], a[0:3]
    ds_read_b64_tr_b16 v[60:61], v4 offset:24576
    v_mfma_f32_16x16x32_bf16 a[4:7], v[28:31], v[160:163], a[4:7]
    ds_read_b64_tr_b16 v[62:63], v4 offset:28672
    v_mfma_f32_16x16x32_bf16 a[8:11], v[28:31], v[164:167], a[8:11]
    ds_read_b64_tr_b16 v[64:65], v5 offset:24576
    v_mfma_f32_16x16x32_bf16 a[12:15], v[28:31], v[168:171], a[12:15]
    ds_read_b64_tr_b16 v[66:67], v5 offset:28672
    v_mfma_f32_16x16x32_bf16 a[16:19], v[28:31], v[172:175], a[16:19]
    ds_read_b64_tr_b16 v[68:69], v6 offset:24576
    v_mfma_f32_16x16x32_bf16 a[20:23], v[28:31], v[176:179], a[20:23]
    ds_read_b64_tr_b16 v[70:71], v6 offset:28672
    v_mfma_f32_16x16x32_bf16 a[24:27], v[28:31], v[180:183], a[24:27]
    ds_read_b64_tr_b16 v[72:73], v7 offset:24576
    v_mfma_f32_16x16x32_bf16 a[28:31], v[28:31], v[184:187], a[28:31]
    ds_read_b64_tr_b16 v[74:75], v7 offset:28672
    v_mfma_f32_16x16x32_bf16 a[32:35], v[32:35], v[156:159], a[32:35]
    ds_read_b64_tr_b16 v[76:77], v8 offset:24576
    v_mfma_f32_16x16x32_bf16 a[36:39], v[32:35], v[160:163], a[36:39]
    ds_read_b64_tr_b16 v[78:79], v8 offset:28672
    v_mfma_f32_16x16x32_bf16 a[40:43], v[32:35], v[164:167], a[40:43]
    ds_read_b64_tr_b16 v[80:81], v9 offset:24576
    v_mfma_f32_16x16x32_bf16 a[44:47], v[32:35], v[168:171], a[44:47]
    ds_read_b64_tr_b16 v[82:83], v9 offset:28672
    v_mfma_f32_16x16x32_bf16 a[48:51], v[32:35], v[172:175], a[48:51]
    ds_read_b64_tr_b16 v[84:85], v10 offset:24576
    v_mfma_f32_16x16x32_bf16 a[52:55], v[32:35], v[176:179], a[52:55]
    ds_read_b64_tr_b16 v[86:87], v10 offset:28672
    v_mfma_f32_16x16x32_bf16 a[56:59], v[32:35], v[180:183], a[56:59]
    ds_read_b64_tr_b16 v[88:89], v11 offset:24576
    v_mfma_f32_16x16x32_bf16 a[60:63], v[32:35], v[184:187], a[60:63]
    ds_read_b64_tr_b16 v[90:91], v11 offset:28672
    v_mfma_f32_16x16x32_bf16 a[64:67], v[36:39], v[156:159], a[64:67]
    s_mov_b32 s63, s69
    v_mfma_f32_16x16x32_bf16 a[68:71], v[36:39], v[160:163], a[68:71]
    buffer_load_dwordx4 v[92:95], v1, s[56:59], s63 offen sc1
    v_mfma_f32_16x16x32_bf16 a[72:75], v[36:39], v[164:167], a[72:75]
    s_add_u32 s63, s63, s79
    v_mfma_f32_16x16x32_bf16 a[76:79], v[36:39], v[168:171], a[76:79]
    buffer_load_dwordx4 v[96:99], v1, s[56:59], s63 offen sc1
    v_mfma_f32_16x16x32_bf16 a[80:83], v[36:39], v[172:175], a[80:83]
    s_add_u32 s63, s63, s79
    v_mfma_f32_16x16x32_bf16 a[84:87], v[36:39], v[176:179], a[84:87]
    buffer_load_dwordx4 v[100:103], v1, s[56:59], s63 offen sc1
    v_mfma_f32_16x16x32_bf16 a[88:91], v[36:39], v[180:183], a[88:91]
    s_add_u32 s63, s63, s79
    v_mfma_f32_16x16x32_bf16 a[92:95], v[36:39], v[184:187], a[92:95]
    buffer_load_dwordx4 v[104:107], v1, s[56:59], s63 offen sc1
    v_mfma_f32_16x16x32_bf16 a[96:99], v[40:43], v[156:159], a[96:99]
    s_add_u32 s63, s63, s79
    v_mfma_f32_16x16x32_bf16 a[100:103], v[40:43], v[160:163], a[100:103]
    buffer_load_dwordx4 v[108:111], v1, s[56:59], s63 offen sc1
    v_mfma_f32_16x16x32_bf16 a[104:107], v[40:43], v[164:167], a[104:107]
    s_add_u32 s63, s63, s79
    v_mfma_f32_16x16x32_bf16 a[108:111], v[40:43], v[168:171], a[108:111]
    buffer_load_dwordx4 v[112:115], v1, s[56:59], s63 offen sc1
    v_mfma_f32_16x16x32_bf16 a[112:115], v[40:43], v[172:175], a[112:115]
    s_add_u32 s63, s63, s79
    v_mfma_f32_16x16x32_bf16 a[116:119], v[40:43], v[176:179], a[116:119]
    buffer_load_dwordx4 v[116:119], v1, s[56:59], s63 offen sc1
    v_mfma_f32_16x16x32_bf16 a[120:123], v[40:43], v[180:183], a[120:123]
    s_add_u32 s63, s63, s79
    v_mfma_f32_16x16x32_bf16 a[124:127], v[40:43], v[184:187], a[124:127]
    buffer_load_dwordx4 v[120:123], v1, s[56:59], s63 offen sc1
    v_mfma_f32_16x16x32_bf16 a[128:131], v[44:47], v[156:159], a[128:131]
    s_add_u32 s69, s69, 1024
    v_mfma_f32_16x16x32_bf16 a[132:135], v[44:47], v[160:163], a[132:135]
    s_add_u32 m0, s74, 8192
    v_mfma_f32_16x16x32_bf16 a[136:139], v[44:47], v[164:167], a[136:139]
    s_add_u32 s62, s68, 0
    v_mfma_f32_16x16x32_bf16 a[140:143], v[44:47], v[168:171], a[140:143]
    buffer_load_dwordx4 v2, s[20:23], s62 offen lds
    v_mfma_f32_16x16x32_bf16 a[144:147], v[44:47], v[172:175], a[144:147]
    s_add_u32 m0, s74, 9216
    v_mfma_f32_16x16x32_bf16 a[148:151], v[44:47], v[176:179], a[148:151]
    s_add_u32 s62, s68, 32768
    v_mfma_f32_16x16x32_bf16 a[152:155], v[44:47], v[180:183], a[152:155]
    buffer_load_dwordx4 v3, s[20:23], s62 offen lds
    v_mfma_f32_16x16x32_bf16 a[156:159], v[44:47], v[184:187], a[156:159]
    s_add_u32 m0, s74, 10240
    v_mfma_f32_16x16x32_bf16 a[160:163], v[48:51], v[156:159], a[160:163]
    s_add_u32 s62, s68, 65536
    v_mfma_f32_16x16x32_bf16 a[164:167], v[48:51], v[160:163], a[164:167]
    buffer_load_dwordx4 v2, s[20:23], s62 offen lds
    v_mfma_f32_16x16x32_bf16 a[168:171], v[48:51], v[164:167], a[168:171]
    s_add_u32 m0, s74, 11264
    v_mfma_f32_16x16x32_bf16 a[172:175], v[48:51], v[168:171], a[172:175]
    s_add_u32 s62, s68, 98304
    v_mfma_f32_16x16x32_bf16 a[176:179], v[48:51], v[172:175], a[176:179]
    buffer_load_dwordx4 v3, s[20:23], s62 offen lds
    v_mfma_f32_16x16x32_bf16 a[180:183], v[48:51], v[176:179], a[180:183]
    s_add_u32 m0, s74, 12288
    v_mfma_f32_16x16x32_bf16 a[184:187], v[48:51], v[180:183], a[184:187]
    s_add_u32 s62, s68, 131072
    v_mfma_f32_16x16x32_bf16 a[188:191], v[48:51], v[184:187], a[188:191]
    buffer_load_dwordx4 v2, s[20:23], s62 offen lds
    v_mfma_f32_16x16x32_bf16 a[192:195], v[52:55], v[156:159], a[192:195]
    s_add_u32 m0, s74, 13312
    v_mfma_f32_16x16x32_bf16 a[196:199], v[52:55], v[160:163], a[196:199]
    s_add_u32 s62, s68, 163840
    v_mfma_f32_16x16x32_bf16 a[200:203], v[52:55], v[164:167], a[200:203]
    buffer_load_dwordx4 v3, s[20:23], s62 offen lds
    v_mfma_f32_16x16x32_bf16 a[204:207], v[52:55], v[168:171], a[204:207]
    s_add_u32 m0, s74, 14336
    v_mfma_f32_16x16x32_bf16 a[208:211], v[52:55], v[172:175], a[208:211]
    s_add_u32 s62, s68, 196608
    v_mfma_f32_16x16x32_bf16 a[212:215], v[52:55], v[176:179], a[212:215]
    buffer_load_dwordx4 v2, s[20:23], s62 offen lds
    v_mfma_f32_16x16x32_bf16 a[216:219], v[52:55], v[180:183], a[216:219]
    s_add_u32 m0, s74, 15360
    v_mfma_f32_16x16x32_bf16 a[220:223], v[52:55], v[184:187], a[220:223]
    s_add_u32 s62, s68, 229376
    v_mfma_f32_16x16x32_bf16 a[224:227], v[56:59], v[156:159], a[224:227]
    buffer_load_dwordx4 v3, s[20:23], s62 offen lds
    v_mfma_f32_16x16x32_bf16 a[228:231], v[56:59], v[160:163], a[228:231]
    s_add_u32 s68, s68, 262144
    v_mfma_f32_16x16x32_bf16 a[232:235], v[56:59], v[164:167], a[232:235]
    v_mfma_f32_16x16x32_bf16 a[236:239], v[56:59], v[168:171], a[236:239]
    v_mfma_f32_16x16x32_bf16 a[240:243], v[56:59], v[172:175], a[240:243]
    v_mfma_f32_16x16x32_bf16 a[244:247], v[56:59], v[176:179], a[244:247]
    v_mfma_f32_16x16x32_bf16 a[248:251], v[56:59], v[180:183], a[248:251]
    v_mfma_f32_16x16x32_bf16 a[252:255], v[56:59], v[184:187], a[252:255]
    s_waitcnt vmcnt(16) lgkmcnt(0)
    v_mfma_f32_16x16x32_bf16 a[0:3], v[60:63], v[188:191], a[0:3]
    ds_read_b64_tr_b16 v[28:29], v4
    v_mfma_f32_16x16x32_bf16 a[4:7], v[60:63], v[192:195], a[4:7]
    ds_read_b64_tr_b16 v[30:31], v4 offset:4096
    v_mfma_f32_16x16x32_bf16 a[8:11], v[60:63], v[196:199], a[8:11]
    ds_read_b64_tr_b16 v[32:33], v5
    v_mfma_f32_16x16x32_bf16 a[12:15], v[60:63], v[200:203], a[12:15]
    ds_read_b64_tr_b16 v[34:35], v5 offset:4096
    v_mfma_f32_16x16x32_bf16 a[16:19], v[60:63], v[204:207], a[16:19]
    ds_read_b64_tr_b16 v[36:37], v6
    v_mfma_f32_16x16x32_bf16 a[20:23], v[60:63], v[208:211], a[20:23]
    ds_read_b64_tr_b16 v[38:39], v6 offset:4096
    v_mfma_f32_16x16x32_bf16 a[24:27], v[60:63], v[212:215], a[24:27]
    ds_read_b64_tr_b16 v[40:41], v7
    v_mfma_f32_16x16x32_bf16 a[28:31], v[60:63], v[216:219], a[28:31]
    ds_read_b64_tr_b16 v[42:43], v7 offset:4096
    v_mfma_f32_16x16x32_bf16 a[32:35], v[64:67], v[188:191], a[32:35]
    ds_read_b64_tr_b16 v[44:45], v8
    v_mfma_f32_16x16x32_bf16 a[36:39], v[64:67], v[192:195], a[36:39]
    ds_read_b64_tr_b16 v[46:47], v8 offset:4096
    v_mfma_f32_16x16x32_bf16 a[40:43], v[64:67], v[196:199], a[40:43]
    ds_read_b64_tr_b16 v[48:49], v9
    v_mfma_f32_16x16x32_bf16 a[44:47], v[64:67], v[200:203], a[44:47]
    ds_read_b64_tr_b16 v[50:51], v9 offset:4096
    v_mfma_f32_16x16x32_bf16 a[48:51], v[64:67], v[204:207], a[48:51]
    ds_read_b64_tr_b16 v[52:53], v10
    v_mfma_f32_16x16x32_bf16 a[52:55], v[64:67], v[208:211], a[52:55]
    ds_read_b64_tr_b16 v[54:55], v10 offset:4096
    v_mfma_f32_16x16x32_bf16 a[56:59], v[64:67], v[212:215], a[56:59]
    ds_read_b64_tr_b16 v[56:57], v11
    v_mfma_f32_16x16x32_bf16 a[60:63], v[64:67], v[216:219], a[60:63]
    ds_read_b64_tr_b16 v[58:59], v11 offset:4096
    v_mfma_f32_16x16x32_bf16 a[64:67], v[68:71], v[188:191], a[64:67]
    s_mov_b32 s63, s69
    v_mfma_f32_16x16x32_bf16 a[68:71], v[68:71], v[192:195], a[68:71]
    buffer_load_dwordx4 v[124:127], v1, s[56:59], s63 offen sc1
    v_mfma_f32_16x16x32_bf16 a[72:75], v[68:71], v[196:199], a[72:75]
    s_add_u32 s63, s63, s79
    v_mfma_f32_16x16x32_bf16 a[76:79], v[68:71], v[200:203], a[76:79]
    buffer_load_dwordx4 v[128:131], v1, s[56:59], s63 offen sc1
    v_mfma_f32_16x16x32_bf16 a[80:83], v[68:71], v[204:207], a[80:83]
    s_add_u32 s63, s63, s79
    v_mfma_f32_16x16x32_bf16 a[84:87], v[68:71], v[208:211], a[84:87]
    buffer_load_dwordx4 v[132:135], v1, s[56:59], s63 offen sc1
    v_mfma_f32_16x16x32_bf16 a[88:91], v[68:71], v[212:215], a[88:91]
    s_add_u32 s63, s63, s79
    v_mfma_f32_16x16x32_bf16 a[92:95], v[68:71], v[216:219], a[92:95]
    buffer_load_dwordx4 v[136:139], v1, s[56:59], s63 offen sc1
    v_mfma_f32_16x16x32_bf16 a[96:99], v[72:75], v[188:191], a[96:99]
    s_add_u32 s63, s63, s79
    v_mfma_f32_16x16x32_bf16 a[100:103], v[72:75], v[192:195], a[100:103]
    buffer_load_dwordx4 v[140:143], v1, s[56:59], s63 offen sc1
    v_mfma_f32_16x16x32_bf16 a[104:107], v[72:75], v[196:199], a[104:107]
    s_add_u32 s63, s63, s79
    v_mfma_f32_16x16x32_bf16 a[108:111], v[72:75], v[200:203], a[108:111]
    buffer_load_dwordx4 v[144:147], v1, s[56:59], s63 offen sc1
    v_mfma_f32_16x16x32_bf16 a[112:115], v[72:75], v[204:207], a[112:115]
    s_add_u32 s63, s63, s79
    v_mfma_f32_16x16x32_bf16 a[116:119], v[72:75], v[208:211], a[116:119]
    buffer_load_dwordx4 v[148:151], v1, s[56:59], s63 offen sc1
    v_mfma_f32_16x16x32_bf16 a[120:123], v[72:75], v[212:215], a[120:123]
    s_add_u32 s63, s63, s79
    v_mfma_f32_16x16x32_bf16 a[124:127], v[72:75], v[216:219], a[124:127]
    buffer_load_dwordx4 v[152:155], v1, s[56:59], s63 offen sc1
    v_mfma_f32_16x16x32_bf16 a[128:131], v[76:79], v[188:191], a[128:131]
    s_add_u32 s69, s69, 1024
    v_mfma_f32_16x16x32_bf16 a[132:135], v[76:79], v[192:195], a[132:135]
    s_add_u32 m0, s74, 16384
    v_mfma_f32_16x16x32_bf16 a[136:139], v[76:79], v[196:199], a[136:139]
    s_add_u32 s62, s68, 0
    v_mfma_f32_16x16x32_bf16 a[140:143], v[76:79], v[200:203], a[140:143]
    buffer_load_dwordx4 v2, s[20:23], s62 offen lds
    v_mfma_f32_16x16x32_bf16 a[144:147], v[76:79], v[204:207], a[144:147]
    s_add_u32 m0, s74, 17408
    v_mfma_f32_16x16x32_bf16 a[148:151], v[76:79], v[208:211], a[148:151]
    s_add_u32 s62, s68, 32768
    v_mfma_f32_16x16x32_bf16 a[152:155], v[76:79], v[212:215], a[152:155]
    buffer_load_dwordx4 v3, s[20:23], s62 offen lds
    v_mfma_f32_16x16x32_bf16 a[156:159], v[76:79], v[216:219], a[156:159]
    s_add_u32 m0, s74, 18432
    v_mfma_f32_16x16x32_bf16 a[160:163], v[80:83], v[188:191], a[160:163]
    s_add_u32 s62, s68, 65536
    v_mfma_f32_16x16x32_bf16 a[164:167], v[80:83], v[192:195], a[164:167]
    buffer_load_dwordx4 v2, s[20:23], s62 offen lds
    v_mfma_f32_16x16x32_bf16 a[168:171], v[80:83], v[196:199], a[168:171]
    s_add_u32 m0, s74, 19456
    v_mfma_f32_16x16x32_bf16 a[172:175], v[80:83], v[200:203], a[172:175]
    s_add_u32 s62, s68, 98304
    v_mfma_f32_16x16x32_bf16 a[176:179], v[80:83], v[204:207], a[176:179]
    buffer_load_dwordx4 v3, s[20:23], s62 offen lds
    v_mfma_f32_16x16x32_bf16 a[180:183], v[80:83], v[208:211], a[180:183]
    s_add_u32 m0, s74, 20480
    v_mfma_f32_16x16x32_bf16 a[184:187], v[80:83], v[212:215], a[184:187]
    s_add_u32 s62, s68, 131072
    v_mfma_f32_16x16x32_bf16 a[188:191], v[80:83], v[216:219], a[188:191]
    buffer_load_dwordx4 v2, s[20:23], s62 offen lds
    v_mfma_f32_16x16x32_bf16 a[192:195], v[84:87], v[188:191], a[192:195]
    s_add_u32 m0, s74, 21504
    v_mfma_f32_16x16x32_bf16 a[196:199], v[84:87], v[192:195], a[196:199]
    s_add_u32 s62, s68, 163840
    v_mfma_f32_16x16x32_bf16 a[200:203], v[84:87], v[196:199], a[200:203]
    buffer_load_dwordx4 v3, s[20:23], s62 offen lds
    v_mfma_f32_16x16x32_bf16 a[204:207], v[84:87], v[200:203], a[204:207]
    s_add_u32 m0, s74, 22528
    v_mfma_f32_16x16x32_bf16 a[208:211], v[84:87], v[204:207], a[208:211]
    s_add_u32 s62, s68, 196608
    v_mfma_f32_16x16x32_bf16 a[212:215], v[84:87], v[208:211], a[212:215]
    buffer_load_dwordx4 v2, s[20:23], s62 offen lds
    v_mfma_f32_16x16x32_bf16 a[216:219], v[84:87], v[212:215], a[216:219]
    s_add_u32 m0, s74, 23552
    v_mfma_f32_16x16x32_bf16 a[220:223], v[84:87], v[216:219], a[220:223]
    s_add_u32 s62, s68, 229376
    v_mfma_f32_16x16x32_bf16 a[224:227], v[88:91], v[188:191], a[224:227]
    buffer_load_dwordx4 v3, s[20:23], s62 offen lds
    v_mfma_f32_16x16x32_bf16 a[228:231], v[88:91], v[192:195], a[228:231]
    s_add_u32 s68, s68, 262144
    v_mfma_f32_16x16x32_bf16 a[232:235], v[88:91], v[196:199], a[232:235]
    v_mfma_f32_16x16x32_bf16 a[236:239], v[88:91], v[200:203], a[236:239]
    v_mfma_f32_16x16x32_bf16 a[240:243], v[88:91], v[204:207], a[240:243]
    v_mfma_f32_16x16x32_bf16 a[244:247], v[88:91], v[208:211], a[244:247]
    v_mfma_f32_16x16x32_bf16 a[248:251], v[88:91], v[212:215], a[248:251]
    v_mfma_f32_16x16x32_bf16 a[252:255], v[88:91], v[216:219], a[252:255]
    s_add_u32 s70, s70, 4
    s_cmp_lt_u32 s70, s64
    s_cbranch_scc1 L_gk_loop
    s_waitcnt vmcnt(0) lgkmcnt(0)
    s_nop 7
    s_nop 7
    s_lshl_b32 s71, s72, 7
    s_add_u32 s71, s71, s77
    s_lshl_b32 s71, s71, 13
    s_add_u32 s71, s71, 4194304
    v_accvgpr_read_b32 v28, a0
    v_accvgpr_read_b32 v29, a1
    v_accvgpr_read_b32 v30, a2
    v_accvgpr_read_b32 v31, a3
    v_cvt_pk_bf16_f32 v36, v28, v29
    v_cvt_pk_bf16_f32 v37, v30, v31
    v_accvgpr_read_b32 v32, a32
    v_accvgpr_read_b32 v33, a33
    v_accvgpr_read_b32 v34, a34
    v_accvgpr_read_b32 v35, a35
    v_cvt_pk_bf16_f32 v38, v32, v33
    v_cvt_pk_bf16_f32 v39, v34, v35
    s_add_u32 s62, s71, 0
    buffer_store_dwordx4 v[36:39], v1, s[56:59], s62 offen sc1
    v_accvgpr_read_b32 v28, a64
    v_accvgpr_read_b32 v29, a65
    v_accvgpr_read_b32 v30, a66
    v_accvgpr_read_b32 v31, a67
    v_cvt_pk_bf16_f32 v40, v28, v29
    v_cvt_pk_bf16_f32 v41, v30, v31
    v_accvgpr_read_b32 v32, a96
    v_accvgpr_read_b32 v33, a97
    v_accvgpr_read_b32 v34, a98
    v_accvgpr_read_b32 v35, a99
    v_cvt_pk_bf16_f32 v42, v32, v33
    v_cvt_pk_bf16_f32 v43, v34, v35
    s_add_u32 s62, s71, 0
    buffer_store_dwordx4 v[40:43], v1, s[56:59], s62 offen offset:1024 sc1
    v_accvgpr_read_b32 v28, a128
    v_accvgpr_read_b32 v29, a129
    v_accvgpr_read_b32 v30, a130
    v_accvgpr_read_b32 v31, a131
    v_cvt_pk_bf16_f32 v36, v28, v29
    v_cvt_pk_bf16_f32 v37, v30, v31
    v_accvgpr_read_b32 v32, a160
    v_accvgpr_read_b32 v33, a161
    v_accvgpr_read_b32 v34, a162
    v_accvgpr_read_b32 v35, a163
    v_cvt_pk_bf16_f32 v38, v32, v33
    v_cvt_pk_bf16_f32 v39, v34, v35
    s_add_u32 s62, s71, 0
    buffer_store_dwordx4 v[36:39], v1, s[56:59], s62 offen offset:2048 sc1
    v_accvgpr_read_b32 v28, a192
    v_accvgpr_read_b32 v29, a193
    v_accvgpr_read_b32 v30, a194
    v_accvgpr_read_b32 v31, a195
    v_cvt_pk_bf16_f32 v40, v28, v29
    v_cvt_pk_bf16_f32 v41, v30, v31
    v_accvgpr_read_b32 v32, a224
    v_accvgpr_read_b32 v33, a225
    v_accvgpr_read_b32 v34, a226
    v_accvgpr_read_b32 v35, a227
    v_cvt_pk_bf16_f32 v42, v32, v33
    v_cvt_pk_bf16_f32 v43, v34, v35
    s_add_u32 s62, s71, 0
    buffer_store_dwordx4 v[40:43], v1, s[56:59], s62 offen offset:3072 sc1
    v_accvgpr_read_b32 v28, a4
    v_accvgpr_read_b32 v29, a5
    v_accvgpr_read_b32 v30, a6
    v_accvgpr_read_b32 v31, a7
    v_cvt_pk_bf16_f32 v36, v28, v29
    v_cvt_pk_bf16_f32 v37, v30, v31
    v_accvgpr_read_b32 v32, a36
    v_accvgpr_read_b32 v33, a37
    v_accvgpr_read_b32 v34, a38
    v_accvgpr_read_b32 v35, a39
    v_cvt_pk_bf16_f32 v38, v32, v33
    v_cvt_pk_bf16_f32 v39, v34, v35
    s_add_u32 s62, s71, 4096
    buffer_store_dwordx4 v[36:39], v1, s[56:59], s62 offen sc1
    v_accvgpr_read_b32 v28, a68
    v_accvgpr_read_b32 v29, a69
    v_accvgpr_read_b32 v30, a70
    v_accvgpr_read_b32 v31, a71
    v_cvt_pk_bf16_f32 v40, v28, v29
    v_cvt_pk_bf16_f32 v41, v30, v31
    v_accvgpr_read_b32 v32, a100
    v_accvgpr_read_b32 v33, a101
    v_accvgpr_read_b32 v34, a102
    v_accvgpr_read_b32 v35, a103
    v_cvt_pk_bf16_f32 v42, v32, v33
    v_cvt_pk_bf16_f32 v43, v34, v35
    s_add_u32 s62, s71, 4096
    buffer_store_dwordx4 v[40:43], v1, s[56:59], s62 offen offset:1024 sc1
    v_accvgpr_read_b32 v28, a132
    v_accvgpr_read_b32 v29, a133
    v_accvgpr_read_b32 v30, a134
    v_accvgpr_read_b32 v31, a135
    v_cvt_pk_bf16_f32 v36, v28, v29
    v_cvt_pk_bf16_f32 v37, v30, v31
    v_accvgpr_read_b32 v32, a164
    v_accvgpr_read_b32 v33, a165
    v_accvgpr_read_b32 v34, a166
    v_accvgpr_read_b32 v35, a167
    v_cvt_pk_bf16_f32 v38, v32, v33
    v_cvt_pk_bf16_f32 v39, v34, v35
    s_add_u32 s62, s71, 4096
    buffer_store_dwordx4 v[36:39], v1, s[56:59], s62 offen offset:2048 sc1
    v_accvgpr_read_b32 v28, a196
    v_accvgpr_read_b32 v29, a197
    v_accvgpr_read_b32 v30, a198
    v_accvgpr_read_b32 v31, a199
    v_cvt_pk_bf16_f32 v40, v28, v29
    v_cvt_pk_bf16_f32 v41, v30, v31
    v_accvgpr_read_b32 v32, a228
    v_accvgpr_read_b32 v33, a229
    v_accvgpr_read_b32 v34, a230
    v_accvgpr_read_b32 v35, a231
    v_cvt_pk_bf16_f32 v42, v32, v33
    v_cvt_pk_bf16_f32 v43, v34, v35
    s_add_u32 s62, s71, 4096
    buffer_store_dwordx4 v[40:43], v1, s[56:59], s62 offen offset:3072 sc1
    v_accvgpr_read_b32 v28, a8
    v_accvgpr_read_b32 v29, a9
    v_accvgpr_read_b32 v30, a10
    v_accvgpr_read_b32 v31, a11
    v_cvt_pk_bf16_f32 v36, v28, v29
    v_cvt_pk_bf16_f32 v37, v30, v31
    v_accvgpr_read_b32 v32, a40
    v_accvgpr_read_b32 v33, a41
    v_accvgpr_read_b32 v34, a42
    v_accvgpr_read_b32 v35, a43
    v_cvt_pk_bf16_f32 v38, v32, v33
    v_cvt_pk_bf16_f32 v39, v34, v35
    s_add_u32 s62, s71, 262144
    buffer_store_dwordx4 v[36:39], v1, s[56:59], s62 offen sc1
    v_accvgpr_read_b32 v28, a72
    v_accvgpr_read_b32 v29, a73
    v_accvgpr_read_b32 v30, a74
    v_accvgpr_read_b32 v31, a75
    v_cvt_pk_bf16_f32 v40, v28, v29
    v_cvt_pk_bf16_f32 v41, v30, v31
    v_accvgpr_read_b32 v32, a104
    v_accvgpr_read_b32 v33, a105
    v_accvgpr_read_b32 v34, a106
    v_accvgpr_read_b32 v35, a107
    v_cvt_pk_bf16_f32 v42, v32, v33
    v_cvt_pk_bf16_f32 v43, v34, v35
    s_add_u32 s62, s71, 262144
    buffer_store_dwordx4 v[40:43], v1, s[56:59], s62 offen offset:1024 sc1
    v_accvgpr_read_b32 v28, a136
    v_accvgpr_read_b32 v29, a137
    v_accvgpr_read_b32 v30, a138
    v_accvgpr_read_b32 v31, a139
    v_cvt_pk_bf16_f32 v36, v28, v29
    v_cvt_pk_bf16_f32 v37, v30, v31
    v_accvgpr_read_b32 v32, a168
    v_accvgpr_read_b32 v33, a169
    v_accvgpr_read_b32 v34, a170
    v_accvgpr_read_b32 v35, a171
    v_cvt_pk_bf16_f32 v38, v32, v33
    v_cvt_pk_bf16_f32 v39, v34, v35
    s_add_u32 s62, s71, 262144
    buffer_store_dwordx4 v[36:39], v1, s[56:59], s62 offen offset:2048 sc1
    v_accvgpr_read_b32 v28, a200
    v_accvgpr_read_b32 v29, a201
    v_accvgpr_read_b32 v30, a202
    v_accvgpr_read_b32 v31, a203
    v_cvt_pk_bf16_f32 v40, v28, v29
    v_cvt_pk_bf16_f32 v41, v30, v31
    v_accvgpr_read_b32 v32, a232
    v_accvgpr_read_b32 v33, a233
    v_accvgpr_read_b32 v34, a234
    v_accvgpr_read_b32 v35, a235
    v_cvt_pk_bf16_f32 v42, v32, v33
    v_cvt_pk_bf16_f32 v43, v34, v35
    s_add_u32 s62, s71, 262144
    buffer_store_dwordx4 v[40:43], v1, s[56:59], s62 offen offset:3072 sc1
    v_accvgpr_read_b32 v28, a12
    v_accvgpr_read_b32 v29, a13
    v_accvgpr_read_b32 v30, a14
    v_accvgpr_read_b32 v31, a15
    v_cvt_pk_bf16_f32 v36, v28, v29
    v_cvt_pk_bf16_f32 v37, v30, v31
    v_accvgpr_read_b32 v32, a44
    v_accvgpr_read_b32 v33, a45
    v_accvgpr_read_b32 v34, a46
    v_accvgpr_read_b32 v35, a47
    v_cvt_pk_bf16_f32 v38, v32, v33
    v_cvt_pk_bf16_f32 v39, v34, v35
    s_add_u32 s62, s71, 266240
    buffer_store_dwordx4 v[36:39], v1, s[56:59], s62 offen sc1
    v_accvgpr_read_b32 v28, a76
    v_accvgpr_read_b32 v29, a77
    v_accvgpr_read_b32 v30, a78
    v_accvgpr_read_b32 v31, a79
    v_cvt_pk_bf16_f32 v40, v28, v29
    v_cvt_pk_bf16_f32 v41, v30, v31
    v_accvgpr_read_b32 v32, a108
    v_accvgpr_read_b32 v33, a109
    v_accvgpr_read_b32 v34, a110
    v_accvgpr_read_b32 v35, a111
    v_cvt_pk_bf16_f32 v42, v32, v33
    v_cvt_pk_bf16_f32 v43, v34, v35
    s_add_u32 s62, s71, 266240
    buffer_store_dwordx4 v[40:43], v1, s[56:59], s62 offen offset:1024 sc1
    v_accvgpr_read_b32 v28, a140
    v_accvgpr_read_b32 v29, a141
    v_accvgpr_read_b32 v30, a142
    v_accvgpr_read_b32 v31, a143
    v_cvt_pk_bf16_f32 v36, v28, v29
    v_cvt_pk_bf16_f32 v37, v30, v31
    v_accvgpr_read_b32 v32, a172
    v_accvgpr_read_b32 v33, a173
    v_accvgpr_read_b32 v34, a174
    v_accvgpr_read_b32 v35, a175
    v_cvt_pk_bf16_f32 v38, v32, v33
    v_cvt_pk_bf16_f32 v39, v34, v35
    s_add_u32 s62, s71, 266240
    buffer_store_dwordx4 v[36:39], v1, s[56:59], s62 offen offset:2048 sc1
    v_accvgpr_read_b32 v28, a204
    v_accvgpr_read_b32 v29, a205
    v_accvgpr_read_b32 v30, a206
    v_accvgpr_read_b32 v31, a207
    v_cvt_pk_bf16_f32 v40, v28, v29
    v_cvt_pk_bf16_f32 v41, v30, v31
    v_accvgpr_read_b32 v32, a236
    v_accvgpr_read_b32 v33, a237
    v_accvgpr_read_b32 v34, a238
    v_accvgpr_read_b32 v35, a239
    v_cvt_pk_bf16_f32 v42, v32, v33
    v_cvt_pk_bf16_f32 v43, v34, v35
    s_add_u32 s62, s71, 266240
    buffer_store_dwordx4 v[40:43], v1, s[56:59], s62 offen offset:3072 sc1
    v_accvgpr_read_b32 v28, a16
    v_accvgpr_read_b32 v29, a17
    v_accvgpr_read_b32 v30, a18
    v_accvgpr_read_b32 v31, a19
    v_cvt_pk_bf16_f32 v36, v28, v29
    v_cvt_pk_bf16_f32 v37, v30, v31
    v_accvgpr_read_b32 v32, a48
    v_accvgpr_read_b32 v33, a49
    v_accvgpr_read_b32 v34, a50
    v_accvgpr_read_b32 v35, a51
    v_cvt_pk_bf16_f32 v38, v32, v33
    v_cvt_pk_bf16_f32 v39, v34, v35
    s_add_u32 s62, s71, 524288
    buffer_store_dwordx4 v[36:39], v1, s[56:59], s62 offen sc1
    v_accvgpr_read_b32 v28, a80
    v_accvgpr_read_b32 v29, a81
    v_accvgpr_read_b32 v30, a82
    v_accvgpr_read_b32 v31, a83
    v_cvt_pk_bf16_f32 v40, v28, v29
    v_cvt_pk_bf16_f32 v41, v30, v31
    v_accvgpr_read_b32 v32, a112
    v_accvgpr_read_b32 v33, a113
    v_accvgpr_read_b32 v34, a114
    v_accvgpr_read_b32 v35, a115
    v_cvt_pk_bf16_f32 v42, v32, v33
    v_cvt_pk_bf16_f32 v43, v34, v35
    s_add_u32 s62, s71, 524288
    buffer_store_dwordx4 v[40:43], v1, s[56:59], s62 offen offset:1024 sc1
    v_accvgpr_read_b32 v28, a144
    v_accvgpr_read_b32 v29, a145
    v_accvgpr_read_b32 v30, a146
    v_accvgpr_read_b32 v31, a147
    v_cvt_pk_bf16_f32 v36, v28, v29
    v_cvt_pk_bf16_f32 v37, v30, v31
    v_accvgpr_read_b32 v32, a176
    v_accvgpr_read_b32 v33, a177
    v_accvgpr_read_b32 v34, a178
    v_accvgpr_read_b32 v35, a179
    v_cvt_pk_bf16_f32 v38, v32, v33
    v_cvt_pk_bf16_f32 v39, v34, v35
    s_add_u32 s62, s71, 524288
    buffer_store_dwordx4 v[36:39], v1, s[56:59], s62 offen offset:2048 sc1
    v_accvgpr_read_b32 v28, a208
    v_accvgpr_read_b32 v29, a209
    v_accvgpr_read_b32 v30, a210
    v_accvgpr_read_b32 v31, a211
    v_cvt_pk_bf16_f32 v40, v28, v29
    v_cvt_pk_bf16_f32 v41, v30, v31
    v_accvgpr_read_b32 v32, a240
    v_accvgpr_read_b32 v33, a241
    v_accvgpr_read_b32 v34, a242
    v_accvgpr_read_b32 v35, a243
    v_cvt_pk_bf16_f32 v42, v32, v33
    v_cvt_pk_bf16_f32 v43, v34, v35
    s_add_u32 s62, s71, 524288
    buffer_store_dwordx4 v[40:43], v1, s[56:59], s62 offen offset:3072 sc1
    v_accvgpr_read_b32 v28, a20
    v_accvgpr_read_b32 v29, a21
    v_accvgpr_read_b32 v30, a22
    v_accvgpr_read_b32 v31, a23
    v_cvt_pk_bf16_f32 v36, v28, v29
    v_cvt_pk_bf16_f32 v37, v30, v31
    v_accvgpr_read_b32 v32, a52
    v_accvgpr_read_b32 v33, a53
    v_accvgpr_read_b32 v34, a54
    v_accvgpr_read_b32 v35, a55
    v_cvt_pk_bf16_f32 v38, v32, v33
    v_cvt_pk_bf16_f32 v39, v34, v35
    s_add_u32 s62, s71, 528384
    buffer_store_dwordx4 v[36:39], v1, s[56:59], s62 offen sc1
    v_accvgpr_read_b32 v28, a84
    v_accvgpr_read_b32 v29, a85
    v_accvgpr_read_b32 v30, a86
    v_accvgpr_read_b32 v31, a87
    v_cvt_pk_bf16_f32 v40, v28, v29
    v_cvt_pk_bf16_f32 v41, v30, v31
    v_accvgpr_read_b32 v32, a116
    v_accvgpr_read_b32 v33, a117
    v_accvgpr_read_b32 v34, a118
    v_accvgpr_read_b32 v35, a119
    v_cvt_pk_bf16_f32 v42, v32, v33
    v_cvt_pk_bf16_f32 v43, v34, v35
    s_add_u32 s62, s71, 528384
    buffer_store_dwordx4 v[40:43], v1, s[56:59], s62 offen offset:1024 sc1
    v_accvgpr_read_b32 v28, a148
    v_accvgpr_read_b32 v29, a149
    v_accvgpr_read_b32 v30, a150
    v_accvgpr_read_b32 v31, a151
    v_cvt_pk_bf16_f32 v36, v28, v29
    v_cvt_pk_bf16_f32 v37, v30, v31
    v_accvgpr_read_b32 v32, a180
    v_accvgpr_read_b32 v33, a181
    v_accvgpr_read_b32 v34, a182
    v_accvgpr_read_b32 v35, a183
    v_cvt_pk_bf16_f32 v38, v32, v33
    v_cvt_pk_bf16_f32 v39, v34, v35
    s_add_u32 s62, s71, 528384
    buffer_store_dwordx4 v[36:39], v1, s[56:59], s62 offen offset:2048 sc1
    v_accvgpr_read_b32 v28, a212
    v_accvgpr_read_b32 v29, a213
    v_accvgpr_read_b32 v30, a214
    v_accvgpr_read_b32 v31, a215
    v_cvt_pk_bf16_f32 v40, v28, v29
    v_cvt_pk_bf16_f32 v41, v30, v31
    v_accvgpr_read_b32 v32, a244
    v_accvgpr_read_b32 v33, a245
    v_accvgpr_read_b32 v34, a246
    v_accvgpr_read_b32 v35, a247
    v_cvt_pk_bf16_f32 v42, v32, v33
    v_cvt_pk_bf16_f32 v43, v34, v35
    s_add_u32 s62, s71, 528384
    buffer_store_dwordx4 v[40:43], v1, s[56:59], s62 offen offset:3072 sc1
    v_accvgpr_read_b32 v28, a24
    v_accvgpr_read_b32 v29, a25
    v_accvgpr_read_b32 v30, a26
    v_accvgpr_read_b32 v31, a27
    v_cvt_pk_bf16_f32 v36, v28, v29
    v_cvt_pk_bf16_f32 v37, v30, v31
    v_accvgpr_read_b32 v32, a56
    v_accvgpr_read_b32 v33, a57
    v_accvgpr_read_b32 v34, a58
    v_accvgpr_read_b32 v35, a59
    v_cvt_pk_bf16_f32 v38, v32, v33
    v_cvt_pk_bf16_f32 v39, v34, v35
    s_add_u32 s62, s71, 786432
    buffer_store_dwordx4 v[36:39], v1, s[56:59], s62 offen sc1
    v_accvgpr_read_b32 v28, a88
    v_accvgpr_read_b32 v29, a89
    v_accvgpr_read_b32 v30, a90
    v_accvgpr_read_b32 v31, a91
    v_cvt_pk_bf16_f32 v40, v28, v29
    v_cvt_pk_bf16_f32 v41, v30, v31
    v_accvgpr_read_b32 v32, a120
    v_accvgpr_read_b32 v33, a121
    v_accvgpr_read_b32 v34, a122
    v_accvgpr_read_b32 v35, a123
    v_cvt_pk_bf16_f32 v42, v32, v33
    v_cvt_pk_bf16_f32 v43, v34, v35
    s_add_u32 s62, s71, 786432
    buffer_store_dwordx4 v[40:43], v1, s[56:59], s62 offen offset:1024 sc1
    v_accvgpr_read_b32 v28, a152
    v_accvgpr_read_b32 v29, a153
    v_accvgpr_read_b32 v30, a154
    v_accvgpr_read_b32 v31, a155
    v_cvt_pk_bf16_f32 v36, v28, v29
    v_cvt_pk_bf16_f32 v37, v30, v31
    v_accvgpr_read_b32 v32, a184
    v_accvgpr_read_b32 v33, a185
    v_accvgpr_read_b32 v34, a186
    v_accvgpr_read_b32 v35, a187
    v_cvt_pk_bf16_f32 v38, v32, v33
    v_cvt_pk_bf16_f32 v39, v34, v35
    s_add_u32 s62, s71, 786432
    buffer_store_dwordx4 v[36:39], v1, s[56:59], s62 offen offset:2048 sc1
    v_accvgpr_read_b32 v28, a216
    v_accvgpr_read_b32 v29, a217
    v_accvgpr_read_b32 v30, a218
    v_accvgpr_read_b32 v31, a219
    v_cvt_pk_bf16_f32 v40, v28, v29
    v_cvt_pk_bf16_f32 v41, v30, v31
    v_accvgpr_read_b32 v32, a248
    v_accvgpr_read_b32 v33, a249
    v_accvgpr_read_b32 v34, a250
    v_accvgpr_read_b32 v35, a251
    v_cvt_pk_bf16_f32 v42, v32, v33
    v_cvt_pk_bf16_f32 v43, v34, v35
    s_add_u32 s62, s71, 786432
    buffer_store_dwordx4 v[40:43], v1, s[56:59], s62 offen offset:3072 sc1
    v_accvgpr_read_b32 v28, a28
    v_accvgpr_read_b32 v29, a29
    v_accvgpr_read_b32 v30, a30
    v_accvgpr_read_b32 v31, a31
    v_cvt_pk_bf16_f32 v36, v28, v29
    v_cvt_pk_bf16_f32 v37, v30, v31
    v_accvgpr_read_b32 v32, a60
    v_accvgpr_read_b32 v33, a61
    v_accvgpr_read_b32 v34, a62
    v_accvgpr_read_b32 v35, a63
    v_cvt_pk_bf16_f32 v38, v32, v33
    v_cvt_pk_bf16_f32 v39, v34, v35
    s_add_u32 s62, s71, 790528
    buffer_store_dwordx4 v[36:39], v1, s[56:59], s62 offen sc1
    v_accvgpr_read_b32 v28, a92
    v_accvgpr_read_b32 v29, a93
    v_accvgpr_read_b32 v30, a94
    v_accvgpr_read_b32 v31, a95
    v_cvt_pk_bf16_f32 v40, v28, v29
    v_cvt_pk_bf16_f32 v41, v30, v31
    v_accvgpr_read_b32 v32, a124
    v_accvgpr_read_b32 v33, a125
    v_accvgpr_read_b32 v34, a126
    v_accvgpr_read_b32 v35, a127
    v_cvt_pk_bf16_f32 v42, v32, v33
    v_cvt_pk_bf16_f32 v43, v34, v35
    s_add_u32 s62, s71, 790528
    buffer_store_dwordx4 v[40:43], v1, s[56:59], s62 offen offset:1024 sc1
    v_accvgpr_read_b32 v28, a156
    v_accvgpr_read_b32 v29, a157
    v_accvgpr_read_b32 v30, a158
    v_accvgpr_read_b32 v31, a159
    v_cvt_pk_bf16_f32 v36, v28, v29
    v_cvt_pk_bf16_f32 v37, v30, v31
    v_accvgpr_read_b32 v32, a188
    v_accvgpr_read_b32 v33, a189
    v_accvgpr_read_b32 v34, a190
    v_accvgpr_read_b32 v35, a191
    v_cvt_pk_bf16_f32 v38, v32, v33
    v_cvt_pk_bf16_f32 v39, v34, v35
    s_add_u32 s62, s71, 790528
    buffer_store_dwordx4 v[36:39], v1, s[56:59], s62 offen offset:2048 sc1
    v_accvgpr_read_b32 v28, a220
    v_accvgpr_read_b32 v29, a221
    v_accvgpr_read_b32 v30, a222
    v_accvgpr_read_b32 v31, a223
    v_cvt_pk_bf16_f32 v40, v28, v29
    v_cvt_pk_bf16_f32 v41, v30, v31
    v_accvgpr_read_b32 v32, a252
    v_accvgpr_read_b32 v33, a253
    v_accvgpr_read_b32 v34, a254
    v_accvgpr_read_b32 v35, a255
    v_cvt_pk_bf16_f32 v42, v32, v33
    v_cvt_pk_bf16_f32 v43, v34, v35
    s_add_u32 s62, s71, 790528
    buffer_store_dwordx4 v[40:43], v1, s[56:59], s62 offen offset:3072 sc1
    s_lshl_b32 s65, s72, 7
    s_add_u32 s65, s65, 94372864
    s_waitcnt vmcnt(0)
    s_barrier
    s_cmp_lg_u32 s61, 0
    s_cbranch_scc1 L_sig3
    v_mov_b32 v12, 32
    v_mov_b32 v13, 0
    s_mov_b64 exec, 1
    buffer_atomic_add v12, v13, s[56:59], s65 offen sc1
    s_mov_b64 exec, -1
L_sig3:
    s_branch L_next
L_tv:
    s_mov_b32 s62, 8192
    v_mul_lo_u32 v12, v25, s62
    v_lshlrev_b32 v13, 1, v25
    v_xor_b32 v13, v13, v26
    v_lshl_add_u32 v2, v13, 4, v12
    v_lshlrev_b32 v13, 1, v25
    v_add_u32 v13, 8, v13
    v_xor_b32 v13, v13, v26
    v_lshl_add_u32 v3, v13, 4, v12
    s_lshl_b32 s65, s72, 7
    s_add_u32 s65, s65, 94372864
    s_cmp_lg_u32 s61, 0
    s_cbranch_scc1 L_wf4d
    v_mov_b32 v13, 0
L_wf4:
    buffer_load_dword v12, v13, s[56:59], s65 offen sc1
    s_waitcnt vmcnt(0)
    v_lshrrev_b32 v12, 0, v12
    v_and_b32 v12, 31, v12
    v_cmp_le_u32 vcc, 16, v12
    s_cbranch_vccnz L_wf4d
    s_sleep 2
    s_branch L_wf4
L_wf4d:
    s_barrier
    s_lshl_b32 s68, s77, 8
    s_mul_i32 s69, s72, 163840
    s_add_u32 s69, s69, 0
    s_mov_b32 s79, 20480
    s_mov_b32 s64, 20
    v_accvgpr_write_b32 a0, 0
    v_accvgpr_write_b32 a1, 0
    v_accvgpr_write_b32 a2, 0
    v_accvgpr_write_b32 a3, 0
    v_accvgpr_write_b32 a4, 0
    v_accvgpr_write_b32 a5, 0
    v_accvgpr_write_b32 a6, 0
    v_accvgpr_write_b32 a7, 0
    v_accvgpr_write_b32 a8, 0
    v_accvgpr_write_b32 a9, 0
    v_accvgpr_write_b32 a10, 0
    v_accvgpr_write_b32 a11, 0
    v_accvgpr_write_b32 a12, 0
    v_accvgpr_write_b32 a13, 0
    v_accvgpr_write_b32 a14, 0
    v_accvgpr_write_b32 a15, 0
    v_accvgpr_write_b32 a16, 0
    v_accvgpr_write_b32 a17, 0
    v_accvgpr_write_b32 a18, 0
    v_accvgpr_write_b32 a19, 0
    v_accvgpr_write_b32 a20, 0
    v_accvgpr_write_b32 a21, 0
    v_accvgpr_write_b32 a22, 0
    v_accvgpr_write_b32 a23, 0
    v_accvgpr_write_b32 a24, 0
    v_accvgpr_write_b32 a25, 0
    v_accvgpr_write_b32 a26, 0
    v_accvgpr_write_b32 a27, 0
    v_accvgpr_write_b32 a28, 0
    v_accvgpr_write_b32 a29, 0
    v_accvgpr_write_b32 a30, 0
    v_accvgpr_write_b32 a31, 0
    v_accvgpr_write_b32 a32, 0
    v_accvgpr_write_b32 a33, 0
    v_accvgpr_write_b32 a34, 0
    v_accvgpr_write_b32 a35, 0
    v_accvgpr_write_b32 a36, 0
    v_accvgpr_write_b32 a37, 0
    v_accvgpr_write_b32 a38, 0
    v_accvgpr_write_b32 a39, 0
    v_accvgpr_write_b32 a40, 0
    v_accvgpr_write_b32 a41, 0
    v_accvgpr_write_b32 a42, 0
    v_accvgpr_write_b32 a43, 0
    v_accvgpr_write_b32 a44, 0
    v_accvgpr_write_b32 a45, 0
    v_accvgpr_write_b32 a46, 0
    v_accvgpr_write_b32 a47, 0
    v_accvgpr_write_b32 a48, 0
    v_accvgpr_write_b32 a49, 0
    v_accvgpr_write_b32 a50, 0
    v_accvgpr_write_b32 a51, 0
    v_accvgpr_write_b32 a52, 0
    v_accvgpr_write_b32 a53, 0
    v_accvgpr_write_b32 a54, 0
    v_accvgpr_write_b32 a55, 0
    v_accvgpr_write_b32 a56, 0
    v_accvgpr_write_b32 a57, 0
    v_accvgpr_write_b32 a58, 0
    v_accvgpr_write_b32 a59, 0
    v_accvgpr_write_b32 a60, 0
    v_accvgpr_write_b32 a61, 0
    v_accvgpr_write_b32 a62, 0
    v_accvgpr_write_b32 a63, 0
    v_accvgpr_write_b32 a64, 0
    v_accvgpr_write_b32 a65, 0
    v_accvgpr_write_b32 a66, 0
    v_accvgpr_write_b32 a67, 0
    v_accvgpr_write_b32 a68, 0
    v_accvgpr_write_b32 a69, 0
    v_accvgpr_write_b32 a70, 0
    v_accvgpr_write_b32 a71, 0
    v_accvgpr_write_b32 a72, 0
    v_accvgpr_write_b32 a73, 0
    v_accvgpr_write_b32 a74, 0
    v_accvgpr_write_b32 a75, 0
    v_accvgpr_write_b32 a76, 0
    v_accvgpr_write_b32 a77, 0
    v_accvgpr_write_b32 a78, 0
    v_accvgpr_write_b32 a79, 0
    v_accvgpr_write_b32 a80, 0
    v_accvgpr_write_b32 a81, 0
    v_accvgpr_write_b32 a82, 0
    v_accvgpr_write_b32 a83, 0
    v_accvgpr_write_b32 a84, 0
    v_accvgpr_write_b32 a85, 0
    v_accvgpr_write_b32 a86, 0
    v_accvgpr_write_b32 a87, 0
    v_accvgpr_write_b32 a88, 0
    v_accvgpr_write_b32 a89, 0
    v_accvgpr_write_b32 a90, 0
    v_accvgpr_write_b32 a91, 0
    v_accvgpr_write_b32 a92, 0
    v_accvgpr_write_b32 a93, 0
    v_accvgpr_write_b32 a94, 0
    v_accvgpr_write_b32 a95, 0
    v_accvgpr_write_b32 a96, 0
    v_accvgpr_write_b32 a97, 0
    v_accvgpr_write_b32 a98, 0
    v_accvgpr_write_b32 a99, 0
    v_accvgpr_write_b32 a100, 0
    v_accvgpr_write_b32 a101, 0
    v_accvgpr_write_b32 a102, 0
    v_accvgpr_write_b32 a103, 0
    v_accvgpr_write_b32 a104, 0
    v_accvgpr_write_b32 a105, 0
    v_accvgpr_write_b32 a106, 0
    v_accvgpr_write_b32 a107, 0
    v_accvgpr_write_b32 a108, 0
    v_accvgpr_write_b32 a109, 0
    v_accvgpr_write_b32 a110, 0
    v_accvgpr_write_b32 a111, 0
    v_accvgpr_write_b32 a112, 0
    v_accvgpr_write_b32 a113, 0
    v_accvgpr_write_b32 a114, 0
    v_accvgpr_write_b32 a115, 0
    v_accvgpr_write_b32 a116, 0
    v_accvgpr_write_b32 a117, 0
    v_accvgpr_write_b32 a118, 0
    v_accvgpr_write_b32 a119, 0
    v_accvgpr_write_b32 a120, 0
    v_accvgpr_write_b32 a121, 0
    v_accvgpr_write_b32 a122, 0
    v_accvgpr_write_b32 a123, 0
    v_accvgpr_write_b32 a124, 0
    v_accvgpr_write_b32 a125, 0
    v_accvgpr_write_b32 a126, 0
    v_accvgpr_write_b32 a127, 0
    v_accvgpr_write_b32 a128, 0
    v_accvgpr_write_b32 a129, 0
    v_accvgpr_write_b32 a130, 0
    v_accvgpr_write_b32 a131, 0
    v_accvgpr_write_b32 a132, 0
    v_accvgpr_write_b32 a133, 0
    v_accvgpr_write_b32 a134, 0
    v_accvgpr_write_b32 a135, 0
    v_accvgpr_write_b32 a136, 0
    v_accvgpr_write_b32 a137, 0
    v_accvgpr_write_b32 a138, 0
    v_accvgpr_write_b32 a139, 0
    v_accvgpr_write_b32 a140, 0
    v_accvgpr_write_b32 a141, 0
    v_accvgpr_write_b32 a142, 0
    v_accvgpr_write_b32 a143, 0
    v_accvgpr_write_b32 a144, 0
    v_accvgpr_write_b32 a145, 0
    v_accvgpr_write_b32 a146, 0
    v_accvgpr_write_b32 a147, 0
    v_accvgpr_write_b32 a148, 0
    v_accvgpr_write_b32 a149, 0
    v_accvgpr_write_b32 a150, 0
    v_accvgpr_write_b32 a151, 0
    v_accvgpr_write_b32 a152, 0
    v_accvgpr_write_b32 a153, 0
    v_accvgpr_write_b32 a154, 0
    v_accvgpr_write_b32 a155, 0
    v_accvgpr_write_b32 a156, 0
    v_accvgpr_write_b32 a157, 0
    v_accvgpr_write_b32 a158, 0
    v_accvgpr_write_b32 a159, 0
    v_accvgpr_write_b32 a160, 0
    v_accvgpr_write_b32 a161, 0
    v_accvgpr_write_b32 a162, 0
    v_accvgpr_write_b32 a163, 0
    v_accvgpr_write_b32 a164, 0
    v_accvgpr_write_b32 a165, 0
    v_accvgpr_write_b32 a166, 0
    v_accvgpr_write_b32 a167, 0
    v_accvgpr_write_b32 a168, 0
    v_accvgpr_write_b32 a169, 0
    v_accvgpr_write_b32 a170, 0
    v_accvgpr_write_b32 a171, 0
    v_accvgpr_write_b32 a172, 0
    v_accvgpr_write_b32 a173, 0
    v_accvgpr_write_b32 a174, 0
    v_accvgpr_write_b32 a175, 0
    v_accvgpr_write_b32 a176, 0
    v_accvgpr_write_b32 a177, 0
    v_accvgpr_write_b32 a178, 0
    v_accvgpr_write_b32 a179, 0
    v_accvgpr_write_b32 a180, 0
    v_accvgpr_write_b32 a181, 0
    v_accvgpr_write_b32 a182, 0
    v_accvgpr_write_b32 a183, 0
    v_accvgpr_write_b32 a184, 0
    v_accvgpr_write_b32 a185, 0
    v_accvgpr_write_b32 a186, 0
    v_accvgpr_write_b32 a187, 0
    v_accvgpr_write_b32 a188, 0
    v_accvgpr_write_b32 a189, 0
    v_accvgpr_write_b32 a190, 0
    v_accvgpr_write_b32 a191, 0
    v_accvgpr_write_b32 a192, 0
    v_accvgpr_write_b32 a193, 0
    v_accvgpr_write_b32 a194, 0
    v_accvgpr_write_b32 a195, 0
    v_accvgpr_write_b32 a196, 0
    v_accvgpr_write_b32 a197, 0
    v_accvgpr_write_b32 a198, 0
    v_accvgpr_write_b32 a199, 0
    v_accvgpr_write_b32 a200, 0
    v_accvgpr_write_b32 a201, 0
    v_accvgpr_write_b32 a202, 0
    v_accvgpr_write_b32 a203, 0
    v_accvgpr_write_b32 a204, 0
    v_accvgpr_write_b32 a205, 0
    v_accvgpr_write_b32 a206, 0
    v_accvgpr_write_b32 a207, 0
    v_accvgpr_write_b32 a208, 0
    v_accvgpr_write_b32 a209, 0
    v_accvgpr_write_b32 a210, 0
    v_accvgpr_write_b32 a211, 0
    v_accvgpr_write_b32 a212, 0
    v_accvgpr_write_b32 a213, 0
    v_accvgpr_write_b32 a214, 0
    v_accvgpr_write_b32 a215, 0
    v_accvgpr_write_b32 a216, 0
    v_accvgpr_write_b32 a217, 0
    v_accvgpr_write_b32 a218, 0
    v_accvgpr_write_b32 a219, 0
    v_accvgpr_write_b32 a220, 0
    v_accvgpr_write_b32 a221, 0
    v_accvgpr_write_b32 a222, 0
    v_accvgpr_write_b32 a223, 0
    v_accvgpr_write_b32 a224, 0
    v_accvgpr_write_b32 a225, 0
    v_accvgpr_write_b32 a226, 0
    v_accvgpr_write_b32 a227, 0
    v_accvgpr_write_b32 a228, 0
    v_accvgpr_write_b32 a229, 0
    v_accvgpr_write_b32 a230, 0
    v_accvgpr_write_b32 a231, 0
    v_accvgpr_write_b32 a232, 0
    v_accvgpr_write_b32 a233, 0
    v_accvgpr_write_b32 a234, 0
    v_accvgpr_write_b32 a235, 0
    v_accvgpr_write_b32 a236, 0
    v_accvgpr_write_b32 a237, 0
    v_accvgpr_write_b32 a238, 0
    v_accvgpr_write_b32 a239, 0
    v_accvgpr_write_b32 a240, 0
    v_accvgpr_write_b32 a241, 0
    v_accvgpr_write_b32 a242, 0
    v_accvgpr_write_b32 a243, 0
    v_accvgpr_write_b32 a244, 0
    v_accvgpr_write_b32 a245, 0
    v_accvgpr_write_b32 a246, 0
    v_accvgpr_write_b32 a247, 0
    v_accvgpr_write_b32 a248, 0
    v_accvgpr_write_b32 a249, 0
    v_accvgpr_write_b32 a250, 0
    v_accvgpr_write_b32 a251, 0
    v_accvgpr_write_b32 a252, 0
    v_accvgpr_write_b32 a253, 0
    v_accvgpr_write_b32 a254, 0
    v_accvgpr_write_b32 a255, 0
    s_add_u32 m0, s74, 0
    s_add_u32 s62, s68, 0
    buffer_load_dwordx4 v2, s[24:27], s62 offen lds
    s_add_u32 m0, s74, 1024
    s_add_u32 s62, s68, 32768
    buffer_load_dwordx4 v3, s[24:27], s62 offen lds
    s_add_u32 m0, s74, 2048
    s_add_u32 s62, s68, 65536
    buffer_load_dwordx4 v2, s[24:27], s62 offen lds
    s_add_u32 m0, s74, 3072
    s_add_u32 s62, s68, 98304
    buffer_load_dwordx4 v3, s[24:27], s62 offen lds
    s_add_u32 m0, s74, 4096
    s_add_u32 s62, s68, 131072
    buffer_load_dwordx4 v2, s[24:27], s62 offen lds
    s_add_u32 m0, s74, 5120
    s_add_u32 s62, s68, 163840
    buffer_load_dwordx4 v3, s[24:27], s62 offen lds
    s_add_u32 m0, s74, 6144
    s_add_u32 s62, s68, 196608
    buffer_load_dwordx4 v2, s[24:27], s62 offen lds
    s_add_u32 m0, s74, 7168
    s_add_u32 s62, s68, 229376
    buffer_load_dwordx4 v3, s[24:27], s62 offen lds
    s_add_u32 s68, s68, 262144
    s_mov_b32 s63, s69
    buffer_load_dwordx4 v[92:95], v1, s[56:59], s63 offen sc1
    s_add_u32 s63, s63, s79
    buffer_load_dwordx4 v[96:99], v1, s[56:59], s63 offen sc1
    s_add_u32 s63, s63, s79
    buffer_load_dwordx4 v[100:103], v1, s[56:59], s63 offen sc1
    s_add_u32 s63, s63, s79
    buffer_load_dwordx4 v[104:107], v1, s[56:59], s63 offen sc1
    s_add_u32 s63, s63, s79
    buffer_load_dwordx4 v[108:111], v1, s[56:59], s63 offen sc1
    s_add_u32 s63, s63, s79
    buffer_load_dwordx4 v[112:115], v1, s[56:59], s63 offen sc1
    s_add_u32 s63, s63, s79
    buffer_load_dwordx4 v[116:119], v1, s[56:59], s63 offen sc1
    s_add_u32 s63, s63, s79
    buffer_load_dwordx4 v[120:123], v1, s[56:59], s63 offen sc1
    s_add_u32 s69, s69, 1024
    s_add_u32 m0, s74, 8192
    s_add_u32 s62, s68, 0
    buffer_load_dwordx4 v2, s[24:27], s62 offen lds
    s_add_u32 m0, s74, 9216
    s_add_u32 s62, s68, 32768
    buffer_load_dwordx4 v3, s[24:27], s62 offen lds
    s_add_u32 m0, s74, 10240
    s_add_u32 s62, s68, 65536
    buffer_load_dwordx4 v2, s[24:27], s62 offen lds
    s_add_u32 m0, s74, 11264
    s_add_u32 s62, s68, 98304
    buffer_load_dwordx4 v3, s[24:27], s62 offen lds
    s_add_u32 m0, s74, 12288
    s_add_u32 s62, s68, 131072
    buffer_load_dwordx4 v2, s[24:27], s62 offen lds
    s_add_u32 m0, s74, 13312
    s_add_u32 s62, s68, 163840
    buffer_load_dwordx4 v3, s[24:27], s62 offen lds
    s_add_u32 m0, s74, 14336
    s_add_u32 s62, s68, 196608
    buffer_load_dwordx4 v2, s[24:27], s62 offen lds
    s_add_u32 m0, s74, 15360
    s_add_u32 s62, s68, 229376
    buffer_load_dwordx4 v3, s[24:27], s62 offen lds
    s_add_u32 s68, s68, 262144
    s_mov_b32 s63, s69
    buffer_load_dwordx4 v[124:127], v1, s[56:59], s63 offen sc1
    s_add_u32 s63, s63, s79
    buffer_load_dwordx4 v[128:131], v1, s[56:59], s63 offen sc1
    s_add_u32 s63, s63, s79
    buffer_load_dwordx4 v[132:135], v1, s[56:59], s63 offen sc1
    s_add_u32 s63, s63, s79
    buffer_load_dwordx4 v[136:139], v1, s[56:59], s63 offen sc1
    s_add_u32 s63, s63, s79
    buffer_load_dwordx4 v[140:143], v1, s[56:59], s63 offen sc1
    s_add_u32 s63, s63, s79
    buffer_load_dwordx4 v[144:147], v1, s[56:59], s63 offen sc1
    s_add_u32 s63, s63, s79
    buffer_load_dwordx4 v[148:151], v1, s[56:59], s63 offen sc1
    s_add_u32 s63, s63, s79
    buffer_load_dwordx4 v[152:155], v1, s[56:59], s63 offen sc1
    s_add_u32 s69, s69, 1024
    s_add_u32 m0, s74, 16384
    s_add_u32 s62, s68, 0
    buffer_load_dwordx4 v2, s[24:27], s62 offen lds
    s_add_u32 m0, s74, 17408
    s_add_u32 s62, s68, 32768
    buffer_load_dwordx4 v3, s[24:27], s62 offen lds
    s_add_u32 m0, s74, 18432
    s_add_u32 s62, s68, 65536
    buffer_load_dwordx4 v2, s[24:27], s62 offen lds
    s_add_u32 m0, s74, 19456
    s_add_u32 s62, s68, 98304
    buffer_load_dwordx4 v3, s[24:27], s62 offen lds
    s_add_u32 m0, s74, 20480
    s_add_u32 s62, s68, 131072
    buffer_load_dwordx4 v2, s[24:27], s62 offen lds
    s_add_u32 m0, s74, 21504
    s_add_u32 s62, s68, 163840
    buffer_load_dwordx4 v3, s[24:27], s62 offen lds
    s_add_u32 m0, s74, 22528
    s_add_u32 s62, s68, 196608
    buffer_load_dwordx4 v2, s[24:27], s62 offen lds
    s_add_u32 m0, s74, 23552
    s_add_u32 s62, s68, 229376
    buffer_load_dwordx4 v3, s[24:27], s62 offen lds
    s_add_u32 s68, s68, 262144
    s_waitcnt vmcnt(32)
    ds_read_b64_tr_b16 v[28:29], v4
    ds_read_b64_tr_b16 v[30:31], v4 offset:4096
    ds_read_b64_tr_b16 v[32:33], v5
    ds_read_b64_tr_b16 v[34:35], v5 offset:4096
    ds_read_b64_tr_b16 v[36:37], v6
    ds_read_b64_tr_b16 v[38:39], v6 offset:4096
    ds_read_b64_tr_b16 v[40:41], v7
    ds_read_b64_tr_b16 v[42:43], v7 offset:4096
    ds_read_b64_tr_b16 v[44:45], v8
    ds_read_b64_tr_b16 v[46:47], v8 offset:4096
    ds_read_b64_tr_b16 v[48:49], v9
    ds_read_b64_tr_b16 v[50:51], v9 offset:4096
    ds_read_b64_tr_b16 v[52:53], v10
    ds_read_b64_tr_b16 v[54:55], v10 offset:4096
    ds_read_b64_tr_b16 v[56:57], v11
    ds_read_b64_tr_b16 v[58:59], v11 offset:4096
    s_mov_b32 s70, 0
L_gv_loop:
    s_waitcnt vmcnt(16) lgkmcnt(0)
    v_mfma_f32_16x16x32_bf16 a[0:3], v[92:95], v[28:31], a[0:3]
    ds_read_b64_tr_b16 v[60:61], v4 offset:8192
    v_mfma_f32_16x16x32_bf16 a[4:7], v[96:99], v[28:31], a[4:7]
    ds_read_b64_tr_b16 v[62:63], v4 offset:12288
    v_mfma_f32_16x16x32_bf16 a[8:11], v[100:103], v[28:31], a[8:11]
    ds_read_b64_tr_b16 v[64:65], v5 offset:8192
    v_mfma_f32_16x16x32_bf16 a[12:15], v[104:107], v[28:31], a[12:15]
    ds_read_b64_tr_b16 v[66:67], v5 offset:12288
    v_mfma_f32_16x16x32_bf16 a[16:19], v[108:111], v[28:31], a[16:19]
    ds_read_b64_tr_b16 v[68:69], v6 offset:8192
    v_mfma_f32_16x16x32_bf16 a[20:23], v[112:115], v[28:31], a[20:23]
    ds_read_b64_tr_b16 v[70:71], v6 offset:12288
    v_mfma_f32_16x16x32_bf16 a[24:27], v[116:119], v[28:31], a[24:27]
    ds_read_b64_tr_b16 v[72:73], v7 offset:8192
    v_mfma_f32_16x16x32_bf16 a[28:31], v[120:123], v[28:31], a[28:31]
    ds_read_b64_tr_b16 v[74:75], v7 offset:12288
    v_mfma_f32_16x16x32_bf16 a[32:35], v[92:95], v[32:35], a[32:35]
    ds_read_b64_tr_b16 v[76:77], v8 offset:8192
    v_mfma_f32_16x16x32_bf16 a[36:39], v[96:99], v[32:35], a[36:39]
    ds_read_b64_tr_b16 v[78:79], v8 offset:12288
    v_mfma_f32_16x16x32_bf16 a[40:43], v[100:103], v[32:35], a[40:43]
    ds_read_b64_tr_b16 v[80:81], v9 offset:8192
    v_mfma_f32_16x16x32_bf16 a[44:47], v[104:107], v[32:35], a[44:47]
    ds_read_b64_tr_b16 v[82:83], v9 offset:12288
    v_mfma_f32_16x16x32_bf16 a[48:51], v[108:111], v[32:35], a[48:51]
    ds_read_b64_tr_b16 v[84:85], v10 offset:8192
    v_mfma_f32_16x16x32_bf16 a[52:55], v[112:115], v[32:35], a[52:55]
    ds_read_b64_tr_b16 v[86:87], v10 offset:12288
    v_mfma_f32_16x16x32_bf16 a[56:59], v[116:119], v[32:35], a[56:59]
    ds_read_b64_tr_b16 v[88:89], v11 offset:8192
    v_mfma_f32_16x16x32_bf16 a[60:63], v[120:123], v[32:35], a[60:63]
    ds_read_b64_tr_b16 v[90:91], v11 offset:12288
    v_mfma_f32_16x16x32_bf16 a[64:67], v[92:95], v[36:39], a[64:67]
    s_mov_b32 s63, s69
    v_mfma_f32_16x16x32_bf16 a[68:71], v[96:99], v[36:39], a[68:71]
    buffer_load_dwordx4 v[156:159], v1, s[56:59], s63 offen sc1
    v_mfma_f32_16x16x32_bf16 a[72:75], v[100:103], v[36:39], a[72:75]
    s_add_u32 s63, s63, s79
    v_mfma_f32_16x16x32_bf16 a[76:79], v[104:107], v[36:39], a[76:79]
    buffer_load_dwordx4 v[160:163], v1, s[56:59], s63 offen sc1
    v_mfma_f32_16x16x32_bf16 a[80:83], v[108:111], v[36:39], a[80:83]
    s_add_u32 s63, s63, s79
    v_mfma_f32_16x16x32_bf16 a[84:87], v[112:115], v[36:39], a[84:87]
    buffer_load_dwordx4 v[164:167], v1, s[56:59], s63 offen sc1
    v_mfma_f32_16x16x32_bf16 a[88:91], v[116:119], v[36:39], a[88:91]
    s_add_u32 s63, s63, s79
    v_mfma_f32_16x16x32_bf16 a[92:95], v[120:123], v[36:39], a[92:95]
    buffer_load_dwordx4 v[168:171], v1, s[56:59], s63 offen sc1
    v_mfma_f32_16x16x32_bf16 a[96:99], v[92:95], v[40:43], a[96:99]
    s_add_u32 s63, s63, s79
    v_mfma_f32_16x16x32_bf16 a[100:103], v[96:99], v[40:43], a[100:103]
    buffer_load_dwordx4 v[172:175], v1, s[56:59], s63 offen sc1
    v_mfma_f32_16x16x32_bf16 a[104:107], v[100:103], v[40:43], a[104:107]
    s_add_u32 s63, s63, s79
    v_mfma_f32_16x16x32_bf16 a[108:111], v[104:107], v[40:43], a[108:111]
    buffer_load_dwordx4 v[176:179], v1, s[56:59], s63 offen sc1
    v_mfma_f32_16x16x32_bf16 a[112:115], v[108:111], v[40:43], a[112:115]
    s_add_u32 s63, s63, s79
    v_mfma_f32_16x16x32_bf16 a[116:119], v[112:115], v[40:43], a[116:119]
    buffer_load_dwordx4 v[180:183], v1, s[56:59], s63 offen sc1
    v_mfma_f32_16x16x32_bf16 a[120:123], v[116:119], v[40:43], a[120:123]
    s_add_u32 s63, s63, s79
    v_mfma_f32_16x16x32_bf16 a[124:127], v[120:123], v[40:43], a[124:127]
    buffer_load_dwordx4 v[184:187], v1, s[56:59], s63 offen sc1
    v_mfma_f32_16x16x32_bf16 a[128:131], v[92:95], v[44:47], a[128:131]
    s_add_u32 s69, s69, 1024
    v_mfma_f32_16x16x32_bf16 a[132:135], v[96:99], v[44:47], a[132:135]
    s_add_u32 m0, s74, 24576
    v_mfma_f32_16x16x32_bf16 a[136:139], v[100:103], v[44:47], a[136:139]
    s_add_u32 s62, s68, 0
    v_mfma_f32_16x16x32_bf16 a[140:143], v[104:107], v[44:47], a[140:143]
    buffer_load_dwordx4 v2, s[24:27], s62 offen lds
    v_mfma_f32_16x16x32_bf16 a[144:147], v[108:111], v[44:47], a[144:147]
    s_add_u32 m0, s74, 25600
    v_mfma_f32_16x16x32_bf16 a[148:151], v[112:115], v[44:47], a[148:151]
    s_add_u32 s62, s68, 32768
    v_mfma_f32_16x16x32_bf16 a[152:155], v[116:119], v[44:47], a[152:155]
    buffer_load_dwordx4 v3, s[24:27], s62 offen lds
    v_mfma_f32_16x16x32_bf16 a[156:159], v[120:123], v[44:47], a[156:159]
    s_add_u32 m0, s74, 26624
    v_mfma_f32_16x16x32_bf16 a[160:163], v[92:95], v[48:51], a[160:163]
    s_add_u32 s62, s68, 65536
    v_mfma_f32_16x16x32_bf16 a[164:167], v[96:99], v[48:51], a[164:167]
    buffer_load_dwordx4 v2, s[24:27], s62 offen lds
    v_mfma_f32_16x16x32_bf16 a[168:171], v[100:103], v[48:51], a[168:171]
    s_add_u32 m0, s74, 27648
    v_mfma_f32_16x16x32_bf16 a[172:175], v[104:107], v[48:51], a[172:175]
    s_add_u32 s62, s68, 98304
    v_mfma_f32_16x16x32_bf16 a[176:179], v[108:111], v[48:51], a[176:179]
    buffer_load_dwordx4 v3, s[24:27], s62 offen lds
    v_mfma_f32_16x16x32_bf16 a[180:183], v[112:115], v[48:51], a[180:183]
    s_add_u32 m0, s74, 28672
    v_mfma_f32_16x16x32_bf16 a[184:187], v[116:119], v[48:51], a[184:187]
    s_add_u32 s62, s68, 131072
    v_mfma_f32_16x16x32_bf16 a[188:191], v[120:123], v[48:51], a[188:191]
    buffer_load_dwordx4 v2, s[24:27], s62 offen lds
    v_mfma_f32_16x16x32_bf16 a[192:195], v[92:95], v[52:55], a[192:195]
    s_add_u32 m0, s74, 29696
    v_mfma_f32_16x16x32_bf16 a[196:199], v[96:99], v[52:55], a[196:199]
    s_add_u32 s62, s68, 163840
    v_mfma_f32_16x16x32_bf16 a[200:203], v[100:103], v[52:55], a[200:203]
    buffer_load_dwordx4 v3, s[24:27], s62 offen lds
    v_mfma_f32_16x16x32_bf16 a[204:207], v[104:107], v[52:55], a[204:207]
    s_add_u32 m0, s74, 30720
    v_mfma_f32_16x16x32_bf16 a[208:211], v[108:111], v[52:55], a[208:211]
    s_add_u32 s62, s68, 196608
    v_mfma_f32_16x16x32_bf16 a[212:215], v[112:115], v[52:55], a[212:215]
    buffer_load_dwordx4 v2, s[24:27], s62 offen lds
    v_mfma_f32_16x16x32_bf16 a[216:219], v[116:119], v[52:55], a[216:219]
    s_add_u32 m0, s74, 31744
    v_mfma_f32_16x16x32_bf16 a[220:223], v[120:123], v[52:55], a[220:223]
    s_add_u32 s62, s68, 229376
    v_mfma_f32_16x16x32_bf16 a[224:227], v[92:95], v[56:59], a[224:227]
    buffer_load_dwordx4 v3, s[24:27], s62 offen lds
    v_mfma_f32_16x16x32_bf16 a[228:231], v[96:99], v[56:59], a[228:231]
    s_add_u32 s68, s68, 262144
    v_mfma_f32_16x16x32_bf16 a[232:235], v[100:103], v[56:59], a[232:235]
    v_mfma_f32_16x16x32_bf16 a[236:239], v[104:107], v[56:59], a[236:239]
    v_mfma_f32_16x16x32_bf16 a[240:243], v[108:111], v[56:59], a[240:243]
    v_mfma_f32_16x16x32_bf16 a[244:247], v[112:115], v[56:59], a[244:247]
    v_mfma_f32_16x16x32_bf16 a[248:251], v[116:119], v[56:59], a[248:251]
    v_mfma_f32_16x16x32_bf16 a[252:255], v[120:123], v[56:59], a[252:255]
    s_waitcnt vmcnt(16) lgkmcnt(0)
    v_mfma_f32_16x16x32_bf16 a[0:3], v[124:127], v[60:63], a[0:3]
    ds_read_b64_tr_b16 v[28:29], v4 offset:16384
    v_mfma_f32_16x16x32_bf16 a[4:7], v[128:131], v[60:63], a[4:7]
    ds_read_b64_tr_b16 v[30:31], v4 offset:20480
    v_mfma_f32_16x16x32_bf16 a[8:11], v[132:135], v[60:63], a[8:11]
    ds_read_b64_tr_b16 v[32:33], v5 offset:16384
    v_mfma_f32_16x16x32_bf16 a[12:15], v[136:139], v[60:63], a[12:15]
    ds_read_b64_tr_b16 v[34:35], v5 offset:20480
    v_mfma_f32_16x16x32_bf16 a[16:19], v[140:143], v[60:63], a[16:19]
    ds_read_b64_tr_b16 v[36:37], v6 offset:16384
    v_mfma_f32_16x16x32_bf16 a[20:23], v[144:147], v[60:63], a[20:23]
    ds_read_b64_tr_b16 v[38:39], v6 offset:20480
    v_mfma_f32_16x16x32_bf16 a[24:27], v[148:151], v[60:63], a[24:27]
    ds_read_b64_tr_b16 v[40:41], v7 offset:16384
    v_mfma_f32_16x16x32_bf16 a[28:31], v[152:155], v[60:63], a[28:31]
    ds_read_b64_tr_b16 v[42:43], v7 offset:20480
    v_mfma_f32_16x16x32_bf16 a[32:35], v[124:127], v[64:67], a[32:35]
    ds_read_b64_tr_b16 v[44:45], v8 offset:16384
    v_mfma_f32_16x16x32_bf16 a[36:39], v[128:131], v[64:67], a[36:39]
    ds_read_b64_tr_b16 v[46:47], v8 offset:20480
    v_mfma_f32_16x16x32_bf16 a[40:43], v[132:135], v[64:67], a[40:43]
    ds_read_b64_tr_b16 v[48:49], v9 offset:16384
    v_mfma_f32_16x16x32_bf16 a[44:47], v[136:139], v[64:67], a[44:47]
    ds_read_b64_tr_b16 v[50:51], v9 offset:20480
    v_mfma_f32_16x16x32_bf16 a[48:51], v[140:143], v[64:67], a[48:51]
    ds_read_b64_tr_b16 v[52:53], v10 offset:16384
    v_mfma_f32_16x16x32_bf16 a[52:55], v[144:147], v[64:67], a[52:55]
    ds_read_b64_tr_b16 v[54:55], v10 offset:20480
    v_mfma_f32_16x16x32_bf16 a[56:59], v[148:151], v[64:67], a[56:59]
    ds_read_b64_tr_b16 v[56:57], v11 offset:16384
    v_mfma_f32_16x16x32_bf16 a[60:63], v[152:155], v[64:67], a[60:63]
    ds_read_b64_tr_b16 v[58:59], v11 offset:20480
    v_mfma_f32_16x16x32_bf16 a[64:67], v[124:127], v[68:71], a[64:67]
    s_mov_b32 s63, s69
    v_mfma_f32_16x16x32_bf16 a[68:71], v[128:131], v[68:71], a[68:71]
    buffer_load_dwordx4 v[188:191], v1, s[56:59], s63 offen sc1
    v_mfma_f32_16x16x32_bf16 a[72:75], v[132:135], v[68:71], a[72:75]
    s_add_u32 s63, s63, s79
    v_mfma_f32_16x16x32_bf16 a[76:79], v[136:139], v[68:71], a[76:79]
    buffer_load_dwordx4 v[192:195], v1, s[56:59], s63 offen sc1
    v_mfma_f32_16x16x32_bf16 a[80:83], v[140:143], v[68:71], a[80:83]
    s_add_u32 s63, s63, s79
    v_mfma_f32_16x16x32_bf16 a[84:87], v[144:147], v[68:71], a[84:87]
    buffer_load_dwordx4 v[196:199], v1, s[56:59], s63 offen sc1
    v_mfma_f32_16x16x32_bf16 a[88:91], v[148:151], v[68:71], a[88:91]
    s_add_u32 s63, s63, s79
    v_mfma_f32_16x16x32_bf16 a[92:95], v[152:155], v[68:71], a[92:95]
    buffer_load_dwordx4 v[200:203], v1, s[56:59], s63 offen sc1
    v_mfma_f32_16x16x32_bf16 a[96:99], v[124:127], v[72:75], a[96:99]
    s_add_u32 s63, s63, s79
    v_mfma_f32_16x16x32_bf16 a[100:103], v[128:131], v[72:75], a[100:103]
    buffer_load_dwordx4 v[204:207], v1, s[56:59], s63 offen sc1
    v_mfma_f32_16x16x32_bf16 a[104:107], v[132:135], v[72:75], a[104:107]
    s_add_u32 s63, s63, s79
    v_mfma_f32_16x16x32_bf16 a[108:111], v[136:139], v[72:75], a[108:111]
    buffer_load_dwordx4 v[208:211], v1, s[56:59], s63 offen sc1
    v_mfma_f32_16x16x32_bf16 a[112:115], v[140:143], v[72:75], a[112:115]
    s_add_u32 s63, s63, s79
    v_mfma_f32_16x16x32_bf16 a[116:119], v[144:147], v[72:75], a[116:119]
    buffer_load_dwordx4 v[212:215], v1, s[56:59], s63 offen sc1
    v_mfma_f32_16x16x32_bf16 a[120:123], v[148:151], v[72:75], a[120:123]
    s_add_u32 s63, s63, s79
    v_mfma_f32_16x16x32_bf16 a[124:127], v[152:155], v[72:75], a[124:127]
    buffer_load_dwordx4 v[216:219], v1, s[56:59], s63 offen sc1
    v_mfma_f32_16x16x32_bf16 a[128:131], v[124:127], v[76:79], a[128:131]
    s_add_u32 s69, s69, 1024
    v_mfma_f32_16x16x32_bf16 a[132:135], v[128:131], v[76:79], a[132:135]
    s_add_u32 m0, s74, 0
    v_mfma_f32_16x16x32_bf16 a[136:139], v[132:135], v[76:79], a[136:139]
    s_add_u32 s62, s68, 0
    v_mfma_f32_16x16x32_bf16 a[140:143], v[136:139], v[76:79], a[140:143]
    buffer_load_dwordx4 v2, s[24:27], s62 offen lds
    v_mfma_f32_16x16x32_bf16 a[144:147], v[140:143], v[76:79], a[144:147]
    s_add_u32 m0, s74, 1024
    v_mfma_f32_16x16x32_bf16 a[148:151], v[144:147], v[76:79], a[148:151]
    s_add_u32 s62, s68, 32768
    v_mfma_f32_16x16x32_bf16 a[152:155], v[148:151], v[76:79], a[152:155]
    buffer_load_dwordx4 v3, s[24:27], s62 offen lds
    v_mfma_f32_16x16x32_bf16 a[156:159], v[152:155], v[76:79], a[156:159]
    s_add_u32 m0, s74, 2048
    v_mfma_f32_16x16x32_bf16 a[160:163], v[124:127], v[80:83], a[160:163]
    s_add_u32 s62, s68, 65536
    v_mfma_f32_16x16x32_bf16 a[164:167], v[128:131], v[80:83], a[164:167]
    buffer_load_dwordx4 v2, s[24:27], s62 offen lds
    v_mfma_f32_16x16x32_bf16 a[168:171], v[132:135], v[80:83], a[168:171]
    s_add_u32 m0, s74, 3072
    v_mfma_f32_16x16x32_bf16 a[172:175], v[136:139], v[80:83], a[172:175]
    s_add_u32 s62, s68, 98304
    v_mfma_f32_16x16x32_bf16 a[176:179], v[140:143], v[80:83], a[176:179]
    buffer_load_dwordx4 v3, s[24:27], s62 offen lds
    v_mfma_f32_16x16x32_bf16 a[180:183], v[144:147], v[80:83], a[180:183]
    s_add_u32 m0, s74, 4096
    v_mfma_f32_16x16x32_bf16 a[184:187], v[148:151], v[80:83], a[184:187]
    s_add_u32 s62, s68, 131072
    v_mfma_f32_16x16x32_bf16 a[188:191], v[152:155], v[80:83], a[188:191]
    buffer_load_dwordx4 v2, s[24:27], s62 offen lds
    v_mfma_f32_16x16x32_bf16 a[192:195], v[124:127], v[84:87], a[192:195]
    s_add_u32 m0, s74, 5120
    v_mfma_f32_16x16x32_bf16 a[196:199], v[128:131], v[84:87], a[196:199]
    s_add_u32 s62, s68, 163840
    v_mfma_f32_16x16x32_bf16 a[200:203], v[132:135], v[84:87], a[200:203]
    buffer_load_dwordx4 v3, s[24:27], s62 offen lds
    v_mfma_f32_16x16x32_bf16 a[204:207], v[136:139], v[84:87], a[204:207]
    s_add_u32 m0, s74, 6144
    v_mfma_f32_16x16x32_bf16 a[208:211], v[140:143], v[84:87], a[208:211]
    s_add_u32 s62, s68, 196608
    v_mfma_f32_16x16x32_bf16 a[212:215], v[144:147], v[84:87], a[212:215]
    buffer_load_dwordx4 v2, s[24:27], s62 offen lds
    v_mfma_f32_16x16x32_bf16 a[216:219], v[148:151], v[84:87], a[216:219]
    s_add_u32 m0, s74, 7168
    v_mfma_f32_16x16x32_bf16 a[220:223], v[152:155], v[84:87], a[220:223]
    s_add_u32 s62, s68, 229376
    v_mfma_f32_16x16x32_bf16 a[224:227], v[124:127], v[88:91], a[224:227]
    buffer_load_dwordx4 v3, s[24:27], s62 offen lds
    v_mfma_f32_16x16x32_bf16 a[228:231], v[128:131], v[88:91], a[228:231]
    s_add_u32 s68, s68, 262144
    v_mfma_f32_16x16x32_bf16 a[232:235], v[132:135], v[88:91], a[232:235]
    v_mfma_f32_16x16x32_bf16 a[236:239], v[136:139], v[88:91], a[236:239]
    v_mfma_f32_16x16x32_bf16 a[240:243], v[140:143], v[88:91], a[240:243]
    v_mfma_f32_16x16x32_bf16 a[244:247], v[144:147], v[88:91], a[244:247]
    v_mfma_f32_16x16x32_bf16 a[248:251], v[148:151], v[88:91], a[248:251]
    v_mfma_f32_16x16x32_bf16 a[252:255], v[152:155], v[88:91], a[252:255]
    s_waitcnt vmcnt(16) lgkmcnt(0)
    v_mfma_f32_16x16x32_bf16 a[0:3], v[156:159], v[28:31], a[0:3]
    ds_read_b64_tr_b16 v[60:61], v4 offset:24576
    v_mfma_f32_16x16x32_bf16 a[4:7], v[160:163], v[28:31], a[4:7]
    ds_read_b64_tr_b16 v[62:63], v4 offset:28672
    v_mfma_f32_16x16x32_bf16 a[8:11], v[164:167], v[28:31], a[8:11]
    ds_read_b64_tr_b16 v[64:65], v5 offset:24576
    v_mfma_f32_16x16x32_bf16 a[12:15], v[168:171], v[28:31], a[12:15]
    ds_read_b64_tr_b16 v[66:67], v5 offset:28672
    v_mfma_f32_16x16x32_bf16 a[16:19], v[172:175], v[28:31], a[16:19]
    ds_read_b64_tr_b16 v[68:69], v6 offset:24576
    v_mfma_f32_16x16x32_bf16 a[20:23], v[176:179], v[28:31], a[20:23]
    ds_read_b64_tr_b16 v[70:71], v6 offset:28672
    v_mfma_f32_16x16x32_bf16 a[24:27], v[180:183], v[28:31], a[24:27]
    ds_read_b64_tr_b16 v[72:73], v7 offset:24576
    v_mfma_f32_16x16x32_bf16 a[28:31], v[184:187], v[28:31], a[28:31]
    ds_read_b64_tr_b16 v[74:75], v7 offset:28672
    v_mfma_f32_16x16x32_bf16 a[32:35], v[156:159], v[32:35], a[32:35]
    ds_read_b64_tr_b16 v[76:77], v8 offset:24576
    v_mfma_f32_16x16x32_bf16 a[36:39], v[160:163], v[32:35], a[36:39]
    ds_read_b64_tr_b16 v[78:79], v8 offset:28672
    v_mfma_f32_16x16x32_bf16 a[40:43], v[164:167], v[32:35], a[40:43]
    ds_read_b64_tr_b16 v[80:81], v9 offset:24576
    v_mfma_f32_16x16x32_bf16 a[44:47], v[168:171], v[32:35], a[44:47]
    ds_read_b64_tr_b16 v[82:83], v9 offset:28672
    v_mfma_f32_16x16x32_bf16 a[48:51], v[172:175], v[32:35], a[48:51]
    ds_read_b64_tr_b16 v[84:85], v10 offset:24576
    v_mfma_f32_16x16x32_bf16 a[52:55], v[176:179], v[32:35], a[52:55]
    ds_read_b64_tr_b16 v[86:87], v10 offset:28672
    v_mfma_f32_16x16x32_bf16 a[56:59], v[180:183], v[32:35], a[56:59]
    ds_read_b64_tr_b16 v[88:89], v11 offset:24576
    v_mfma_f32_16x16x32_bf16 a[60:63], v[184:187], v[32:35], a[60:63]
    ds_read_b64_tr_b16 v[90:91], v11 offset:28672
    v_mfma_f32_16x16x32_bf16 a[64:67], v[156:159], v[36:39], a[64:67]
    s_mov_b32 s63, s69
    v_mfma_f32_16x16x32_bf16 a[68:71], v[160:163], v[36:39], a[68:71]
    buffer_load_dwordx4 v[92:95], v1, s[56:59], s63 offen sc1
    v_mfma_f32_16x16x32_bf16 a[72:75], v[164:167], v[36:39], a[72:75]
    s_add_u32 s63, s63, s79
    v_mfma_f32_16x16x32_bf16 a[76:79], v[168:171], v[36:39], a[76:79]
    buffer_load_dwordx4 v[96:99], v1, s[56:59], s63 offen sc1
    v_mfma_f32_16x16x32_bf16 a[80:83], v[172:175], v[36:39], a[80:83]
    s_add_u32 s63, s63, s79
    v_mfma_f32_16x16x32_bf16 a[84:87], v[176:179], v[36:39], a[84:87]
    buffer_load_dwordx4 v[100:103], v1, s[56:59], s63 offen sc1
    v_mfma_f32_16x16x32_bf16 a[88:91], v[180:183], v[36:39], a[88:91]
    s_add_u32 s63, s63, s79
    v_mfma_f32_16x16x32_bf16 a[92:95], v[184:187], v[36:39], a[92:95]
    buffer_load_dwordx4 v[104:107], v1, s[56:59], s63 offen sc1
    v_mfma_f32_16x16x32_bf16 a[96:99], v[156:159], v[40:43], a[96:99]
    s_add_u32 s63, s63, s79
    v_mfma_f32_16x16x32_bf16 a[100:103], v[160:163], v[40:43], a[100:103]
    buffer_load_dwordx4 v[108:111], v1, s[56:59], s63 offen sc1
    v_mfma_f32_16x16x32_bf16 a[104:107], v[164:167], v[40:43], a[104:107]
    s_add_u32 s63, s63, s79
    v_mfma_f32_16x16x32_bf16 a[108:111], v[168:171], v[40:43], a[108:111]
    buffer_load_dwordx4 v[112:115], v1, s[56:59], s63 offen sc1
    v_mfma_f32_16x16x32_bf16 a[112:115], v[172:175], v[40:43], a[112:115]
    s_add_u32 s63, s63, s79
    v_mfma_f32_16x16x32_bf16 a[116:119], v[176:179], v[40:43], a[116:119]
    buffer_load_dwordx4 v[116:119], v1, s[56:59], s63 offen sc1
    v_mfma_f32_16x16x32_bf16 a[120:123], v[180:183], v[40:43], a[120:123]
    s_add_u32 s63, s63, s79
    v_mfma_f32_16x16x32_bf16 a[124:127], v[184:187], v[40:43], a[124:127]
    buffer_load_dwordx4 v[120:123], v1, s[56:59], s63 offen sc1
    v_mfma_f32_16x16x32_bf16 a[128:131], v[156:159], v[44:47], a[128:131]
    s_add_u32 s69, s69, 1024
    v_mfma_f32_16x16x32_bf16 a[132:135], v[160:163], v[44:47], a[132:135]
    s_add_u32 m0, s74, 8192
    v_mfma_f32_16x16x32_bf16 a[136:139], v[164:167], v[44:47], a[136:139]
    s_add_u32 s62, s68, 0
    v_mfma_f32_16x16x32_bf16 a[140:143], v[168:171], v[44:47], a[140:143]
    buffer_load_dwordx4 v2, s[24:27], s62 offen lds
    v_mfma_f32_16x16x32_bf16 a[144:147], v[172:175], v[44:47], a[144:147]
    s_add_u32 m0, s74, 9216
    v_mfma_f32_16x16x32_bf16 a[148:151], v[176:179], v[44:47], a[148:151]
    s_add_u32 s62, s68, 32768
    v_mfma_f32_16x16x32_bf16 a[152:155], v[180:183], v[44:47], a[152:155]
    buffer_load_dwordx4 v3, s[24:27], s62 offen lds
    v_mfma_f32_16x16x32_bf16 a[156:159], v[184:187], v[44:47], a[156:159]
    s_add_u32 m0, s74, 10240
    v_mfma_f32_16x16x32_bf16 a[160:163], v[156:159], v[48:51], a[160:163]
    s_add_u32 s62, s68, 65536
    v_mfma_f32_16x16x32_bf16 a[164:167], v[160:163], v[48:51], a[164:167]
    buffer_load_dwordx4 v2, s[24:27], s62 offen lds
    v_mfma_f32_16x16x32_bf16 a[168:171], v[164:167], v[48:51], a[168:171]
    s_add_u32 m0, s74, 11264
    v_mfma_f32_16x16x32_bf16 a[172:175], v[168:171], v[48:51], a[172:175]
    s_add_u32 s62, s68, 98304
    v_mfma_f32_16x16x32_bf16 a[176:179], v[172:175], v[48:51], a[176:179]
    buffer_load_dwordx4 v3, s[24:27], s62 offen lds
    v_mfma_f32_16x16x32_bf16 a[180:183], v[176:179], v[48:51], a[180:183]
    s_add_u32 m0, s74, 12288
    v_mfma_f32_16x16x32_bf16 a[184:187], v[180:183], v[48:51], a[184:187]
    s_add_u32 s62, s68, 131072
    v_mfma_f32_16x16x32_bf16 a[188:191], v[184:187], v[48:51], a[188:191]
    buffer_load_dwordx4 v2, s[24:27], s62 offen lds
    v_mfma_f32_16x16x32_bf16 a[192:195], v[156:159], v[52:55], a[192:195]
    s_add_u32 m0, s74, 13312
    v_mfma_f32_16x16x32_bf16 a[196:199], v[160:163], v[52:55], a[196:199]
    s_add_u32 s62, s68, 163840
    v_mfma_f32_16x16x32_bf16 a[200:203], v[164:167], v[52:55], a[200:203]
    buffer_load_dwordx4 v3, s[24:27], s62 offen lds
    v_mfma_f32_16x16x32_bf16 a[204:207], v[168:171], v[52:55], a[204:207]
    s_add_u32 m0, s74, 14336
    v_mfma_f32_16x16x32_bf16 a[208:211], v[172:175], v[52:55], a[208:211]
    s_add_u32 s62, s68, 196608
    v_mfma_f32_16x16x32_bf16 a[212:215], v[176:179], v[52:55], a[212:215]
    buffer_load_dwordx4 v2, s[24:27], s62 offen lds
    v_mfma_f32_16x16x32_bf16 a[216:219], v[180:183], v[52:55], a[216:219]
    s_add_u32 m0, s74, 15360
    v_mfma_f32_16x16x32_bf16 a[220:223], v[184:187], v[52:55], a[220:223]
    s_add_u32 s62, s68, 229376
    v_mfma_f32_16x16x32_bf16 a[224:227], v[156:159], v[56:59], a[224:227]
    buffer_load_dwordx4 v3, s[24:27], s62 offen lds
    v_mfma_f32_16x16x32_bf16 a[228:231], v[160:163], v[56:59], a[228:231]
    s_add_u32 s68, s68, 262144
    v_mfma_f32_16x16x32_bf16 a[232:235], v[164:167], v[56:59], a[232:235]
    v_mfma_f32_16x16x32_bf16 a[236:239], v[168:171], v[56:59], a[236:239]
    v_mfma_f32_16x16x32_bf16 a[240:243], v[172:175], v[56:59], a[240:243]
    v_mfma_f32_16x16x32_bf16 a[244:247], v[176:179], v[56:59], a[244:247]
    v_mfma_f32_16x16x32_bf16 a[248:251], v[180:183], v[56:59], a[248:251]
    v_mfma_f32_16x16x32_bf16 a[252:255], v[184:187], v[56:59], a[252:255]
    s_waitcnt vmcnt(16) lgkmcnt(0)
    v_mfma_f32_16x16x32_bf16 a[0:3], v[188:191], v[60:63], a[0:3]
    ds_read_b64_tr_b16 v[28:29], v4
    v_mfma_f32_16x16x32_bf16 a[4:7], v[192:195], v[60:63], a[4:7]
    ds_read_b64_tr_b16 v[30:31], v4 offset:4096
    v_mfma_f32_16x16x32_bf16 a[8:11], v[196:199], v[60:63], a[8:11]
    ds_read_b64_tr_b16 v[32:33], v5
    v_mfma_f32_16x16x32_bf16 a[12:15], v[200:203], v[60:63], a[12:15]
    ds_read_b64_tr_b16 v[34:35], v5 offset:4096
    v_mfma_f32_16x16x32_bf16 a[16:19], v[204:207], v[60:63], a[16:19]
    ds_read_b64_tr_b16 v[36:37], v6
    v_mfma_f32_16x16x32_bf16 a[20:23], v[208:211], v[60:63], a[20:23]
    ds_read_b64_tr_b16 v[38:39], v6 offset:4096
    v_mfma_f32_16x16x32_bf16 a[24:27], v[212:215], v[60:63], a[24:27]
    ds_read_b64_tr_b16 v[40:41], v7
    v_mfma_f32_16x16x32_bf16 a[28:31], v[216:219], v[60:63], a[28:31]
    ds_read_b64_tr_b16 v[42:43], v7 offset:4096
    v_mfma_f32_16x16x32_bf16 a[32:35], v[188:191], v[64:67], a[32:35]
    ds_read_b64_tr_b16 v[44:45], v8
    v_mfma_f32_16x16x32_bf16 a[36:39], v[192:195], v[64:67], a[36:39]
    ds_read_b64_tr_b16 v[46:47], v8 offset:4096
    v_mfma_f32_16x16x32_bf16 a[40:43], v[196:199], v[64:67], a[40:43]
    ds_read_b64_tr_b16 v[48:49], v9
    v_mfma_f32_16x16x32_bf16 a[44:47], v[200:203], v[64:67], a[44:47]
    ds_read_b64_tr_b16 v[50:51], v9 offset:4096
    v_mfma_f32_16x16x32_bf16 a[48:51], v[204:207], v[64:67], a[48:51]
    ds_read_b64_tr_b16 v[52:53], v10
    v_mfma_f32_16x16x32_bf16 a[52:55], v[208:211], v[64:67], a[52:55]
    ds_read_b64_tr_b16 v[54:55], v10 offset:4096
    v_mfma_f32_16x16x32_bf16 a[56:59], v[212:215], v[64:67], a[56:59]
    ds_read_b64_tr_b16 v[56:57], v11
    v_mfma_f32_16x16x32_bf16 a[60:63], v[216:219], v[64:67], a[60:63]
    ds_read_b64_tr_b16 v[58:59], v11 offset:4096
    v_mfma_f32_16x16x32_bf16 a[64:67], v[188:191], v[68:71], a[64:67]
    s_mov_b32 s63, s69
    v_mfma_f32_16x16x32_bf16 a[68:71], v[192:195], v[68:71], a[68:71]
    buffer_load_dwordx4 v[124:127], v1, s[56:59], s63 offen sc1
    v_mfma_f32_16x16x32_bf16 a[72:75], v[196:199], v[68:71], a[72:75]
    s_add_u32 s63, s63, s79
    v_mfma_f32_16x16x32_bf16 a[76:79], v[200:203], v[68:71], a[76:79]
    buffer_load_dwordx4 v[128:131], v1, s[56:59], s63 offen sc1
    v_mfma_f32_16x16x32_bf16 a[80:83], v[204:207], v[68:71], a[80:83]
    s_add_u32 s63, s63, s79
    v_mfma_f32_16x16x32_bf16 a[84:87], v[208:211], v[68:71], a[84:87]
    buffer_load_dwordx4 v[132:135], v1, s[56:59], s63 offen sc1
    v_mfma_f32_16x16x32_bf16 a[88:91], v[212:215], v[68:71], a[88:91]
    s_add_u32 s63, s63, s79
    v_mfma_f32_16x16x32_bf16 a[92:95], v[216:219], v[68:71], a[92:95]
    buffer_load_dwordx4 v[136:139], v1, s[56:59], s63 offen sc1
    v_mfma_f32_16x16x32_bf16 a[96:99], v[188:191], v[72:75], a[96:99]
    s_add_u32 s63, s63, s79
    v_mfma_f32_16x16x32_bf16 a[100:103], v[192:195], v[72:75], a[100:103]
    buffer_load_dwordx4 v[140:143], v1, s[56:59], s63 offen sc1
    v_mfma_f32_16x16x32_bf16 a[104:107], v[196:199], v[72:75], a[104:107]
    s_add_u32 s63, s63, s79
    v_mfma_f32_16x16x32_bf16 a[108:111], v[200:203], v[72:75], a[108:111]
    buffer_load_dwordx4 v[144:147], v1, s[56:59], s63 offen sc1
    v_mfma_f32_16x16x32_bf16 a[112:115], v[204:207], v[72:75], a[112:115]
    s_add_u32 s63, s63, s79
    v_mfma_f32_16x16x32_bf16 a[116:119], v[208:211], v[72:75], a[116:119]
    buffer_load_dwordx4 v[148:151], v1, s[56:59], s63 offen sc1
    v_mfma_f32_16x16x32_bf16 a[120:123], v[212:215], v[72:75], a[120:123]
    s_add_u32 s63, s63, s79
    v_mfma_f32_16x16x32_bf16 a[124:127], v[216:219], v[72:75], a[124:127]
    buffer_load_dwordx4 v[152:155], v1, s[56:59], s63 offen sc1
    v_mfma_f32_16x16x32_bf16 a[128:131], v[188:191], v[76:79], a[128:131]
    s_add_u32 s69, s69, 1024
    v_mfma_f32_16x16x32_bf16 a[132:135], v[192:195], v[76:79], a[132:135]
    s_add_u32 m0, s74, 16384
    v_mfma_f32_16x16x32_bf16 a[136:139], v[196:199], v[76:79], a[136:139]
    s_add_u32 s62, s68, 0
    v_mfma_f32_16x16x32_bf16 a[140:143], v[200:203], v[76:79], a[140:143]
    buffer_load_dwordx4 v2, s[24:27], s62 offen lds
    v_mfma_f32_16x16x32_bf16 a[144:147], v[204:207], v[76:79], a[144:147]
    s_add_u32 m0, s74, 17408
    v_mfma_f32_16x16x32_bf16 a[148:151], v[208:211], v[76:79], a[148:151]
    s_add_u32 s62, s68, 32768
    v_mfma_f32_16x16x32_bf16 a[152:155], v[212:215], v[76:79], a[152:155]
    buffer_load_dwordx4 v3, s[24:27], s62 offen lds
    v_mfma_f32_16x16x32_bf16 a[156:159], v[216:219], v[76:79], a[156:159]
    s_add_u32 m0, s74, 18432
    v_mfma_f32_16x16x32_bf16 a[160:163], v[188:191], v[80:83], a[160:163]
    s_add_u32 s62, s68, 65536
    v_mfma_f32_16x16x32_bf16 a[164:167], v[192:195], v[80:83], a[164:167]
    buffer_load_dwordx4 v2, s[24:27], s62 offen lds
    v_mfma_f32_16x16x32_bf16 a[168:171], v[196:199], v[80:83], a[168:171]
    s_add_u32 m0, s74, 19456
    v_mfma_f32_16x16x32_bf16 a[172:175], v[200:203], v[80:83], a[172:175]
    s_add_u32 s62, s68, 98304
    v_mfma_f32_16x16x32_bf16 a[176:179], v[204:207], v[80:83], a[176:179]
    buffer_load_dwordx4 v3, s[24:27], s62 offen lds
    v_mfma_f32_16x16x32_bf16 a[180:183], v[208:211], v[80:83], a[180:183]
    s_add_u32 m0, s74, 20480
    v_mfma_f32_16x16x32_bf16 a[184:187], v[212:215], v[80:83], a[184:187]
    s_add_u32 s62, s68, 131072
    v_mfma_f32_16x16x32_bf16 a[188:191], v[216:219], v[80:83], a[188:191]
    buffer_load_dwordx4 v2, s[24:27], s62 offen lds
    v_mfma_f32_16x16x32_bf16 a[192:195], v[188:191], v[84:87], a[192:195]
    s_add_u32 m0, s74, 21504
    v_mfma_f32_16x16x32_bf16 a[196:199], v[192:195], v[84:87], a[196:199]
    s_add_u32 s62, s68, 163840
    v_mfma_f32_16x16x32_bf16 a[200:203], v[196:199], v[84:87], a[200:203]
    buffer_load_dwordx4 v3, s[24:27], s62 offen lds
    v_mfma_f32_16x16x32_bf16 a[204:207], v[200:203], v[84:87], a[204:207]
    s_add_u32 m0, s74, 22528
    v_mfma_f32_16x16x32_bf16 a[208:211], v[204:207], v[84:87], a[208:211]
    s_add_u32 s62, s68, 196608
    v_mfma_f32_16x16x32_bf16 a[212:215], v[208:211], v[84:87], a[212:215]
    buffer_load_dwordx4 v2, s[24:27], s62 offen lds
    v_mfma_f32_16x16x32_bf16 a[216:219], v[212:215], v[84:87], a[216:219]
    s_add_u32 m0, s74, 23552
    v_mfma_f32_16x16x32_bf16 a[220:223], v[216:219], v[84:87], a[220:223]
    s_add_u32 s62, s68, 229376
    v_mfma_f32_16x16x32_bf16 a[224:227], v[188:191], v[88:91], a[224:227]
    buffer_load_dwordx4 v3, s[24:27], s62 offen lds
    v_mfma_f32_16x16x32_bf16 a[228:231], v[192:195], v[88:91], a[228:231]
    s_add_u32 s68, s68, 262144
    v_mfma_f32_16x16x32_bf16 a[232:235], v[196:199], v[88:91], a[232:235]
    v_mfma_f32_16x16x32_bf16 a[236:239], v[200:203], v[88:91], a[236:239]
    v_mfma_f32_16x16x32_bf16 a[240:243], v[204:207], v[88:91], a[240:243]
    v_mfma_f32_16x16x32_bf16 a[244:247], v[208:211], v[88:91], a[244:247]
    v_mfma_f32_16x16x32_bf16 a[248:251], v[212:215], v[88:91], a[248:251]
    v_mfma_f32_16x16x32_bf16 a[252:255], v[216:219], v[88:91], a[252:255]
    s_add_u32 s70, s70, 4
    s_cmp_lt_u32 s70, s64
    s_cbranch_scc1 L_gv_loop
    s_waitcnt vmcnt(0) lgkmcnt(0)
    s_nop 7
    s_nop 7
    s_lshl_b32 s71, s72, 7
    s_add_u32 s71, s71, s77
    s_lshl_b32 s71, s71, 13
    s_add_u32 s71, s71, 20971520
    v_accvgpr_read_b32 v28, a0
    v_accvgpr_read_b32 v29, a1
    v_accvgpr_read_b32 v30, a2
    v_accvgpr_read_b32 v31, a3
    v_cvt_pk_bf16_f32 v36, v28, v29
    v_cvt_pk_bf16_f32 v37, v30, v31
    v_accvgpr_read_b32 v32, a4
    v_accvgpr_read_b32 v33, a5
    v_accvgpr_read_b32 v34, a6
    v_accvgpr_read_b32 v35, a7
    v_cvt_pk_bf16_f32 v38, v32, v33
    v_cvt_pk_bf16_f32 v39, v34, v35
    s_add_u32 s62, s71, 0
    buffer_store_dwordx4 v[36:39], v1, s[56:59], s62 offen sc1
    v_accvgpr_read_b32 v28, a32
    v_accvgpr_read_b32 v29, a33
    v_accvgpr_read_b32 v30, a34
    v_accvgpr_read_b32 v31, a35
    v_cvt_pk_bf16_f32 v40, v28, v29
    v_cvt_pk_bf16_f32 v41, v30, v31
    v_accvgpr_read_b32 v32, a36
    v_accvgpr_read_b32 v33, a37
    v_accvgpr_read_b32 v34, a38
    v_accvgpr_read_b32 v35, a39
    v_cvt_pk_bf16_f32 v42, v32, v33
    v_cvt_pk_bf16_f32 v43, v34, v35
    s_add_u32 s62, s71, 0
    buffer_store_dwordx4 v[40:43], v1, s[56:59], s62 offen offset:1024 sc1
    v_accvgpr_read_b32 v28, a64
    v_accvgpr_read_b32 v29, a65
    v_accvgpr_read_b32 v30, a66
    v_accvgpr_read_b32 v31, a67
    v_cvt_pk_bf16_f32 v36, v28, v29
    v_cvt_pk_bf16_f32 v37, v30, v31
    v_accvgpr_read_b32 v32, a68
    v_accvgpr_read_b32 v33, a69
    v_accvgpr_read_b32 v34, a70
    v_accvgpr_read_b32 v35, a71
    v_cvt_pk_bf16_f32 v38, v32, v33
    v_cvt_pk_bf16_f32 v39, v34, v35
    s_add_u32 s62, s71, 0
    buffer_store_dwordx4 v[36:39], v1, s[56:59], s62 offen offset:2048 sc1
    v_accvgpr_read_b32 v28, a96
    v_accvgpr_read_b32 v29, a97
    v_accvgpr_read_b32 v30, a98
    v_accvgpr_read_b32 v31, a99
    v_cvt_pk_bf16_f32 v40, v28, v29
    v_cvt_pk_bf16_f32 v41, v30, v31
    v_accvgpr_read_b32 v32, a100
    v_accvgpr_read_b32 v33, a101
    v_accvgpr_read_b32 v34, a102
    v_accvgpr_read_b32 v35, a103
    v_cvt_pk_bf16_f32 v42, v32, v33
    v_cvt_pk_bf16_f32 v43, v34, v35
    s_add_u32 s62, s71, 0
    buffer_store_dwordx4 v[40:43], v1, s[56:59], s62 offen offset:3072 sc1
    v_accvgpr_read_b32 v28, a128
    v_accvgpr_read_b32 v29, a129
    v_accvgpr_read_b32 v30, a130
    v_accvgpr_read_b32 v31, a131
    v_cvt_pk_bf16_f32 v36, v28, v29
    v_cvt_pk_bf16_f32 v37, v30, v31
    v_accvgpr_read_b32 v32, a132
    v_accvgpr_read_b32 v33, a133
    v_accvgpr_read_b32 v34, a134
    v_accvgpr_read_b32 v35, a135
    v_cvt_pk_bf16_f32 v38, v32, v33
    v_cvt_pk_bf16_f32 v39, v34, v35
    s_add_u32 s62, s71, 4096
    buffer_store_dwordx4 v[36:39], v1, s[56:59], s62 offen sc1
    v_accvgpr_read_b32 v28, a160
    v_accvgpr_read_b32 v29, a161
    v_accvgpr_read_b32 v30, a162
    v_accvgpr_read_b32 v31, a163
    v_cvt_pk_bf16_f32 v40, v28, v29
    v_cvt_pk_bf16_f32 v41, v30, v31
    v_accvgpr_read_b32 v32, a164
    v_accvgpr_read_b32 v33, a165
    v_accvgpr_read_b32 v34, a166
    v_accvgpr_read_b32 v35, a167
    v_cvt_pk_bf16_f32 v42, v32, v33
    v_cvt_pk_bf16_f32 v43, v34, v35
    s_add_u32 s62, s71, 4096
    buffer_store_dwordx4 v[40:43], v1, s[56:59], s62 offen offset:1024 sc1
    v_accvgpr_read_b32 v28, a192
    v_accvgpr_read_b32 v29, a193
    v_accvgpr_read_b32 v30, a194
    v_accvgpr_read_b32 v31, a195
    v_cvt_pk_bf16_f32 v36, v28, v29
    v_cvt_pk_bf16_f32 v37, v30, v31
    v_accvgpr_read_b32 v32, a196
    v_accvgpr_read_b32 v33, a197
    v_accvgpr_read_b32 v34, a198
    v_accvgpr_read_b32 v35, a199
    v_cvt_pk_bf16_f32 v38, v32, v33
    v_cvt_pk_bf16_f32 v39, v34, v35
    s_add_u32 s62, s71, 4096
    buffer_store_dwordx4 v[36:39], v1, s[56:59], s62 offen offset:2048 sc1
    v_accvgpr_read_b32 v28, a224
    v_accvgpr_read_b32 v29, a225
    v_accvgpr_read_b32 v30, a226
    v_accvgpr_read_b32 v31, a227
    v_cvt_pk_bf16_f32 v40, v28, v29
    v_cvt_pk_bf16_f32 v41, v30, v31
    v_accvgpr_read_b32 v32, a228
    v_accvgpr_read_b32 v33, a229
    v_accvgpr_read_b32 v34, a230
    v_accvgpr_read_b32 v35, a231
    v_cvt_pk_bf16_f32 v42, v32, v33
    v_cvt_pk_bf16_f32 v43, v34, v35
    s_add_u32 s62, s71, 4096
    buffer_store_dwordx4 v[40:43], v1, s[56:59], s62 offen offset:3072 sc1
    v_accvgpr_read_b32 v28, a8
    v_accvgpr_read_b32 v29, a9
    v_accvgpr_read_b32 v30, a10
    v_accvgpr_read_b32 v31, a11
    v_cvt_pk_bf16_f32 v36, v28, v29
    v_cvt_pk_bf16_f32 v37, v30, v31
    v_accvgpr_read_b32 v32, a12
    v_accvgpr_read_b32 v33, a13
    v_accvgpr_read_b32 v34, a14
    v_accvgpr_read_b32 v35, a15
    v_cvt_pk_bf16_f32 v38, v32, v33
    v_cvt_pk_bf16_f32 v39, v34, v35
    s_add_u32 s62, s71, 262144
    buffer_store_dwordx4 v[36:39], v1, s[56:59], s62 offen sc1
    v_accvgpr_read_b32 v28, a40
    v_accvgpr_read_b32 v29, a41
    v_accvgpr_read_b32 v30, a42
    v_accvgpr_read_b32 v31, a43
    v_cvt_pk_bf16_f32 v40, v28, v29
    v_cvt_pk_bf16_f32 v41, v30, v31
    v_accvgpr_read_b32 v32, a44
    v_accvgpr_read_b32 v33, a45
    v_accvgpr_read_b32 v34, a46
    v_accvgpr_read_b32 v35, a47
    v_cvt_pk_bf16_f32 v42, v32, v33
    v_cvt_pk_bf16_f32 v43, v34, v35
    s_add_u32 s62, s71, 262144
    buffer_store_dwordx4 v[40:43], v1, s[56:59], s62 offen offset:1024 sc1
    v_accvgpr_read_b32 v28, a72
    v_accvgpr_read_b32 v29, a73
    v_accvgpr_read_b32 v30, a74
    v_accvgpr_read_b32 v31, a75
    v_cvt_pk_bf16_f32 v36, v28, v29
    v_cvt_pk_bf16_f32 v37, v30, v31
    v_accvgpr_read_b32 v32, a76
    v_accvgpr_read_b32 v33, a77
    v_accvgpr_read_b32 v34, a78
    v_accvgpr_read_b32 v35, a79
    v_cvt_pk_bf16_f32 v38, v32, v33
    v_cvt_pk_bf16_f32 v39, v34, v35
    s_add_u32 s62, s71, 262144
    buffer_store_dwordx4 v[36:39], v1, s[56:59], s62 offen offset:2048 sc1
    v_accvgpr_read_b32 v28, a104
    v_accvgpr_read_b32 v29, a105
    v_accvgpr_read_b32 v30, a106
    v_accvgpr_read_b32 v31, a107
    v_cvt_pk_bf16_f32 v40, v28, v29
    v_cvt_pk_bf16_f32 v41, v30, v31
    v_accvgpr_read_b32 v32, a108
    v_accvgpr_read_b32 v33, a109
    v_accvgpr_read_b32 v34, a110
    v_accvgpr_read_b32 v35, a111
    v_cvt_pk_bf16_f32 v42, v32, v33
    v_cvt_pk_bf16_f32 v43, v34, v35
    s_add_u32 s62, s71, 262144
    buffer_store_dwordx4 v[40:43], v1, s[56:59], s62 offen offset:3072 sc1
    v_accvgpr_read_b32 v28, a136
    v_accvgpr_read_b32 v29, a137
    v_accvgpr_read_b32 v30, a138
    v_accvgpr_read_b32 v31, a139
    v_cvt_pk_bf16_f32 v36, v28, v29
    v_cvt_pk_bf16_f32 v37, v30, v31
    v_accvgpr_read_b32 v32, a140
    v_accvgpr_read_b32 v33, a141
    v_accvgpr_read_b32 v34, a142
    v_accvgpr_read_b32 v35, a143
    v_cvt_pk_bf16_f32 v38, v32, v33
    v_cvt_pk_bf16_f32 v39, v34, v35
    s_add_u32 s62, s71, 266240
    buffer_store_dwordx4 v[36:39], v1, s[56:59], s62 offen sc1
    v_accvgpr_read_b32 v28, a168
    v_accvgpr_read_b32 v29, a169
    v_accvgpr_read_b32 v30, a170
    v_accvgpr_read_b32 v31, a171
    v_cvt_pk_bf16_f32 v40, v28, v29
    v_cvt_pk_bf16_f32 v41, v30, v31
    v_accvgpr_read_b32 v32, a172
    v_accvgpr_read_b32 v33, a173
    v_accvgpr_read_b32 v34, a174
    v_accvgpr_read_b32 v35, a175
    v_cvt_pk_bf16_f32 v42, v32, v33
    v_cvt_pk_bf16_f32 v43, v34, v35
    s_add_u32 s62, s71, 266240
    buffer_store_dwordx4 v[40:43], v1, s[56:59], s62 offen offset:1024 sc1
    v_accvgpr_read_b32 v28, a200
    v_accvgpr_read_b32 v29, a201
    v_accvgpr_read_b32 v30, a202
    v_accvgpr_read_b32 v31, a203
    v_cvt_pk_bf16_f32 v36, v28, v29
    v_cvt_pk_bf16_f32 v37, v30, v31
    v_accvgpr_read_b32 v32, a204
    v_accvgpr_read_b32 v33, a205
    v_accvgpr_read_b32 v34, a206
    v_accvgpr_read_b32 v35, a207
    v_cvt_pk_bf16_f32 v38, v32, v33
    v_cvt_pk_bf16_f32 v39, v34, v35
    s_add_u32 s62, s71, 266240
    buffer_store_dwordx4 v[36:39], v1, s[56:59], s62 offen offset:2048 sc1
    v_accvgpr_read_b32 v28, a232
    v_accvgpr_read_b32 v29, a233
    v_accvgpr_read_b32 v30, a234
    v_accvgpr_read_b32 v31, a235
    v_cvt_pk_bf16_f32 v40, v28, v29
    v_cvt_pk_bf16_f32 v41, v30, v31
    v_accvgpr_read_b32 v32, a236
    v_accvgpr_read_b32 v33, a237
    v_accvgpr_read_b32 v34, a238
    v_accvgpr_read_b32 v35, a239
    v_cvt_pk_bf16_f32 v42, v32, v33
    v_cvt_pk_bf16_f32 v43, v34, v35
    s_add_u32 s62, s71, 266240
    buffer_store_dwordx4 v[40:43], v1, s[56:59], s62 offen offset:3072 sc1
    v_accvgpr_read_b32 v28, a16
    v_accvgpr_read_b32 v29, a17
    v_accvgpr_read_b32 v30, a18
    v_accvgpr_read_b32 v31, a19
    v_cvt_pk_bf16_f32 v36, v28, v29
    v_cvt_pk_bf16_f32 v37, v30, v31
    v_accvgpr_read_b32 v32, a20
    v_accvgpr_read_b32 v33, a21
    v_accvgpr_read_b32 v34, a22
    v_accvgpr_read_b32 v35, a23
    v_cvt_pk_bf16_f32 v38, v32, v33
    v_cvt_pk_bf16_f32 v39, v34, v35
    s_add_u32 s62, s71, 524288
    buffer_store_dwordx4 v[36:39], v1, s[56:59], s62 offen sc1
    v_accvgpr_read_b32 v28, a48
    v_accvgpr_read_b32 v29, a49
    v_accvgpr_read_b32 v30, a50
    v_accvgpr_read_b32 v31, a51
    v_cvt_pk_bf16_f32 v40, v28, v29
    v_cvt_pk_bf16_f32 v41, v30, v31
    v_accvgpr_read_b32 v32, a52
    v_accvgpr_read_b32 v33, a53
    v_accvgpr_read_b32 v34, a54
    v_accvgpr_read_b32 v35, a55
    v_cvt_pk_bf16_f32 v42, v32, v33
    v_cvt_pk_bf16_f32 v43, v34, v35
    s_add_u32 s62, s71, 524288
    buffer_store_dwordx4 v[40:43], v1, s[56:59], s62 offen offset:1024 sc1
    v_accvgpr_read_b32 v28, a80
    v_accvgpr_read_b32 v29, a81
    v_accvgpr_read_b32 v30, a82
    v_accvgpr_read_b32 v31, a83
    v_cvt_pk_bf16_f32 v36, v28, v29
    v_cvt_pk_bf16_f32 v37, v30, v31
    v_accvgpr_read_b32 v32, a84
    v_accvgpr_read_b32 v33, a85
    v_accvgpr_read_b32 v34, a86
    v_accvgpr_read_b32 v35, a87
    v_cvt_pk_bf16_f32 v38, v32, v33
    v_cvt_pk_bf16_f32 v39, v34, v35
    s_add_u32 s62, s71, 524288
    buffer_store_dwordx4 v[36:39], v1, s[56:59], s62 offen offset:2048 sc1
    v_accvgpr_read_b32 v28, a112
    v_accvgpr_read_b32 v29, a113
    v_accvgpr_read_b32 v30, a114
    v_accvgpr_read_b32 v31, a115
    v_cvt_pk_bf16_f32 v40, v28, v29
    v_cvt_pk_bf16_f32 v41, v30, v31
    v_accvgpr_read_b32 v32, a116
    v_accvgpr_read_b32 v33, a117
    v_accvgpr_read_b32 v34, a118
    v_accvgpr_read_b32 v35, a119
    v_cvt_pk_bf16_f32 v42, v32, v33
    v_cvt_pk_bf16_f32 v43, v34, v35
    s_add_u32 s62, s71, 524288
    buffer_store_dwordx4 v[40:43], v1, s[56:59], s62 offen offset:3072 sc1
    v_accvgpr_read_b32 v28, a144
    v_accvgpr_read_b32 v29, a145
    v_accvgpr_read_b32 v30, a146
    v_accvgpr_read_b32 v31, a147
    v_cvt_pk_bf16_f32 v36, v28, v29
    v_cvt_pk_bf16_f32 v37, v30, v31
    v_accvgpr_read_b32 v32, a148
    v_accvgpr_read_b32 v33, a149
    v_accvgpr_read_b32 v34, a150
    v_accvgpr_read_b32 v35, a151
    v_cvt_pk_bf16_f32 v38, v32, v33
    v_cvt_pk_bf16_f32 v39, v34, v35
    s_add_u32 s62, s71, 528384
    buffer_store_dwordx4 v[36:39], v1, s[56:59], s62 offen sc1
    v_accvgpr_read_b32 v28, a176
    v_accvgpr_read_b32 v29, a177
    v_accvgpr_read_b32 v30, a178
    v_accvgpr_read_b32 v31, a179
    v_cvt_pk_bf16_f32 v40, v28, v29
    v_cvt_pk_bf16_f32 v41, v30, v31
    v_accvgpr_read_b32 v32, a180
    v_accvgpr_read_b32 v33, a181
    v_accvgpr_read_b32 v34, a182
    v_accvgpr_read_b32 v35, a183
    v_cvt_pk_bf16_f32 v42, v32, v33
    v_cvt_pk_bf16_f32 v43, v34, v35
    s_add_u32 s62, s71, 528384
    buffer_store_dwordx4 v[40:43], v1, s[56:59], s62 offen offset:1024 sc1
    v_accvgpr_read_b32 v28, a208
    v_accvgpr_read_b32 v29, a209
    v_accvgpr_read_b32 v30, a210
    v_accvgpr_read_b32 v31, a211
    v_cvt_pk_bf16_f32 v36, v28, v29
    v_cvt_pk_bf16_f32 v37, v30, v31
    v_accvgpr_read_b32 v32, a212
    v_accvgpr_read_b32 v33, a213
    v_accvgpr_read_b32 v34, a214
    v_accvgpr_read_b32 v35, a215
    v_cvt_pk_bf16_f32 v38, v32, v33
    v_cvt_pk_bf16_f32 v39, v34, v35
    s_add_u32 s62, s71, 528384
    buffer_store_dwordx4 v[36:39], v1, s[56:59], s62 offen offset:2048 sc1
    v_accvgpr_read_b32 v28, a240
    v_accvgpr_read_b32 v29, a241
    v_accvgpr_read_b32 v30, a242
    v_accvgpr_read_b32 v31, a243
    v_cvt_pk_bf16_f32 v40, v28, v29
    v_cvt_pk_bf16_f32 v41, v30, v31
    v_accvgpr_read_b32 v32, a244
    v_accvgpr_read_b32 v33, a245
    v_accvgpr_read_b32 v34, a246
    v_accvgpr_read_b32 v35, a247
    v_cvt_pk_bf16_f32 v42, v32, v33
    v_cvt_pk_bf16_f32 v43, v34, v35
    s_add_u32 s62, s71, 528384
    buffer_store_dwordx4 v[40:43], v1, s[56:59], s62 offen offset:3072 sc1
    v_accvgpr_read_b32 v28, a24
    v_accvgpr_read_b32 v29, a25
    v_accvgpr_read_b32 v30, a26
    v_accvgpr_read_b32 v31, a27
    v_cvt_pk_bf16_f32 v36, v28, v29
    v_cvt_pk_bf16_f32 v37, v30, v31
    v_accvgpr_read_b32 v32, a28
    v_accvgpr_read_b32 v33, a29
    v_accvgpr_read_b32 v34, a30
    v_accvgpr_read_b32 v35, a31
    v_cvt_pk_bf16_f32 v38, v32, v33
    v_cvt_pk_bf16_f32 v39, v34, v35
    s_add_u32 s62, s71, 786432
    buffer_store_dwordx4 v[36:39], v1, s[56:59], s62 offen sc1
    v_accvgpr_read_b32 v28, a56
    v_accvgpr_read_b32 v29, a57
    v_accvgpr_read_b32 v30, a58
    v_accvgpr_read_b32 v31, a59
    v_cvt_pk_bf16_f32 v40, v28, v29
    v_cvt_pk_bf16_f32 v41, v30, v31
    v_accvgpr_read_b32 v32, a60
    v_accvgpr_read_b32 v33, a61
    v_accvgpr_read_b32 v34, a62
    v_accvgpr_read_b32 v35, a63
    v_cvt_pk_bf16_f32 v42, v32, v33
    v_cvt_pk_bf16_f32 v43, v34, v35
    s_add_u32 s62, s71, 786432
    buffer_store_dwordx4 v[40:43], v1, s[56:59], s62 offen offset:1024 sc1
    v_accvgpr_read_b32 v28, a88
    v_accvgpr_read_b32 v29, a89
    v_accvgpr_read_b32 v30, a90
    v_accvgpr_read_b32 v31, a91
    v_cvt_pk_bf16_f32 v36, v28, v29
    v_cvt_pk_bf16_f32 v37, v30, v31
    v_accvgpr_read_b32 v32, a92
    v_accvgpr_read_b32 v33, a93
    v_accvgpr_read_b32 v34, a94
    v_accvgpr_read_b32 v35, a95
    v_cvt_pk_bf16_f32 v38, v32, v33
    v_cvt_pk_bf16_f32 v39, v34, v35
    s_add_u32 s62, s71, 786432
    buffer_store_dwordx4 v[36:39], v1, s[56:59], s62 offen offset:2048 sc1
    v_accvgpr_read_b32 v28, a120
    v_accvgpr_read_b32 v29, a121
    v_accvgpr_read_b32 v30, a122
    v_accvgpr_read_b32 v31, a123
    v_cvt_pk_bf16_f32 v40, v28, v29
    v_cvt_pk_bf16_f32 v41, v30, v31
    v_accvgpr_read_b32 v32, a124
    v_accvgpr_read_b32 v33, a125
    v_accvgpr_read_b32 v34, a126
    v_accvgpr_read_b32 v35, a127
    v_cvt_pk_bf16_f32 v42, v32, v33
    v_cvt_pk_bf16_f32 v43, v34, v35
    s_add_u32 s62, s71, 786432
    buffer_store_dwordx4 v[40:43], v1, s[56:59], s62 offen offset:3072 sc1
    v_accvgpr_read_b32 v28, a152
    v_accvgpr_read_b32 v29, a153
    v_accvgpr_read_b32 v30, a154
    v_accvgpr_read_b32 v31, a155
    v_cvt_pk_bf16_f32 v36, v28, v29
    v_cvt_pk_bf16_f32 v37, v30, v31
    v_accvgpr_read_b32 v32, a156
    v_accvgpr_read_b32 v33, a157
    v_accvgpr_read_b32 v34, a158
    v_accvgpr_read_b32 v35, a159
    v_cvt_pk_bf16_f32 v38, v32, v33
    v_cvt_pk_bf16_f32 v39, v34, v35
    s_add_u32 s62, s71, 790528
    buffer_store_dwordx4 v[36:39], v1, s[56:59], s62 offen sc1
    v_accvgpr_read_b32 v28, a184
    v_accvgpr_read_b32 v29, a185
    v_accvgpr_read_b32 v30, a186
    v_accvgpr_read_b32 v31, a187
    v_cvt_pk_bf16_f32 v40, v28, v29
    v_cvt_pk_bf16_f32 v41, v30, v31
    v_accvgpr_read_b32 v32, a188
    v_accvgpr_read_b32 v33, a189
    v_accvgpr_read_b32 v34, a190
    v_accvgpr_read_b32 v35, a191
    v_cvt_pk_bf16_f32 v42, v32, v33
    v_cvt_pk_bf16_f32 v43, v34, v35
    s_add_u32 s62, s71, 790528
    buffer_store_dwordx4 v[40:43], v1, s[56:59], s62 offen offset:1024 sc1
    v_accvgpr_read_b32 v28, a216
    v_accvgpr_read_b32 v29, a217
    v_accvgpr_read_b32 v30, a218
    v_accvgpr_read_b32 v31, a219
    v_cvt_pk_bf16_f32 v36, v28, v29
    v_cvt_pk_bf16_f32 v37, v30, v31
    v_accvgpr_read_b32 v32, a220
    v_accvgpr_read_b32 v33, a221
    v_accvgpr_read_b32 v34, a222
    v_accvgpr_read_b32 v35, a223
    v_cvt_pk_bf16_f32 v38, v32, v33
    v_cvt_pk_bf16_f32 v39, v34, v35
    s_add_u32 s62, s71, 790528
    buffer_store_dwordx4 v[36:39], v1, s[56:59], s62 offen offset:2048 sc1
    v_accvgpr_read_b32 v28, a248
    v_accvgpr_read_b32 v29, a249
    v_accvgpr_read_b32 v30, a250
    v_accvgpr_read_b32 v31, a251
    v_cvt_pk_bf16_f32 v40, v28, v29
    v_cvt_pk_bf16_f32 v41, v30, v31
    v_accvgpr_read_b32 v32, a252
    v_accvgpr_read_b32 v33, a253
    v_accvgpr_read_b32 v34, a254
    v_accvgpr_read_b32 v35, a255
    v_cvt_pk_bf16_f32 v42, v32, v33
    v_cvt_pk_bf16_f32 v43, v34, v35
    s_add_u32 s62, s71, 790528
    buffer_store_dwordx4 v[40:43], v1, s[56:59], s62 offen offset:3072 sc1
    s_lshl_b32 s65, s72, 7
    s_add_u32 s65, s65, 94372864
    s_waitcnt vmcnt(0)
    s_barrier
    s_cmp_lg_u32 s61, 0
    s_cbranch_scc1 L_sig5
    v_mov_b32 v12, 32
    v_mov_b32 v13, 0
    s_mov_b64 exec, 1
    buffer_atomic_add v12, v13, s[56:59], s65 offen sc1
    s_mov_b64 exec, -1
L_sig5:
    s_branch L_next
L_doth:
    s_and_b32 s63, s62, 7
    s_lshl_b32 s63, s63, 2
    s_add_u32 s77, s63, s61
    s_cmp_ge_u32 s62, 8
    s_cbranch_scc1 L_tf
    s_mov_b32 s62, 8192
    v_mul_lo_u32 v12, v25, s62
    v_lshlrev_b32 v13, 1, v25
    v_xor_b32 v13, v13, v26
    v_lshl_add_u32 v2, v13, 4, v12
    v_lshlrev_b32 v13, 1, v25
    v_add_u32 v13, 8, v13
    v_xor_b32 v13, v13, v26
    v_lshl_add_u32 v3, v13, 4, v12
    s_lshl_b32 s65, s72, 7
    s_add_u32 s65, s65, 94372864
    s_cmp_lg_u32 s61, 0
    s_cbranch_scc1 L_wf6d
    v_mov_b32 v13, 0
L_wf6:
    buffer_load_dword v12, v13, s[56:59], s65 offen sc1
    s_waitcnt vmcnt(0)
    v_lshrrev_b32 v12, 0, v12
    v_and_b32 v12, 31, v12
    v_cmp_le_u32 vcc, 16, v12
    s_cbranch_vccnz L_wf6d
    s_sleep 2
    s_branch L_wf6
L_wf6d:
    s_barrier
    s_lshl_b32 s68, s77, 8
    s_mul_i32 s69, s72, 163840
    s_add_u32 s69, s69, 0
    s_mov_b32 s79, 20480
    s_mov_b32 s64, 20
    v_accvgpr_write_b32 a0, 0
    v_accvgpr_write_b32 a1, 0
    v_accvgpr_write_b32 a2, 0
    v_accvgpr_write_b32 a3, 0
    v_accvgpr_write_b32 a4, 0
    v_accvgpr_write_b32 a5, 0
    v_accvgpr_write_b32 a6, 0
    v_accvgpr_write_b32 a7, 0
    v_accvgpr_write_b32 a8, 0
    v_accvgpr_write_b32 a9, 0
    v_accvgpr_write_b32 a10, 0
    v_accvgpr_write_b32 a11, 0
    v_accvgpr_write_b32 a12, 0
    v_accvgpr_write_b32 a13, 0
    v_accvgpr_write_b32 a14, 0
    v_accvgpr_write_b32 a15, 0
    v_accvgpr_write_b32 a16, 0
    v_accvgpr_write_b32 a17, 0
    v_accvgpr_write_b32 a18, 0
    v_accvgpr_write_b32 a19, 0
    v_accvgpr_write_b32 a20, 0
    v_accvgpr_write_b32 a21, 0
    v_accvgpr_write_b32 a22, 0
    v_accvgpr_write_b32 a23, 0
    v_accvgpr_write_b32 a24, 0
    v_accvgpr_write_b32 a25, 0
    v_accvgpr_write_b32 a26, 0
    v_accvgpr_write_b32 a27, 0
    v_accvgpr_write_b32 a28, 0
    v_accvgpr_write_b32 a29, 0
    v_accvgpr_write_b32 a30, 0
    v_accvgpr_write_b32 a31, 0
    v_accvgpr_write_b32 a32, 0
    v_accvgpr_write_b32 a33, 0
    v_accvgpr_write_b32 a34, 0
    v_accvgpr_write_b32 a35, 0
    v_accvgpr_write_b32 a36, 0
    v_accvgpr_write_b32 a37, 0
    v_accvgpr_write_b32 a38, 0
    v_accvgpr_write_b32 a39, 0
    v_accvgpr_write_b32 a40, 0
    v_accvgpr_write_b32 a41, 0
    v_accvgpr_write_b32 a42, 0
    v_accvgpr_write_b32 a43, 0
    v_accvgpr_write_b32 a44, 0
    v_accvgpr_write_b32 a45, 0
    v_accvgpr_write_b32 a46, 0
    v_accvgpr_write_b32 a47, 0
    v_accvgpr_write_b32 a48, 0
    v_accvgpr_write_b32 a49, 0
    v_accvgpr_write_b32 a50, 0
    v_accvgpr_write_b32 a51, 0
    v_accvgpr_write_b32 a52, 0
    v_accvgpr_write_b32 a53, 0
    v_accvgpr_write_b32 a54, 0
    v_accvgpr_write_b32 a55, 0
    v_accvgpr_write_b32 a56, 0
    v_accvgpr_write_b32 a57, 0
    v_accvgpr_write_b32 a58, 0
    v_accvgpr_write_b32 a59, 0
    v_accvgpr_write_b32 a60, 0
    v_accvgpr_write_b32 a61, 0
    v_accvgpr_write_b32 a62, 0
    v_accvgpr_write_b32 a63, 0
    v_accvgpr_write_b32 a64, 0
    v_accvgpr_write_b32 a65, 0
    v_accvgpr_write_b32 a66, 0
    v_accvgpr_write_b32 a67, 0
    v_accvgpr_write_b32 a68, 0
    v_accvgpr_write_b32 a69, 0
    v_accvgpr_write_b32 a70, 0
    v_accvgpr_write_b32 a71, 0
    v_accvgpr_write_b32 a72, 0
    v_accvgpr_write_b32 a73, 0
    v_accvgpr_write_b32 a74, 0
    v_accvgpr_write_b32 a75, 0
    v_accvgpr_write_b32 a76, 0
    v_accvgpr_write_b32 a77, 0
    v_accvgpr_write_b32 a78, 0
    v_accvgpr_write_b32 a79, 0
    v_accvgpr_write_b32 a80, 0
    v_accvgpr_write_b32 a81, 0
    v_accvgpr_write_b32 a82, 0
    v_accvgpr_write_b32 a83, 0
    v_accvgpr_write_b32 a84, 0
    v_accvgpr_write_b32 a85, 0
    v_accvgpr_write_b32 a86, 0
    v_accvgpr_write_b32 a87, 0
    v_accvgpr_write_b32 a88, 0
    v_accvgpr_write_b32 a89, 0
    v_accvgpr_write_b32 a90, 0
    v_accvgpr_write_b32 a91, 0
    v_accvgpr_write_b32 a92, 0
    v_accvgpr_write_b32 a93, 0
    v_accvgpr_write_b32 a94, 0
    v_accvgpr_write_b32 a95, 0
    v_accvgpr_write_b32 a96, 0
    v_accvgpr_write_b32 a97, 0
    v_accvgpr_write_b32 a98, 0
    v_accvgpr_write_b32 a99, 0
    v_accvgpr_write_b32 a100, 0
    v_accvgpr_write_b32 a101, 0
    v_accvgpr_write_b32 a102, 0
    v_accvgpr_write_b32 a103, 0
    v_accvgpr_write_b32 a104, 0
    v_accvgpr_write_b32 a105, 0
    v_accvgpr_write_b32 a106, 0
    v_accvgpr_write_b32 a107, 0
    v_accvgpr_write_b32 a108, 0
    v_accvgpr_write_b32 a109, 0
    v_accvgpr_write_b32 a110, 0
    v_accvgpr_write_b32 a111, 0
    v_accvgpr_write_b32 a112, 0
    v_accvgpr_write_b32 a113, 0
    v_accvgpr_write_b32 a114, 0
    v_accvgpr_write_b32 a115, 0
    v_accvgpr_write_b32 a116, 0
    v_accvgpr_write_b32 a117, 0
    v_accvgpr_write_b32 a118, 0
    v_accvgpr_write_b32 a119, 0
    v_accvgpr_write_b32 a120, 0
    v_accvgpr_write_b32 a121, 0
    v_accvgpr_write_b32 a122, 0
    v_accvgpr_write_b32 a123, 0
    v_accvgpr_write_b32 a124, 0
    v_accvgpr_write_b32 a125, 0
    v_accvgpr_write_b32 a126, 0
    v_accvgpr_write_b32 a127, 0
    v_accvgpr_write_b32 a128, 0
    v_accvgpr_write_b32 a129, 0
    v_accvgpr_write_b32 a130, 0
    v_accvgpr_write_b32 a131, 0
    v_accvgpr_write_b32 a132, 0
    v_accvgpr_write_b32 a133, 0
    v_accvgpr_write_b32 a134, 0
    v_accvgpr_write_b32 a135, 0
    v_accvgpr_write_b32 a136, 0
    v_accvgpr_write_b32 a137, 0
    v_accvgpr_write_b32 a138, 0
    v_accvgpr_write_b32 a139, 0
    v_accvgpr_write_b32 a140, 0
    v_accvgpr_write_b32 a141, 0
    v_accvgpr_write_b32 a142, 0
    v_accvgpr_write_b32 a143, 0
    v_accvgpr_write_b32 a144, 0
    v_accvgpr_write_b32 a145, 0
    v_accvgpr_write_b32 a146, 0
    v_accvgpr_write_b32 a147, 0
    v_accvgpr_write_b32 a148, 0
    v_accvgpr_write_b32 a149, 0
    v_accvgpr_write_b32 a150, 0
    v_accvgpr_write_b32 a151, 0
    v_accvgpr_write_b32 a152, 0
    v_accvgpr_write_b32 a153, 0
    v_accvgpr_write_b32 a154, 0
    v_accvgpr_write_b32 a155, 0
    v_accvgpr_write_b32 a156, 0
    v_accvgpr_write_b32 a157, 0
    v_accvgpr_write_b32 a158, 0
    v_accvgpr_write_b32 a159, 0
    v_accvgpr_write_b32 a160, 0
    v_accvgpr_write_b32 a161, 0
    v_accvgpr_write_b32 a162, 0
    v_accvgpr_write_b32 a163, 0
    v_accvgpr_write_b32 a164, 0
    v_accvgpr_write_b32 a165, 0
    v_accvgpr_write_b32 a166, 0
    v_accvgpr_write_b32 a167, 0
    v_accvgpr_write_b32 a168, 0
    v_accvgpr_write_b32 a169, 0
    v_accvgpr_write_b32 a170, 0
    v_accvgpr_write_b32 a171, 0
    v_accvgpr_write_b32 a172, 0
    v_accvgpr_write_b32 a173, 0
    v_accvgpr_write_b32 a174, 0
    v_accvgpr_write_b32 a175, 0
    v_accvgpr_write_b32 a176, 0
    v_accvgpr_write_b32 a177, 0
    v_accvgpr_write_b32 a178, 0
    v_accvgpr_write_b32 a179, 0
    v_accvgpr_write_b32 a180, 0
    v_accvgpr_write_b32 a181, 0
    v_accvgpr_write_b32 a182, 0
    v_accvgpr_write_b32 a183, 0
    v_accvgpr_write_b32 a184, 0
    v_accvgpr_write_b32 a185, 0
    v_accvgpr_write_b32 a186, 0
    v_accvgpr_write_b32 a187, 0
    v_accvgpr_write_b32 a188, 0
    v_accvgpr_write_b32 a189, 0
    v_accvgpr_write_b32 a190, 0
    v_accvgpr_write_b32 a191, 0
    v_accvgpr_write_b32 a192, 0
    v_accvgpr_write_b32 a193, 0
    v_accvgpr_write_b32 a194, 0
    v_accvgpr_write_b32 a195, 0
    v_accvgpr_write_b32 a196, 0
    v_accvgpr_write_b32 a197, 0
    v_accvgpr_write_b32 a198, 0
    v_accvgpr_write_b32 a199, 0
    v_accvgpr_write_b32 a200, 0
    v_accvgpr_write_b32 a201, 0
    v_accvgpr_write_b32 a202, 0
    v_accvgpr_write_b32 a203, 0
    v_accvgpr_write_b32 a204, 0
    v_accvgpr_write_b32 a205, 0
    v_accvgpr_write_b32 a206, 0
    v_accvgpr_write_b32 a207, 0
    v_accvgpr_write_b32 a208, 0
    v_accvgpr_write_b32 a209, 0
    v_accvgpr_write_b32 a210, 0
    v_accvgpr_write_b32 a211, 0
    v_accvgpr_write_b32 a212, 0
    v_accvgpr_write_b32 a213, 0
    v_accvgpr_write_b32 a214, 0
    v_accvgpr_write_b32 a215, 0
    v_accvgpr_write_b32 a216, 0
    v_accvgpr_write_b32 a217, 0
    v_accvgpr_write_b32 a218, 0
    v_accvgpr_write_b32 a219, 0
    v_accvgpr_write_b32 a220, 0
    v_accvgpr_write_b32 a221, 0
    v_accvgpr_write_b32 a222, 0
    v_accvgpr_write_b32 a223, 0
    v_accvgpr_write_b32 a224, 0
    v_accvgpr_write_b32 a225, 0
    v_accvgpr_write_b32 a226, 0
    v_accvgpr_write_b32 a227, 0
    v_accvgpr_write_b32 a228, 0
    v_accvgpr_write_b32 a229, 0
    v_accvgpr_write_b32 a230, 0
    v_accvgpr_write_b32 a231, 0
    v_accvgpr_write_b32 a232, 0
    v_accvgpr_write_b32 a233, 0
    v_accvgpr_write_b32 a234, 0
    v_accvgpr_write_b32 a235, 0
    v_accvgpr_write_b32 a236, 0
    v_accvgpr_write_b32 a237, 0
    v_accvgpr_write_b32 a238, 0
    v_accvgpr_write_b32 a239, 0
    v_accvgpr_write_b32 a240, 0
    v_accvgpr_write_b32 a241, 0
    v_accvgpr_write_b32 a242, 0
    v_accvgpr_write_b32 a243, 0
    v_accvgpr_write_b32 a244, 0
    v_accvgpr_write_b32 a245, 0
    v_accvgpr_write_b32 a246, 0
    v_accvgpr_write_b32 a247, 0
    v_accvgpr_write_b32 a248, 0
    v_accvgpr_write_b32 a249, 0
    v_accvgpr_write_b32 a250, 0
    v_accvgpr_write_b32 a251, 0
    v_accvgpr_write_b32 a252, 0
    v_accvgpr_write_b32 a253, 0
    v_accvgpr_write_b32 a254, 0
    v_accvgpr_write_b32 a255, 0
    s_add_u32 m0, s74, 0
    s_add_u32 s62, s68, 0
    buffer_load_dwordx4 v2, s[16:19], s62 offen lds
    s_add_u32 m0, s74, 1024
    s_add_u32 s62, s68, 32768
    buffer_load_dwordx4 v3, s[16:19], s62 offen lds
    s_add_u32 m0, s74, 2048
    s_add_u32 s62, s68, 65536
    buffer_load_dwordx4 v2, s[16:19], s62 offen lds
    s_add_u32 m0, s74, 3072
    s_add_u32 s62, s68, 98304
    buffer_load_dwordx4 v3, s[16:19], s62 offen lds
    s_add_u32 m0, s74, 4096
    s_add_u32 s62, s68, 131072
    buffer_load_dwordx4 v2, s[16:19], s62 offen lds
    s_add_u32 m0, s74, 5120
    s_add_u32 s62, s68, 163840
    buffer_load_dwordx4 v3, s[16:19], s62 offen lds
    s_add_u32 m0, s74, 6144
    s_add_u32 s62, s68, 196608
    buffer_load_dwordx4 v2, s[16:19], s62 offen lds
    s_add_u32 m0, s74, 7168
    s_add_u32 s62, s68, 229376
    buffer_load_dwordx4 v3, s[16:19], s62 offen lds
    s_add_u32 s68, s68, 262144
    s_mov_b32 s63, s69
    buffer_load_dwordx4 v[92:95], v1, s[56:59], s63 offen sc1
    s_add_u32 s63, s63, s79
    buffer_load_dwordx4 v[96:99], v1, s[56:59], s63 offen sc1
    s_add_u32 s63, s63, s79
    buffer_load_dwordx4 v[100:103], v1, s[56:59], s63 offen sc1
    s_add_u32 s63, s63, s79
    buffer_load_dwordx4 v[104:107], v1, s[56:59], s63 offen sc1
    s_add_u32 s63, s63, s79
    buffer_load_dwordx4 v[108:111], v1, s[56:59], s63 offen sc1
    s_add_u32 s63, s63, s79
    buffer_load_dwordx4 v[112:115], v1, s[56:59], s63 offen sc1
    s_add_u32 s63, s63, s79
    buffer_load_dwordx4 v[116:119], v1, s[56:59], s63 offen sc1
    s_add_u32 s63, s63, s79
    buffer_load_dwordx4 v[120:123], v1, s[56:59], s63 offen sc1
    s_add_u32 s69, s69, 1024
    s_add_u32 m0, s74, 8192
    s_add_u32 s62, s68, 0
    buffer_load_dwordx4 v2, s[16:19], s62 offen lds
    s_add_u32 m0, s74, 9216
    s_add_u32 s62, s68, 32768
    buffer_load_dwordx4 v3, s[16:19], s62 offen lds
    s_add_u32 m0, s74, 10240
    s_add_u32 s62, s68, 65536
    buffer_load_dwordx4 v2, s[16:19], s62 offen lds
    s_add_u32 m0, s74, 11264
    s_add_u32 s62, s68, 98304
    buffer_load_dwordx4 v3, s[16:19], s62 offen lds
    s_add_u32 m0, s74, 12288
    s_add_u32 s62, s68, 131072
    buffer_load_dwordx4 v2, s[16:19], s62 offen lds
    s_add_u32 m0, s74, 13312
    s_add_u32 s62, s68, 163840
    buffer_load_dwordx4 v3, s[16:19], s62 offen lds
    s_add_u32 m0, s74, 14336
    s_add_u32 s62, s68, 196608
    buffer_load_dwordx4 v2, s[16:19], s62 offen lds
    s_add_u32 m0, s74, 15360
    s_add_u32 s62, s68, 229376
    buffer_load_dwordx4 v3, s[16:19], s62 offen lds
    s_add_u32 s68, s68, 262144
    s_mov_b32 s63, s69
    buffer_load_dwordx4 v[124:127], v1, s[56:59], s63 offen sc1
    s_add_u32 s63, s63, s79
    buffer_load_dwordx4 v[128:131], v1, s[56:59], s63 offen sc1
    s_add_u32 s63, s63, s79
    buffer_load_dwordx4 v[132:135], v1, s[56:59], s63 offen sc1
    s_add_u32 s63, s63, s79
    buffer_load_dwordx4 v[136:139], v1, s[56:59], s63 offen sc1
    s_add_u32 s63, s63, s79
    buffer_load_dwordx4 v[140:143], v1, s[56:59], s63 offen sc1
    s_add_u32 s63, s63, s79
    buffer_load_dwordx4 v[144:147], v1, s[56:59], s63 offen sc1
    s_add_u32 s63, s63, s79
    buffer_load_dwordx4 v[148:151], v1, s[56:59], s63 offen sc1
    s_add_u32 s63, s63, s79
    buffer_load_dwordx4 v[152:155], v1, s[56:59], s63 offen sc1
    s_add_u32 s69, s69, 1024
    s_add_u32 m0, s74, 16384
    s_add_u32 s62, s68, 0
    buffer_load_dwordx4 v2, s[16:19], s62 offen lds
    s_add_u32 m0, s74, 17408
    s_add_u32 s62, s68, 32768
    buffer_load_dwordx4 v3, s[16:19], s62 offen lds
    s_add_u32 m0, s74, 18432
    s_add_u32 s62, s68, 65536
    buffer_load_dwordx4 v2, s[16:19], s62 offen lds
    s_add_u32 m0, s74, 19456
    s_add_u32 s62, s68, 98304
    buffer_load_dwordx4 v3, s[16:19], s62 offen lds
    s_add_u32 m0, s74, 20480
    s_add_u32 s62, s68, 131072
    buffer_load_dwordx4 v2, s[16:19], s62 offen lds
    s_add_u32 m0, s74, 21504
    s_add_u32 s62, s68, 163840
    buffer_load_dwordx4 v3, s[16:19], s62 offen lds
    s_add_u32 m0, s74, 22528
    s_add_u32 s62, s68, 196608
    buffer_load_dwordx4 v2, s[16:19], s62 offen lds
    s_add_u32 m0, s74, 23552
    s_add_u32 s62, s68, 229376
    buffer_load_dwordx4 v3, s[16:19], s62 offen lds
    s_add_u32 s68, s68, 262144
    s_waitcnt vmcnt(32)
    ds_read_b64_tr_b16 v[28:29], v4
    ds_read_b64_tr_b16 v[30:31], v4 offset:4096
    ds_read_b64_tr_b16 v[32:33], v5
    ds_read_b64_tr_b16 v[34:35], v5 offset:4096
    ds_read_b64_tr_b16 v[36:37], v6
    ds_read_b64_tr_b16 v[38:39], v6 offset:4096
    ds_read_b64_tr_b16 v[40:41], v7
    ds_read_b64_tr_b16 v[42:43], v7 offset:4096
    ds_read_b64_tr_b16 v[44:45], v8
    ds_read_b64_tr_b16 v[46:47], v8 offset:4096
    ds_read_b64_tr_b16 v[48:49], v9
    ds_read_b64_tr_b16 v[50:51], v9 offset:4096
    ds_read_b64_tr_b16 v[52:53], v10
    ds_read_b64_tr_b16 v[54:55], v10 offset:4096
    ds_read_b64_tr_b16 v[56:57], v11
    ds_read_b64_tr_b16 v[58:59], v11 offset:4096
    s_mov_b32 s70, 0
L_gq_loop:
    s_waitcnt vmcnt(16) lgkmcnt(0)
    v_mfma_f32_16x16x32_bf16 a[0:3], v[28:31], v[92:95], a[0:3]
    ds_read_b64_tr_b16 v[60:61], v4 offset:8192
    v_mfma_f32_16x16x32_bf16 a[4:7], v[28:31], v[96:99], a[4:7]
    ds_read_b64_tr_b16 v[62:63], v4 offset:12288
    v_mfma_f32_16x16x32_bf16 a[8:11], v[28:31], v[100:103], a[8:11]
    ds_read_b64_tr_b16 v[64:65], v5 offset:8192
    v_mfma_f32_16x16x32_bf16 a[12:15], v[28:31], v[104:107], a[12:15]
    ds_read_b64_tr_b16 v[66:67], v5 offset:12288
    v_mfma_f32_16x16x32_bf16 a[16:19], v[28:31], v[108:111], a[16:19]
    ds_read_b64_tr_b16 v[68:69], v6 offset:8192
    v_mfma_f32_16x16x32_bf16 a[20:23], v[28:31], v[112:115], a[20:23]
    ds_read_b64_tr_b16 v[70:71], v6 offset:12288
    v_mfma_f32_16x16x32_bf16 a[24:27], v[28:31], v[116:119], a[24:27]
    ds_read_b64_tr_b16 v[72:73], v7 offset:8192
    v_mfma_f32_16x16x32_bf16 a[28:31], v[28:31], v[120:123], a[28:31]
    ds_read_b64_tr_b16 v[74:75], v7 offset:12288
    v_mfma_f32_16x16x32_bf16 a[32:35], v[32:35], v[92:95], a[32:35]
    ds_read_b64_tr_b16 v[76:77], v8 offset:8192
    v_mfma_f32_16x16x32_bf16 a[36:39], v[32:35], v[96:99], a[36:39]
    ds_read_b64_tr_b16 v[78:79], v8 offset:12288
    v_mfma_f32_16x16x32_bf16 a[40:43], v[32:35], v[100:103], a[40:43]
    ds_read_b64_tr_b16 v[80:81], v9 offset:8192
    v_mfma_f32_16x16x32_bf16 a[44:47], v[32:35], v[104:107], a[44:47]
    ds_read_b64_tr_b16 v[82:83], v9 offset:12288
    v_mfma_f32_16x16x32_bf16 a[48:51], v[32:35], v[108:111], a[48:51]
    ds_read_b64_tr_b16 v[84:85], v10 offset:8192
    v_mfma_f32_16x16x32_bf16 a[52:55], v[32:35], v[112:115], a[52:55]
    ds_read_b64_tr_b16 v[86:87], v10 offset:12288
    v_mfma_f32_16x16x32_bf16 a[56:59], v[32:35], v[116:119], a[56:59]
    ds_read_b64_tr_b16 v[88:89], v11 offset:8192
    v_mfma_f32_16x16x32_bf16 a[60:63], v[32:35], v[120:123], a[60:63]
    ds_read_b64_tr_b16 v[90:91], v11 offset:12288
    v_mfma_f32_16x16x32_bf16 a[64:67], v[36:39], v[92:95], a[64:67]
    s_mov_b32 s63, s69
    v_mfma_f32_16x16x32_bf16 a[68:71], v[36:39], v[96:99], a[68:71]
    buffer_load_dwordx4 v[156:159], v1, s[56:59], s63 offen sc1
    v_mfma_f32_16x16x32_bf16 a[72:75], v[36:39], v[100:103], a[72:75]
    s_add_u32 s63, s63, s79
    v_mfma_f32_16x16x32_bf16 a[76:79], v[36:39], v[104:107], a[76:79]
    buffer_load_dwordx4 v[160:163], v1, s[56:59], s63 offen sc1
    v_mfma_f32_16x16x32_bf16 a[80:83], v[36:39], v[108:111], a[80:83]
    s_add_u32 s63, s63, s79
    v_mfma_f32_16x16x32_bf16 a[84:87], v[36:39], v[112:115], a[84:87]
    buffer_load_dwordx4 v[164:167], v1, s[56:59], s63 offen sc1
    v_mfma_f32_16x16x32_bf16 a[88:91], v[36:39], v[116:119], a[88:91]
    s_add_u32 s63, s63, s79
    v_mfma_f32_16x16x32_bf16 a[92:95], v[36:39], v[120:123], a[92:95]
    buffer_load_dwordx4 v[168:171], v1, s[56:59], s63 offen sc1
    v_mfma_f32_16x16x32_bf16 a[96:99], v[40:43], v[92:95], a[96:99]
    s_add_u32 s63, s63, s79
    v_mfma_f32_16x16x32_bf16 a[100:103], v[40:43], v[96:99], a[100:103]
    buffer_load_dwordx4 v[172:175], v1, s[56:59], s63 offen sc1
    v_mfma_f32_16x16x32_bf16 a[104:107], v[40:43], v[100:103], a[104:107]
    s_add_u32 s63, s63, s79
    v_mfma_f32_16x16x32_bf16 a[108:111], v[40:43], v[104:107], a[108:111]
    buffer_load_dwordx4 v[176:179], v1, s[56:59], s63 offen sc1
    v_mfma_f32_16x16x32_bf16 a[112:115], v[40:43], v[108:111], a[112:115]
    s_add_u32 s63, s63, s79
    v_mfma_f32_16x16x32_bf16 a[116:119], v[40:43], v[112:115], a[116:119]
    buffer_load_dwordx4 v[180:183], v1, s[56:59], s63 offen sc1
    v_mfma_f32_16x16x32_bf16 a[120:123], v[40:43], v[116:119], a[120:123]
    s_add_u32 s63, s63, s79
    v_mfma_f32_16x16x32_bf16 a[124:127], v[40:43], v[120:123], a[124:127]
    buffer_load_dwordx4 v[184:187], v1, s[56:59], s63 offen sc1
    v_mfma_f32_16x16x32_bf16 a[128:131], v[44:47], v[92:95], a[128:131]
    s_add_u32 s69, s69, 1024
    v_mfma_f32_16x16x32_bf16 a[132:135], v[44:47], v[96:99], a[132:135]
    s_add_u32 m0, s74, 24576
    v_mfma_f32_16x16x32_bf16 a[136:139], v[44:47], v[100:103], a[136:139]
    s_add_u32 s62, s68, 0
    v_mfma_f32_16x16x32_bf16 a[140:143], v[44:47], v[104:107], a[140:143]
    buffer_load_dwordx4 v2, s[16:19], s62 offen lds
    v_mfma_f32_16x16x32_bf16 a[144:147], v[44:47], v[108:111], a[144:147]
    s_add_u32 m0, s74, 25600
    v_mfma_f32_16x16x32_bf16 a[148:151], v[44:47], v[112:115], a[148:151]
    s_add_u32 s62, s68, 32768
    v_mfma_f32_16x16x32_bf16 a[152:155], v[44:47], v[116:119], a[152:155]
    buffer_load_dwordx4 v3, s[16:19], s62 offen lds
    v_mfma_f32_16x16x32_bf16 a[156:159], v[44:47], v[120:123], a[156:159]
    s_add_u32 m0, s74, 26624
    v_mfma_f32_16x16x32_bf16 a[160:163], v[48:51], v[92:95], a[160:163]
    s_add_u32 s62, s68, 65536
    v_mfma_f32_16x16x32_bf16 a[164:167], v[48:51], v[96:99], a[164:167]
    buffer_load_dwordx4 v2, s[16:19], s62 offen lds
    v_mfma_f32_16x16x32_bf16 a[168:171], v[48:51], v[100:103], a[168:171]
    s_add_u32 m0, s74, 27648
    v_mfma_f32_16x16x32_bf16 a[172:175], v[48:51], v[104:107], a[172:175]
    s_add_u32 s62, s68, 98304
    v_mfma_f32_16x16x32_bf16 a[176:179], v[48:51], v[108:111], a[176:179]
    buffer_load_dwordx4 v3, s[16:19], s62 offen lds
    v_mfma_f32_16x16x32_bf16 a[180:183], v[48:51], v[112:115], a[180:183]
    s_add_u32 m0, s74, 28672
    v_mfma_f32_16x16x32_bf16 a[184:187], v[48:51], v[116:119], a[184:187]
    s_add_u32 s62, s68, 131072
    v_mfma_f32_16x16x32_bf16 a[188:191], v[48:51], v[120:123], a[188:191]
    buffer_load_dwordx4 v2, s[16:19], s62 offen lds
    v_mfma_f32_16x16x32_bf16 a[192:195], v[52:55], v[92:95], a[192:195]
    s_add_u32 m0, s74, 29696
    v_mfma_f32_16x16x32_bf16 a[196:199], v[52:55], v[96:99], a[196:199]
    s_add_u32 s62, s68, 163840
    v_mfma_f32_16x16x32_bf16 a[200:203], v[52:55], v[100:103], a[200:203]
    buffer_load_dwordx4 v3, s[16:19], s62 offen lds
    v_mfma_f32_16x16x32_bf16 a[204:207], v[52:55], v[104:107], a[204:207]
    s_add_u32 m0, s74, 30720
    v_mfma_f32_16x16x32_bf16 a[208:211], v[52:55], v[108:111], a[208:211]
    s_add_u32 s62, s68, 196608
    v_mfma_f32_16x16x32_bf16 a[212:215], v[52:55], v[112:115], a[212:215]
    buffer_load_dwordx4 v2, s[16:19], s62 offen lds
    v_mfma_f32_16x16x32_bf16 a[216:219], v[52:55], v[116:119], a[216:219]
    s_add_u32 m0, s74, 31744
    v_mfma_f32_16x16x32_bf16 a[220:223], v[52:55], v[120:123], a[220:223]
    s_add_u32 s62, s68, 229376
    v_mfma_f32_16x16x32_bf16 a[224:227], v[56:59], v[92:95], a[224:227]
    buffer_load_dwordx4 v3, s[16:19], s62 offen lds
    v_mfma_f32_16x16x32_bf16 a[228:231], v[56:59], v[96:99], a[228:231]
    s_add_u32 s68, s68, 262144
    v_mfma_f32_16x16x32_bf16 a[232:235], v[56:59], v[100:103], a[232:235]
    v_mfma_f32_16x16x32_bf16 a[236:239], v[56:59], v[104:107], a[236:239]
    v_mfma_f32_16x16x32_bf16 a[240:243], v[56:59], v[108:111], a[240:243]
    v_mfma_f32_16x16x32_bf16 a[244:247], v[56:59], v[112:115], a[244:247]
    v_mfma_f32_16x16x32_bf16 a[248:251], v[56:59], v[116:119], a[248:251]
    v_mfma_f32_16x16x32_bf16 a[252:255], v[56:59], v[120:123], a[252:255]
    s_waitcnt vmcnt(16) lgkmcnt(0)
    v_mfma_f32_16x16x32_bf16 a[0:3], v[60:63], v[124:127], a[0:3]
    ds_read_b64_tr_b16 v[28:29], v4 offset:16384
    v_mfma_f32_16x16x32_bf16 a[4:7], v[60:63], v[128:131], a[4:7]
    ds_read_b64_tr_b16 v[30:31], v4 offset:20480
    v_mfma_f32_16x16x32_bf16 a[8:11], v[60:63], v[132:135], a[8:11]
    ds_read_b64_tr_b16 v[32:33], v5 offset:16384
    v_mfma_f32_16x16x32_bf16 a[12:15], v[60:63], v[136:139], a[12:15]
    ds_read_b64_tr_b16 v[34:35], v5 offset:20480
    v_mfma_f32_16x16x32_bf16 a[16:19], v[60:63], v[140:143], a[16:19]
    ds_read_b64_tr_b16 v[36:37], v6 offset:16384
    v_mfma_f32_16x16x32_bf16 a[20:23], v[60:63], v[144:147], a[20:23]
    ds_read_b64_tr_b16 v[38:39], v6 offset:20480
    v_mfma_f32_16x16x32_bf16 a[24:27], v[60:63], v[148:151], a[24:27]
    ds_read_b64_tr_b16 v[40:41], v7 offset:16384
    v_mfma_f32_16x16x32_bf16 a[28:31], v[60:63], v[152:155], a[28:31]
    ds_read_b64_tr_b16 v[42:43], v7 offset:20480
    v_mfma_f32_16x16x32_bf16 a[32:35], v[64:67], v[124:127], a[32:35]
    ds_read_b64_tr_b16 v[44:45], v8 offset:16384
    v_mfma_f32_16x16x32_bf16 a[36:39], v[64:67], v[128:131], a[36:39]
    ds_read_b64_tr_b16 v[46:47], v8 offset:20480
    v_mfma_f32_16x16x32_bf16 a[40:43], v[64:67], v[132:135], a[40:43]
    ds_read_b64_tr_b16 v[48:49], v9 offset:16384
    v_mfma_f32_16x16x32_bf16 a[44:47], v[64:67], v[136:139], a[44:47]
    ds_read_b64_tr_b16 v[50:51], v9 offset:20480
    v_mfma_f32_16x16x32_bf16 a[48:51], v[64:67], v[140:143], a[48:51]
    ds_read_b64_tr_b16 v[52:53], v10 offset:16384
    v_mfma_f32_16x16x32_bf16 a[52:55], v[64:67], v[144:147], a[52:55]
    ds_read_b64_tr_b16 v[54:55], v10 offset:20480
    v_mfma_f32_16x16x32_bf16 a[56:59], v[64:67], v[148:151], a[56:59]
    ds_read_b64_tr_b16 v[56:57], v11 offset:16384
    v_mfma_f32_16x16x32_bf16 a[60:63], v[64:67], v[152:155], a[60:63]
    ds_read_b64_tr_b16 v[58:59], v11 offset:20480
    v_mfma_f32_16x16x32_bf16 a[64:67], v[68:71], v[124:127], a[64:67]
    s_mov_b32 s63, s69
    v_mfma_f32_16x16x32_bf16 a[68:71], v[68:71], v[128:131], a[68:71]
    buffer_load_dwordx4 v[188:191], v1, s[56:59], s63 offen sc1
    v_mfma_f32_16x16x32_bf16 a[72:75], v[68:71], v[132:135], a[72:75]
    s_add_u32 s63, s63, s79
    v_mfma_f32_16x16x32_bf16 a[76:79], v[68:71], v[136:139], a[76:79]
    buffer_load_dwordx4 v[192:195], v1, s[56:59], s63 offen sc1
    v_mfma_f32_16x16x32_bf16 a[80:83], v[68:71], v[140:143], a[80:83]
    s_add_u32 s63, s63, s79
    v_mfma_f32_16x16x32_bf16 a[84:87], v[68:71], v[144:147], a[84:87]
    buffer_load_dwordx4 v[196:199], v1, s[56:59], s63 offen sc1
    v_mfma_f32_16x16x32_bf16 a[88:91], v[68:71], v[148:151], a[88:91]
    s_add_u32 s63, s63, s79
    v_mfma_f32_16x16x32_bf16 a[92:95], v[68:71], v[152:155], a[92:95]
    buffer_load_dwordx4 v[200:203], v1, s[56:59], s63 offen sc1
    v_mfma_f32_16x16x32_bf16 a[96:99], v[72:75], v[124:127], a[96:99]
    s_add_u32 s63, s63, s79
    v_mfma_f32_16x16x32_bf16 a[100:103], v[72:75], v[128:131], a[100:103]
    buffer_load_dwordx4 v[204:207], v1, s[56:59], s63 offen sc1
    v_mfma_f32_16x16x32_bf16 a[104:107], v[72:75], v[132:135], a[104:107]
    s_add_u32 s63, s63, s79
    v_mfma_f32_16x16x32_bf16 a[108:111], v[72:75], v[136:139], a[108:111]
    buffer_load_dwordx4 v[208:211], v1, s[56:59], s63 offen sc1
    v_mfma_f32_16x16x32_bf16 a[112:115], v[72:75], v[140:143], a[112:115]
    s_add_u32 s63, s63, s79
    v_mfma_f32_16x16x32_bf16 a[116:119], v[72:75], v[144:147], a[116:119]
    buffer_load_dwordx4 v[212:215], v1, s[56:59], s63 offen sc1
    v_mfma_f32_16x16x32_bf16 a[120:123], v[72:75], v[148:151], a[120:123]
    s_add_u32 s63, s63, s79
    v_mfma_f32_16x16x32_bf16 a[124:127], v[72:75], v[152:155], a[124:127]
    buffer_load_dwordx4 v[216:219], v1, s[56:59], s63 offen sc1
    v_mfma_f32_16x16x32_bf16 a[128:131], v[76:79], v[124:127], a[128:131]
    s_add_u32 s69, s69, 1024
    v_mfma_f32_16x16x32_bf16 a[132:135], v[76:79], v[128:131], a[132:135]
    s_add_u32 m0, s74, 0
    v_mfma_f32_16x16x32_bf16 a[136:139], v[76:79], v[132:135], a[136:139]
    s_add_u32 s62, s68, 0
    v_mfma_f32_16x16x32_bf16 a[140:143], v[76:79], v[136:139], a[140:143]
    buffer_load_dwordx4 v2, s[16:19], s62 offen lds
    v_mfma_f32_16x16x32_bf16 a[144:147], v[76:79], v[140:143], a[144:147]
    s_add_u32 m0, s74, 1024
    v_mfma_f32_16x16x32_bf16 a[148:151], v[76:79], v[144:147], a[148:151]
    s_add_u32 s62, s68, 32768
    v_mfma_f32_16x16x32_bf16 a[152:155], v[76:79], v[148:151], a[152:155]
    buffer_load_dwordx4 v3, s[16:19], s62 offen lds
    v_mfma_f32_16x16x32_bf16 a[156:159], v[76:79], v[152:155], a[156:159]
    s_add_u32 m0, s74, 2048
    v_mfma_f32_16x16x32_bf16 a[160:163], v[80:83], v[124:127], a[160:163]
    s_add_u32 s62, s68, 65536
    v_mfma_f32_16x16x32_bf16 a[164:167], v[80:83], v[128:131], a[164:167]
    buffer_load_dwordx4 v2, s[16:19], s62 offen lds
    v_mfma_f32_16x16x32_bf16 a[168:171], v[80:83], v[132:135], a[168:171]
    s_add_u32 m0, s74, 3072
    v_mfma_f32_16x16x32_bf16 a[172:175], v[80:83], v[136:139], a[172:175]
    s_add_u32 s62, s68, 98304
    v_mfma_f32_16x16x32_bf16 a[176:179], v[80:83], v[140:143], a[176:179]
    buffer_load_dwordx4 v3, s[16:19], s62 offen lds
    v_mfma_f32_16x16x32_bf16 a[180:183], v[80:83], v[144:147], a[180:183]
    s_add_u32 m0, s74, 4096
    v_mfma_f32_16x16x32_bf16 a[184:187], v[80:83], v[148:151], a[184:187]
    s_add_u32 s62, s68, 131072
    v_mfma_f32_16x16x32_bf16 a[188:191], v[80:83], v[152:155], a[188:191]
    buffer_load_dwordx4 v2, s[16:19], s62 offen lds
    v_mfma_f32_16x16x32_bf16 a[192:195], v[84:87], v[124:127], a[192:195]
    s_add_u32 m0, s74, 5120
    v_mfma_f32_16x16x32_bf16 a[196:199], v[84:87], v[128:131], a[196:199]
    s_add_u32 s62, s68, 163840
    v_mfma_f32_16x16x32_bf16 a[200:203], v[84:87], v[132:135], a[200:203]
    buffer_load_dwordx4 v3, s[16:19], s62 offen lds
    v_mfma_f32_16x16x32_bf16 a[204:207], v[84:87], v[136:139], a[204:207]
    s_add_u32 m0, s74, 6144
    v_mfma_f32_16x16x32_bf16 a[208:211], v[84:87], v[140:143], a[208:211]
    s_add_u32 s62, s68, 196608
    v_mfma_f32_16x16x32_bf16 a[212:215], v[84:87], v[144:147], a[212:215]
    buffer_load_dwordx4 v2, s[16:19], s62 offen lds
    v_mfma_f32_16x16x32_bf16 a[216:219], v[84:87], v[148:151], a[216:219]
    s_add_u32 m0, s74, 7168
    v_mfma_f32_16x16x32_bf16 a[220:223], v[84:87], v[152:155], a[220:223]
    s_add_u32 s62, s68, 229376
    v_mfma_f32_16x16x32_bf16 a[224:227], v[88:91], v[124:127], a[224:227]
    buffer_load_dwordx4 v3, s[16:19], s62 offen lds
    v_mfma_f32_16x16x32_bf16 a[228:231], v[88:91], v[128:131], a[228:231]
    s_add_u32 s68, s68, 262144
    v_mfma_f32_16x16x32_bf16 a[232:235], v[88:91], v[132:135], a[232:235]
    v_mfma_f32_16x16x32_bf16 a[236:239], v[88:91], v[136:139], a[236:239]
    v_mfma_f32_16x16x32_bf16 a[240:243], v[88:91], v[140:143], a[240:243]
    v_mfma_f32_16x16x32_bf16 a[244:247], v[88:91], v[144:147], a[244:247]
    v_mfma_f32_16x16x32_bf16 a[248:251], v[88:91], v[148:151], a[248:251]
    v_mfma_f32_16x16x32_bf16 a[252:255], v[88:91], v[152:155], a[252:255]
    s_waitcnt vmcnt(16) lgkmcnt(0)
    v_mfma_f32_16x16x32_bf16 a[0:3], v[28:31], v[156:159], a[0:3]
    ds_read_b64_tr_b16 v[60:61], v4 offset:24576
    v_mfma_f32_16x16x32_bf16 a[4:7], v[28:31], v[160:163], a[4:7]
    ds_read_b64_tr_b16 v[62:63], v4 offset:28672
    v_mfma_f32_16x16x32_bf16 a[8:11], v[28:31], v[164:167], a[8:11]
    ds_read_b64_tr_b16 v[64:65], v5 offset:24576
    v_mfma_f32_16x16x32_bf16 a[12:15], v[28:31], v[168:171], a[12:15]
    ds_read_b64_tr_b16 v[66:67], v5 offset:28672
    v_mfma_f32_16x16x32_bf16 a[16:19], v[28:31], v[172:175], a[16:19]
    ds_read_b64_tr_b16 v[68:69], v6 offset:24576
    v_mfma_f32_16x16x32_bf16 a[20:23], v[28:31], v[176:179], a[20:23]
    ds_read_b64_tr_b16 v[70:71], v6 offset:28672
    v_mfma_f32_16x16x32_bf16 a[24:27], v[28:31], v[180:183], a[24:27]
    ds_read_b64_tr_b16 v[72:73], v7 offset:24576
    v_mfma_f32_16x16x32_bf16 a[28:31], v[28:31], v[184:187], a[28:31]
    ds_read_b64_tr_b16 v[74:75], v7 offset:28672
    v_mfma_f32_16x16x32_bf16 a[32:35], v[32:35], v[156:159], a[32:35]
    ds_read_b64_tr_b16 v[76:77], v8 offset:24576
    v_mfma_f32_16x16x32_bf16 a[36:39], v[32:35], v[160:163], a[36:39]
    ds_read_b64_tr_b16 v[78:79], v8 offset:28672
    v_mfma_f32_16x16x32_bf16 a[40:43], v[32:35], v[164:167], a[40:43]
    ds_read_b64_tr_b16 v[80:81], v9 offset:24576
    v_mfma_f32_16x16x32_bf16 a[44:47], v[32:35], v[168:171], a[44:47]
    ds_read_b64_tr_b16 v[82:83], v9 offset:28672
    v_mfma_f32_16x16x32_bf16 a[48:51], v[32:35], v[172:175], a[48:51]
    ds_read_b64_tr_b16 v[84:85], v10 offset:24576
    v_mfma_f32_16x16x32_bf16 a[52:55], v[32:35], v[176:179], a[52:55]
    ds_read_b64_tr_b16 v[86:87], v10 offset:28672
    v_mfma_f32_16x16x32_bf16 a[56:59], v[32:35], v[180:183], a[56:59]
    ds_read_b64_tr_b16 v[88:89], v11 offset:24576
    v_mfma_f32_16x16x32_bf16 a[60:63], v[32:35], v[184:187], a[60:63]
    ds_read_b64_tr_b16 v[90:91], v11 offset:28672
    v_mfma_f32_16x16x32_bf16 a[64:67], v[36:39], v[156:159], a[64:67]
    s_mov_b32 s63, s69
    v_mfma_f32_16x16x32_bf16 a[68:71], v[36:39], v[160:163], a[68:71]
    buffer_load_dwordx4 v[92:95], v1, s[56:59], s63 offen sc1
    v_mfma_f32_16x16x32_bf16 a[72:75], v[36:39], v[164:167], a[72:75]
    s_add_u32 s63, s63, s79
    v_mfma_f32_16x16x32_bf16 a[76:79], v[36:39], v[168:171], a[76:79]
    buffer_load_dwordx4 v[96:99], v1, s[56:59], s63 offen sc1
    v_mfma_f32_16x16x32_bf16 a[80:83], v[36:39], v[172:175], a[80:83]
    s_add_u32 s63, s63, s79
    v_mfma_f32_16x16x32_bf16 a[84:87], v[36:39], v[176:179], a[84:87]
    buffer_load_dwordx4 v[100:103], v1, s[56:59], s63 offen sc1
    v_mfma_f32_16x16x32_bf16 a[88:91], v[36:39], v[180:183], a[88:91]
    s_add_u32 s63, s63, s79
    v_mfma_f32_16x16x32_bf16 a[92:95], v[36:39], v[184:187], a[92:95]
    buffer_load_dwordx4 v[104:107], v1, s[56:59], s63 offen sc1
    v_mfma_f32_16x16x32_bf16 a[96:99], v[40:43], v[156:159], a[96:99]
    s_add_u32 s63, s63, s79
    v_mfma_f32_16x16x32_bf16 a[100:103], v[40:43], v[160:163], a[100:103]
    buffer_load_dwordx4 v[108:111], v1, s[56:59], s63 offen sc1
    v_mfma_f32_16x16x32_bf16 a[104:107], v[40:43], v[164:167], a[104:107]
    s_add_u32 s63, s63, s79
    v_mfma_f32_16x16x32_bf16 a[108:111], v[40:43], v[168:171], a[108:111]
    buffer_load_dwordx4 v[112:115], v1, s[56:59], s63 offen sc1
    v_mfma_f32_16x16x32_bf16 a[112:115], v[40:43], v[172:175], a[112:115]
    s_add_u32 s63, s63, s79
    v_mfma_f32_16x16x32_bf16 a[116:119], v[40:43], v[176:179], a[116:119]
    buffer_load_dwordx4 v[116:119], v1, s[56:59], s63 offen sc1
    v_mfma_f32_16x16x32_bf16 a[120:123], v[40:43], v[180:183], a[120:123]
    s_add_u32 s63, s63, s79
    v_mfma_f32_16x16x32_bf16 a[124:127], v[40:43], v[184:187], a[124:127]
    buffer_load_dwordx4 v[120:123], v1, s[56:59], s63 offen sc1
    v_mfma_f32_16x16x32_bf16 a[128:131], v[44:47], v[156:159], a[128:131]
    s_add_u32 s69, s69, 1024
    v_mfma_f32_16x16x32_bf16 a[132:135], v[44:47], v[160:163], a[132:135]
    s_add_u32 m0, s74, 8192
    v_mfma_f32_16x16x32_bf16 a[136:139], v[44:47], v[164:167], a[136:139]
    s_add_u32 s62, s68, 0
    v_mfma_f32_16x16x32_bf16 a[140:143], v[44:47], v[168:171], a[140:143]
    buffer_load_dwordx4 v2, s[16:19], s62 offen lds
    v_mfma_f32_16x16x32_bf16 a[144:147], v[44:47], v[172:175], a[144:147]
    s_add_u32 m0, s74, 9216
    v_mfma_f32_16x16x32_bf16 a[148:151], v[44:47], v[176:179], a[148:151]
    s_add_u32 s62, s68, 32768
    v_mfma_f32_16x16x32_bf16 a[152:155], v[44:47], v[180:183], a[152:155]
    buffer_load_dwordx4 v3, s[16:19], s62 offen lds
    v_mfma_f32_16x16x32_bf16 a[156:159], v[44:47], v[184:187], a[156:159]
    s_add_u32 m0, s74, 10240
    v_mfma_f32_16x16x32_bf16 a[160:163], v[48:51], v[156:159], a[160:163]
    s_add_u32 s62, s68, 65536
    v_mfma_f32_16x16x32_bf16 a[164:167], v[48:51], v[160:163], a[164:167]
    buffer_load_dwordx4 v2, s[16:19], s62 offen lds
    v_mfma_f32_16x16x32_bf16 a[168:171], v[48:51], v[164:167], a[168:171]
    s_add_u32 m0, s74, 11264
    v_mfma_f32_16x16x32_bf16 a[172:175], v[48:51], v[168:171], a[172:175]
    s_add_u32 s62, s68, 98304
    v_mfma_f32_16x16x32_bf16 a[176:179], v[48:51], v[172:175], a[176:179]
    buffer_load_dwordx4 v3, s[16:19], s62 offen lds
    v_mfma_f32_16x16x32_bf16 a[180:183], v[48:51], v[176:179], a[180:183]
    s_add_u32 m0, s74, 12288
    v_mfma_f32_16x16x32_bf16 a[184:187], v[48:51], v[180:183], a[184:187]
    s_add_u32 s62, s68, 131072
    v_mfma_f32_16x16x32_bf16 a[188:191], v[48:51], v[184:187], a[188:191]
    buffer_load_dwordx4 v2, s[16:19], s62 offen lds
    v_mfma_f32_16x16x32_bf16 a[192:195], v[52:55], v[156:159], a[192:195]
    s_add_u32 m0, s74, 13312
    v_mfma_f32_16x16x32_bf16 a[196:199], v[52:55], v[160:163], a[196:199]
    s_add_u32 s62, s68, 163840
    v_mfma_f32_16x16x32_bf16 a[200:203], v[52:55], v[164:167], a[200:203]
    buffer_load_dwordx4 v3, s[16:19], s62 offen lds
    v_mfma_f32_16x16x32_bf16 a[204:207], v[52:55], v[168:171], a[204:207]
    s_add_u32 m0, s74, 14336
    v_mfma_f32_16x16x32_bf16 a[208:211], v[52:55], v[172:175], a[208:211]
    s_add_u32 s62, s68, 196608
    v_mfma_f32_16x16x32_bf16 a[212:215], v[52:55], v[176:179], a[212:215]
    buffer_load_dwordx4 v2, s[16:19], s62 offen lds
    v_mfma_f32_16x16x32_bf16 a[216:219], v[52:55], v[180:183], a[216:219]
    s_add_u32 m0, s74, 15360
    v_mfma_f32_16x16x32_bf16 a[220:223], v[52:55], v[184:187], a[220:223]
    s_add_u32 s62, s68, 229376
    v_mfma_f32_16x16x32_bf16 a[224:227], v[56:59], v[156:159], a[224:227]
    buffer_load_dwordx4 v3, s[16:19], s62 offen lds
    v_mfma_f32_16x16x32_bf16 a[228:231], v[56:59], v[160:163], a[228:231]
    s_add_u32 s68, s68, 262144
    v_mfma_f32_16x16x32_bf16 a[232:235], v[56:59], v[164:167], a[232:235]
    v_mfma_f32_16x16x32_bf16 a[236:239], v[56:59], v[168:171], a[236:239]
    v_mfma_f32_16x16x32_bf16 a[240:243], v[56:59], v[172:175], a[240:243]
    v_mfma_f32_16x16x32_bf16 a[244:247], v[56:59], v[176:179], a[244:247]
    v_mfma_f32_16x16x32_bf16 a[248:251], v[56:59], v[180:183], a[248:251]
    v_mfma_f32_16x16x32_bf16 a[252:255], v[56:59], v[184:187], a[252:255]
    s_waitcnt vmcnt(16) lgkmcnt(0)
    v_mfma_f32_16x16x32_bf16 a[0:3], v[60:63], v[188:191], a[0:3]
    ds_read_b64_tr_b16 v[28:29], v4
    v_mfma_f32_16x16x32_bf16 a[4:7], v[60:63], v[192:195], a[4:7]
    ds_read_b64_tr_b16 v[30:31], v4 offset:4096
    v_mfma_f32_16x16x32_bf16 a[8:11], v[60:63], v[196:199], a[8:11]
    ds_read_b64_tr_b16 v[32:33], v5
    v_mfma_f32_16x16x32_bf16 a[12:15], v[60:63], v[200:203], a[12:15]
    ds_read_b64_tr_b16 v[34:35], v5 offset:4096
    v_mfma_f32_16x16x32_bf16 a[16:19], v[60:63], v[204:207], a[16:19]
    ds_read_b64_tr_b16 v[36:37], v6
    v_mfma_f32_16x16x32_bf16 a[20:23], v[60:63], v[208:211], a[20:23]
    ds_read_b64_tr_b16 v[38:39], v6 offset:4096
    v_mfma_f32_16x16x32_bf16 a[24:27], v[60:63], v[212:215], a[24:27]
    ds_read_b64_tr_b16 v[40:41], v7
    v_mfma_f32_16x16x32_bf16 a[28:31], v[60:63], v[216:219], a[28:31]
    ds_read_b64_tr_b16 v[42:43], v7 offset:4096
    v_mfma_f32_16x16x32_bf16 a[32:35], v[64:67], v[188:191], a[32:35]
    ds_read_b64_tr_b16 v[44:45], v8
    v_mfma_f32_16x16x32_bf16 a[36:39], v[64:67], v[192:195], a[36:39]
    ds_read_b64_tr_b16 v[46:47], v8 offset:4096
    v_mfma_f32_16x16x32_bf16 a[40:43], v[64:67], v[196:199], a[40:43]
    ds_read_b64_tr_b16 v[48:49], v9
    v_mfma_f32_16x16x32_bf16 a[44:47], v[64:67], v[200:203], a[44:47]
    ds_read_b64_tr_b16 v[50:51], v9 offset:4096
    v_mfma_f32_16x16x32_bf16 a[48:51], v[64:67], v[204:207], a[48:51]
    ds_read_b64_tr_b16 v[52:53], v10
    v_mfma_f32_16x16x32_bf16 a[52:55], v[64:67], v[208:211], a[52:55]
    ds_read_b64_tr_b16 v[54:55], v10 offset:4096
    v_mfma_f32_16x16x32_bf16 a[56:59], v[64:67], v[212:215], a[56:59]
    ds_read_b64_tr_b16 v[56:57], v11
    v_mfma_f32_16x16x32_bf16 a[60:63], v[64:67], v[216:219], a[60:63]
    ds_read_b64_tr_b16 v[58:59], v11 offset:4096
    v_mfma_f32_16x16x32_bf16 a[64:67], v[68:71], v[188:191], a[64:67]
    s_mov_b32 s63, s69
    v_mfma_f32_16x16x32_bf16 a[68:71], v[68:71], v[192:195], a[68:71]
    buffer_load_dwordx4 v[124:127], v1, s[56:59], s63 offen sc1
    v_mfma_f32_16x16x32_bf16 a[72:75], v[68:71], v[196:199], a[72:75]
    s_add_u32 s63, s63, s79
    v_mfma_f32_16x16x32_bf16 a[76:79], v[68:71], v[200:203], a[76:79]
    buffer_load_dwordx4 v[128:131], v1, s[56:59], s63 offen sc1
    v_mfma_f32_16x16x32_bf16 a[80:83], v[68:71], v[204:207], a[80:83]
    s_add_u32 s63, s63, s79
    v_mfma_f32_16x16x32_bf16 a[84:87], v[68:71], v[208:211], a[84:87]
    buffer_load_dwordx4 v[132:135], v1, s[56:59], s63 offen sc1
    v_mfma_f32_16x16x32_bf16 a[88:91], v[68:71], v[212:215], a[88:91]
    s_add_u32 s63, s63, s79
    v_mfma_f32_16x16x32_bf16 a[92:95], v[68:71], v[216:219], a[92:95]
    buffer_load_dwordx4 v[136:139], v1, s[56:59], s63 offen sc1
    v_mfma_f32_16x16x32_bf16 a[96:99], v[72:75], v[188:191], a[96:99]
    s_add_u32 s63, s63, s79
    v_mfma_f32_16x16x32_bf16 a[100:103], v[72:75], v[192:195], a[100:103]
    buffer_load_dwordx4 v[140:143], v1, s[56:59], s63 offen sc1
    v_mfma_f32_16x16x32_bf16 a[104:107], v[72:75], v[196:199], a[104:107]
    s_add_u32 s63, s63, s79
    v_mfma_f32_16x16x32_bf16 a[108:111], v[72:75], v[200:203], a[108:111]
    buffer_load_dwordx4 v[144:147], v1, s[56:59], s63 offen sc1
    v_mfma_f32_16x16x32_bf16 a[112:115], v[72:75], v[204:207], a[112:115]
    s_add_u32 s63, s63, s79
    v_mfma_f32_16x16x32_bf16 a[116:119], v[72:75], v[208:211], a[116:119]
    buffer_load_dwordx4 v[148:151], v1, s[56:59], s63 offen sc1
    v_mfma_f32_16x16x32_bf16 a[120:123], v[72:75], v[212:215], a[120:123]
    s_add_u32 s63, s63, s79
    v_mfma_f32_16x16x32_bf16 a[124:127], v[72:75], v[216:219], a[124:127]
    buffer_load_dwordx4 v[152:155], v1, s[56:59], s63 offen sc1
    v_mfma_f32_16x16x32_bf16 a[128:131], v[76:79], v[188:191], a[128:131]
    s_add_u32 s69, s69, 1024
    v_mfma_f32_16x16x32_bf16 a[132:135], v[76:79], v[192:195], a[132:135]
    s_add_u32 m0, s74, 16384
    v_mfma_f32_16x16x32_bf16 a[136:139], v[76:79], v[196:199], a[136:139]
    s_add_u32 s62, s68, 0
    v_mfma_f32_16x16x32_bf16 a[140:143], v[76:79], v[200:203], a[140:143]
    buffer_load_dwordx4 v2, s[16:19], s62 offen lds
    v_mfma_f32_16x16x32_bf16 a[144:147], v[76:79], v[204:207], a[144:147]
    s_add_u32 m0, s74, 17408
    v_mfma_f32_16x16x32_bf16 a[148:151], v[76:79], v[208:211], a[148:151]
    s_add_u32 s62, s68, 32768
    v_mfma_f32_16x16x32_bf16 a[152:155], v[76:79], v[212:215], a[152:155]
    buffer_load_dwordx4 v3, s[16:19], s62 offen lds
    v_mfma_f32_16x16x32_bf16 a[156:159], v[76:79], v[216:219], a[156:159]
    s_add_u32 m0, s74, 18432
    v_mfma_f32_16x16x32_bf16 a[160:163], v[80:83], v[188:191], a[160:163]
    s_add_u32 s62, s68, 65536
    v_mfma_f32_16x16x32_bf16 a[164:167], v[80:83], v[192:195], a[164:167]
    buffer_load_dwordx4 v2, s[16:19], s62 offen lds
    v_mfma_f32_16x16x32_bf16 a[168:171], v[80:83], v[196:199], a[168:171]
    s_add_u32 m0, s74, 19456
    v_mfma_f32_16x16x32_bf16 a[172:175], v[80:83], v[200:203], a[172:175]
    s_add_u32 s62, s68, 98304
    v_mfma_f32_16x16x32_bf16 a[176:179], v[80:83], v[204:207], a[176:179]
    buffer_load_dwordx4 v3, s[16:19], s62 offen lds
    v_mfma_f32_16x16x32_bf16 a[180:183], v[80:83], v[208:211], a[180:183]
    s_add_u32 m0, s74, 20480
    v_mfma_f32_16x16x32_bf16 a[184:187], v[80:83], v[212:215], a[184:187]
    s_add_u32 s62, s68, 131072
    v_mfma_f32_16x16x32_bf16 a[188:191], v[80:83], v[216:219], a[188:191]
    buffer_load_dwordx4 v2, s[16:19], s62 offen lds
    v_mfma_f32_16x16x32_bf16 a[192:195], v[84:87], v[188:191], a[192:195]
    s_add_u32 m0, s74, 21504
    v_mfma_f32_16x16x32_bf16 a[196:199], v[84:87], v[192:195], a[196:199]
    s_add_u32 s62, s68, 163840
    v_mfma_f32_16x16x32_bf16 a[200:203], v[84:87], v[196:199], a[200:203]
    buffer_load_dwordx4 v3, s[16:19], s62 offen lds
    v_mfma_f32_16x16x32_bf16 a[204:207], v[84:87], v[200:203], a[204:207]
    s_add_u32 m0, s74, 22528
    v_mfma_f32_16x16x32_bf16 a[208:211], v[84:87], v[204:207], a[208:211]
    s_add_u32 s62, s68, 196608
    v_mfma_f32_16x16x32_bf16 a[212:215], v[84:87], v[208:211], a[212:215]
    buffer_load_dwordx4 v2, s[16:19], s62 offen lds
    v_mfma_f32_16x16x32_bf16 a[216:219], v[84:87], v[212:215], a[216:219]
    s_add_u32 m0, s74, 23552
    v_mfma_f32_16x16x32_bf16 a[220:223], v[84:87], v[216:219], a[220:223]
    s_add_u32 s62, s68, 229376
    v_mfma_f32_16x16x32_bf16 a[224:227], v[88:91], v[188:191], a[224:227]
    buffer_load_dwordx4 v3, s[16:19], s62 offen lds
    v_mfma_f32_16x16x32_bf16 a[228:231], v[88:91], v[192:195], a[228:231]
    s_add_u32 s68, s68, 262144
    v_mfma_f32_16x16x32_bf16 a[232:235], v[88:91], v[196:199], a[232:235]
    v_mfma_f32_16x16x32_bf16 a[236:239], v[88:91], v[200:203], a[236:239]
    v_mfma_f32_16x16x32_bf16 a[240:243], v[88:91], v[204:207], a[240:243]
    v_mfma_f32_16x16x32_bf16 a[244:247], v[88:91], v[208:211], a[244:247]
    v_mfma_f32_16x16x32_bf16 a[248:251], v[88:91], v[212:215], a[248:251]
    v_mfma_f32_16x16x32_bf16 a[252:255], v[88:91], v[216:219], a[252:255]
    s_add_u32 s70, s70, 4
    s_cmp_lt_u32 s70, s64
    s_cbranch_scc1 L_gq_loop
    s_waitcnt vmcnt(0) lgkmcnt(0)
    s_nop 7
    s_nop 7
    s_lshl_b32 s71, s72, 7
    s_add_u32 s71, s71, s77
    s_lshl_b32 s71, s71, 13
    s_add_u32 s71, s71, 37748736
    v_accvgpr_read_b32 v28, a0
    v_accvgpr_read_b32 v29, a1
    v_accvgpr_read_b32 v30, a2
    v_accvgpr_read_b32 v31, a3
    v_cvt_pk_bf16_f32 v36, v28, v29
    v_cvt_pk_bf16_f32 v37, v30, v31
    v_accvgpr_read_b32 v32, a32
    v_accvgpr_read_b32 v33, a33
    v_accvgpr_read_b32 v34, a34
    v_accvgpr_read_b32 v35, a35
    v_cvt_pk_bf16_f32 v38, v32, v33
    v_cvt_pk_bf16_f32 v39, v34, v35
    s_add_u32 s62, s71, 0
    buffer_store_dwordx4 v[36:39], v1, s[56:59], s62 offen sc1
    v_accvgpr_read_b32 v28, a64
    v_accvgpr_read_b32 v29, a65
    v_accvgpr_read_b32 v30, a66
    v_accvgpr_read_b32 v31, a67
    v_cvt_pk_bf16_f32 v40, v28, v29
    v_cvt_pk_bf16_f32 v41, v30, v31
    v_accvgpr_read_b32 v32, a96
    v_accvgpr_read_b32 v33, a97
    v_accvgpr_read_b32 v34, a98
    v_accvgpr_read_b32 v35, a99
    v_cvt_pk_bf16_f32 v42, v32, v33
    v_cvt_pk_bf16_f32 v43, v34, v35
    s_add_u32 s62, s71, 0
    buffer_store_dwordx4 v[40:43], v1, s[56:59], s62 offen offset:1024 sc1
    v_accvgpr_read_b32 v28, a128
    v_accvgpr_read_b32 v29, a129
    v_accvgpr_read_b32 v30, a130
    v_accvgpr_read_b32 v31, a131
    v_cvt_pk_bf16_f32 v36, v28, v29
    v_cvt_pk_bf16_f32 v37, v30, v31
    v_accvgpr_read_b32 v32, a160
    v_accvgpr_read_b32 v33, a161
    v_accvgpr_read_b32 v34, a162
    v_accvgpr_read_b32 v35, a163
    v_cvt_pk_bf16_f32 v38, v32, v33
    v_cvt_pk_bf16_f32 v39, v34, v35
    s_add_u32 s62, s71, 0
    buffer_store_dwordx4 v[36:39], v1, s[56:59], s62 offen offset:2048 sc1
    v_accvgpr_read_b32 v28, a192
    v_accvgpr_read_b32 v29, a193
    v_accvgpr_read_b32 v30, a194
    v_accvgpr_read_b32 v31, a195
    v_cvt_pk_bf16_f32 v40, v28, v29
    v_cvt_pk_bf16_f32 v41, v30, v31
    v_accvgpr_read_b32 v32, a224
    v_accvgpr_read_b32 v33, a225
    v_accvgpr_read_b32 v34, a226
    v_accvgpr_read_b32 v35, a227
    v_cvt_pk_bf16_f32 v42, v32, v33
    v_cvt_pk_bf16_f32 v43, v34, v35
    s_add_u32 s62, s71, 0
    buffer_store_dwordx4 v[40:43], v1, s[56:59], s62 offen offset:3072 sc1
    v_accvgpr_read_b32 v28, a4
    v_accvgpr_read_b32 v29, a5
    v_accvgpr_read_b32 v30, a6
    v_accvgpr_read_b32 v31, a7
    v_cvt_pk_bf16_f32 v36, v28, v29
    v_cvt_pk_bf16_f32 v37, v30, v31
    v_accvgpr_read_b32 v32, a36
    v_accvgpr_read_b32 v33, a37
    v_accvgpr_read_b32 v34, a38
    v_accvgpr_read_b32 v35, a39
    v_cvt_pk_bf16_f32 v38, v32, v33
    v_cvt_pk_bf16_f32 v39, v34, v35
    s_add_u32 s62, s71, 4096
    buffer_store_dwordx4 v[36:39], v1, s[56:59], s62 offen sc1
    v_accvgpr_read_b32 v28, a68
    v_accvgpr_read_b32 v29, a69
    v_accvgpr_read_b32 v30, a70
    v_accvgpr_read_b32 v31, a71
    v_cvt_pk_bf16_f32 v40, v28, v29
    v_cvt_pk_bf16_f32 v41, v30, v31
    v_accvgpr_read_b32 v32, a100
    v_accvgpr_read_b32 v33, a101
    v_accvgpr_read_b32 v34, a102
    v_accvgpr_read_b32 v35, a103
    v_cvt_pk_bf16_f32 v42, v32, v33
    v_cvt_pk_bf16_f32 v43, v34, v35
    s_add_u32 s62, s71, 4096
    buffer_store_dwordx4 v[40:43], v1, s[56:59], s62 offen offset:1024 sc1
    v_accvgpr_read_b32 v28, a132
    v_accvgpr_read_b32 v29, a133
    v_accvgpr_read_b32 v30, a134
    v_accvgpr_read_b32 v31, a135
    v_cvt_pk_bf16_f32 v36, v28, v29
    v_cvt_pk_bf16_f32 v37, v30, v31
    v_accvgpr_read_b32 v32, a164
    v_accvgpr_read_b32 v33, a165
    v_accvgpr_read_b32 v34, a166
    v_accvgpr_read_b32 v35, a167
    v_cvt_pk_bf16_f32 v38, v32, v33
    v_cvt_pk_bf16_f32 v39, v34, v35
    s_add_u32 s62, s71, 4096
    buffer_store_dwordx4 v[36:39], v1, s[56:59], s62 offen offset:2048 sc1
    v_accvgpr_read_b32 v28, a196
    v_accvgpr_read_b32 v29, a197
    v_accvgpr_read_b32 v30, a198
    v_accvgpr_read_b32 v31, a199
    v_cvt_pk_bf16_f32 v40, v28, v29
    v_cvt_pk_bf16_f32 v41, v30, v31
    v_accvgpr_read_b32 v32, a228
    v_accvgpr_read_b32 v33, a229
    v_accvgpr_read_b32 v34, a230
    v_accvgpr_read_b32 v35, a231
    v_cvt_pk_bf16_f32 v42, v32, v33
    v_cvt_pk_bf16_f32 v43, v34, v35
    s_add_u32 s62, s71, 4096
    buffer_store_dwordx4 v[40:43], v1, s[56:59], s62 offen offset:3072 sc1
    v_accvgpr_read_b32 v28, a8
    v_accvgpr_read_b32 v29, a9
    v_accvgpr_read_b32 v30, a10
    v_accvgpr_read_b32 v31, a11
    v_cvt_pk_bf16_f32 v36, v28, v29
    v_cvt_pk_bf16_f32 v37, v30, v31
    v_accvgpr_read_b32 v32, a40
    v_accvgpr_read_b32 v33, a41
    v_accvgpr_read_b32 v34, a42
    v_accvgpr_read_b32 v35, a43
    v_cvt_pk_bf16_f32 v38, v32, v33
    v_cvt_pk_bf16_f32 v39, v34, v35
    s_add_u32 s62, s71, 262144
    buffer_store_dwordx4 v[36:39], v1, s[56:59], s62 offen sc1
    v_accvgpr_read_b32 v28, a72
    v_accvgpr_read_b32 v29, a73
    v_accvgpr_read_b32 v30, a74
    v_accvgpr_read_b32 v31, a75
    v_cvt_pk_bf16_f32 v40, v28, v29
    v_cvt_pk_bf16_f32 v41, v30, v31
    v_accvgpr_read_b32 v32, a104
    v_accvgpr_read_b32 v33, a105
    v_accvgpr_read_b32 v34, a106
    v_accvgpr_read_b32 v35, a107
    v_cvt_pk_bf16_f32 v42, v32, v33
    v_cvt_pk_bf16_f32 v43, v34, v35
    s_add_u32 s62, s71, 262144
    buffer_store_dwordx4 v[40:43], v1, s[56:59], s62 offen offset:1024 sc1
    v_accvgpr_read_b32 v28, a136
    v_accvgpr_read_b32 v29, a137
    v_accvgpr_read_b32 v30, a138
    v_accvgpr_read_b32 v31, a139
    v_cvt_pk_bf16_f32 v36, v28, v29
    v_cvt_pk_bf16_f32 v37, v30, v31
    v_accvgpr_read_b32 v32, a168
    v_accvgpr_read_b32 v33, a169
    v_accvgpr_read_b32 v34, a170
    v_accvgpr_read_b32 v35, a171
    v_cvt_pk_bf16_f32 v38, v32, v33
    v_cvt_pk_bf16_f32 v39, v34, v35
    s_add_u32 s62, s71, 262144
    buffer_store_dwordx4 v[36:39], v1, s[56:59], s62 offen offset:2048 sc1
    v_accvgpr_read_b32 v28, a200
    v_accvgpr_read_b32 v29, a201
    v_accvgpr_read_b32 v30, a202
    v_accvgpr_read_b32 v31, a203
    v_cvt_pk_bf16_f32 v40, v28, v29
    v_cvt_pk_bf16_f32 v41, v30, v31
    v_accvgpr_read_b32 v32, a232
    v_accvgpr_read_b32 v33, a233
    v_accvgpr_read_b32 v34, a234
    v_accvgpr_read_b32 v35, a235
    v_cvt_pk_bf16_f32 v42, v32, v33
    v_cvt_pk_bf16_f32 v43, v34, v35
    s_add_u32 s62, s71, 262144
    buffer_store_dwordx4 v[40:43], v1, s[56:59], s62 offen offset:3072 sc1
    v_accvgpr_read_b32 v28, a12
    v_accvgpr_read_b32 v29, a13
    v_accvgpr_read_b32 v30, a14
    v_accvgpr_read_b32 v31, a15
    v_cvt_pk_bf16_f32 v36, v28, v29
    v_cvt_pk_bf16_f32 v37, v30, v31
    v_accvgpr_read_b32 v32, a44
    v_accvgpr_read_b32 v33, a45
    v_accvgpr_read_b32 v34, a46
    v_accvgpr_read_b32 v35, a47
    v_cvt_pk_bf16_f32 v38, v32, v33
    v_cvt_pk_bf16_f32 v39, v34, v35
    s_add_u32 s62, s71, 266240
    buffer_store_dwordx4 v[36:39], v1, s[56:59], s62 offen sc1
    v_accvgpr_read_b32 v28, a76
    v_accvgpr_read_b32 v29, a77
    v_accvgpr_read_b32 v30, a78
    v_accvgpr_read_b32 v31, a79
    v_cvt_pk_bf16_f32 v40, v28, v29
    v_cvt_pk_bf16_f32 v41, v30, v31
    v_accvgpr_read_b32 v32, a108
    v_accvgpr_read_b32 v33, a109
    v_accvgpr_read_b32 v34, a110
    v_accvgpr_read_b32 v35, a111
    v_cvt_pk_bf16_f32 v42, v32, v33
    v_cvt_pk_bf16_f32 v43, v34, v35
    s_add_u32 s62, s71, 266240
    buffer_store_dwordx4 v[40:43], v1, s[56:59], s62 offen offset:1024 sc1
    v_accvgpr_read_b32 v28, a140
    v_accvgpr_read_b32 v29, a141
    v_accvgpr_read_b32 v30, a142
    v_accvgpr_read_b32 v31, a143
    v_cvt_pk_bf16_f32 v36, v28, v29
    v_cvt_pk_bf16_f32 v37, v30, v31
    v_accvgpr_read_b32 v32, a172
    v_accvgpr_read_b32 v33, a173
    v_accvgpr_read_b32 v34, a174
    v_accvgpr_read_b32 v35, a175
    v_cvt_pk_bf16_f32 v38, v32, v33
    v_cvt_pk_bf16_f32 v39, v34, v35
    s_add_u32 s62, s71, 266240
    buffer_store_dwordx4 v[36:39], v1, s[56:59], s62 offen offset:2048 sc1
    v_accvgpr_read_b32 v28, a204
    v_accvgpr_read_b32 v29, a205
    v_accvgpr_read_b32 v30, a206
    v_accvgpr_read_b32 v31, a207
    v_cvt_pk_bf16_f32 v40, v28, v29
    v_cvt_pk_bf16_f32 v41, v30, v31
    v_accvgpr_read_b32 v32, a236
    v_accvgpr_read_b32 v33, a237
    v_accvgpr_read_b32 v34, a238
    v_accvgpr_read_b32 v35, a239
    v_cvt_pk_bf16_f32 v42, v32, v33
    v_cvt_pk_bf16_f32 v43, v34, v35
    s_add_u32 s62, s71, 266240
    buffer_store_dwordx4 v[40:43], v1, s[56:59], s62 offen offset:3072 sc1
    v_accvgpr_read_b32 v28, a16
    v_accvgpr_read_b32 v29, a17
    v_accvgpr_read_b32 v30, a18
    v_accvgpr_read_b32 v31, a19
    v_cvt_pk_bf16_f32 v36, v28, v29
    v_cvt_pk_bf16_f32 v37, v30, v31
    v_accvgpr_read_b32 v32, a48
    v_accvgpr_read_b32 v33, a49
    v_accvgpr_read_b32 v34, a50
    v_accvgpr_read_b32 v35, a51
    v_cvt_pk_bf16_f32 v38, v32, v33
    v_cvt_pk_bf16_f32 v39, v34, v35
    s_add_u32 s62, s71, 524288
    buffer_store_dwordx4 v[36:39], v1, s[56:59], s62 offen sc1
    v_accvgpr_read_b32 v28, a80
    v_accvgpr_read_b32 v29, a81
    v_accvgpr_read_b32 v30, a82
    v_accvgpr_read_b32 v31, a83
    v_cvt_pk_bf16_f32 v40, v28, v29
    v_cvt_pk_bf16_f32 v41, v30, v31
    v_accvgpr_read_b32 v32, a112
    v_accvgpr_read_b32 v33, a113
    v_accvgpr_read_b32 v34, a114
    v_accvgpr_read_b32 v35, a115
    v_cvt_pk_bf16_f32 v42, v32, v33
    v_cvt_pk_bf16_f32 v43, v34, v35
    s_add_u32 s62, s71, 524288
    buffer_store_dwordx4 v[40:43], v1, s[56:59], s62 offen offset:1024 sc1
    v_accvgpr_read_b32 v28, a144
    v_accvgpr_read_b32 v29, a145
    v_accvgpr_read_b32 v30, a146
    v_accvgpr_read_b32 v31, a147
    v_cvt_pk_bf16_f32 v36, v28, v29
    v_cvt_pk_bf16_f32 v37, v30, v31
    v_accvgpr_read_b32 v32, a176
    v_accvgpr_read_b32 v33, a177
    v_accvgpr_read_b32 v34, a178
    v_accvgpr_read_b32 v35, a179
    v_cvt_pk_bf16_f32 v38, v32, v33
    v_cvt_pk_bf16_f32 v39, v34, v35
    s_add_u32 s62, s71, 524288
    buffer_store_dwordx4 v[36:39], v1, s[56:59], s62 offen offset:2048 sc1
    v_accvgpr_read_b32 v28, a208
    v_accvgpr_read_b32 v29, a209
    v_accvgpr_read_b32 v30, a210
    v_accvgpr_read_b32 v31, a211
    v_cvt_pk_bf16_f32 v40, v28, v29
    v_cvt_pk_bf16_f32 v41, v30, v31
    v_accvgpr_read_b32 v32, a240
    v_accvgpr_read_b32 v33, a241
    v_accvgpr_read_b32 v34, a242
    v_accvgpr_read_b32 v35, a243
    v_cvt_pk_bf16_f32 v42, v32, v33
    v_cvt_pk_bf16_f32 v43, v34, v35
    s_add_u32 s62, s71, 524288
    buffer_store_dwordx4 v[40:43], v1, s[56:59], s62 offen offset:3072 sc1
    v_accvgpr_read_b32 v28, a20
    v_accvgpr_read_b32 v29, a21
    v_accvgpr_read_b32 v30, a22
    v_accvgpr_read_b32 v31, a23
    v_cvt_pk_bf16_f32 v36, v28, v29
    v_cvt_pk_bf16_f32 v37, v30, v31
    v_accvgpr_read_b32 v32, a52
    v_accvgpr_read_b32 v33, a53
    v_accvgpr_read_b32 v34, a54
    v_accvgpr_read_b32 v35, a55
    v_cvt_pk_bf16_f32 v38, v32, v33
    v_cvt_pk_bf16_f32 v39, v34, v35
    s_add_u32 s62, s71, 528384
    buffer_store_dwordx4 v[36:39], v1, s[56:59], s62 offen sc1
    v_accvgpr_read_b32 v28, a84
    v_accvgpr_read_b32 v29, a85
    v_accvgpr_read_b32 v30, a86
    v_accvgpr_read_b32 v31, a87
    v_cvt_pk_bf16_f32 v40, v28, v29
    v_cvt_pk_bf16_f32 v41, v30, v31
    v_accvgpr_read_b32 v32, a116
    v_accvgpr_read_b32 v33, a117
    v_accvgpr_read_b32 v34, a118
    v_accvgpr_read_b32 v35, a119
    v_cvt_pk_bf16_f32 v42, v32, v33
    v_cvt_pk_bf16_f32 v43, v34, v35
    s_add_u32 s62, s71, 528384
    buffer_store_dwordx4 v[40:43], v1, s[56:59], s62 offen offset:1024 sc1
    v_accvgpr_read_b32 v28, a148
    v_accvgpr_read_b32 v29, a149
    v_accvgpr_read_b32 v30, a150
    v_accvgpr_read_b32 v31, a151
    v_cvt_pk_bf16_f32 v36, v28, v29
    v_cvt_pk_bf16_f32 v37, v30, v31
    v_accvgpr_read_b32 v32, a180
    v_accvgpr_read_b32 v33, a181
    v_accvgpr_read_b32 v34, a182
    v_accvgpr_read_b32 v35, a183
    v_cvt_pk_bf16_f32 v38, v32, v33
    v_cvt_pk_bf16_f32 v39, v34, v35
    s_add_u32 s62, s71, 528384
    buffer_store_dwordx4 v[36:39], v1, s[56:59], s62 offen offset:2048 sc1
    v_accvgpr_read_b32 v28, a212
    v_accvgpr_read_b32 v29, a213
    v_accvgpr_read_b32 v30, a214
    v_accvgpr_read_b32 v31, a215
    v_cvt_pk_bf16_f32 v40, v28, v29
    v_cvt_pk_bf16_f32 v41, v30, v31
    v_accvgpr_read_b32 v32, a244
    v_accvgpr_read_b32 v33, a245
    v_accvgpr_read_b32 v34, a246
    v_accvgpr_read_b32 v35, a247
    v_cvt_pk_bf16_f32 v42, v32, v33
    v_cvt_pk_bf16_f32 v43, v34, v35
    s_add_u32 s62, s71, 528384
    buffer_store_dwordx4 v[40:43], v1, s[56:59], s62 offen offset:3072 sc1
    v_accvgpr_read_b32 v28, a24
    v_accvgpr_read_b32 v29, a25
    v_accvgpr_read_b32 v30, a26
    v_accvgpr_read_b32 v31, a27
    v_cvt_pk_bf16_f32 v36, v28, v29
    v_cvt_pk_bf16_f32 v37, v30, v31
    v_accvgpr_read_b32 v32, a56
    v_accvgpr_read_b32 v33, a57
    v_accvgpr_read_b32 v34, a58
    v_accvgpr_read_b32 v35, a59
    v_cvt_pk_bf16_f32 v38, v32, v33
    v_cvt_pk_bf16_f32 v39, v34, v35
    s_add_u32 s62, s71, 786432
    buffer_store_dwordx4 v[36:39], v1, s[56:59], s62 offen sc1
    v_accvgpr_read_b32 v28, a88
    v_accvgpr_read_b32 v29, a89
    v_accvgpr_read_b32 v30, a90
    v_accvgpr_read_b32 v31, a91
    v_cvt_pk_bf16_f32 v40, v28, v29
    v_cvt_pk_bf16_f32 v41, v30, v31
    v_accvgpr_read_b32 v32, a120
    v_accvgpr_read_b32 v33, a121
    v_accvgpr_read_b32 v34, a122
    v_accvgpr_read_b32 v35, a123
    v_cvt_pk_bf16_f32 v42, v32, v33
    v_cvt_pk_bf16_f32 v43, v34, v35
    s_add_u32 s62, s71, 786432
    buffer_store_dwordx4 v[40:43], v1, s[56:59], s62 offen offset:1024 sc1
    v_accvgpr_read_b32 v28, a152
    v_accvgpr_read_b32 v29, a153
    v_accvgpr_read_b32 v30, a154
    v_accvgpr_read_b32 v31, a155
    v_cvt_pk_bf16_f32 v36, v28, v29
    v_cvt_pk_bf16_f32 v37, v30, v31
    v_accvgpr_read_b32 v32, a184
    v_accvgpr_read_b32 v33, a185
    v_accvgpr_read_b32 v34, a186
    v_accvgpr_read_b32 v35, a187
    v_cvt_pk_bf16_f32 v38, v32, v33
    v_cvt_pk_bf16_f32 v39, v34, v35
    s_add_u32 s62, s71, 786432
    buffer_store_dwordx4 v[36:39], v1, s[56:59], s62 offen offset:2048 sc1
    v_accvgpr_read_b32 v28, a216
    v_accvgpr_read_b32 v29, a217
    v_accvgpr_read_b32 v30, a218
    v_accvgpr_read_b32 v31, a219
    v_cvt_pk_bf16_f32 v40, v28, v29
    v_cvt_pk_bf16_f32 v41, v30, v31
    v_accvgpr_read_b32 v32, a248
    v_accvgpr_read_b32 v33, a249
    v_accvgpr_read_b32 v34, a250
    v_accvgpr_read_b32 v35, a251
    v_cvt_pk_bf16_f32 v42, v32, v33
    v_cvt_pk_bf16_f32 v43, v34, v35
    s_add_u32 s62, s71, 786432
    buffer_store_dwordx4 v[40:43], v1, s[56:59], s62 offen offset:3072 sc1
    v_accvgpr_read_b32 v28, a28
    v_accvgpr_read_b32 v29, a29
    v_accvgpr_read_b32 v30, a30
    v_accvgpr_read_b32 v31, a31
    v_cvt_pk_bf16_f32 v36, v28, v29
    v_cvt_pk_bf16_f32 v37, v30, v31
    v_accvgpr_read_b32 v32, a60
    v_accvgpr_read_b32 v33, a61
    v_accvgpr_read_b32 v34, a62
    v_accvgpr_read_b32 v35, a63
    v_cvt_pk_bf16_f32 v38, v32, v33
    v_cvt_pk_bf16_f32 v39, v34, v35
    s_add_u32 s62, s71, 790528
    buffer_store_dwordx4 v[36:39], v1, s[56:59], s62 offen sc1
    v_accvgpr_read_b32 v28, a92
    v_accvgpr_read_b32 v29, a93
    v_accvgpr_read_b32 v30, a94
    v_accvgpr_read_b32 v31, a95
    v_cvt_pk_bf16_f32 v40, v28, v29
    v_cvt_pk_bf16_f32 v41, v30, v31
    v_accvgpr_read_b32 v32, a124
    v_accvgpr_read_b32 v33, a125
    v_accvgpr_read_b32 v34, a126
    v_accvgpr_read_b32 v35, a127
    v_cvt_pk_bf16_f32 v42, v32, v33
    v_cvt_pk_bf16_f32 v43, v34, v35
    s_add_u32 s62, s71, 790528
    buffer_store_dwordx4 v[40:43], v1, s[56:59], s62 offen offset:1024 sc1
    v_accvgpr_read_b32 v28, a156
    v_accvgpr_read_b32 v29, a157
    v_accvgpr_read_b32 v30, a158
    v_accvgpr_read_b32 v31, a159
    v_cvt_pk_bf16_f32 v36, v28, v29
    v_cvt_pk_bf16_f32 v37, v30, v31
    v_accvgpr_read_b32 v32, a188
    v_accvgpr_read_b32 v33, a189
    v_accvgpr_read_b32 v34, a190
    v_accvgpr_read_b32 v35, a191
    v_cvt_pk_bf16_f32 v38, v32, v33
    v_cvt_pk_bf16_f32 v39, v34, v35
    s_add_u32 s62, s71, 790528
    buffer_store_dwordx4 v[36:39], v1, s[56:59], s62 offen offset:2048 sc1
    v_accvgpr_read_b32 v28, a220
    v_accvgpr_read_b32 v29, a221
    v_accvgpr_read_b32 v30, a222
    v_accvgpr_read_b32 v31, a223
    v_cvt_pk_bf16_f32 v40, v28, v29
    v_cvt_pk_bf16_f32 v41, v30, v31
    v_accvgpr_read_b32 v32, a252
    v_accvgpr_read_b32 v33, a253
    v_accvgpr_read_b32 v34, a254
    v_accvgpr_read_b32 v35, a255
    v_cvt_pk_bf16_f32 v42, v32, v33
    v_cvt_pk_bf16_f32 v43, v34, v35
    s_add_u32 s62, s71, 790528
    buffer_store_dwordx4 v[40:43], v1, s[56:59], s62 offen offset:3072 sc1
    s_lshl_b32 s65, s72, 7
    s_add_u32 s65, s65, 94372864
    s_waitcnt vmcnt(0)
    s_barrier
    s_cmp_lg_u32 s61, 0
    s_cbranch_scc1 L_sig7
    v_mov_b32 v12, 2048
    v_mov_b32 v13, 0
    s_mov_b64 exec, 1
    buffer_atomic_add v12, v13, s[56:59], s65 offen sc1
    s_mov_b64 exec, -1
L_sig7:
    s_branch L_next
L_tf:
    s_mov_b32 s62, 3456
    v_mul_lo_u32 v12, v25, s62
    v_lshlrev_b32 v13, 1, v25
    v_xor_b32 v13, v13, v26
    v_lshl_add_u32 v2, v13, 4, v12
    v_lshlrev_b32 v13, 1, v25
    v_add_u32 v13, 8, v13
    v_xor_b32 v13, v13, v26
    v_lshl_add_u32 v3, v13, 4, v12
    s_lshl_b32 s65, s72, 7
    s_add_u32 s65, s65, 94372864
    s_cmp_lg_u32 s61, 0
    s_cbranch_scc1 L_wf9d
    v_mov_b32 v13, 0
L_wf9:
    buffer_load_dword v12, v13, s[56:59], s65 offen sc1
    s_waitcnt vmcnt(0)
    v_lshrrev_b32 v12, 0, v12
    v_and_b32 v12, 31, v12
    v_cmp_le_u32 vcc, 16, v12
    s_cbranch_vccnz L_wf9d
    s_sleep 2
    s_branch L_wf9
L_wf9d:
    s_barrier
    s_cmp_ge_u32 s77, 14
    s_cbranch_scc1 L_f1skip8
    s_lshl_b32 s68, s77, 8
    s_mul_i32 s69, s72, 163840
    s_add_u32 s69, s69, 0
    s_mov_b32 s79, 20480
    s_mov_b32 s64, 20
    v_accvgpr_write_b32 a0, 0
    v_accvgpr_write_b32 a1, 0
    v_accvgpr_write_b32 a2, 0
    v_accvgpr_write_b32 a3, 0
    v_accvgpr_write_b32 a4, 0
    v_accvgpr_write_b32 a5, 0
    v_accvgpr_write_b32 a6, 0
    v_accvgpr_write_b32 a7, 0
    v_accvgpr_write_b32 a8, 0
    v_accvgpr_write_b32 a9, 0
    v_accvgpr_write_b32 a10, 0
    v_accvgpr_write_b32 a11, 0
    v_accvgpr_write_b32 a12, 0
    v_accvgpr_write_b32 a13, 0
    v_accvgpr_write_b32 a14, 0
    v_accvgpr_write_b32 a15, 0
    v_accvgpr_write_b32 a16, 0
    v_accvgpr_write_b32 a17, 0
    v_accvgpr_write_b32 a18, 0
    v_accvgpr_write_b32 a19, 0
    v_accvgpr_write_b32 a20, 0
    v_accvgpr_write_b32 a21, 0
    v_accvgpr_write_b32 a22, 0
    v_accvgpr_write_b32 a23, 0
    v_accvgpr_write_b32 a24, 0
    v_accvgpr_write_b32 a25, 0
    v_accvgpr_write_b32 a26, 0
    v_accvgpr_write_b32 a27, 0
    v_accvgpr_write_b32 a28, 0
    v_accvgpr_write_b32 a29, 0
    v_accvgpr_write_b32 a30, 0
    v_accvgpr_write_b32 a31, 0
    v_accvgpr_write_b32 a32, 0
    v_accvgpr_write_b32 a33, 0
    v_accvgpr_write_b32 a34, 0
    v_accvgpr_write_b32 a35, 0
    v_accvgpr_write_b32 a36, 0
    v_accvgpr_write_b32 a37, 0
    v_accvgpr_write_b32 a38, 0
    v_accvgpr_write_b32 a39, 0
    v_accvgpr_write_b32 a40, 0
    v_accvgpr_write_b32 a41, 0
    v_accvgpr_write_b32 a42, 0
    v_accvgpr_write_b32 a43, 0
    v_accvgpr_write_b32 a44, 0
    v_accvgpr_write_b32 a45, 0
    v_accvgpr_write_b32 a46, 0
    v_accvgpr_write_b32 a47, 0
    v_accvgpr_write_b32 a48, 0
    v_accvgpr_write_b32 a49, 0
    v_accvgpr_write_b32 a50, 0
    v_accvgpr_write_b32 a51, 0
    v_accvgpr_write_b32 a52, 0
    v_accvgpr_write_b32 a53, 0
    v_accvgpr_write_b32 a54, 0
    v_accvgpr_write_b32 a55, 0
    v_accvgpr_write_b32 a56, 0
    v_accvgpr_write_b32 a57, 0
    v_accvgpr_write_b32 a58, 0
    v_accvgpr_write_b32 a59, 0
    v_accvgpr_write_b32 a60, 0
    v_accvgpr_write_b32 a61, 0
    v_accvgpr_write_b32 a62, 0
    v_accvgpr_write_b32 a63, 0
    v_accvgpr_write_b32 a64, 0
    v_accvgpr_write_b32 a65, 0
    v_accvgpr_write_b32 a66, 0
    v_accvgpr_write_b32 a67, 0
    v_accvgpr_write_b32 a68, 0
    v_accvgpr_write_b32 a69, 0
    v_accvgpr_write_b32 a70, 0
    v_accvgpr_write_b32 a71, 0
    v_accvgpr_write_b32 a72, 0
    v_accvgpr_write_b32 a73, 0
    v_accvgpr_write_b32 a74, 0
    v_accvgpr_write_b32 a75, 0
    v_accvgpr_write_b32 a76, 0
    v_accvgpr_write_b32 a77, 0
    v_accvgpr_write_b32 a78, 0
    v_accvgpr_write_b32 a79, 0
    v_accvgpr_write_b32 a80, 0
    v_accvgpr_write_b32 a81, 0
    v_accvgpr_write_b32 a82, 0
    v_accvgpr_write_b32 a83, 0
    v_accvgpr_write_b32 a84, 0
    v_accvgpr_write_b32 a85, 0
    v_accvgpr_write_b32 a86, 0
    v_accvgpr_write_b32 a87, 0
    v_accvgpr_write_b32 a88, 0
    v_accvgpr_write_b32 a89, 0
    v_accvgpr_write_b32 a90, 0
    v_accvgpr_write_b32 a91, 0
    v_accvgpr_write_b32 a92, 0
    v_accvgpr_write_b32 a93, 0
    v_accvgpr_write_b32 a94, 0
    v_accvgpr_write_b32 a95, 0
    v_accvgpr_write_b32 a96, 0
    v_accvgpr_write_b32 a97, 0
    v_accvgpr_write_b32 a98, 0
    v_accvgpr_write_b32 a99, 0
    v_accvgpr_write_b32 a100, 0
    v_accvgpr_write_b32 a101, 0
    v_accvgpr_write_b32 a102, 0
    v_accvgpr_write_b32 a103, 0
    v_accvgpr_write_b32 a104, 0
    v_accvgpr_write_b32 a105, 0
    v_accvgpr_write_b32 a106, 0
    v_accvgpr_write_b32 a107, 0
    v_accvgpr_write_b32 a108, 0
    v_accvgpr_write_b32 a109, 0
    v_accvgpr_write_b32 a110, 0
    v_accvgpr_write_b32 a111, 0
    v_accvgpr_write_b32 a112, 0
    v_accvgpr_write_b32 a113, 0
    v_accvgpr_write_b32 a114, 0
    v_accvgpr_write_b32 a115, 0
    v_accvgpr_write_b32 a116, 0
    v_accvgpr_write_b32 a117, 0
    v_accvgpr_write_b32 a118, 0
    v_accvgpr_write_b32 a119, 0
    v_accvgpr_write_b32 a120, 0
    v_accvgpr_write_b32 a121, 0
    v_accvgpr_write_b32 a122, 0
    v_accvgpr_write_b32 a123, 0
    v_accvgpr_write_b32 a124, 0
    v_accvgpr_write_b32 a125, 0
    v_accvgpr_write_b32 a126, 0
    v_accvgpr_write_b32 a127, 0
    v_accvgpr_write_b32 a128, 0
    v_accvgpr_write_b32 a129, 0
    v_accvgpr_write_b32 a130, 0
    v_accvgpr_write_b32 a131, 0
    v_accvgpr_write_b32 a132, 0
    v_accvgpr_write_b32 a133, 0
    v_accvgpr_write_b32 a134, 0
    v_accvgpr_write_b32 a135, 0
    v_accvgpr_write_b32 a136, 0
    v_accvgpr_write_b32 a137, 0
    v_accvgpr_write_b32 a138, 0
    v_accvgpr_write_b32 a139, 0
    v_accvgpr_write_b32 a140, 0
    v_accvgpr_write_b32 a141, 0
    v_accvgpr_write_b32 a142, 0
    v_accvgpr_write_b32 a143, 0
    v_accvgpr_write_b32 a144, 0
    v_accvgpr_write_b32 a145, 0
    v_accvgpr_write_b32 a146, 0
    v_accvgpr_write_b32 a147, 0
    v_accvgpr_write_b32 a148, 0
    v_accvgpr_write_b32 a149, 0
    v_accvgpr_write_b32 a150, 0
    v_accvgpr_write_b32 a151, 0
    v_accvgpr_write_b32 a152, 0
    v_accvgpr_write_b32 a153, 0
    v_accvgpr_write_b32 a154, 0
    v_accvgpr_write_b32 a155, 0
    v_accvgpr_write_b32 a156, 0
    v_accvgpr_write_b32 a157, 0
    v_accvgpr_write_b32 a158, 0
    v_accvgpr_write_b32 a159, 0
    v_accvgpr_write_b32 a160, 0
    v_accvgpr_write_b32 a161, 0
    v_accvgpr_write_b32 a162, 0
    v_accvgpr_write_b32 a163, 0
    v_accvgpr_write_b32 a164, 0
    v_accvgpr_write_b32 a165, 0
    v_accvgpr_write_b32 a166, 0
    v_accvgpr_write_b32 a167, 0
    v_accvgpr_write_b32 a168, 0
    v_accvgpr_write_b32 a169, 0
    v_accvgpr_write_b32 a170, 0
    v_accvgpr_write_b32 a171, 0
    v_accvgpr_write_b32 a172, 0
    v_accvgpr_write_b32 a173, 0
    v_accvgpr_write_b32 a174, 0
    v_accvgpr_write_b32 a175, 0
    v_accvgpr_write_b32 a176, 0
    v_accvgpr_write_b32 a177, 0
    v_accvgpr_write_b32 a178, 0
    v_accvgpr_write_b32 a179, 0
    v_accvgpr_write_b32 a180, 0
    v_accvgpr_write_b32 a181, 0
    v_accvgpr_write_b32 a182, 0
    v_accvgpr_write_b32 a183, 0
    v_accvgpr_write_b32 a184, 0
    v_accvgpr_write_b32 a185, 0
    v_accvgpr_write_b32 a186, 0
    v_accvgpr_write_b32 a187, 0
    v_accvgpr_write_b32 a188, 0
    v_accvgpr_write_b32 a189, 0
    v_accvgpr_write_b32 a190, 0
    v_accvgpr_write_b32 a191, 0
    v_accvgpr_write_b32 a192, 0
    v_accvgpr_write_b32 a193, 0
    v_accvgpr_write_b32 a194, 0
    v_accvgpr_write_b32 a195, 0
    v_accvgpr_write_b32 a196, 0
    v_accvgpr_write_b32 a197, 0
    v_accvgpr_write_b32 a198, 0
    v_accvgpr_write_b32 a199, 0
    v_accvgpr_write_b32 a200, 0
    v_accvgpr_write_b32 a201, 0
    v_accvgpr_write_b32 a202, 0
    v_accvgpr_write_b32 a203, 0
    v_accvgpr_write_b32 a204, 0
    v_accvgpr_write_b32 a205, 0
    v_accvgpr_write_b32 a206, 0
    v_accvgpr_write_b32 a207, 0
    v_accvgpr_write_b32 a208, 0
    v_accvgpr_write_b32 a209, 0
    v_accvgpr_write_b32 a210, 0
    v_accvgpr_write_b32 a211, 0
    v_accvgpr_write_b32 a212, 0
    v_accvgpr_write_b32 a213, 0
    v_accvgpr_write_b32 a214, 0
    v_accvgpr_write_b32 a215, 0
    v_accvgpr_write_b32 a216, 0
    v_accvgpr_write_b32 a217, 0
    v_accvgpr_write_b32 a218, 0
    v_accvgpr_write_b32 a219, 0
    v_accvgpr_write_b32 a220, 0
    v_accvgpr_write_b32 a221, 0
    v_accvgpr_write_b32 a222, 0
    v_accvgpr_write_b32 a223, 0
    v_accvgpr_write_b32 a224, 0
    v_accvgpr_write_b32 a225, 0
    v_accvgpr_write_b32 a226, 0
    v_accvgpr_write_b32 a227, 0
    v_accvgpr_write_b32 a228, 0
    v_accvgpr_write_b32 a229, 0
    v_accvgpr_write_b32 a230, 0
    v_accvgpr_write_b32 a231, 0
    v_accvgpr_write_b32 a232, 0
    v_accvgpr_write_b32 a233, 0
    v_accvgpr_write_b32 a234, 0
    v_accvgpr_write_b32 a235, 0
    v_accvgpr_write_b32 a236, 0
    v_accvgpr_write_b32 a237, 0
    v_accvgpr_write_b32 a238, 0
    v_accvgpr_write_b32 a239, 0
    v_accvgpr_write_b32 a240, 0
    v_accvgpr_write_b32 a241, 0
    v_accvgpr_write_b32 a242, 0
    v_accvgpr_write_b32 a243, 0
    v_accvgpr_write_b32 a244, 0
    v_accvgpr_write_b32 a245, 0
    v_accvgpr_write_b32 a246, 0
    v_accvgpr_write_b32 a247, 0
    v_accvgpr_write_b32 a248, 0
    v_accvgpr_write_b32 a249, 0
    v_accvgpr_write_b32 a250, 0
    v_accvgpr_write_b32 a251, 0
    v_accvgpr_write_b32 a252, 0
    v_accvgpr_write_b32 a253, 0
    v_accvgpr_write_b32 a254, 0
    v_accvgpr_write_b32 a255, 0
    s_add_u32 m0, s74, 0
    s_add_u32 s62, s68, 0
    buffer_load_dwordx4 v2, s[32:35], s62 offen lds
    s_add_u32 m0, s74, 1024
    s_add_u32 s62, s68, 13824
    buffer_load_dwordx4 v3, s[32:35], s62 offen lds
    s_add_u32 m0, s74, 2048
    s_add_u32 s62, s68, 27648
    buffer_load_dwordx4 v2, s[32:35], s62 offen lds
    s_add_u32 m0, s74, 3072
    s_add_u32 s62, s68, 41472
    buffer_load_dwordx4 v3, s[32:35], s62 offen lds
    s_add_u32 m0, s74, 4096
    s_add_u32 s62, s68, 55296
    buffer_load_dwordx4 v2, s[32:35], s62 offen lds
    s_add_u32 m0, s74, 5120
    s_add_u32 s62, s68, 69120
    buffer_load_dwordx4 v3, s[32:35], s62 offen lds
    s_add_u32 m0, s74, 6144
    s_add_u32 s62, s68, 82944
    buffer_load_dwordx4 v2, s[32:35], s62 offen lds
    s_add_u32 m0, s74, 7168
    s_add_u32 s62, s68, 96768
    buffer_load_dwordx4 v3, s[32:35], s62 offen lds
    s_add_u32 s68, s68, 110592
    s_mov_b32 s63, s69
    buffer_load_dwordx4 v[92:95], v1, s[56:59], s63 offen sc1
    s_add_u32 s63, s63, s79
    buffer_load_dwordx4 v[96:99], v1, s[56:59], s63 offen sc1
    s_add_u32 s63, s63, s79
    buffer_load_dwordx4 v[100:103], v1, s[56:59], s63 offen sc1
    s_add_u32 s63, s63, s79
    buffer_load_dwordx4 v[104:107], v1, s[56:59], s63 offen sc1
    s_add_u32 s63, s63, s79
    buffer_load_dwordx4 v[108:111], v1, s[56:59], s63 offen sc1
    s_add_u32 s63, s63, s79
    buffer_load_dwordx4 v[112:115], v1, s[56:59], s63 offen sc1
    s_add_u32 s63, s63, s79
    buffer_load_dwordx4 v[116:119], v1, s[56:59], s63 offen sc1
    s_add_u32 s63, s63, s79
    buffer_load_dwordx4 v[120:123], v1, s[56:59], s63 offen sc1
    s_add_u32 s69, s69, 1024
    s_add_u32 m0, s74, 8192
    s_add_u32 s62, s68, 0
    buffer_load_dwordx4 v2, s[32:35], s62 offen lds
    s_add_u32 m0, s74, 9216
    s_add_u32 s62, s68, 13824
    buffer_load_dwordx4 v3, s[32:35], s62 offen lds
    s_add_u32 m0, s74, 10240
    s_add_u32 s62, s68, 27648
    buffer_load_dwordx4 v2, s[32:35], s62 offen lds
    s_add_u32 m0, s74, 11264
    s_add_u32 s62, s68, 41472
    buffer_load_dwordx4 v3, s[32:35], s62 offen lds
    s_add_u32 m0, s74, 12288
    s_add_u32 s62, s68, 55296
    buffer_load_dwordx4 v2, s[32:35], s62 offen lds
    s_add_u32 m0, s74, 13312
    s_add_u32 s62, s68, 69120
    buffer_load_dwordx4 v3, s[32:35], s62 offen lds
    s_add_u32 m0, s74, 14336
    s_add_u32 s62, s68, 82944
    buffer_load_dwordx4 v2, s[32:35], s62 offen lds
    s_add_u32 m0, s74, 15360
    s_add_u32 s62, s68, 96768
    buffer_load_dwordx4 v3, s[32:35], s62 offen lds
    s_add_u32 s68, s68, 110592
    s_mov_b32 s63, s69
    buffer_load_dwordx4 v[124:127], v1, s[56:59], s63 offen sc1
    s_add_u32 s63, s63, s79
    buffer_load_dwordx4 v[128:131], v1, s[56:59], s63 offen sc1
    s_add_u32 s63, s63, s79
    buffer_load_dwordx4 v[132:135], v1, s[56:59], s63 offen sc1
    s_add_u32 s63, s63, s79
    buffer_load_dwordx4 v[136:139], v1, s[56:59], s63 offen sc1
    s_add_u32 s63, s63, s79
    buffer_load_dwordx4 v[140:143], v1, s[56:59], s63 offen sc1
    s_add_u32 s63, s63, s79
    buffer_load_dwordx4 v[144:147], v1, s[56:59], s63 offen sc1
    s_add_u32 s63, s63, s79
    buffer_load_dwordx4 v[148:151], v1, s[56:59], s63 offen sc1
    s_add_u32 s63, s63, s79
    buffer_load_dwordx4 v[152:155], v1, s[56:59], s63 offen sc1
    s_add_u32 s69, s69, 1024
    s_add_u32 m0, s74, 16384
    s_add_u32 s62, s68, 0
    buffer_load_dwordx4 v2, s[32:35], s62 offen lds
    s_add_u32 m0, s74, 17408
    s_add_u32 s62, s68, 13824
    buffer_load_dwordx4 v3, s[32:35], s62 offen lds
    s_add_u32 m0, s74, 18432
    s_add_u32 s62, s68, 27648
    buffer_load_dwordx4 v2, s[32:35], s62 offen lds
    s_add_u32 m0, s74, 19456
    s_add_u32 s62, s68, 41472
    buffer_load_dwordx4 v3, s[32:35], s62 offen lds
    s_add_u32 m0, s74, 20480
    s_add_u32 s62, s68, 55296
    buffer_load_dwordx4 v2, s[32:35], s62 offen lds
    s_add_u32 m0, s74, 21504
    s_add_u32 s62, s68, 69120
    buffer_load_dwordx4 v3, s[32:35], s62 offen lds
    s_add_u32 m0, s74, 22528
    s_add_u32 s62, s68, 82944
    buffer_load_dwordx4 v2, s[32:35], s62 offen lds
    s_add_u32 m0, s74, 23552
    s_add_u32 s62, s68, 96768
    buffer_load_dwordx4 v3, s[32:35], s62 offen lds
    s_add_u32 s68, s68, 110592
    s_waitcnt vmcnt(32)
    ds_read_b64_tr_b16 v[28:29], v4
    ds_read_b64_tr_b16 v[30:31], v4 offset:4096
    ds_read_b64_tr_b16 v[32:33], v5
    ds_read_b64_tr_b16 v[34:35], v5 offset:4096
    ds_read_b64_tr_b16 v[36:37], v6
    ds_read_b64_tr_b16 v[38:39], v6 offset:4096
    ds_read_b64_tr_b16 v[40:41], v7
    ds_read_b64_tr_b16 v[42:43], v7 offset:4096
    ds_read_b64_tr_b16 v[44:45], v8
    ds_read_b64_tr_b16 v[46:47], v8 offset:4096
    ds_read_b64_tr_b16 v[48:49], v9
    ds_read_b64_tr_b16 v[50:51], v9 offset:4096
    ds_read_b64_tr_b16 v[52:53], v10
    ds_read_b64_tr_b16 v[54:55], v10 offset:4096
    ds_read_b64_tr_b16 v[56:57], v11
    ds_read_b64_tr_b16 v[58:59], v11 offset:4096
    s_mov_b32 s70, 0
L_gf_loop:
    s_waitcnt vmcnt(16) lgkmcnt(0)
    v_mfma_f32_16x16x32_bf16 a[0:3], v[28:31], v[92:95], a[0:3]
    ds_read_b64_tr_b16 v[60:61], v4 offset:8192
    v_mfma_f32_16x16x32_bf16 a[4:7], v[28:31], v[96:99], a[4:7]
    ds_read_b64_tr_b16 v[62:63], v4 offset:12288
    v_mfma_f32_16x16x32_bf16 a[8:11], v[28:31], v[100:103], a[8:11]
    ds_read_b64_tr_b16 v[64:65], v5 offset:8192
    v_mfma_f32_16x16x32_bf16 a[12:15], v[28:31], v[104:107], a[12:15]
    ds_read_b64_tr_b16 v[66:67], v5 offset:12288
    v_mfma_f32_16x16x32_bf16 a[16:19], v[28:31], v[108:111], a[16:19]
    ds_read_b64_tr_b16 v[68:69], v6 offset:8192
    v_mfma_f32_16x16x32_bf16 a[20:23], v[28:31], v[112:115], a[20:23]
    ds_read_b64_tr_b16 v[70:71], v6 offset:12288
    v_mfma_f32_16x16x32_bf16 a[24:27], v[28:31], v[116:119], a[24:27]
    ds_read_b64_tr_b16 v[72:73], v7 offset:8192
    v_mfma_f32_16x16x32_bf16 a[28:31], v[28:31], v[120:123], a[28:31]
    ds_read_b64_tr_b16 v[74:75], v7 offset:12288
    v_mfma_f32_16x16x32_bf16 a[32:35], v[32:35], v[92:95], a[32:35]
    ds_read_b64_tr_b16 v[76:77], v8 offset:8192
    v_mfma_f32_16x16x32_bf16 a[36:39], v[32:35], v[96:99], a[36:39]
    ds_read_b64_tr_b16 v[78:79], v8 offset:12288
    v_mfma_f32_16x16x32_bf16 a[40:43], v[32:35], v[100:103], a[40:43]
    ds_read_b64_tr_b16 v[80:81], v9 offset:8192
    v_mfma_f32_16x16x32_bf16 a[44:47], v[32:35], v[104:107], a[44:47]
    ds_read_b64_tr_b16 v[82:83], v9 offset:12288
    v_mfma_f32_16x16x32_bf16 a[48:51], v[32:35], v[108:111], a[48:51]
    ds_read_b64_tr_b16 v[84:85], v10 offset:8192
    v_mfma_f32_16x16x32_bf16 a[52:55], v[32:35], v[112:115], a[52:55]
    ds_read_b64_tr_b16 v[86:87], v10 offset:12288
    v_mfma_f32_16x16x32_bf16 a[56:59], v[32:35], v[116:119], a[56:59]
    ds_read_b64_tr_b16 v[88:89], v11 offset:8192
    v_mfma_f32_16x16x32_bf16 a[60:63], v[32:35], v[120:123], a[60:63]
    ds_read_b64_tr_b16 v[90:91], v11 offset:12288
    v_mfma_f32_16x16x32_bf16 a[64:67], v[36:39], v[92:95], a[64:67]
    s_mov_b32 s63, s69
    v_mfma_f32_16x16x32_bf16 a[68:71], v[36:39], v[96:99], a[68:71]
    buffer_load_dwordx4 v[156:159], v1, s[56:59], s63 offen sc1
    v_mfma_f32_16x16x32_bf16 a[72:75], v[36:39], v[100:103], a[72:75]
    s_add_u32 s63, s63, s79
    v_mfma_f32_16x16x32_bf16 a[76:79], v[36:39], v[104:107], a[76:79]
    buffer_load_dwordx4 v[160:163], v1, s[56:59], s63 offen sc1
    v_mfma_f32_16x16x32_bf16 a[80:83], v[36:39], v[108:111], a[80:83]
    s_add_u32 s63, s63, s79
    v_mfma_f32_16x16x32_bf16 a[84:87], v[36:39], v[112:115], a[84:87]
    buffer_load_dwordx4 v[164:167], v1, s[56:59], s63 offen sc1
    v_mfma_f32_16x16x32_bf16 a[88:91], v[36:39], v[116:119], a[88:91]
    s_add_u32 s63, s63, s79
    v_mfma_f32_16x16x32_bf16 a[92:95], v[36:39], v[120:123], a[92:95]
    buffer_load_dwordx4 v[168:171], v1, s[56:59], s63 offen sc1
    v_mfma_f32_16x16x32_bf16 a[96:99], v[40:43], v[92:95], a[96:99]
    s_add_u32 s63, s63, s79
    v_mfma_f32_16x16x32_bf16 a[100:103], v[40:43], v[96:99], a[100:103]
    buffer_load_dwordx4 v[172:175], v1, s[56:59], s63 offen sc1
    v_mfma_f32_16x16x32_bf16 a[104:107], v[40:43], v[100:103], a[104:107]
    s_add_u32 s63, s63, s79
    v_mfma_f32_16x16x32_bf16 a[108:111], v[40:43], v[104:107], a[108:111]
    buffer_load_dwordx4 v[176:179], v1, s[56:59], s63 offen sc1
    v_mfma_f32_16x16x32_bf16 a[112:115], v[40:43], v[108:111], a[112:115]
    s_add_u32 s63, s63, s79
    v_mfma_f32_16x16x32_bf16 a[116:119], v[40:43], v[112:115], a[116:119]
    buffer_load_dwordx4 v[180:183], v1, s[56:59], s63 offen sc1
    v_mfma_f32_16x16x32_bf16 a[120:123], v[40:43], v[116:119], a[120:123]
    s_add_u32 s63, s63, s79
    v_mfma_f32_16x16x32_bf16 a[124:127], v[40:43], v[120:123], a[124:127]
    buffer_load_dwordx4 v[184:187], v1, s[56:59], s63 offen sc1
    v_mfma_f32_16x16x32_bf16 a[128:131], v[44:47], v[92:95], a[128:131]
    s_add_u32 s69, s69, 1024
    v_mfma_f32_16x16x32_bf16 a[132:135], v[44:47], v[96:99], a[132:135]
    s_add_u32 m0, s74, 24576
    v_mfma_f32_16x16x32_bf16 a[136:139], v[44:47], v[100:103], a[136:139]
    s_add_u32 s62, s68, 0
    v_mfma_f32_16x16x32_bf16 a[140:143], v[44:47], v[104:107], a[140:143]
    buffer_load_dwordx4 v2, s[32:35], s62 offen lds
    v_mfma_f32_16x16x32_bf16 a[144:147], v[44:47], v[108:111], a[144:147]
    s_add_u32 m0, s74, 25600
    v_mfma_f32_16x16x32_bf16 a[148:151], v[44:47], v[112:115], a[148:151]
    s_add_u32 s62, s68, 13824
    v_mfma_f32_16x16x32_bf16 a[152:155], v[44:47], v[116:119], a[152:155]
    buffer_load_dwordx4 v3, s[32:35], s62 offen lds
    v_mfma_f32_16x16x32_bf16 a[156:159], v[44:47], v[120:123], a[156:159]
    s_add_u32 m0, s74, 26624
    v_mfma_f32_16x16x32_bf16 a[160:163], v[48:51], v[92:95], a[160:163]
    s_add_u32 s62, s68, 27648
    v_mfma_f32_16x16x32_bf16 a[164:167], v[48:51], v[96:99], a[164:167]
    buffer_load_dwordx4 v2, s[32:35], s62 offen lds
    v_mfma_f32_16x16x32_bf16 a[168:171], v[48:51], v[100:103], a[168:171]
    s_add_u32 m0, s74, 27648
    v_mfma_f32_16x16x32_bf16 a[172:175], v[48:51], v[104:107], a[172:175]
    s_add_u32 s62, s68, 41472
    v_mfma_f32_16x16x32_bf16 a[176:179], v[48:51], v[108:111], a[176:179]
    buffer_load_dwordx4 v3, s[32:35], s62 offen lds
    v_mfma_f32_16x16x32_bf16 a[180:183], v[48:51], v[112:115], a[180:183]
    s_add_u32 m0, s74, 28672
    v_mfma_f32_16x16x32_bf16 a[184:187], v[48:51], v[116:119], a[184:187]
    s_add_u32 s62, s68, 55296
    v_mfma_f32_16x16x32_bf16 a[188:191], v[48:51], v[120:123], a[188:191]
    buffer_load_dwordx4 v2, s[32:35], s62 offen lds
    v_mfma_f32_16x16x32_bf16 a[192:195], v[52:55], v[92:95], a[192:195]
    s_add_u32 m0, s74, 29696
    v_mfma_f32_16x16x32_bf16 a[196:199], v[52:55], v[96:99], a[196:199]
    s_add_u32 s62, s68, 69120
    v_mfma_f32_16x16x32_bf16 a[200:203], v[52:55], v[100:103], a[200:203]
    buffer_load_dwordx4 v3, s[32:35], s62 offen lds
    v_mfma_f32_16x16x32_bf16 a[204:207], v[52:55], v[104:107], a[204:207]
    s_add_u32 m0, s74, 30720
    v_mfma_f32_16x16x32_bf16 a[208:211], v[52:55], v[108:111], a[208:211]
    s_add_u32 s62, s68, 82944
    v_mfma_f32_16x16x32_bf16 a[212:215], v[52:55], v[112:115], a[212:215]
    buffer_load_dwordx4 v2, s[32:35], s62 offen lds
    v_mfma_f32_16x16x32_bf16 a[216:219], v[52:55], v[116:119], a[216:219]
    s_add_u32 m0, s74, 31744
    v_mfma_f32_16x16x32_bf16 a[220:223], v[52:55], v[120:123], a[220:223]
    s_add_u32 s62, s68, 96768
    v_mfma_f32_16x16x32_bf16 a[224:227], v[56:59], v[92:95], a[224:227]
    buffer_load_dwordx4 v3, s[32:35], s62 offen lds
    v_mfma_f32_16x16x32_bf16 a[228:231], v[56:59], v[96:99], a[228:231]
    s_add_u32 s68, s68, 110592
    v_mfma_f32_16x16x32_bf16 a[232:235], v[56:59], v[100:103], a[232:235]
    v_mfma_f32_16x16x32_bf16 a[236:239], v[56:59], v[104:107], a[236:239]
    v_mfma_f32_16x16x32_bf16 a[240:243], v[56:59], v[108:111], a[240:243]
    v_mfma_f32_16x16x32_bf16 a[244:247], v[56:59], v[112:115], a[244:247]
    v_mfma_f32_16x16x32_bf16 a[248:251], v[56:59], v[116:119], a[248:251]
    v_mfma_f32_16x16x32_bf16 a[252:255], v[56:59], v[120:123], a[252:255]
    s_waitcnt vmcnt(16) lgkmcnt(0)
    v_mfma_f32_16x16x32_bf16 a[0:3], v[60:63], v[124:127], a[0:3]
    ds_read_b64_tr_b16 v[28:29], v4 offset:16384
    v_mfma_f32_16x16x32_bf16 a[4:7], v[60:63], v[128:131], a[4:7]
    ds_read_b64_tr_b16 v[30:31], v4 offset:20480
    v_mfma_f32_16x16x32_bf16 a[8:11], v[60:63], v[132:135], a[8:11]
    ds_read_b64_tr_b16 v[32:33], v5 offset:16384
    v_mfma_f32_16x16x32_bf16 a[12:15], v[60:63], v[136:139], a[12:15]
    ds_read_b64_tr_b16 v[34:35], v5 offset:20480
    v_mfma_f32_16x16x32_bf16 a[16:19], v[60:63], v[140:143], a[16:19]
    ds_read_b64_tr_b16 v[36:37], v6 offset:16384
    v_mfma_f32_16x16x32_bf16 a[20:23], v[60:63], v[144:147], a[20:23]
    ds_read_b64_tr_b16 v[38:39], v6 offset:20480
    v_mfma_f32_16x16x32_bf16 a[24:27], v[60:63], v[148:151], a[24:27]
    ds_read_b64_tr_b16 v[40:41], v7 offset:16384
    v_mfma_f32_16x16x32_bf16 a[28:31], v[60:63], v[152:155], a[28:31]
    ds_read_b64_tr_b16 v[42:43], v7 offset:20480
    v_mfma_f32_16x16x32_bf16 a[32:35], v[64:67], v[124:127], a[32:35]
    ds_read_b64_tr_b16 v[44:45], v8 offset:16384
    v_mfma_f32_16x16x32_bf16 a[36:39], v[64:67], v[128:131], a[36:39]
    ds_read_b64_tr_b16 v[46:47], v8 offset:20480
    v_mfma_f32_16x16x32_bf16 a[40:43], v[64:67], v[132:135], a[40:43]
    ds_read_b64_tr_b16 v[48:49], v9 offset:16384
    v_mfma_f32_16x16x32_bf16 a[44:47], v[64:67], v[136:139], a[44:47]
    ds_read_b64_tr_b16 v[50:51], v9 offset:20480
    v_mfma_f32_16x16x32_bf16 a[48:51], v[64:67], v[140:143], a[48:51]
    ds_read_b64_tr_b16 v[52:53], v10 offset:16384
    v_mfma_f32_16x16x32_bf16 a[52:55], v[64:67], v[144:147], a[52:55]
    ds_read_b64_tr_b16 v[54:55], v10 offset:20480
    v_mfma_f32_16x16x32_bf16 a[56:59], v[64:67], v[148:151], a[56:59]
    ds_read_b64_tr_b16 v[56:57], v11 offset:16384
    v_mfma_f32_16x16x32_bf16 a[60:63], v[64:67], v[152:155], a[60:63]
    ds_read_b64_tr_b16 v[58:59], v11 offset:20480
    v_mfma_f32_16x16x32_bf16 a[64:67], v[68:71], v[124:127], a[64:67]
    s_mov_b32 s63, s69
    v_mfma_f32_16x16x32_bf16 a[68:71], v[68:71], v[128:131], a[68:71]
    buffer_load_dwordx4 v[188:191], v1, s[56:59], s63 offen sc1
    v_mfma_f32_16x16x32_bf16 a[72:75], v[68:71], v[132:135], a[72:75]
    s_add_u32 s63, s63, s79
    v_mfma_f32_16x16x32_bf16 a[76:79], v[68:71], v[136:139], a[76:79]
    buffer_load_dwordx4 v[192:195], v1, s[56:59], s63 offen sc1
    v_mfma_f32_16x16x32_bf16 a[80:83], v[68:71], v[140:143], a[80:83]
    s_add_u32 s63, s63, s79
    v_mfma_f32_16x16x32_bf16 a[84:87], v[68:71], v[144:147], a[84:87]
    buffer_load_dwordx4 v[196:199], v1, s[56:59], s63 offen sc1
    v_mfma_f32_16x16x32_bf16 a[88:91], v[68:71], v[148:151], a[88:91]
    s_add_u32 s63, s63, s79
    v_mfma_f32_16x16x32_bf16 a[92:95], v[68:71], v[152:155], a[92:95]
    buffer_load_dwordx4 v[200:203], v1, s[56:59], s63 offen sc1
    v_mfma_f32_16x16x32_bf16 a[96:99], v[72:75], v[124:127], a[96:99]
    s_add_u32 s63, s63, s79
    v_mfma_f32_16x16x32_bf16 a[100:103], v[72:75], v[128:131], a[100:103]
    buffer_load_dwordx4 v[204:207], v1, s[56:59], s63 offen sc1
    v_mfma_f32_16x16x32_bf16 a[104:107], v[72:75], v[132:135], a[104:107]
    s_add_u32 s63, s63, s79
    v_mfma_f32_16x16x32_bf16 a[108:111], v[72:75], v[136:139], a[108:111]
    buffer_load_dwordx4 v[208:211], v1, s[56:59], s63 offen sc1
    v_mfma_f32_16x16x32_bf16 a[112:115], v[72:75], v[140:143], a[112:115]
    s_add_u32 s63, s63, s79
    v_mfma_f32_16x16x32_bf16 a[116:119], v[72:75], v[144:147], a[116:119]
    buffer_load_dwordx4 v[212:215], v1, s[56:59], s63 offen sc1
    v_mfma_f32_16x16x32_bf16 a[120:123], v[72:75], v[148:151], a[120:123]
    s_add_u32 s63, s63, s79
    v_mfma_f32_16x16x32_bf16 a[124:127], v[72:75], v[152:155], a[124:127]
    buffer_load_dwordx4 v[216:219], v1, s[56:59], s63 offen sc1
    v_mfma_f32_16x16x32_bf16 a[128:131], v[76:79], v[124:127], a[128:131]
    s_add_u32 s69, s69, 1024
    v_mfma_f32_16x16x32_bf16 a[132:135], v[76:79], v[128:131], a[132:135]
    s_add_u32 m0, s74, 0
    v_mfma_f32_16x16x32_bf16 a[136:139], v[76:79], v[132:135], a[136:139]
    s_add_u32 s62, s68, 0
    v_mfma_f32_16x16x32_bf16 a[140:143], v[76:79], v[136:139], a[140:143]
    buffer_load_dwordx4 v2, s[32:35], s62 offen lds
    v_mfma_f32_16x16x32_bf16 a[144:147], v[76:79], v[140:143], a[144:147]
    s_add_u32 m0, s74, 1024
    v_mfma_f32_16x16x32_bf16 a[148:151], v[76:79], v[144:147], a[148:151]
    s_add_u32 s62, s68, 13824
    v_mfma_f32_16x16x32_bf16 a[152:155], v[76:79], v[148:151], a[152:155]
    buffer_load_dwordx4 v3, s[32:35], s62 offen lds
    v_mfma_f32_16x16x32_bf16 a[156:159], v[76:79], v[152:155], a[156:159]
    s_add_u32 m0, s74, 2048
    v_mfma_f32_16x16x32_bf16 a[160:163], v[80:83], v[124:127], a[160:163]
    s_add_u32 s62, s68, 27648
    v_mfma_f32_16x16x32_bf16 a[164:167], v[80:83], v[128:131], a[164:167]
    buffer_load_dwordx4 v2, s[32:35], s62 offen lds
    v_mfma_f32_16x16x32_bf16 a[168:171], v[80:83], v[132:135], a[168:171]
    s_add_u32 m0, s74, 3072
    v_mfma_f32_16x16x32_bf16 a[172:175], v[80:83], v[136:139], a[172:175]
    s_add_u32 s62, s68, 41472
    v_mfma_f32_16x16x32_bf16 a[176:179], v[80:83], v[140:143], a[176:179]
    buffer_load_dwordx4 v3, s[32:35], s62 offen lds
    v_mfma_f32_16x16x32_bf16 a[180:183], v[80:83], v[144:147], a[180:183]
    s_add_u32 m0, s74, 4096
    v_mfma_f32_16x16x32_bf16 a[184:187], v[80:83], v[148:151], a[184:187]
    s_add_u32 s62, s68, 55296
    v_mfma_f32_16x16x32_bf16 a[188:191], v[80:83], v[152:155], a[188:191]
    buffer_load_dwordx4 v2, s[32:35], s62 offen lds
    v_mfma_f32_16x16x32_bf16 a[192:195], v[84:87], v[124:127], a[192:195]
    s_add_u32 m0, s74, 5120
    v_mfma_f32_16x16x32_bf16 a[196:199], v[84:87], v[128:131], a[196:199]
    s_add_u32 s62, s68, 69120
    v_mfma_f32_16x16x32_bf16 a[200:203], v[84:87], v[132:135], a[200:203]
    buffer_load_dwordx4 v3, s[32:35], s62 offen lds
    v_mfma_f32_16x16x32_bf16 a[204:207], v[84:87], v[136:139], a[204:207]
    s_add_u32 m0, s74, 6144
    v_mfma_f32_16x16x32_bf16 a[208:211], v[84:87], v[140:143], a[208:211]
    s_add_u32 s62, s68, 82944
    v_mfma_f32_16x16x32_bf16 a[212:215], v[84:87], v[144:147], a[212:215]
    buffer_load_dwordx4 v2, s[32:35], s62 offen lds
    v_mfma_f32_16x16x32_bf16 a[216:219], v[84:87], v[148:151], a[216:219]
    s_add_u32 m0, s74, 7168
    v_mfma_f32_16x16x32_bf16 a[220:223], v[84:87], v[152:155], a[220:223]
    s_add_u32 s62, s68, 96768
    v_mfma_f32_16x16x32_bf16 a[224:227], v[88:91], v[124:127], a[224:227]
    buffer_load_dwordx4 v3, s[32:35], s62 offen lds
    v_mfma_f32_16x16x32_bf16 a[228:231], v[88:91], v[128:131], a[228:231]
    s_add_u32 s68, s68, 110592
    v_mfma_f32_16x16x32_bf16 a[232:235], v[88:91], v[132:135], a[232:235]
    v_mfma_f32_16x16x32_bf16 a[236:239], v[88:91], v[136:139], a[236:239]
    v_mfma_f32_16x16x32_bf16 a[240:243], v[88:91], v[140:143], a[240:243]
    v_mfma_f32_16x16x32_bf16 a[244:247], v[88:91], v[144:147], a[244:247]
    v_mfma_f32_16x16x32_bf16 a[248:251], v[88:91], v[148:151], a[248:251]
    v_mfma_f32_16x16x32_bf16 a[252:255], v[88:91], v[152:155], a[252:255]
    s_waitcnt vmcnt(16) lgkmcnt(0)
    v_mfma_f32_16x16x32_bf16 a[0:3], v[28:31], v[156:159], a[0:3]
    ds_read_b64_tr_b16 v[60:61], v4 offset:24576
    v_mfma_f32_16x16x32_bf16 a[4:7], v[28:31], v[160:163], a[4:7]
    ds_read_b64_tr_b16 v[62:63], v4 offset:28672
    v_mfma_f32_16x16x32_bf16 a[8:11], v[28:31], v[164:167], a[8:11]
    ds_read_b64_tr_b16 v[64:65], v5 offset:24576
    v_mfma_f32_16x16x32_bf16 a[12:15], v[28:31], v[168:171], a[12:15]
    ds_read_b64_tr_b16 v[66:67], v5 offset:28672
    v_mfma_f32_16x16x32_bf16 a[16:19], v[28:31], v[172:175], a[16:19]
    ds_read_b64_tr_b16 v[68:69], v6 offset:24576
    v_mfma_f32_16x16x32_bf16 a[20:23], v[28:31], v[176:179], a[20:23]
    ds_read_b64_tr_b16 v[70:71], v6 offset:28672
    v_mfma_f32_16x16x32_bf16 a[24:27], v[28:31], v[180:183], a[24:27]
    ds_read_b64_tr_b16 v[72:73], v7 offset:24576
    v_mfma_f32_16x16x32_bf16 a[28:31], v[28:31], v[184:187], a[28:31]
    ds_read_b64_tr_b16 v[74:75], v7 offset:28672
    v_mfma_f32_16x16x32_bf16 a[32:35], v[32:35], v[156:159], a[32:35]
    ds_read_b64_tr_b16 v[76:77], v8 offset:24576
    v_mfma_f32_16x16x32_bf16 a[36:39], v[32:35], v[160:163], a[36:39]
    ds_read_b64_tr_b16 v[78:79], v8 offset:28672
    v_mfma_f32_16x16x32_bf16 a[40:43], v[32:35], v[164:167], a[40:43]
    ds_read_b64_tr_b16 v[80:81], v9 offset:24576
    v_mfma_f32_16x16x32_bf16 a[44:47], v[32:35], v[168:171], a[44:47]
    ds_read_b64_tr_b16 v[82:83], v9 offset:28672
    v_mfma_f32_16x16x32_bf16 a[48:51], v[32:35], v[172:175], a[48:51]
    ds_read_b64_tr_b16 v[84:85], v10 offset:24576
    v_mfma_f32_16x16x32_bf16 a[52:55], v[32:35], v[176:179], a[52:55]
    ds_read_b64_tr_b16 v[86:87], v10 offset:28672
    v_mfma_f32_16x16x32_bf16 a[56:59], v[32:35], v[180:183], a[56:59]
    ds_read_b64_tr_b16 v[88:89], v11 offset:24576
    v_mfma_f32_16x16x32_bf16 a[60:63], v[32:35], v[184:187], a[60:63]
    ds_read_b64_tr_b16 v[90:91], v11 offset:28672
    v_mfma_f32_16x16x32_bf16 a[64:67], v[36:39], v[156:159], a[64:67]
    s_mov_b32 s63, s69
    v_mfma_f32_16x16x32_bf16 a[68:71], v[36:39], v[160:163], a[68:71]
    buffer_load_dwordx4 v[92:95], v1, s[56:59], s63 offen sc1
    v_mfma_f32_16x16x32_bf16 a[72:75], v[36:39], v[164:167], a[72:75]
    s_add_u32 s63, s63, s79
    v_mfma_f32_16x16x32_bf16 a[76:79], v[36:39], v[168:171], a[76:79]
    buffer_load_dwordx4 v[96:99], v1, s[56:59], s63 offen sc1
    v_mfma_f32_16x16x32_bf16 a[80:83], v[36:39], v[172:175], a[80:83]
    s_add_u32 s63, s63, s79
    v_mfma_f32_16x16x32_bf16 a[84:87], v[36:39], v[176:179], a[84:87]
    buffer_load_dwordx4 v[100:103], v1, s[56:59], s63 offen sc1
    v_mfma_f32_16x16x32_bf16 a[88:91], v[36:39], v[180:183], a[88:91]
    s_add_u32 s63, s63, s79
    v_mfma_f32_16x16x32_bf16 a[92:95], v[36:39], v[184:187], a[92:95]
    buffer_load_dwordx4 v[104:107], v1, s[56:59], s63 offen sc1
    v_mfma_f32_16x16x32_bf16 a[96:99], v[40:43], v[156:159], a[96:99]
    s_add_u32 s63, s63, s79
    v_mfma_f32_16x16x32_bf16 a[100:103], v[40:43], v[160:163], a[100:103]
    buffer_load_dwordx4 v[108:111], v1, s[56:59], s63 offen sc1
    v_mfma_f32_16x16x32_bf16 a[104:107], v[40:43], v[164:167], a[104:107]
    s_add_u32 s63, s63, s79
    v_mfma_f32_16x16x32_bf16 a[108:111], v[40:43], v[168:171], a[108:111]
    buffer_load_dwordx4 v[112:115], v1, s[56:59], s63 offen sc1
    v_mfma_f32_16x16x32_bf16 a[112:115], v[40:43], v[172:175], a[112:115]
    s_add_u32 s63, s63, s79
    v_mfma_f32_16x16x32_bf16 a[116:119], v[40:43], v[176:179], a[116:119]
    buffer_load_dwordx4 v[116:119], v1, s[56:59], s63 offen sc1
    v_mfma_f32_16x16x32_bf16 a[120:123], v[40:43], v[180:183], a[120:123]
    s_add_u32 s63, s63, s79
    v_mfma_f32_16x16x32_bf16 a[124:127], v[40:43], v[184:187], a[124:127]
    buffer_load_dwordx4 v[120:123], v1, s[56:59], s63 offen sc1
    v_mfma_f32_16x16x32_bf16 a[128:131], v[44:47], v[156:159], a[128:131]
    s_add_u32 s69, s69, 1024
    v_mfma_f32_16x16x32_bf16 a[132:135], v[44:47], v[160:163], a[132:135]
    s_add_u32 m0, s74, 8192
    v_mfma_f32_16x16x32_bf16 a[136:139], v[44:47], v[164:167], a[136:139]
    s_add_u32 s62, s68, 0
    v_mfma_f32_16x16x32_bf16 a[140:143], v[44:47], v[168:171], a[140:143]
    buffer_load_dwordx4 v2, s[32:35], s62 offen lds
    v_mfma_f32_16x16x32_bf16 a[144:147], v[44:47], v[172:175], a[144:147]
    s_add_u32 m0, s74, 9216
    v_mfma_f32_16x16x32_bf16 a[148:151], v[44:47], v[176:179], a[148:151]
    s_add_u32 s62, s68, 13824
    v_mfma_f32_16x16x32_bf16 a[152:155], v[44:47], v[180:183], a[152:155]
    buffer_load_dwordx4 v3, s[32:35], s62 offen lds
    v_mfma_f32_16x16x32_bf16 a[156:159], v[44:47], v[184:187], a[156:159]
    s_add_u32 m0, s74, 10240
    v_mfma_f32_16x16x32_bf16 a[160:163], v[48:51], v[156:159], a[160:163]
    s_add_u32 s62, s68, 27648
    v_mfma_f32_16x16x32_bf16 a[164:167], v[48:51], v[160:163], a[164:167]
    buffer_load_dwordx4 v2, s[32:35], s62 offen lds
    v_mfma_f32_16x16x32_bf16 a[168:171], v[48:51], v[164:167], a[168:171]
    s_add_u32 m0, s74, 11264
    v_mfma_f32_16x16x32_bf16 a[172:175], v[48:51], v[168:171], a[172:175]
    s_add_u32 s62, s68, 41472
    v_mfma_f32_16x16x32_bf16 a[176:179], v[48:51], v[172:175], a[176:179]
    buffer_load_dwordx4 v3, s[32:35], s62 offen lds
    v_mfma_f32_16x16x32_bf16 a[180:183], v[48:51], v[176:179], a[180:183]
    s_add_u32 m0, s74, 12288
    v_mfma_f32_16x16x32_bf16 a[184:187], v[48:51], v[180:183], a[184:187]
    s_add_u32 s62, s68, 55296
    v_mfma_f32_16x16x32_bf16 a[188:191], v[48:51], v[184:187], a[188:191]
    buffer_load_dwordx4 v2, s[32:35], s62 offen lds
    v_mfma_f32_16x16x32_bf16 a[192:195], v[52:55], v[156:159], a[192:195]
    s_add_u32 m0, s74, 13312
    v_mfma_f32_16x16x32_bf16 a[196:199], v[52:55], v[160:163], a[196:199]
    s_add_u32 s62, s68, 69120
    v_mfma_f32_16x16x32_bf16 a[200:203], v[52:55], v[164:167], a[200:203]
    buffer_load_dwordx4 v3, s[32:35], s62 offen lds
    v_mfma_f32_16x16x32_bf16 a[204:207], v[52:55], v[168:171], a[204:207]
    s_add_u32 m0, s74, 14336
    v_mfma_f32_16x16x32_bf16 a[208:211], v[52:55], v[172:175], a[208:211]
    s_add_u32 s62, s68, 82944
    v_mfma_f32_16x16x32_bf16 a[212:215], v[52:55], v[176:179], a[212:215]
    buffer_load_dwordx4 v2, s[32:35], s62 offen lds
    v_mfma_f32_16x16x32_bf16 a[216:219], v[52:55], v[180:183], a[216:219]
    s_add_u32 m0, s74, 15360
    v_mfma_f32_16x16x32_bf16 a[220:223], v[52:55], v[184:187], a[220:223]
    s_add_u32 s62, s68, 96768
    v_mfma_f32_16x16x32_bf16 a[224:227], v[56:59], v[156:159], a[224:227]
    buffer_load_dwordx4 v3, s[32:35], s62 offen lds
    v_mfma_f32_16x16x32_bf16 a[228:231], v[56:59], v[160:163], a[228:231]
    s_add_u32 s68, s68, 110592
    v_mfma_f32_16x16x32_bf16 a[232:235], v[56:59], v[164:167], a[232:235]
    v_mfma_f32_16x16x32_bf16 a[236:239], v[56:59], v[168:171], a[236:239]
    v_mfma_f32_16x16x32_bf16 a[240:243], v[56:59], v[172:175], a[240:243]
    v_mfma_f32_16x16x32_bf16 a[244:247], v[56:59], v[176:179], a[244:247]
    v_mfma_f32_16x16x32_bf16 a[248:251], v[56:59], v[180:183], a[248:251]
    v_mfma_f32_16x16x32_bf16 a[252:255], v[56:59], v[184:187], a[252:255]
    s_waitcnt vmcnt(16) lgkmcnt(0)
    v_mfma_f32_16x16x32_bf16 a[0:3], v[60:63], v[188:191], a[0:3]
    ds_read_b64_tr_b16 v[28:29], v4
    v_mfma_f32_16x16x32_bf16 a[4:7], v[60:63], v[192:195], a[4:7]
    ds_read_b64_tr_b16 v[30:31], v4 offset:4096
    v_mfma_f32_16x16x32_bf16 a[8:11], v[60:63], v[196:199], a[8:11]
    ds_read_b64_tr_b16 v[32:33], v5
    v_mfma_f32_16x16x32_bf16 a[12:15], v[60:63], v[200:203], a[12:15]
    ds_read_b64_tr_b16 v[34:35], v5 offset:4096
    v_mfma_f32_16x16x32_bf16 a[16:19], v[60:63], v[204:207], a[16:19]
    ds_read_b64_tr_b16 v[36:37], v6
    v_mfma_f32_16x16x32_bf16 a[20:23], v[60:63], v[208:211], a[20:23]
    ds_read_b64_tr_b16 v[38:39], v6 offset:4096
    v_mfma_f32_16x16x32_bf16 a[24:27], v[60:63], v[212:215], a[24:27]
    ds_read_b64_tr_b16 v[40:41], v7
    v_mfma_f32_16x16x32_bf16 a[28:31], v[60:63], v[216:219], a[28:31]
    ds_read_b64_tr_b16 v[42:43], v7 offset:4096
    v_mfma_f32_16x16x32_bf16 a[32:35], v[64:67], v[188:191], a[32:35]
    ds_read_b64_tr_b16 v[44:45], v8
    v_mfma_f32_16x16x32_bf16 a[36:39], v[64:67], v[192:195], a[36:39]
    ds_read_b64_tr_b16 v[46:47], v8 offset:4096
    v_mfma_f32_16x16x32_bf16 a[40:43], v[64:67], v[196:199], a[40:43]
    ds_read_b64_tr_b16 v[48:49], v9
    v_mfma_f32_16x16x32_bf16 a[44:47], v[64:67], v[200:203], a[44:47]
    ds_read_b64_tr_b16 v[50:51], v9 offset:4096
    v_mfma_f32_16x16x32_bf16 a[48:51], v[64:67], v[204:207], a[48:51]
    ds_read_b64_tr_b16 v[52:53], v10
    v_mfma_f32_16x16x32_bf16 a[52:55], v[64:67], v[208:211], a[52:55]
    ds_read_b64_tr_b16 v[54:55], v10 offset:4096
    v_mfma_f32_16x16x32_bf16 a[56:59], v[64:67], v[212:215], a[56:59]
    ds_read_b64_tr_b16 v[56:57], v11
    v_mfma_f32_16x16x32_bf16 a[60:63], v[64:67], v[216:219], a[60:63]
    ds_read_b64_tr_b16 v[58:59], v11 offset:4096
    v_mfma_f32_16x16x32_bf16 a[64:67], v[68:71], v[188:191], a[64:67]
    s_mov_b32 s63, s69
    v_mfma_f32_16x16x32_bf16 a[68:71], v[68:71], v[192:195], a[68:71]
    buffer_load_dwordx4 v[124:127], v1, s[56:59], s63 offen sc1
    v_mfma_f32_16x16x32_bf16 a[72:75], v[68:71], v[196:199], a[72:75]
    s_add_u32 s63, s63, s79
    v_mfma_f32_16x16x32_bf16 a[76:79], v[68:71], v[200:203], a[76:79]
    buffer_load_dwordx4 v[128:131], v1, s[56:59], s63 offen sc1
    v_mfma_f32_16x16x32_bf16 a[80:83], v[68:71], v[204:207], a[80:83]
    s_add_u32 s63, s63, s79
    v_mfma_f32_16x16x32_bf16 a[84:87], v[68:71], v[208:211], a[84:87]
    buffer_load_dwordx4 v[132:135], v1, s[56:59], s63 offen sc1
    v_mfma_f32_16x16x32_bf16 a[88:91], v[68:71], v[212:215], a[88:91]
    s_add_u32 s63, s63, s79
    v_mfma_f32_16x16x32_bf16 a[92:95], v[68:71], v[216:219], a[92:95]
    buffer_load_dwordx4 v[136:139], v1, s[56:59], s63 offen sc1
    v_mfma_f32_16x16x32_bf16 a[96:99], v[72:75], v[188:191], a[96:99]
    s_add_u32 s63, s63, s79
    v_mfma_f32_16x16x32_bf16 a[100:103], v[72:75], v[192:195], a[100:103]
    buffer_load_dwordx4 v[140:143], v1, s[56:59], s63 offen sc1
    v_mfma_f32_16x16x32_bf16 a[104:107], v[72:75], v[196:199], a[104:107]
    s_add_u32 s63, s63, s79
    v_mfma_f32_16x16x32_bf16 a[108:111], v[72:75], v[200:203], a[108:111]
    buffer_load_dwordx4 v[144:147], v1, s[56:59], s63 offen sc1
    v_mfma_f32_16x16x32_bf16 a[112:115], v[72:75], v[204:207], a[112:115]
    s_add_u32 s63, s63, s79
    v_mfma_f32_16x16x32_bf16 a[116:119], v[72:75], v[208:211], a[116:119]
    buffer_load_dwordx4 v[148:151], v1, s[56:59], s63 offen sc1
    v_mfma_f32_16x16x32_bf16 a[120:123], v[72:75], v[212:215], a[120:123]
    s_add_u32 s63, s63, s79
    v_mfma_f32_16x16x32_bf16 a[124:127], v[72:75], v[216:219], a[124:127]
    buffer_load_dwordx4 v[152:155], v1, s[56:59], s63 offen sc1
    v_mfma_f32_16x16x32_bf16 a[128:131], v[76:79], v[188:191], a[128:131]
    s_add_u32 s69, s69, 1024
    v_mfma_f32_16x16x32_bf16 a[132:135], v[76:79], v[192:195], a[132:135]
    s_add_u32 m0, s74, 16384
    v_mfma_f32_16x16x32_bf16 a[136:139], v[76:79], v[196:199], a[136:139]
    s_add_u32 s62, s68, 0
    v_mfma_f32_16x16x32_bf16 a[140:143], v[76:79], v[200:203], a[140:143]
    buffer_load_dwordx4 v2, s[32:35], s62 offen lds
    v_mfma_f32_16x16x32_bf16 a[144:147], v[76:79], v[204:207], a[144:147]
    s_add_u32 m0, s74, 17408
    v_mfma_f32_16x16x32_bf16 a[148:151], v[76:79], v[208:211], a[148:151]
    s_add_u32 s62, s68, 13824
    v_mfma_f32_16x16x32_bf16 a[152:155], v[76:79], v[212:215], a[152:155]
    buffer_load_dwordx4 v3, s[32:35], s62 offen lds
    v_mfma_f32_16x16x32_bf16 a[156:159], v[76:79], v[216:219], a[156:159]
    s_add_u32 m0, s74, 18432
    v_mfma_f32_16x16x32_bf16 a[160:163], v[80:83], v[188:191], a[160:163]
    s_add_u32 s62, s68, 27648
    v_mfma_f32_16x16x32_bf16 a[164:167], v[80:83], v[192:195], a[164:167]
    buffer_load_dwordx4 v2, s[32:35], s62 offen lds
    v_mfma_f32_16x16x32_bf16 a[168:171], v[80:83], v[196:199], a[168:171]
    s_add_u32 m0, s74, 19456
    v_mfma_f32_16x16x32_bf16 a[172:175], v[80:83], v[200:203], a[172:175]
    s_add_u32 s62, s68, 41472
    v_mfma_f32_16x16x32_bf16 a[176:179], v[80:83], v[204:207], a[176:179]
    buffer_load_dwordx4 v3, s[32:35], s62 offen lds
    v_mfma_f32_16x16x32_bf16 a[180:183], v[80:83], v[208:211], a[180:183]
    s_add_u32 m0, s74, 20480
    v_mfma_f32_16x16x32_bf16 a[184:187], v[80:83], v[212:215], a[184:187]
    s_add_u32 s62, s68, 55296
    v_mfma_f32_16x16x32_bf16 a[188:191], v[80:83], v[216:219], a[188:191]
    buffer_load_dwordx4 v2, s[32:35], s62 offen lds
    v_mfma_f32_16x16x32_bf16 a[192:195], v[84:87], v[188:191], a[192:195]
    s_add_u32 m0, s74, 21504
    v_mfma_f32_16x16x32_bf16 a[196:199], v[84:87], v[192:195], a[196:199]
    s_add_u32 s62, s68, 69120
    v_mfma_f32_16x16x32_bf16 a[200:203], v[84:87], v[196:199], a[200:203]
    buffer_load_dwordx4 v3, s[32:35], s62 offen lds
    v_mfma_f32_16x16x32_bf16 a[204:207], v[84:87], v[200:203], a[204:207]
    s_add_u32 m0, s74, 22528
    v_mfma_f32_16x16x32_bf16 a[208:211], v[84:87], v[204:207], a[208:211]
    s_add_u32 s62, s68, 82944
    v_mfma_f32_16x16x32_bf16 a[212:215], v[84:87], v[208:211], a[212:215]
    buffer_load_dwordx4 v2, s[32:35], s62 offen lds
    v_mfma_f32_16x16x32_bf16 a[216:219], v[84:87], v[212:215], a[216:219]
    s_add_u32 m0, s74, 23552
    v_mfma_f32_16x16x32_bf16 a[220:223], v[84:87], v[216:219], a[220:223]
    s_add_u32 s62, s68, 96768
    v_mfma_f32_16x16x32_bf16 a[224:227], v[88:91], v[188:191], a[224:227]
    buffer_load_dwordx4 v3, s[32:35], s62 offen lds
    v_mfma_f32_16x16x32_bf16 a[228:231], v[88:91], v[192:195], a[228:231]
    s_add_u32 s68, s68, 110592
    v_mfma_f32_16x16x32_bf16 a[232:235], v[88:91], v[196:199], a[232:235]
    v_mfma_f32_16x16x32_bf16 a[236:239], v[88:91], v[200:203], a[236:239]
    v_mfma_f32_16x16x32_bf16 a[240:243], v[88:91], v[204:207], a[240:243]
    v_mfma_f32_16x16x32_bf16 a[244:247], v[88:91], v[208:211], a[244:247]
    v_mfma_f32_16x16x32_bf16 a[248:251], v[88:91], v[212:215], a[248:251]
    v_mfma_f32_16x16x32_bf16 a[252:255], v[88:91], v[216:219], a[252:255]
    s_add_u32 s70, s70, 4
    s_cmp_lt_u32 s70, s64
    s_cbranch_scc1 L_gf_loop
    s_waitcnt vmcnt(0) lgkmcnt(0)
    s_nop 7
    s_nop 7
    v_lshlrev_b32 v14, 3, v25
    s_lshl_b32 s62, s77, 8
    buffer_load_dwordx2 v[76:77], v14, s[36:39], s62 offen
    buffer_load_dwordx2 v[78:79], v14, s[36:39], s62 offen offset:32
    buffer_load_dwordx2 v[80:81], v14, s[36:39], s62 offen offset:64
    buffer_load_dwordx2 v[82:83], v14, s[36:39], s62 offen offset:96
    buffer_load_dwordx2 v[84:85], v14, s[36:39], s62 offen offset:128
    buffer_load_dwordx2 v[86:87], v14, s[36:39], s62 offen offset:160
    buffer_load_dwordx2 v[88:89], v14, s[36:39], s62 offen offset:192
    buffer_load_dwordx2 v[90:91], v14, s[36:39], s62 offen offset:224
    s_waitcnt vmcnt(7)
    v_lshlrev_b32 v44, 16, v76
    v_and_b32 v45, 0xffff0000, v76
    v_lshlrev_b32 v46, 16, v77
    v_and_b32 v47, 0xffff0000, v77
    s_waitcnt vmcnt(6)
    v_lshlrev_b32 v48, 16, v78
    v_and_b32 v49, 0xffff0000, v78
    v_lshlrev_b32 v50, 16, v79
    v_and_b32 v51, 0xffff0000, v79
    s_waitcnt vmcnt(5)
    v_lshlrev_b32 v52, 16, v80
    v_and_b32 v53, 0xffff0000, v80
    v_lshlrev_b32 v54, 16, v81
    v_and_b32 v55, 0xffff0000, v81
    s_waitcnt vmcnt(4)
    v_lshlrev_b32 v56, 16, v82
    v_and_b32 v57, 0xffff0000, v82
    v_lshlrev_b32 v58, 16, v83
    v_and_b32 v59, 0xffff0000, v83
    s_waitcnt vmcnt(3)
    v_lshlrev_b32 v60, 16, v84
    v_and_b32 v61, 0xffff0000, v84
    v_lshlrev_b32 v62, 16, v85
    v_and_b32 v63, 0xffff0000, v85
    s_waitcnt vmcnt(2)
    v_lshlrev_b32 v64, 16, v86
    v_and_b32 v65, 0xffff0000, v86
    v_lshlrev_b32 v66, 16, v87
    v_and_b32 v67, 0xffff0000, v87
    s_waitcnt vmcnt(1)
    v_lshlrev_b32 v68, 16, v88
    v_and_b32 v69, 0xffff0000, v88
    v_lshlrev_b32 v70, 16, v89
    v_and_b32 v71, 0xffff0000, v89
    s_waitcnt vmcnt(0)
    v_lshlrev_b32 v72, 16, v90
    v_and_b32 v73, 0xffff0000, v90
    v_lshlrev_b32 v74, 16, v91
    v_and_b32 v75, 0xffff0000, v91
    s_mul_i32 s71, s72, 458752
    s_lshl_b32 s62, s77, 12
    s_add_u32 s71, s71, s62
    s_add_u32 s71, s71, 54525952
    s_cmp_eq_u32 s77, 13
    s_cselect_b32 s66, 0, -1
    v_accvgpr_read_b32 v28, a0
    v_accvgpr_read_b32 v29, a1
    v_accvgpr_read_b32 v30, a2
    v_accvgpr_read_b32 v31, a3
    v_cvt_pk_bf16_f32 v93, v28, v29
    v_lshlrev_b32 v28, 16, v93
    v_and_b32 v29, 0xffff0000, v93
    v_add_f32 v28, v28, v44
    v_add_f32 v29, v29, v45
    v_cvt_pk_bf16_f32 v93, v28, v29
    v_lshlrev_b32 v28, 16, v93
    v_and_b32 v29, 0xffff0000, v93
    v_max_f32 v28, 0, v28
    v_max_f32 v29, 0, v29
    v_mul_f32 v28, v28, v28
    v_mul_f32 v29, v29, v29
    v_cvt_pk_bf16_f32 v36, v28, v29
    v_cvt_pk_bf16_f32 v93, v30, v31
    v_lshlrev_b32 v30, 16, v93
    v_and_b32 v31, 0xffff0000, v93
    v_add_f32 v30, v30, v46
    v_add_f32 v31, v31, v47
    v_cvt_pk_bf16_f32 v93, v30, v31
    v_lshlrev_b32 v30, 16, v93
    v_and_b32 v31, 0xffff0000, v93
    v_max_f32 v30, 0, v30
    v_max_f32 v31, 0, v31
    v_mul_f32 v30, v30, v30
    v_mul_f32 v31, v31, v31
    v_cvt_pk_bf16_f32 v37, v30, v31
    v_accvgpr_read_b32 v32, a32
    v_accvgpr_read_b32 v33, a33
    v_accvgpr_read_b32 v34, a34
    v_accvgpr_read_b32 v35, a35
    v_cvt_pk_bf16_f32 v93, v32, v33
    v_lshlrev_b32 v32, 16, v93
    v_and_b32 v33, 0xffff0000, v93
    v_add_f32 v32, v32, v48
    v_add_f32 v33, v33, v49
    v_cvt_pk_bf16_f32 v93, v32, v33
    v_lshlrev_b32 v32, 16, v93
    v_and_b32 v33, 0xffff0000, v93
    v_max_f32 v32, 0, v32
    v_max_f32 v33, 0, v33
    v_mul_f32 v32, v32, v32
    v_mul_f32 v33, v33, v33
    v_cvt_pk_bf16_f32 v38, v32, v33
    v_cvt_pk_bf16_f32 v93, v34, v35
    v_lshlrev_b32 v34, 16, v93
    v_and_b32 v35, 0xffff0000, v93
    v_add_f32 v34, v34, v50
    v_add_f32 v35, v35, v51
    v_cvt_pk_bf16_f32 v93, v34, v35
    v_lshlrev_b32 v34, 16, v93
    v_and_b32 v35, 0xffff0000, v93
    v_max_f32 v34, 0, v34
    v_max_f32 v35, 0, v35
    v_mul_f32 v34, v34, v34
    v_mul_f32 v35, v35, v35
    v_cvt_pk_bf16_f32 v39, v34, v35
    s_add_u32 s62, s71, 0
    buffer_store_dwordx4 v[36:39], v1, s[56:59], s62 offen sc1
    v_accvgpr_read_b32 v28, a64
    v_accvgpr_read_b32 v29, a65
    v_accvgpr_read_b32 v30, a66
    v_accvgpr_read_b32 v31, a67
    v_cvt_pk_bf16_f32 v93, v28, v29
    v_lshlrev_b32 v28, 16, v93
    v_and_b32 v29, 0xffff0000, v93
    v_add_f32 v28, v28, v52
    v_add_f32 v29, v29, v53
    v_cvt_pk_bf16_f32 v93, v28, v29
    v_lshlrev_b32 v28, 16, v93
    v_and_b32 v29, 0xffff0000, v93
    v_max_f32 v28, 0, v28
    v_max_f32 v29, 0, v29
    v_mul_f32 v28, v28, v28
    v_mul_f32 v29, v29, v29
    v_cvt_pk_bf16_f32 v40, v28, v29
    v_cvt_pk_bf16_f32 v93, v30, v31
    v_lshlrev_b32 v30, 16, v93
    v_and_b32 v31, 0xffff0000, v93
    v_add_f32 v30, v30, v54
    v_add_f32 v31, v31, v55
    v_cvt_pk_bf16_f32 v93, v30, v31
    v_lshlrev_b32 v30, 16, v93
    v_and_b32 v31, 0xffff0000, v93
    v_max_f32 v30, 0, v30
    v_max_f32 v31, 0, v31
    v_mul_f32 v30, v30, v30
    v_mul_f32 v31, v31, v31
    v_cvt_pk_bf16_f32 v41, v30, v31
    v_accvgpr_read_b32 v32, a96
    v_accvgpr_read_b32 v33, a97
    v_accvgpr_read_b32 v34, a98
    v_accvgpr_read_b32 v35, a99
    v_cvt_pk_bf16_f32 v93, v32, v33
    v_lshlrev_b32 v32, 16, v93
    v_and_b32 v33, 0xffff0000, v93
    v_add_f32 v32, v32, v56
    v_add_f32 v33, v33, v57
    v_cvt_pk_bf16_f32 v93, v32, v33
    v_lshlrev_b32 v32, 16, v93
    v_and_b32 v33, 0xffff0000, v93
    v_max_f32 v32, 0, v32
    v_max_f32 v33, 0, v33
    v_mul_f32 v32, v32, v32
    v_mul_f32 v33, v33, v33
    v_cvt_pk_bf16_f32 v42, v32, v33
    v_cvt_pk_bf16_f32 v93, v34, v35
    v_lshlrev_b32 v34, 16, v93
    v_and_b32 v35, 0xffff0000, v93
    v_add_f32 v34, v34, v58
    v_add_f32 v35, v35, v59
    v_cvt_pk_bf16_f32 v93, v34, v35
    v_lshlrev_b32 v34, 16, v93
    v_and_b32 v35, 0xffff0000, v93
    v_max_f32 v34, 0, v34
    v_max_f32 v35, 0, v35
    v_mul_f32 v34, v34, v34
    v_mul_f32 v35, v35, v35
    v_cvt_pk_bf16_f32 v43, v34, v35
    s_add_u32 s62, s71, 0
    buffer_store_dwordx4 v[40:43], v1, s[56:59], s62 offen offset:1024 sc1
    v_accvgpr_read_b32 v28, a128
    v_accvgpr_read_b32 v29, a129
    v_accvgpr_read_b32 v30, a130
    v_accvgpr_read_b32 v31, a131
    v_cvt_pk_bf16_f32 v93, v28, v29
    v_lshlrev_b32 v28, 16, v93
    v_and_b32 v29, 0xffff0000, v93
    v_add_f32 v28, v28, v60
    v_add_f32 v29, v29, v61
    v_cvt_pk_bf16_f32 v93, v28, v29
    v_lshlrev_b32 v28, 16, v93
    v_and_b32 v29, 0xffff0000, v93
    v_max_f32 v28, 0, v28
    v_max_f32 v29, 0, v29
    v_mul_f32 v28, v28, v28
    v_mul_f32 v29, v29, v29
    v_cvt_pk_bf16_f32 v36, v28, v29
    v_and_b32 v36, s66, v36
    v_cvt_pk_bf16_f32 v93, v30, v31
    v_lshlrev_b32 v30, 16, v93
    v_and_b32 v31, 0xffff0000, v93
    v_add_f32 v30, v30, v62
    v_add_f32 v31, v31, v63
    v_cvt_pk_bf16_f32 v93, v30, v31
    v_lshlrev_b32 v30, 16, v93
    v_and_b32 v31, 0xffff0000, v93
    v_max_f32 v30, 0, v30
    v_max_f32 v31, 0, v31
    v_mul_f32 v30, v30, v30
    v_mul_f32 v31, v31, v31
    v_cvt_pk_bf16_f32 v37, v30, v31
    v_and_b32 v37, s66, v37
    v_accvgpr_read_b32 v32, a160
    v_accvgpr_read_b32 v33, a161
    v_accvgpr_read_b32 v34, a162
    v_accvgpr_read_b32 v35, a163
    v_cvt_pk_bf16_f32 v93, v32, v33
    v_lshlrev_b32 v32, 16, v93
    v_and_b32 v33, 0xffff0000, v93
    v_add_f32 v32, v32, v64
    v_add_f32 v33, v33, v65
    v_cvt_pk_bf16_f32 v93, v32, v33
    v_lshlrev_b32 v32, 16, v93
    v_and_b32 v33, 0xffff0000, v93
    v_max_f32 v32, 0, v32
    v_max_f32 v33, 0, v33
    v_mul_f32 v32, v32, v32
    v_mul_f32 v33, v33, v33
    v_cvt_pk_bf16_f32 v38, v32, v33
    v_and_b32 v38, s66, v38
    v_cvt_pk_bf16_f32 v93, v34, v35
    v_lshlrev_b32 v34, 16, v93
    v_and_b32 v35, 0xffff0000, v93
    v_add_f32 v34, v34, v66
    v_add_f32 v35, v35, v67
    v_cvt_pk_bf16_f32 v93, v34, v35
    v_lshlrev_b32 v34, 16, v93
    v_and_b32 v35, 0xffff0000, v93
    v_max_f32 v34, 0, v34
    v_max_f32 v35, 0, v35
    v_mul_f32 v34, v34, v34
    v_mul_f32 v35, v35, v35
    v_cvt_pk_bf16_f32 v39, v34, v35
    v_and_b32 v39, s66, v39
    s_add_u32 s62, s71, 0
    buffer_store_dwordx4 v[36:39], v1, s[56:59], s62 offen offset:2048 sc1
    v_accvgpr_read_b32 v28, a192
    v_accvgpr_read_b32 v29, a193
    v_accvgpr_read_b32 v30, a194
    v_accvgpr_read_b32 v31, a195
    v_cvt_pk_bf16_f32 v93, v28, v29
    v_lshlrev_b32 v28, 16, v93
    v_and_b32 v29, 0xffff0000, v93
    v_add_f32 v28, v28, v68
    v_add_f32 v29, v29, v69
    v_cvt_pk_bf16_f32 v93, v28, v29
    v_lshlrev_b32 v28, 16, v93
    v_and_b32 v29, 0xffff0000, v93
    v_max_f32 v28, 0, v28
    v_max_f32 v29, 0, v29
    v_mul_f32 v28, v28, v28
    v_mul_f32 v29, v29, v29
    v_cvt_pk_bf16_f32 v40, v28, v29
    v_and_b32 v40, s66, v40
    v_cvt_pk_bf16_f32 v93, v30, v31
    v_lshlrev_b32 v30, 16, v93
    v_and_b32 v31, 0xffff0000, v93
    v_add_f32 v30, v30, v70
    v_add_f32 v31, v31, v71
    v_cvt_pk_bf16_f32 v93, v30, v31
    v_lshlrev_b32 v30, 16, v93
    v_and_b32 v31, 0xffff0000, v93
    v_max_f32 v30, 0, v30
    v_max_f32 v31, 0, v31
    v_mul_f32 v30, v30, v30
    v_mul_f32 v31, v31, v31
    v_cvt_pk_bf16_f32 v41, v30, v31
    v_and_b32 v41, s66, v41
    v_accvgpr_read_b32 v32, a224
    v_accvgpr_read_b32 v33, a225
    v_accvgpr_read_b32 v34, a226
    v_accvgpr_read_b32 v35, a227
    v_cvt_pk_bf16_f32 v93, v32, v33
    v_lshlrev_b32 v32, 16, v93
    v_and_b32 v33, 0xffff0000, v93
    v_add_f32 v32, v32, v72
    v_add_f32 v33, v33, v73
    v_cvt_pk_bf16_f32 v93, v32, v33
    v_lshlrev_b32 v32, 16, v93
    v_and_b32 v33, 0xffff0000, v93
    v_max_f32 v32, 0, v32
    v_max_f32 v33, 0, v33
    v_mul_f32 v32, v32, v32
    v_mul_f32 v33, v33, v33
    v_cvt_pk_bf16_f32 v42, v32, v33
    v_and_b32 v42, s66, v42
    v_cvt_pk_bf16_f32 v93, v34, v35
    v_lshlrev_b32 v34, 16, v93
    v_and_b32 v35, 0xffff0000, v93
    v_add_f32 v34, v34, v74
    v_add_f32 v35, v35, v75
    v_cvt_pk_bf16_f32 v93, v34, v35
    v_lshlrev_b32 v34, 16, v93
    v_and_b32 v35, 0xffff0000, v93
    v_max_f32 v34, 0, v34
    v_max_f32 v35, 0, v35
    v_mul_f32 v34, v34, v34
    v_mul_f32 v35, v35, v35
    v_cvt_pk_bf16_f32 v43, v34, v35
    v_and_b32 v43, s66, v43
    s_add_u32 s62, s71, 0
    buffer_store_dwordx4 v[40:43], v1, s[56:59], s62 offen offset:3072 sc1
    v_accvgpr_read_b32 v28, a4
    v_accvgpr_read_b32 v29, a5
    v_accvgpr_read_b32 v30, a6
    v_accvgpr_read_b32 v31, a7
    v_cvt_pk_bf16_f32 v93, v28, v29
    v_lshlrev_b32 v28, 16, v93
    v_and_b32 v29, 0xffff0000, v93
    v_add_f32 v28, v28, v44
    v_add_f32 v29, v29, v45
    v_cvt_pk_bf16_f32 v93, v28, v29
    v_lshlrev_b32 v28, 16, v93
    v_and_b32 v29, 0xffff0000, v93
    v_max_f32 v28, 0, v28
    v_max_f32 v29, 0, v29
    v_mul_f32 v28, v28, v28
    v_mul_f32 v29, v29, v29
    v_cvt_pk_bf16_f32 v36, v28, v29
    v_cvt_pk_bf16_f32 v93, v30, v31
    v_lshlrev_b32 v30, 16, v93
    v_and_b32 v31, 0xffff0000, v93
    v_add_f32 v30, v30, v46
    v_add_f32 v31, v31, v47
    v_cvt_pk_bf16_f32 v93, v30, v31
    v_lshlrev_b32 v30, 16, v93
    v_and_b32 v31, 0xffff0000, v93
    v_max_f32 v30, 0, v30
    v_max_f32 v31, 0, v31
    v_mul_f32 v30, v30, v30
    v_mul_f32 v31, v31, v31
    v_cvt_pk_bf16_f32 v37, v30, v31
    v_accvgpr_read_b32 v32, a36
    v_accvgpr_read_b32 v33, a37
    v_accvgpr_read_b32 v34, a38
    v_accvgpr_read_b32 v35, a39
    v_cvt_pk_bf16_f32 v93, v32, v33
    v_lshlrev_b32 v32, 16, v93
    v_and_b32 v33, 0xffff0000, v93
    v_add_f32 v32, v32, v48
    v_add_f32 v33, v33, v49
    v_cvt_pk_bf16_f32 v93, v32, v33
    v_lshlrev_b32 v32, 16, v93
    v_and_b32 v33, 0xffff0000, v93
    v_max_f32 v32, 0, v32
    v_max_f32 v33, 0, v33
    v_mul_f32 v32, v32, v32
    v_mul_f32 v33, v33, v33
    v_cvt_pk_bf16_f32 v38, v32, v33
    v_cvt_pk_bf16_f32 v93, v34, v35
    v_lshlrev_b32 v34, 16, v93
    v_and_b32 v35, 0xffff0000, v93
    v_add_f32 v34, v34, v50
    v_add_f32 v35, v35, v51
    v_cvt_pk_bf16_f32 v93, v34, v35
    v_lshlrev_b32 v34, 16, v93
    v_and_b32 v35, 0xffff0000, v93
    v_max_f32 v34, 0, v34
    v_max_f32 v35, 0, v35
    v_mul_f32 v34, v34, v34
    v_mul_f32 v35, v35, v35
    v_cvt_pk_bf16_f32 v39, v34, v35
    s_add_u32 s62, s71, 57344
    buffer_store_dwordx4 v[36:39], v1, s[56:59], s62 offen sc1
    v_accvgpr_read_b32 v28, a68
    v_accvgpr_read_b32 v29, a69
    v_accvgpr_read_b32 v30, a70
    v_accvgpr_read_b32 v31, a71
    v_cvt_pk_bf16_f32 v93, v28, v29
    v_lshlrev_b32 v28, 16, v93
    v_and_b32 v29, 0xffff0000, v93
    v_add_f32 v28, v28, v52
    v_add_f32 v29, v29, v53
    v_cvt_pk_bf16_f32 v93, v28, v29
    v_lshlrev_b32 v28, 16, v93
    v_and_b32 v29, 0xffff0000, v93
    v_max_f32 v28, 0, v28
    v_max_f32 v29, 0, v29
    v_mul_f32 v28, v28, v28
    v_mul_f32 v29, v29, v29
    v_cvt_pk_bf16_f32 v40, v28, v29
    v_cvt_pk_bf16_f32 v93, v30, v31
    v_lshlrev_b32 v30, 16, v93
    v_and_b32 v31, 0xffff0000, v93
    v_add_f32 v30, v30, v54
    v_add_f32 v31, v31, v55
    v_cvt_pk_bf16_f32 v93, v30, v31
    v_lshlrev_b32 v30, 16, v93
    v_and_b32 v31, 0xffff0000, v93
    v_max_f32 v30, 0, v30
    v_max_f32 v31, 0, v31
    v_mul_f32 v30, v30, v30
    v_mul_f32 v31, v31, v31
    v_cvt_pk_bf16_f32 v41, v30, v31
    v_accvgpr_read_b32 v32, a100
    v_accvgpr_read_b32 v33, a101
    v_accvgpr_read_b32 v34, a102
    v_accvgpr_read_b32 v35, a103
    v_cvt_pk_bf16_f32 v93, v32, v33
    v_lshlrev_b32 v32, 16, v93
    v_and_b32 v33, 0xffff0000, v93
    v_add_f32 v32, v32, v56
    v_add_f32 v33, v33, v57
    v_cvt_pk_bf16_f32 v93, v32, v33
    v_lshlrev_b32 v32, 16, v93
    v_and_b32 v33, 0xffff0000, v93
    v_max_f32 v32, 0, v32
    v_max_f32 v33, 0, v33
    v_mul_f32 v32, v32, v32
    v_mul_f32 v33, v33, v33
    v_cvt_pk_bf16_f32 v42, v32, v33
    v_cvt_pk_bf16_f32 v93, v34, v35
    v_lshlrev_b32 v34, 16, v93
    v_and_b32 v35, 0xffff0000, v93
    v_add_f32 v34, v34, v58
    v_add_f32 v35, v35, v59
    v_cvt_pk_bf16_f32 v93, v34, v35
    v_lshlrev_b32 v34, 16, v93
    v_and_b32 v35, 0xffff0000, v93
    v_max_f32 v34, 0, v34
    v_max_f32 v35, 0, v35
    v_mul_f32 v34, v34, v34
    v_mul_f32 v35, v35, v35
    v_cvt_pk_bf16_f32 v43, v34, v35
    s_add_u32 s62, s71, 57344
    buffer_store_dwordx4 v[40:43], v1, s[56:59], s62 offen offset:1024 sc1
    v_accvgpr_read_b32 v28, a132
    v_accvgpr_read_b32 v29, a133
    v_accvgpr_read_b32 v30, a134
    v_accvgpr_read_b32 v31, a135
    v_cvt_pk_bf16_f32 v93, v28, v29
    v_lshlrev_b32 v28, 16, v93
    v_and_b32 v29, 0xffff0000, v93
    v_add_f32 v28, v28, v60
    v_add_f32 v29, v29, v61
    v_cvt_pk_bf16_f32 v93, v28, v29
    v_lshlrev_b32 v28, 16, v93
    v_and_b32 v29, 0xffff0000, v93
    v_max_f32 v28, 0, v28
    v_max_f32 v29, 0, v29
    v_mul_f32 v28, v28, v28
    v_mul_f32 v29, v29, v29
    v_cvt_pk_bf16_f32 v36, v28, v29
    v_and_b32 v36, s66, v36
    v_cvt_pk_bf16_f32 v93, v30, v31
    v_lshlrev_b32 v30, 16, v93
    v_and_b32 v31, 0xffff0000, v93
    v_add_f32 v30, v30, v62
    v_add_f32 v31, v31, v63
    v_cvt_pk_bf16_f32 v93, v30, v31
    v_lshlrev_b32 v30, 16, v93
    v_and_b32 v31, 0xffff0000, v93
    v_max_f32 v30, 0, v30
    v_max_f32 v31, 0, v31
    v_mul_f32 v30, v30, v30
    v_mul_f32 v31, v31, v31
    v_cvt_pk_bf16_f32 v37, v30, v31
    v_and_b32 v37, s66, v37
    v_accvgpr_read_b32 v32, a164
    v_accvgpr_read_b32 v33, a165
    v_accvgpr_read_b32 v34, a166
    v_accvgpr_read_b32 v35, a167
    v_cvt_pk_bf16_f32 v93, v32, v33
    v_lshlrev_b32 v32, 16, v93
    v_and_b32 v33, 0xffff0000, v93
    v_add_f32 v32, v32, v64
    v_add_f32 v33, v33, v65
    v_cvt_pk_bf16_f32 v93, v32, v33
    v_lshlrev_b32 v32, 16, v93
    v_and_b32 v33, 0xffff0000, v93
    v_max_f32 v32, 0, v32
    v_max_f32 v33, 0, v33
    v_mul_f32 v32, v32, v32
    v_mul_f32 v33, v33, v33
    v_cvt_pk_bf16_f32 v38, v32, v33
    v_and_b32 v38, s66, v38
    v_cvt_pk_bf16_f32 v93, v34, v35
    v_lshlrev_b32 v34, 16, v93
    v_and_b32 v35, 0xffff0000, v93
    v_add_f32 v34, v34, v66
    v_add_f32 v35, v35, v67
    v_cvt_pk_bf16_f32 v93, v34, v35
    v_lshlrev_b32 v34, 16, v93
    v_and_b32 v35, 0xffff0000, v93
    v_max_f32 v34, 0, v34
    v_max_f32 v35, 0, v35
    v_mul_f32 v34, v34, v34
    v_mul_f32 v35, v35, v35
    v_cvt_pk_bf16_f32 v39, v34, v35
    v_and_b32 v39, s66, v39
    s_add_u32 s62, s71, 57344
    buffer_store_dwordx4 v[36:39], v1, s[56:59], s62 offen offset:2048 sc1
    v_accvgpr_read_b32 v28, a196
    v_accvgpr_read_b32 v29, a197
    v_accvgpr_read_b32 v30, a198
    v_accvgpr_read_b32 v31, a199
    v_cvt_pk_bf16_f32 v93, v28, v29
    v_lshlrev_b32 v28, 16, v93
    v_and_b32 v29, 0xffff0000, v93
    v_add_f32 v28, v28, v68
    v_add_f32 v29, v29, v69
    v_cvt_pk_bf16_f32 v93, v28, v29
    v_lshlrev_b32 v28, 16, v93
    v_and_b32 v29, 0xffff0000, v93
    v_max_f32 v28, 0, v28
    v_max_f32 v29, 0, v29
    v_mul_f32 v28, v28, v28
    v_mul_f32 v29, v29, v29
    v_cvt_pk_bf16_f32 v40, v28, v29
    v_and_b32 v40, s66, v40
    v_cvt_pk_bf16_f32 v93, v30, v31
    v_lshlrev_b32 v30, 16, v93
    v_and_b32 v31, 0xffff0000, v93
    v_add_f32 v30, v30, v70
    v_add_f32 v31, v31, v71
    v_cvt_pk_bf16_f32 v93, v30, v31
    v_lshlrev_b32 v30, 16, v93
    v_and_b32 v31, 0xffff0000, v93
    v_max_f32 v30, 0, v30
    v_max_f32 v31, 0, v31
    v_mul_f32 v30, v30, v30
    v_mul_f32 v31, v31, v31
    v_cvt_pk_bf16_f32 v41, v30, v31
    v_and_b32 v41, s66, v41
    v_accvgpr_read_b32 v32, a228
    v_accvgpr_read_b32 v33, a229
    v_accvgpr_read_b32 v34, a230
    v_accvgpr_read_b32 v35, a231
    v_cvt_pk_bf16_f32 v93, v32, v33
    v_lshlrev_b32 v32, 16, v93
    v_and_b32 v33, 0xffff0000, v93
    v_add_f32 v32, v32, v72
    v_add_f32 v33, v33, v73
    v_cvt_pk_bf16_f32 v93, v32, v33
    v_lshlrev_b32 v32, 16, v93
    v_and_b32 v33, 0xffff0000, v93
    v_max_f32 v32, 0, v32
    v_max_f32 v33, 0, v33
    v_mul_f32 v32, v32, v32
    v_mul_f32 v33, v33, v33
    v_cvt_pk_bf16_f32 v42, v32, v33
    v_and_b32 v42, s66, v42
    v_cvt_pk_bf16_f32 v93, v34, v35
    v_lshlrev_b32 v34, 16, v93
    v_and_b32 v35, 0xffff0000, v93
    v_add_f32 v34, v34, v74
    v_add_f32 v35, v35, v75
    v_cvt_pk_bf16_f32 v93, v34, v35
    v_lshlrev_b32 v34, 16, v93
    v_and_b32 v35, 0xffff0000, v93
    v_max_f32 v34, 0, v34
    v_max_f32 v35, 0, v35
    v_mul_f32 v34, v34, v34
    v_mul_f32 v35, v35, v35
    v_cvt_pk_bf16_f32 v43, v34, v35
    v_and_b32 v43, s66, v43
    s_add_u32 s62, s71, 57344
    buffer_store_dwordx4 v[40:43], v1, s[56:59], s62 offen offset:3072 sc1
    v_accvgpr_read_b32 v28, a8
    v_accvgpr_read_b32 v29, a9
    v_accvgpr_read_b32 v30, a10
    v_accvgpr_read_b32 v31, a11
    v_cvt_pk_bf16_f32 v93, v28, v29
    v_lshlrev_b32 v28, 16, v93
    v_and_b32 v29, 0xffff0000, v93
    v_add_f32 v28, v28, v44
    v_add_f32 v29, v29, v45
    v_cvt_pk_bf16_f32 v93, v28, v29
    v_lshlrev_b32 v28, 16, v93
    v_and_b32 v29, 0xffff0000, v93
    v_max_f32 v28, 0, v28
    v_max_f32 v29, 0, v29
    v_mul_f32 v28, v28, v28
    v_mul_f32 v29, v29, v29
    v_cvt_pk_bf16_f32 v36, v28, v29
    v_cvt_pk_bf16_f32 v93, v30, v31
    v_lshlrev_b32 v30, 16, v93
    v_and_b32 v31, 0xffff0000, v93
    v_add_f32 v30, v30, v46
    v_add_f32 v31, v31, v47
    v_cvt_pk_bf16_f32 v93, v30, v31
    v_lshlrev_b32 v30, 16, v93
    v_and_b32 v31, 0xffff0000, v93
    v_max_f32 v30, 0, v30
    v_max_f32 v31, 0, v31
    v_mul_f32 v30, v30, v30
    v_mul_f32 v31, v31, v31
    v_cvt_pk_bf16_f32 v37, v30, v31
    v_accvgpr_read_b32 v32, a40
    v_accvgpr_read_b32 v33, a41
    v_accvgpr_read_b32 v34, a42
    v_accvgpr_read_b32 v35, a43
    v_cvt_pk_bf16_f32 v93, v32, v33
    v_lshlrev_b32 v32, 16, v93
    v_and_b32 v33, 0xffff0000, v93
    v_add_f32 v32, v32, v48
    v_add_f32 v33, v33, v49
    v_cvt_pk_bf16_f32 v93, v32, v33
    v_lshlrev_b32 v32, 16, v93
    v_and_b32 v33, 0xffff0000, v93
    v_max_f32 v32, 0, v32
    v_max_f32 v33, 0, v33
    v_mul_f32 v32, v32, v32
    v_mul_f32 v33, v33, v33
    v_cvt_pk_bf16_f32 v38, v32, v33
    v_cvt_pk_bf16_f32 v93, v34, v35
    v_lshlrev_b32 v34, 16, v93
    v_and_b32 v35, 0xffff0000, v93
    v_add_f32 v34, v34, v50
    v_add_f32 v35, v35, v51
    v_cvt_pk_bf16_f32 v93, v34, v35
    v_lshlrev_b32 v34, 16, v93
    v_and_b32 v35, 0xffff0000, v93
    v_max_f32 v34, 0, v34
    v_max_f32 v35, 0, v35
    v_mul_f32 v34, v34, v34
    v_mul_f32 v35, v35, v35
    v_cvt_pk_bf16_f32 v39, v34, v35
    s_add_u32 s62, s71, 114688
    buffer_store_dwordx4 v[36:39], v1, s[56:59], s62 offen sc1
    v_accvgpr_read_b32 v28, a72
    v_accvgpr_read_b32 v29, a73
    v_accvgpr_read_b32 v30, a74
    v_accvgpr_read_b32 v31, a75
    v_cvt_pk_bf16_f32 v93, v28, v29
    v_lshlrev_b32 v28, 16, v93
    v_and_b32 v29, 0xffff0000, v93
    v_add_f32 v28, v28, v52
    v_add_f32 v29, v29, v53
    v_cvt_pk_bf16_f32 v93, v28, v29
    v_lshlrev_b32 v28, 16, v93
    v_and_b32 v29, 0xffff0000, v93
    v_max_f32 v28, 0, v28
    v_max_f32 v29, 0, v29
    v_mul_f32 v28, v28, v28
    v_mul_f32 v29, v29, v29
    v_cvt_pk_bf16_f32 v40, v28, v29
    v_cvt_pk_bf16_f32 v93, v30, v31
    v_lshlrev_b32 v30, 16, v93
    v_and_b32 v31, 0xffff0000, v93
    v_add_f32 v30, v30, v54
    v_add_f32 v31, v31, v55
    v_cvt_pk_bf16_f32 v93, v30, v31
    v_lshlrev_b32 v30, 16, v93
    v_and_b32 v31, 0xffff0000, v93
    v_max_f32 v30, 0, v30
    v_max_f32 v31, 0, v31
    v_mul_f32 v30, v30, v30
    v_mul_f32 v31, v31, v31
    v_cvt_pk_bf16_f32 v41, v30, v31
    v_accvgpr_read_b32 v32, a104
    v_accvgpr_read_b32 v33, a105
    v_accvgpr_read_b32 v34, a106
    v_accvgpr_read_b32 v35, a107
    v_cvt_pk_bf16_f32 v93, v32, v33
    v_lshlrev_b32 v32, 16, v93
    v_and_b32 v33, 0xffff0000, v93
    v_add_f32 v32, v32, v56
    v_add_f32 v33, v33, v57
    v_cvt_pk_bf16_f32 v93, v32, v33
    v_lshlrev_b32 v32, 16, v93
    v_and_b32 v33, 0xffff0000, v93
    v_max_f32 v32, 0, v32
    v_max_f32 v33, 0, v33
    v_mul_f32 v32, v32, v32
    v_mul_f32 v33, v33, v33
    v_cvt_pk_bf16_f32 v42, v32, v33
    v_cvt_pk_bf16_f32 v93, v34, v35
    v_lshlrev_b32 v34, 16, v93
    v_and_b32 v35, 0xffff0000, v93
    v_add_f32 v34, v34, v58
    v_add_f32 v35, v35, v59
    v_cvt_pk_bf16_f32 v93, v34, v35
    v_lshlrev_b32 v34, 16, v93
    v_and_b32 v35, 0xffff0000, v93
    v_max_f32 v34, 0, v34
    v_max_f32 v35, 0, v35
    v_mul_f32 v34, v34, v34
    v_mul_f32 v35, v35, v35
    v_cvt_pk_bf16_f32 v43, v34, v35
    s_add_u32 s62, s71, 114688
    buffer_store_dwordx4 v[40:43], v1, s[56:59], s62 offen offset:1024 sc1
    v_accvgpr_read_b32 v28, a136
    v_accvgpr_read_b32 v29, a137
    v_accvgpr_read_b32 v30, a138
    v_accvgpr_read_b32 v31, a139
    v_cvt_pk_bf16_f32 v93, v28, v29
    v_lshlrev_b32 v28, 16, v93
    v_and_b32 v29, 0xffff0000, v93
    v_add_f32 v28, v28, v60
    v_add_f32 v29, v29, v61
    v_cvt_pk_bf16_f32 v93, v28, v29
    v_lshlrev_b32 v28, 16, v93
    v_and_b32 v29, 0xffff0000, v93
    v_max_f32 v28, 0, v28
    v_max_f32 v29, 0, v29
    v_mul_f32 v28, v28, v28
    v_mul_f32 v29, v29, v29
    v_cvt_pk_bf16_f32 v36, v28, v29
    v_and_b32 v36, s66, v36
    v_cvt_pk_bf16_f32 v93, v30, v31
    v_lshlrev_b32 v30, 16, v93
    v_and_b32 v31, 0xffff0000, v93
    v_add_f32 v30, v30, v62
    v_add_f32 v31, v31, v63
    v_cvt_pk_bf16_f32 v93, v30, v31
    v_lshlrev_b32 v30, 16, v93
    v_and_b32 v31, 0xffff0000, v93
    v_max_f32 v30, 0, v30
    v_max_f32 v31, 0, v31
    v_mul_f32 v30, v30, v30
    v_mul_f32 v31, v31, v31
    v_cvt_pk_bf16_f32 v37, v30, v31
    v_and_b32 v37, s66, v37
    v_accvgpr_read_b32 v32, a168
    v_accvgpr_read_b32 v33, a169
    v_accvgpr_read_b32 v34, a170
    v_accvgpr_read_b32 v35, a171
    v_cvt_pk_bf16_f32 v93, v32, v33
    v_lshlrev_b32 v32, 16, v93
    v_and_b32 v33, 0xffff0000, v93
    v_add_f32 v32, v32, v64
    v_add_f32 v33, v33, v65
    v_cvt_pk_bf16_f32 v93, v32, v33
    v_lshlrev_b32 v32, 16, v93
    v_and_b32 v33, 0xffff0000, v93
    v_max_f32 v32, 0, v32
    v_max_f32 v33, 0, v33
    v_mul_f32 v32, v32, v32
    v_mul_f32 v33, v33, v33
    v_cvt_pk_bf16_f32 v38, v32, v33
    v_and_b32 v38, s66, v38
    v_cvt_pk_bf16_f32 v93, v34, v35
    v_lshlrev_b32 v34, 16, v93
    v_and_b32 v35, 0xffff0000, v93
    v_add_f32 v34, v34, v66
    v_add_f32 v35, v35, v67
    v_cvt_pk_bf16_f32 v93, v34, v35
    v_lshlrev_b32 v34, 16, v93
    v_and_b32 v35, 0xffff0000, v93
    v_max_f32 v34, 0, v34
    v_max_f32 v35, 0, v35
    v_mul_f32 v34, v34, v34
    v_mul_f32 v35, v35, v35
    v_cvt_pk_bf16_f32 v39, v34, v35
    v_and_b32 v39, s66, v39
    s_add_u32 s62, s71, 114688
    buffer_store_dwordx4 v[36:39], v1, s[56:59], s62 offen offset:2048 sc1
    v_accvgpr_read_b32 v28, a200
    v_accvgpr_read_b32 v29, a201
    v_accvgpr_read_b32 v30, a202
    v_accvgpr_read_b32 v31, a203
    v_cvt_pk_bf16_f32 v93, v28, v29
    v_lshlrev_b32 v28, 16, v93
    v_and_b32 v29, 0xffff0000, v93
    v_add_f32 v28, v28, v68
    v_add_f32 v29, v29, v69
    v_cvt_pk_bf16_f32 v93, v28, v29
    v_lshlrev_b32 v28, 16, v93
    v_and_b32 v29, 0xffff0000, v93
    v_max_f32 v28, 0, v28
    v_max_f32 v29, 0, v29
    v_mul_f32 v28, v28, v28
    v_mul_f32 v29, v29, v29
    v_cvt_pk_bf16_f32 v40, v28, v29
    v_and_b32 v40, s66, v40
    v_cvt_pk_bf16_f32 v93, v30, v31
    v_lshlrev_b32 v30, 16, v93
    v_and_b32 v31, 0xffff0000, v93
    v_add_f32 v30, v30, v70
    v_add_f32 v31, v31, v71
    v_cvt_pk_bf16_f32 v93, v30, v31
    v_lshlrev_b32 v30, 16, v93
    v_and_b32 v31, 0xffff0000, v93
    v_max_f32 v30, 0, v30
    v_max_f32 v31, 0, v31
    v_mul_f32 v30, v30, v30
    v_mul_f32 v31, v31, v31
    v_cvt_pk_bf16_f32 v41, v30, v31
    v_and_b32 v41, s66, v41
    v_accvgpr_read_b32 v32, a232
    v_accvgpr_read_b32 v33, a233
    v_accvgpr_read_b32 v34, a234
    v_accvgpr_read_b32 v35, a235
    v_cvt_pk_bf16_f32 v93, v32, v33
    v_lshlrev_b32 v32, 16, v93
    v_and_b32 v33, 0xffff0000, v93
    v_add_f32 v32, v32, v72
    v_add_f32 v33, v33, v73
    v_cvt_pk_bf16_f32 v93, v32, v33
    v_lshlrev_b32 v32, 16, v93
    v_and_b32 v33, 0xffff0000, v93
    v_max_f32 v32, 0, v32
    v_max_f32 v33, 0, v33
    v_mul_f32 v32, v32, v32
    v_mul_f32 v33, v33, v33
    v_cvt_pk_bf16_f32 v42, v32, v33
    v_and_b32 v42, s66, v42
    v_cvt_pk_bf16_f32 v93, v34, v35
    v_lshlrev_b32 v34, 16, v93
    v_and_b32 v35, 0xffff0000, v93
    v_add_f32 v34, v34, v74
    v_add_f32 v35, v35, v75
    v_cvt_pk_bf16_f32 v93, v34, v35
    v_lshlrev_b32 v34, 16, v93
    v_and_b32 v35, 0xffff0000, v93
    v_max_f32 v34, 0, v34
    v_max_f32 v35, 0, v35
    v_mul_f32 v34, v34, v34
    v_mul_f32 v35, v35, v35
    v_cvt_pk_bf16_f32 v43, v34, v35
    v_and_b32 v43, s66, v43
    s_add_u32 s62, s71, 114688
    buffer_store_dwordx4 v[40:43], v1, s[56:59], s62 offen offset:3072 sc1
    v_accvgpr_read_b32 v28, a12
    v_accvgpr_read_b32 v29, a13
    v_accvgpr_read_b32 v30, a14
    v_accvgpr_read_b32 v31, a15
    v_cvt_pk_bf16_f32 v93, v28, v29
    v_lshlrev_b32 v28, 16, v93
    v_and_b32 v29, 0xffff0000, v93
    v_add_f32 v28, v28, v44
    v_add_f32 v29, v29, v45
    v_cvt_pk_bf16_f32 v93, v28, v29
    v_lshlrev_b32 v28, 16, v93
    v_and_b32 v29, 0xffff0000, v93
    v_max_f32 v28, 0, v28
    v_max_f32 v29, 0, v29
    v_mul_f32 v28, v28, v28
    v_mul_f32 v29, v29, v29
    v_cvt_pk_bf16_f32 v36, v28, v29
    v_cvt_pk_bf16_f32 v93, v30, v31
    v_lshlrev_b32 v30, 16, v93
    v_and_b32 v31, 0xffff0000, v93
    v_add_f32 v30, v30, v46
    v_add_f32 v31, v31, v47
    v_cvt_pk_bf16_f32 v93, v30, v31
    v_lshlrev_b32 v30, 16, v93
    v_and_b32 v31, 0xffff0000, v93
    v_max_f32 v30, 0, v30
    v_max_f32 v31, 0, v31
    v_mul_f32 v30, v30, v30
    v_mul_f32 v31, v31, v31
    v_cvt_pk_bf16_f32 v37, v30, v31
    v_accvgpr_read_b32 v32, a44
    v_accvgpr_read_b32 v33, a45
    v_accvgpr_read_b32 v34, a46
    v_accvgpr_read_b32 v35, a47
    v_cvt_pk_bf16_f32 v93, v32, v33
    v_lshlrev_b32 v32, 16, v93
    v_and_b32 v33, 0xffff0000, v93
    v_add_f32 v32, v32, v48
    v_add_f32 v33, v33, v49
    v_cvt_pk_bf16_f32 v93, v32, v33
    v_lshlrev_b32 v32, 16, v93
    v_and_b32 v33, 0xffff0000, v93
    v_max_f32 v32, 0, v32
    v_max_f32 v33, 0, v33
    v_mul_f32 v32, v32, v32
    v_mul_f32 v33, v33, v33
    v_cvt_pk_bf16_f32 v38, v32, v33
    v_cvt_pk_bf16_f32 v93, v34, v35
    v_lshlrev_b32 v34, 16, v93
    v_and_b32 v35, 0xffff0000, v93
    v_add_f32 v34, v34, v50
    v_add_f32 v35, v35, v51
    v_cvt_pk_bf16_f32 v93, v34, v35
    v_lshlrev_b32 v34, 16, v93
    v_and_b32 v35, 0xffff0000, v93
    v_max_f32 v34, 0, v34
    v_max_f32 v35, 0, v35
    v_mul_f32 v34, v34, v34
    v_mul_f32 v35, v35, v35
    v_cvt_pk_bf16_f32 v39, v34, v35
    s_add_u32 s62, s71, 172032
    buffer_store_dwordx4 v[36:39], v1, s[56:59], s62 offen sc1
    v_accvgpr_read_b32 v28, a76
    v_accvgpr_read_b32 v29, a77
    v_accvgpr_read_b32 v30, a78
    v_accvgpr_read_b32 v31, a79
    v_cvt_pk_bf16_f32 v93, v28, v29
    v_lshlrev_b32 v28, 16, v93
    v_and_b32 v29, 0xffff0000, v93
    v_add_f32 v28, v28, v52
    v_add_f32 v29, v29, v53
    v_cvt_pk_bf16_f32 v93, v28, v29
    v_lshlrev_b32 v28, 16, v93
    v_and_b32 v29, 0xffff0000, v93
    v_max_f32 v28, 0, v28
    v_max_f32 v29, 0, v29
    v_mul_f32 v28, v28, v28
    v_mul_f32 v29, v29, v29
    v_cvt_pk_bf16_f32 v40, v28, v29
    v_cvt_pk_bf16_f32 v93, v30, v31
    v_lshlrev_b32 v30, 16, v93
    v_and_b32 v31, 0xffff0000, v93
    v_add_f32 v30, v30, v54
    v_add_f32 v31, v31, v55
    v_cvt_pk_bf16_f32 v93, v30, v31
    v_lshlrev_b32 v30, 16, v93
    v_and_b32 v31, 0xffff0000, v93
    v_max_f32 v30, 0, v30
    v_max_f32 v31, 0, v31
    v_mul_f32 v30, v30, v30
    v_mul_f32 v31, v31, v31
    v_cvt_pk_bf16_f32 v41, v30, v31
    v_accvgpr_read_b32 v32, a108
    v_accvgpr_read_b32 v33, a109
    v_accvgpr_read_b32 v34, a110
    v_accvgpr_read_b32 v35, a111
    v_cvt_pk_bf16_f32 v93, v32, v33
    v_lshlrev_b32 v32, 16, v93
    v_and_b32 v33, 0xffff0000, v93
    v_add_f32 v32, v32, v56
    v_add_f32 v33, v33, v57
    v_cvt_pk_bf16_f32 v93, v32, v33
    v_lshlrev_b32 v32, 16, v93
    v_and_b32 v33, 0xffff0000, v93
    v_max_f32 v32, 0, v32
    v_max_f32 v33, 0, v33
    v_mul_f32 v32, v32, v32
    v_mul_f32 v33, v33, v33
    v_cvt_pk_bf16_f32 v42, v32, v33
    v_cvt_pk_bf16_f32 v93, v34, v35
    v_lshlrev_b32 v34, 16, v93
    v_and_b32 v35, 0xffff0000, v93
    v_add_f32 v34, v34, v58
    v_add_f32 v35, v35, v59
    v_cvt_pk_bf16_f32 v93, v34, v35
    v_lshlrev_b32 v34, 16, v93
    v_and_b32 v35, 0xffff0000, v93
    v_max_f32 v34, 0, v34
    v_max_f32 v35, 0, v35
    v_mul_f32 v34, v34, v34
    v_mul_f32 v35, v35, v35
    v_cvt_pk_bf16_f32 v43, v34, v35
    s_add_u32 s62, s71, 172032
    buffer_store_dwordx4 v[40:43], v1, s[56:59], s62 offen offset:1024 sc1
    v_accvgpr_read_b32 v28, a140
    v_accvgpr_read_b32 v29, a141
    v_accvgpr_read_b32 v30, a142
    v_accvgpr_read_b32 v31, a143
    v_cvt_pk_bf16_f32 v93, v28, v29
    v_lshlrev_b32 v28, 16, v93
    v_and_b32 v29, 0xffff0000, v93
    v_add_f32 v28, v28, v60
    v_add_f32 v29, v29, v61
    v_cvt_pk_bf16_f32 v93, v28, v29
    v_lshlrev_b32 v28, 16, v93
    v_and_b32 v29, 0xffff0000, v93
    v_max_f32 v28, 0, v28
    v_max_f32 v29, 0, v29
    v_mul_f32 v28, v28, v28
    v_mul_f32 v29, v29, v29
    v_cvt_pk_bf16_f32 v36, v28, v29
    v_and_b32 v36, s66, v36
    v_cvt_pk_bf16_f32 v93, v30, v31
    v_lshlrev_b32 v30, 16, v93
    v_and_b32 v31, 0xffff0000, v93
    v_add_f32 v30, v30, v62
    v_add_f32 v31, v31, v63
    v_cvt_pk_bf16_f32 v93, v30, v31
    v_lshlrev_b32 v30, 16, v93
    v_and_b32 v31, 0xffff0000, v93
    v_max_f32 v30, 0, v30
    v_max_f32 v31, 0, v31
    v_mul_f32 v30, v30, v30
    v_mul_f32 v31, v31, v31
    v_cvt_pk_bf16_f32 v37, v30, v31
    v_and_b32 v37, s66, v37
    v_accvgpr_read_b32 v32, a172
    v_accvgpr_read_b32 v33, a173
    v_accvgpr_read_b32 v34, a174
    v_accvgpr_read_b32 v35, a175
    v_cvt_pk_bf16_f32 v93, v32, v33
    v_lshlrev_b32 v32, 16, v93
    v_and_b32 v33, 0xffff0000, v93
    v_add_f32 v32, v32, v64
    v_add_f32 v33, v33, v65
    v_cvt_pk_bf16_f32 v93, v32, v33
    v_lshlrev_b32 v32, 16, v93
    v_and_b32 v33, 0xffff0000, v93
    v_max_f32 v32, 0, v32
    v_max_f32 v33, 0, v33
    v_mul_f32 v32, v32, v32
    v_mul_f32 v33, v33, v33
    v_cvt_pk_bf16_f32 v38, v32, v33
    v_and_b32 v38, s66, v38
    v_cvt_pk_bf16_f32 v93, v34, v35
    v_lshlrev_b32 v34, 16, v93
    v_and_b32 v35, 0xffff0000, v93
    v_add_f32 v34, v34, v66
    v_add_f32 v35, v35, v67
    v_cvt_pk_bf16_f32 v93, v34, v35
    v_lshlrev_b32 v34, 16, v93
    v_and_b32 v35, 0xffff0000, v93
    v_max_f32 v34, 0, v34
    v_max_f32 v35, 0, v35
    v_mul_f32 v34, v34, v34
    v_mul_f32 v35, v35, v35
    v_cvt_pk_bf16_f32 v39, v34, v35
    v_and_b32 v39, s66, v39
    s_add_u32 s62, s71, 172032
    buffer_store_dwordx4 v[36:39], v1, s[56:59], s62 offen offset:2048 sc1
    v_accvgpr_read_b32 v28, a204
    v_accvgpr_read_b32 v29, a205
    v_accvgpr_read_b32 v30, a206
    v_accvgpr_read_b32 v31, a207
    v_cvt_pk_bf16_f32 v93, v28, v29
    v_lshlrev_b32 v28, 16, v93
    v_and_b32 v29, 0xffff0000, v93
    v_add_f32 v28, v28, v68
    v_add_f32 v29, v29, v69
    v_cvt_pk_bf16_f32 v93, v28, v29
    v_lshlrev_b32 v28, 16, v93
    v_and_b32 v29, 0xffff0000, v93
    v_max_f32 v28, 0, v28
    v_max_f32 v29, 0, v29
    v_mul_f32 v28, v28, v28
    v_mul_f32 v29, v29, v29
    v_cvt_pk_bf16_f32 v40, v28, v29
    v_and_b32 v40, s66, v40
    v_cvt_pk_bf16_f32 v93, v30, v31
    v_lshlrev_b32 v30, 16, v93
    v_and_b32 v31, 0xffff0000, v93
    v_add_f32 v30, v30, v70
    v_add_f32 v31, v31, v71
    v_cvt_pk_bf16_f32 v93, v30, v31
    v_lshlrev_b32 v30, 16, v93
    v_and_b32 v31, 0xffff0000, v93
    v_max_f32 v30, 0, v30
    v_max_f32 v31, 0, v31
    v_mul_f32 v30, v30, v30
    v_mul_f32 v31, v31, v31
    v_cvt_pk_bf16_f32 v41, v30, v31
    v_and_b32 v41, s66, v41
    v_accvgpr_read_b32 v32, a236
    v_accvgpr_read_b32 v33, a237
    v_accvgpr_read_b32 v34, a238
    v_accvgpr_read_b32 v35, a239
    v_cvt_pk_bf16_f32 v93, v32, v33
    v_lshlrev_b32 v32, 16, v93
    v_and_b32 v33, 0xffff0000, v93
    v_add_f32 v32, v32, v72
    v_add_f32 v33, v33, v73
    v_cvt_pk_bf16_f32 v93, v32, v33
    v_lshlrev_b32 v32, 16, v93
    v_and_b32 v33, 0xffff0000, v93
    v_max_f32 v32, 0, v32
    v_max_f32 v33, 0, v33
    v_mul_f32 v32, v32, v32
    v_mul_f32 v33, v33, v33
    v_cvt_pk_bf16_f32 v42, v32, v33
    v_and_b32 v42, s66, v42
    v_cvt_pk_bf16_f32 v93, v34, v35
    v_lshlrev_b32 v34, 16, v93
    v_and_b32 v35, 0xffff0000, v93
    v_add_f32 v34, v34, v74
    v_add_f32 v35, v35, v75
    v_cvt_pk_bf16_f32 v93, v34, v35
    v_lshlrev_b32 v34, 16, v93
    v_and_b32 v35, 0xffff0000, v93
    v_max_f32 v34, 0, v34
    v_max_f32 v35, 0, v35
    v_mul_f32 v34, v34, v34
    v_mul_f32 v35, v35, v35
    v_cvt_pk_bf16_f32 v43, v34, v35
    v_and_b32 v43, s66, v43
    s_add_u32 s62, s71, 172032
    buffer_store_dwordx4 v[40:43], v1, s[56:59], s62 offen offset:3072 sc1
    v_accvgpr_read_b32 v28, a16
    v_accvgpr_read_b32 v29, a17
    v_accvgpr_read_b32 v30, a18
    v_accvgpr_read_b32 v31, a19
    v_cvt_pk_bf16_f32 v93, v28, v29
    v_lshlrev_b32 v28, 16, v93
    v_and_b32 v29, 0xffff0000, v93
    v_add_f32 v28, v28, v44
    v_add_f32 v29, v29, v45
    v_cvt_pk_bf16_f32 v93, v28, v29
    v_lshlrev_b32 v28, 16, v93
    v_and_b32 v29, 0xffff0000, v93
    v_max_f32 v28, 0, v28
    v_max_f32 v29, 0, v29
    v_mul_f32 v28, v28, v28
    v_mul_f32 v29, v29, v29
    v_cvt_pk_bf16_f32 v36, v28, v29
    v_cvt_pk_bf16_f32 v93, v30, v31
    v_lshlrev_b32 v30, 16, v93
    v_and_b32 v31, 0xffff0000, v93
    v_add_f32 v30, v30, v46
    v_add_f32 v31, v31, v47
    v_cvt_pk_bf16_f32 v93, v30, v31
    v_lshlrev_b32 v30, 16, v93
    v_and_b32 v31, 0xffff0000, v93
    v_max_f32 v30, 0, v30
    v_max_f32 v31, 0, v31
    v_mul_f32 v30, v30, v30
    v_mul_f32 v31, v31, v31
    v_cvt_pk_bf16_f32 v37, v30, v31
    v_accvgpr_read_b32 v32, a48
    v_accvgpr_read_b32 v33, a49
    v_accvgpr_read_b32 v34, a50
    v_accvgpr_read_b32 v35, a51
    v_cvt_pk_bf16_f32 v93, v32, v33
    v_lshlrev_b32 v32, 16, v93
    v_and_b32 v33, 0xffff0000, v93
    v_add_f32 v32, v32, v48
    v_add_f32 v33, v33, v49
    v_cvt_pk_bf16_f32 v93, v32, v33
    v_lshlrev_b32 v32, 16, v93
    v_and_b32 v33, 0xffff0000, v93
    v_max_f32 v32, 0, v32
    v_max_f32 v33, 0, v33
    v_mul_f32 v32, v32, v32
    v_mul_f32 v33, v33, v33
    v_cvt_pk_bf16_f32 v38, v32, v33
    v_cvt_pk_bf16_f32 v93, v34, v35
    v_lshlrev_b32 v34, 16, v93
    v_and_b32 v35, 0xffff0000, v93
    v_add_f32 v34, v34, v50
    v_add_f32 v35, v35, v51
    v_cvt_pk_bf16_f32 v93, v34, v35
    v_lshlrev_b32 v34, 16, v93
    v_and_b32 v35, 0xffff0000, v93
    v_max_f32 v34, 0, v34
    v_max_f32 v35, 0, v35
    v_mul_f32 v34, v34, v34
    v_mul_f32 v35, v35, v35
    v_cvt_pk_bf16_f32 v39, v34, v35
    s_add_u32 s62, s71, 229376
    buffer_store_dwordx4 v[36:39], v1, s[56:59], s62 offen sc1
    v_accvgpr_read_b32 v28, a80
    v_accvgpr_read_b32 v29, a81
    v_accvgpr_read_b32 v30, a82
    v_accvgpr_read_b32 v31, a83
    v_cvt_pk_bf16_f32 v93, v28, v29
    v_lshlrev_b32 v28, 16, v93
    v_and_b32 v29, 0xffff0000, v93
    v_add_f32 v28, v28, v52
    v_add_f32 v29, v29, v53
    v_cvt_pk_bf16_f32 v93, v28, v29
    v_lshlrev_b32 v28, 16, v93
    v_and_b32 v29, 0xffff0000, v93
    v_max_f32 v28, 0, v28
    v_max_f32 v29, 0, v29
    v_mul_f32 v28, v28, v28
    v_mul_f32 v29, v29, v29
    v_cvt_pk_bf16_f32 v40, v28, v29
    v_cvt_pk_bf16_f32 v93, v30, v31
    v_lshlrev_b32 v30, 16, v93
    v_and_b32 v31, 0xffff0000, v93
    v_add_f32 v30, v30, v54
    v_add_f32 v31, v31, v55
    v_cvt_pk_bf16_f32 v93, v30, v31
    v_lshlrev_b32 v30, 16, v93
    v_and_b32 v31, 0xffff0000, v93
    v_max_f32 v30, 0, v30
    v_max_f32 v31, 0, v31
    v_mul_f32 v30, v30, v30
    v_mul_f32 v31, v31, v31
    v_cvt_pk_bf16_f32 v41, v30, v31
    v_accvgpr_read_b32 v32, a112
    v_accvgpr_read_b32 v33, a113
    v_accvgpr_read_b32 v34, a114
    v_accvgpr_read_b32 v35, a115
    v_cvt_pk_bf16_f32 v93, v32, v33
    v_lshlrev_b32 v32, 16, v93
    v_and_b32 v33, 0xffff0000, v93
    v_add_f32 v32, v32, v56
    v_add_f32 v33, v33, v57
    v_cvt_pk_bf16_f32 v93, v32, v33
    v_lshlrev_b32 v32, 16, v93
    v_and_b32 v33, 0xffff0000, v93
    v_max_f32 v32, 0, v32
    v_max_f32 v33, 0, v33
    v_mul_f32 v32, v32, v32
    v_mul_f32 v33, v33, v33
    v_cvt_pk_bf16_f32 v42, v32, v33
    v_cvt_pk_bf16_f32 v93, v34, v35
    v_lshlrev_b32 v34, 16, v93
    v_and_b32 v35, 0xffff0000, v93
    v_add_f32 v34, v34, v58
    v_add_f32 v35, v35, v59
    v_cvt_pk_bf16_f32 v93, v34, v35
    v_lshlrev_b32 v34, 16, v93
    v_and_b32 v35, 0xffff0000, v93
    v_max_f32 v34, 0, v34
    v_max_f32 v35, 0, v35
    v_mul_f32 v34, v34, v34
    v_mul_f32 v35, v35, v35
    v_cvt_pk_bf16_f32 v43, v34, v35
    s_add_u32 s62, s71, 229376
    buffer_store_dwordx4 v[40:43], v1, s[56:59], s62 offen offset:1024 sc1
    v_accvgpr_read_b32 v28, a144
    v_accvgpr_read_b32 v29, a145
    v_accvgpr_read_b32 v30, a146
    v_accvgpr_read_b32 v31, a147
    v_cvt_pk_bf16_f32 v93, v28, v29
    v_lshlrev_b32 v28, 16, v93
    v_and_b32 v29, 0xffff0000, v93
    v_add_f32 v28, v28, v60
    v_add_f32 v29, v29, v61
    v_cvt_pk_bf16_f32 v93, v28, v29
    v_lshlrev_b32 v28, 16, v93
    v_and_b32 v29, 0xffff0000, v93
    v_max_f32 v28, 0, v28
    v_max_f32 v29, 0, v29
    v_mul_f32 v28, v28, v28
    v_mul_f32 v29, v29, v29
    v_cvt_pk_bf16_f32 v36, v28, v29
    v_and_b32 v36, s66, v36
    v_cvt_pk_bf16_f32 v93, v30, v31
    v_lshlrev_b32 v30, 16, v93
    v_and_b32 v31, 0xffff0000, v93
    v_add_f32 v30, v30, v62
    v_add_f32 v31, v31, v63
    v_cvt_pk_bf16_f32 v93, v30, v31
    v_lshlrev_b32 v30, 16, v93
    v_and_b32 v31, 0xffff0000, v93
    v_max_f32 v30, 0, v30
    v_max_f32 v31, 0, v31
    v_mul_f32 v30, v30, v30
    v_mul_f32 v31, v31, v31
    v_cvt_pk_bf16_f32 v37, v30, v31
    v_and_b32 v37, s66, v37
    v_accvgpr_read_b32 v32, a176
    v_accvgpr_read_b32 v33, a177
    v_accvgpr_read_b32 v34, a178
    v_accvgpr_read_b32 v35, a179
    v_cvt_pk_bf16_f32 v93, v32, v33
    v_lshlrev_b32 v32, 16, v93
    v_and_b32 v33, 0xffff0000, v93
    v_add_f32 v32, v32, v64
    v_add_f32 v33, v33, v65
    v_cvt_pk_bf16_f32 v93, v32, v33
    v_lshlrev_b32 v32, 16, v93
    v_and_b32 v33, 0xffff0000, v93
    v_max_f32 v32, 0, v32
    v_max_f32 v33, 0, v33
    v_mul_f32 v32, v32, v32
    v_mul_f32 v33, v33, v33
    v_cvt_pk_bf16_f32 v38, v32, v33
    v_and_b32 v38, s66, v38
    v_cvt_pk_bf16_f32 v93, v34, v35
    v_lshlrev_b32 v34, 16, v93
    v_and_b32 v35, 0xffff0000, v93
    v_add_f32 v34, v34, v66
    v_add_f32 v35, v35, v67
    v_cvt_pk_bf16_f32 v93, v34, v35
    v_lshlrev_b32 v34, 16, v93
    v_and_b32 v35, 0xffff0000, v93
    v_max_f32 v34, 0, v34
    v_max_f32 v35, 0, v35
    v_mul_f32 v34, v34, v34
    v_mul_f32 v35, v35, v35
    v_cvt_pk_bf16_f32 v39, v34, v35
    v_and_b32 v39, s66, v39
    s_add_u32 s62, s71, 229376
    buffer_store_dwordx4 v[36:39], v1, s[56:59], s62 offen offset:2048 sc1
    v_accvgpr_read_b32 v28, a208
    v_accvgpr_read_b32 v29, a209
    v_accvgpr_read_b32 v30, a210
    v_accvgpr_read_b32 v31, a211
    v_cvt_pk_bf16_f32 v93, v28, v29
    v_lshlrev_b32 v28, 16, v93
    v_and_b32 v29, 0xffff0000, v93
    v_add_f32 v28, v28, v68
    v_add_f32 v29, v29, v69
    v_cvt_pk_bf16_f32 v93, v28, v29
    v_lshlrev_b32 v28, 16, v93
    v_and_b32 v29, 0xffff0000, v93
    v_max_f32 v28, 0, v28
    v_max_f32 v29, 0, v29
    v_mul_f32 v28, v28, v28
    v_mul_f32 v29, v29, v29
    v_cvt_pk_bf16_f32 v40, v28, v29
    v_and_b32 v40, s66, v40
    v_cvt_pk_bf16_f32 v93, v30, v31
    v_lshlrev_b32 v30, 16, v93
    v_and_b32 v31, 0xffff0000, v93
    v_add_f32 v30, v30, v70
    v_add_f32 v31, v31, v71
    v_cvt_pk_bf16_f32 v93, v30, v31
    v_lshlrev_b32 v30, 16, v93
    v_and_b32 v31, 0xffff0000, v93
    v_max_f32 v30, 0, v30
    v_max_f32 v31, 0, v31
    v_mul_f32 v30, v30, v30
    v_mul_f32 v31, v31, v31
    v_cvt_pk_bf16_f32 v41, v30, v31
    v_and_b32 v41, s66, v41
    v_accvgpr_read_b32 v32, a240
    v_accvgpr_read_b32 v33, a241
    v_accvgpr_read_b32 v34, a242
    v_accvgpr_read_b32 v35, a243
    v_cvt_pk_bf16_f32 v93, v32, v33
    v_lshlrev_b32 v32, 16, v93
    v_and_b32 v33, 0xffff0000, v93
    v_add_f32 v32, v32, v72
    v_add_f32 v33, v33, v73
    v_cvt_pk_bf16_f32 v93, v32, v33
    v_lshlrev_b32 v32, 16, v93
    v_and_b32 v33, 0xffff0000, v93
    v_max_f32 v32, 0, v32
    v_max_f32 v33, 0, v33
    v_mul_f32 v32, v32, v32
    v_mul_f32 v33, v33, v33
    v_cvt_pk_bf16_f32 v42, v32, v33
    v_and_b32 v42, s66, v42
    v_cvt_pk_bf16_f32 v93, v34, v35
    v_lshlrev_b32 v34, 16, v93
    v_and_b32 v35, 0xffff0000, v93
    v_add_f32 v34, v34, v74
    v_add_f32 v35, v35, v75
    v_cvt_pk_bf16_f32 v93, v34, v35
    v_lshlrev_b32 v34, 16, v93
    v_and_b32 v35, 0xffff0000, v93
    v_max_f32 v34, 0, v34
    v_max_f32 v35, 0, v35
    v_mul_f32 v34, v34, v34
    v_mul_f32 v35, v35, v35
    v_cvt_pk_bf16_f32 v43, v34, v35
    v_and_b32 v43, s66, v43
    s_add_u32 s62, s71, 229376
    buffer_store_dwordx4 v[40:43], v1, s[56:59], s62 offen offset:3072 sc1
    v_accvgpr_read_b32 v28, a20
    v_accvgpr_read_b32 v29, a21
    v_accvgpr_read_b32 v30, a22
    v_accvgpr_read_b32 v31, a23
    v_cvt_pk_bf16_f32 v93, v28, v29
    v_lshlrev_b32 v28, 16, v93
    v_and_b32 v29, 0xffff0000, v93
    v_add_f32 v28, v28, v44
    v_add_f32 v29, v29, v45
    v_cvt_pk_bf16_f32 v93, v28, v29
    v_lshlrev_b32 v28, 16, v93
    v_and_b32 v29, 0xffff0000, v93
    v_max_f32 v28, 0, v28
    v_max_f32 v29, 0, v29
    v_mul_f32 v28, v28, v28
    v_mul_f32 v29, v29, v29
    v_cvt_pk_bf16_f32 v36, v28, v29
    v_cvt_pk_bf16_f32 v93, v30, v31
    v_lshlrev_b32 v30, 16, v93
    v_and_b32 v31, 0xffff0000, v93
    v_add_f32 v30, v30, v46
    v_add_f32 v31, v31, v47
    v_cvt_pk_bf16_f32 v93, v30, v31
    v_lshlrev_b32 v30, 16, v93
    v_and_b32 v31, 0xffff0000, v93
    v_max_f32 v30, 0, v30
    v_max_f32 v31, 0, v31
    v_mul_f32 v30, v30, v30
    v_mul_f32 v31, v31, v31
    v_cvt_pk_bf16_f32 v37, v30, v31
    v_accvgpr_read_b32 v32, a52
    v_accvgpr_read_b32 v33, a53
    v_accvgpr_read_b32 v34, a54
    v_accvgpr_read_b32 v35, a55
    v_cvt_pk_bf16_f32 v93, v32, v33
    v_lshlrev_b32 v32, 16, v93
    v_and_b32 v33, 0xffff0000, v93
    v_add_f32 v32, v32, v48
    v_add_f32 v33, v33, v49
    v_cvt_pk_bf16_f32 v93, v32, v33
    v_lshlrev_b32 v32, 16, v93
    v_and_b32 v33, 0xffff0000, v93
    v_max_f32 v32, 0, v32
    v_max_f32 v33, 0, v33
    v_mul_f32 v32, v32, v32
    v_mul_f32 v33, v33, v33
    v_cvt_pk_bf16_f32 v38, v32, v33
    v_cvt_pk_bf16_f32 v93, v34, v35
    v_lshlrev_b32 v34, 16, v93
    v_and_b32 v35, 0xffff0000, v93
    v_add_f32 v34, v34, v50
    v_add_f32 v35, v35, v51
    v_cvt_pk_bf16_f32 v93, v34, v35
    v_lshlrev_b32 v34, 16, v93
    v_and_b32 v35, 0xffff0000, v93
    v_max_f32 v34, 0, v34
    v_max_f32 v35, 0, v35
    v_mul_f32 v34, v34, v34
    v_mul_f32 v35, v35, v35
    v_cvt_pk_bf16_f32 v39, v34, v35
    s_add_u32 s62, s71, 286720
    buffer_store_dwordx4 v[36:39], v1, s[56:59], s62 offen sc1
    v_accvgpr_read_b32 v28, a84
    v_accvgpr_read_b32 v29, a85
    v_accvgpr_read_b32 v30, a86
    v_accvgpr_read_b32 v31, a87
    v_cvt_pk_bf16_f32 v93, v28, v29
    v_lshlrev_b32 v28, 16, v93
    v_and_b32 v29, 0xffff0000, v93
    v_add_f32 v28, v28, v52
    v_add_f32 v29, v29, v53
    v_cvt_pk_bf16_f32 v93, v28, v29
    v_lshlrev_b32 v28, 16, v93
    v_and_b32 v29, 0xffff0000, v93
    v_max_f32 v28, 0, v28
    v_max_f32 v29, 0, v29
    v_mul_f32 v28, v28, v28
    v_mul_f32 v29, v29, v29
    v_cvt_pk_bf16_f32 v40, v28, v29
    v_cvt_pk_bf16_f32 v93, v30, v31
    v_lshlrev_b32 v30, 16, v93
    v_and_b32 v31, 0xffff0000, v93
    v_add_f32 v30, v30, v54
    v_add_f32 v31, v31, v55
    v_cvt_pk_bf16_f32 v93, v30, v31
    v_lshlrev_b32 v30, 16, v93
    v_and_b32 v31, 0xffff0000, v93
    v_max_f32 v30, 0, v30
    v_max_f32 v31, 0, v31
    v_mul_f32 v30, v30, v30
    v_mul_f32 v31, v31, v31
    v_cvt_pk_bf16_f32 v41, v30, v31
    v_accvgpr_read_b32 v32, a116
    v_accvgpr_read_b32 v33, a117
    v_accvgpr_read_b32 v34, a118
    v_accvgpr_read_b32 v35, a119
    v_cvt_pk_bf16_f32 v93, v32, v33
    v_lshlrev_b32 v32, 16, v93
    v_and_b32 v33, 0xffff0000, v93
    v_add_f32 v32, v32, v56
    v_add_f32 v33, v33, v57
    v_cvt_pk_bf16_f32 v93, v32, v33
    v_lshlrev_b32 v32, 16, v93
    v_and_b32 v33, 0xffff0000, v93
    v_max_f32 v32, 0, v32
    v_max_f32 v33, 0, v33
    v_mul_f32 v32, v32, v32
    v_mul_f32 v33, v33, v33
    v_cvt_pk_bf16_f32 v42, v32, v33
    v_cvt_pk_bf16_f32 v93, v34, v35
    v_lshlrev_b32 v34, 16, v93
    v_and_b32 v35, 0xffff0000, v93
    v_add_f32 v34, v34, v58
    v_add_f32 v35, v35, v59
    v_cvt_pk_bf16_f32 v93, v34, v35
    v_lshlrev_b32 v34, 16, v93
    v_and_b32 v35, 0xffff0000, v93
    v_max_f32 v34, 0, v34
    v_max_f32 v35, 0, v35
    v_mul_f32 v34, v34, v34
    v_mul_f32 v35, v35, v35
    v_cvt_pk_bf16_f32 v43, v34, v35
    s_add_u32 s62, s71, 286720
    buffer_store_dwordx4 v[40:43], v1, s[56:59], s62 offen offset:1024 sc1
    v_accvgpr_read_b32 v28, a148
    v_accvgpr_read_b32 v29, a149
    v_accvgpr_read_b32 v30, a150
    v_accvgpr_read_b32 v31, a151
    v_cvt_pk_bf16_f32 v93, v28, v29
    v_lshlrev_b32 v28, 16, v93
    v_and_b32 v29, 0xffff0000, v93
    v_add_f32 v28, v28, v60
    v_add_f32 v29, v29, v61
    v_cvt_pk_bf16_f32 v93, v28, v29
    v_lshlrev_b32 v28, 16, v93
    v_and_b32 v29, 0xffff0000, v93
    v_max_f32 v28, 0, v28
    v_max_f32 v29, 0, v29
    v_mul_f32 v28, v28, v28
    v_mul_f32 v29, v29, v29
    v_cvt_pk_bf16_f32 v36, v28, v29
    v_and_b32 v36, s66, v36
    v_cvt_pk_bf16_f32 v93, v30, v31
    v_lshlrev_b32 v30, 16, v93
    v_and_b32 v31, 0xffff0000, v93
    v_add_f32 v30, v30, v62
    v_add_f32 v31, v31, v63
    v_cvt_pk_bf16_f32 v93, v30, v31
    v_lshlrev_b32 v30, 16, v93
    v_and_b32 v31, 0xffff0000, v93
    v_max_f32 v30, 0, v30
    v_max_f32 v31, 0, v31
    v_mul_f32 v30, v30, v30
    v_mul_f32 v31, v31, v31
    v_cvt_pk_bf16_f32 v37, v30, v31
    v_and_b32 v37, s66, v37
    v_accvgpr_read_b32 v32, a180
    v_accvgpr_read_b32 v33, a181
    v_accvgpr_read_b32 v34, a182
    v_accvgpr_read_b32 v35, a183
    v_cvt_pk_bf16_f32 v93, v32, v33
    v_lshlrev_b32 v32, 16, v93
    v_and_b32 v33, 0xffff0000, v93
    v_add_f32 v32, v32, v64
    v_add_f32 v33, v33, v65
    v_cvt_pk_bf16_f32 v93, v32, v33
    v_lshlrev_b32 v32, 16, v93
    v_and_b32 v33, 0xffff0000, v93
    v_max_f32 v32, 0, v32
    v_max_f32 v33, 0, v33
    v_mul_f32 v32, v32, v32
    v_mul_f32 v33, v33, v33
    v_cvt_pk_bf16_f32 v38, v32, v33
    v_and_b32 v38, s66, v38
    v_cvt_pk_bf16_f32 v93, v34, v35
    v_lshlrev_b32 v34, 16, v93
    v_and_b32 v35, 0xffff0000, v93
    v_add_f32 v34, v34, v66
    v_add_f32 v35, v35, v67
    v_cvt_pk_bf16_f32 v93, v34, v35
    v_lshlrev_b32 v34, 16, v93
    v_and_b32 v35, 0xffff0000, v93
    v_max_f32 v34, 0, v34
    v_max_f32 v35, 0, v35
    v_mul_f32 v34, v34, v34
    v_mul_f32 v35, v35, v35
    v_cvt_pk_bf16_f32 v39, v34, v35
    v_and_b32 v39, s66, v39
    s_add_u32 s62, s71, 286720
    buffer_store_dwordx4 v[36:39], v1, s[56:59], s62 offen offset:2048 sc1
    v_accvgpr_read_b32 v28, a212
    v_accvgpr_read_b32 v29, a213
    v_accvgpr_read_b32 v30, a214
    v_accvgpr_read_b32 v31, a215
    v_cvt_pk_bf16_f32 v93, v28, v29
    v_lshlrev_b32 v28, 16, v93
    v_and_b32 v29, 0xffff0000, v93
    v_add_f32 v28, v28, v68
    v_add_f32 v29, v29, v69
    v_cvt_pk_bf16_f32 v93, v28, v29
    v_lshlrev_b32 v28, 16, v93
    v_and_b32 v29, 0xffff0000, v93
    v_max_f32 v28, 0, v28
    v_max_f32 v29, 0, v29
    v_mul_f32 v28, v28, v28
    v_mul_f32 v29, v29, v29
    v_cvt_pk_bf16_f32 v40, v28, v29
    v_and_b32 v40, s66, v40
    v_cvt_pk_bf16_f32 v93, v30, v31
    v_lshlrev_b32 v30, 16, v93
    v_and_b32 v31, 0xffff0000, v93
    v_add_f32 v30, v30, v70
    v_add_f32 v31, v31, v71
    v_cvt_pk_bf16_f32 v93, v30, v31
    v_lshlrev_b32 v30, 16, v93
    v_and_b32 v31, 0xffff0000, v93
    v_max_f32 v30, 0, v30
    v_max_f32 v31, 0, v31
    v_mul_f32 v30, v30, v30
    v_mul_f32 v31, v31, v31
    v_cvt_pk_bf16_f32 v41, v30, v31
    v_and_b32 v41, s66, v41
    v_accvgpr_read_b32 v32, a244
    v_accvgpr_read_b32 v33, a245
    v_accvgpr_read_b32 v34, a246
    v_accvgpr_read_b32 v35, a247
    v_cvt_pk_bf16_f32 v93, v32, v33
    v_lshlrev_b32 v32, 16, v93
    v_and_b32 v33, 0xffff0000, v93
    v_add_f32 v32, v32, v72
    v_add_f32 v33, v33, v73
    v_cvt_pk_bf16_f32 v93, v32, v33
    v_lshlrev_b32 v32, 16, v93
    v_and_b32 v33, 0xffff0000, v93
    v_max_f32 v32, 0, v32
    v_max_f32 v33, 0, v33
    v_mul_f32 v32, v32, v32
    v_mul_f32 v33, v33, v33
    v_cvt_pk_bf16_f32 v42, v32, v33
    v_and_b32 v42, s66, v42
    v_cvt_pk_bf16_f32 v93, v34, v35
    v_lshlrev_b32 v34, 16, v93
    v_and_b32 v35, 0xffff0000, v93
    v_add_f32 v34, v34, v74
    v_add_f32 v35, v35, v75
    v_cvt_pk_bf16_f32 v93, v34, v35
    v_lshlrev_b32 v34, 16, v93
    v_and_b32 v35, 0xffff0000, v93
    v_max_f32 v34, 0, v34
    v_max_f32 v35, 0, v35
    v_mul_f32 v34, v34, v34
    v_mul_f32 v35, v35, v35
    v_cvt_pk_bf16_f32 v43, v34, v35
    v_and_b32 v43, s66, v43
    s_add_u32 s62, s71, 286720
    buffer_store_dwordx4 v[40:43], v1, s[56:59], s62 offen offset:3072 sc1
    v_accvgpr_read_b32 v28, a24
    v_accvgpr_read_b32 v29, a25
    v_accvgpr_read_b32 v30, a26
    v_accvgpr_read_b32 v31, a27
    v_cvt_pk_bf16_f32 v93, v28, v29
    v_lshlrev_b32 v28, 16, v93
    v_and_b32 v29, 0xffff0000, v93
    v_add_f32 v28, v28, v44
    v_add_f32 v29, v29, v45
    v_cvt_pk_bf16_f32 v93, v28, v29
    v_lshlrev_b32 v28, 16, v93
    v_and_b32 v29, 0xffff0000, v93
    v_max_f32 v28, 0, v28
    v_max_f32 v29, 0, v29
    v_mul_f32 v28, v28, v28
    v_mul_f32 v29, v29, v29
    v_cvt_pk_bf16_f32 v36, v28, v29
    v_cvt_pk_bf16_f32 v93, v30, v31
    v_lshlrev_b32 v30, 16, v93
    v_and_b32 v31, 0xffff0000, v93
    v_add_f32 v30, v30, v46
    v_add_f32 v31, v31, v47
    v_cvt_pk_bf16_f32 v93, v30, v31
    v_lshlrev_b32 v30, 16, v93
    v_and_b32 v31, 0xffff0000, v93
    v_max_f32 v30, 0, v30
    v_max_f32 v31, 0, v31
    v_mul_f32 v30, v30, v30
    v_mul_f32 v31, v31, v31
    v_cvt_pk_bf16_f32 v37, v30, v31
    v_accvgpr_read_b32 v32, a56
    v_accvgpr_read_b32 v33, a57
    v_accvgpr_read_b32 v34, a58
    v_accvgpr_read_b32 v35, a59
    v_cvt_pk_bf16_f32 v93, v32, v33
    v_lshlrev_b32 v32, 16, v93
    v_and_b32 v33, 0xffff0000, v93
    v_add_f32 v32, v32, v48
    v_add_f32 v33, v33, v49
    v_cvt_pk_bf16_f32 v93, v32, v33
    v_lshlrev_b32 v32, 16, v93
    v_and_b32 v33, 0xffff0000, v93
    v_max_f32 v32, 0, v32
    v_max_f32 v33, 0, v33
    v_mul_f32 v32, v32, v32
    v_mul_f32 v33, v33, v33
    v_cvt_pk_bf16_f32 v38, v32, v33
    v_cvt_pk_bf16_f32 v93, v34, v35
    v_lshlrev_b32 v34, 16, v93
    v_and_b32 v35, 0xffff0000, v93
    v_add_f32 v34, v34, v50
    v_add_f32 v35, v35, v51
    v_cvt_pk_bf16_f32 v93, v34, v35
    v_lshlrev_b32 v34, 16, v93
    v_and_b32 v35, 0xffff0000, v93
    v_max_f32 v34, 0, v34
    v_max_f32 v35, 0, v35
    v_mul_f32 v34, v34, v34
    v_mul_f32 v35, v35, v35
    v_cvt_pk_bf16_f32 v39, v34, v35
    s_add_u32 s62, s71, 344064
    buffer_store_dwordx4 v[36:39], v1, s[56:59], s62 offen sc1
    v_accvgpr_read_b32 v28, a88
    v_accvgpr_read_b32 v29, a89
    v_accvgpr_read_b32 v30, a90
    v_accvgpr_read_b32 v31, a91
    v_cvt_pk_bf16_f32 v93, v28, v29
    v_lshlrev_b32 v28, 16, v93
    v_and_b32 v29, 0xffff0000, v93
    v_add_f32 v28, v28, v52
    v_add_f32 v29, v29, v53
    v_cvt_pk_bf16_f32 v93, v28, v29
    v_lshlrev_b32 v28, 16, v93
    v_and_b32 v29, 0xffff0000, v93
    v_max_f32 v28, 0, v28
    v_max_f32 v29, 0, v29
    v_mul_f32 v28, v28, v28
    v_mul_f32 v29, v29, v29
    v_cvt_pk_bf16_f32 v40, v28, v29
    v_cvt_pk_bf16_f32 v93, v30, v31
    v_lshlrev_b32 v30, 16, v93
    v_and_b32 v31, 0xffff0000, v93
    v_add_f32 v30, v30, v54
    v_add_f32 v31, v31, v55
    v_cvt_pk_bf16_f32 v93, v30, v31
    v_lshlrev_b32 v30, 16, v93
    v_and_b32 v31, 0xffff0000, v93
    v_max_f32 v30, 0, v30
    v_max_f32 v31, 0, v31
    v_mul_f32 v30, v30, v30
    v_mul_f32 v31, v31, v31
    v_cvt_pk_bf16_f32 v41, v30, v31
    v_accvgpr_read_b32 v32, a120
    v_accvgpr_read_b32 v33, a121
    v_accvgpr_read_b32 v34, a122
    v_accvgpr_read_b32 v35, a123
    v_cvt_pk_bf16_f32 v93, v32, v33
    v_lshlrev_b32 v32, 16, v93
    v_and_b32 v33, 0xffff0000, v93
    v_add_f32 v32, v32, v56
    v_add_f32 v33, v33, v57
    v_cvt_pk_bf16_f32 v93, v32, v33
    v_lshlrev_b32 v32, 16, v93
    v_and_b32 v33, 0xffff0000, v93
    v_max_f32 v32, 0, v32
    v_max_f32 v33, 0, v33
    v_mul_f32 v32, v32, v32
    v_mul_f32 v33, v33, v33
    v_cvt_pk_bf16_f32 v42, v32, v33
    v_cvt_pk_bf16_f32 v93, v34, v35
    v_lshlrev_b32 v34, 16, v93
    v_and_b32 v35, 0xffff0000, v93
    v_add_f32 v34, v34, v58
    v_add_f32 v35, v35, v59
    v_cvt_pk_bf16_f32 v93, v34, v35
    v_lshlrev_b32 v34, 16, v93
    v_and_b32 v35, 0xffff0000, v93
    v_max_f32 v34, 0, v34
    v_max_f32 v35, 0, v35
    v_mul_f32 v34, v34, v34
    v_mul_f32 v35, v35, v35
    v_cvt_pk_bf16_f32 v43, v34, v35
    s_add_u32 s62, s71, 344064
    buffer_store_dwordx4 v[40:43], v1, s[56:59], s62 offen offset:1024 sc1
    v_accvgpr_read_b32 v28, a152
    v_accvgpr_read_b32 v29, a153
    v_accvgpr_read_b32 v30, a154
    v_accvgpr_read_b32 v31, a155
    v_cvt_pk_bf16_f32 v93, v28, v29
    v_lshlrev_b32 v28, 16, v93
    v_and_b32 v29, 0xffff0000, v93
    v_add_f32 v28, v28, v60
    v_add_f32 v29, v29, v61
    v_cvt_pk_bf16_f32 v93, v28, v29
    v_lshlrev_b32 v28, 16, v93
    v_and_b32 v29, 0xffff0000, v93
    v_max_f32 v28, 0, v28
    v_max_f32 v29, 0, v29
    v_mul_f32 v28, v28, v28
    v_mul_f32 v29, v29, v29
    v_cvt_pk_bf16_f32 v36, v28, v29
    v_and_b32 v36, s66, v36
    v_cvt_pk_bf16_f32 v93, v30, v31
    v_lshlrev_b32 v30, 16, v93
    v_and_b32 v31, 0xffff0000, v93
    v_add_f32 v30, v30, v62
    v_add_f32 v31, v31, v63
    v_cvt_pk_bf16_f32 v93, v30, v31
    v_lshlrev_b32 v30, 16, v93
    v_and_b32 v31, 0xffff0000, v93
    v_max_f32 v30, 0, v30
    v_max_f32 v31, 0, v31
    v_mul_f32 v30, v30, v30
    v_mul_f32 v31, v31, v31
    v_cvt_pk_bf16_f32 v37, v30, v31
    v_and_b32 v37, s66, v37
    v_accvgpr_read_b32 v32, a184
    v_accvgpr_read_b32 v33, a185
    v_accvgpr_read_b32 v34, a186
    v_accvgpr_read_b32 v35, a187
    v_cvt_pk_bf16_f32 v93, v32, v33
    v_lshlrev_b32 v32, 16, v93
    v_and_b32 v33, 0xffff0000, v93
    v_add_f32 v32, v32, v64
    v_add_f32 v33, v33, v65
    v_cvt_pk_bf16_f32 v93, v32, v33
    v_lshlrev_b32 v32, 16, v93
    v_and_b32 v33, 0xffff0000, v93
    v_max_f32 v32, 0, v32
    v_max_f32 v33, 0, v33
    v_mul_f32 v32, v32, v32
    v_mul_f32 v33, v33, v33
    v_cvt_pk_bf16_f32 v38, v32, v33
    v_and_b32 v38, s66, v38
    v_cvt_pk_bf16_f32 v93, v34, v35
    v_lshlrev_b32 v34, 16, v93
    v_and_b32 v35, 0xffff0000, v93
    v_add_f32 v34, v34, v66
    v_add_f32 v35, v35, v67
    v_cvt_pk_bf16_f32 v93, v34, v35
    v_lshlrev_b32 v34, 16, v93
    v_and_b32 v35, 0xffff0000, v93
    v_max_f32 v34, 0, v34
    v_max_f32 v35, 0, v35
    v_mul_f32 v34, v34, v34
    v_mul_f32 v35, v35, v35
    v_cvt_pk_bf16_f32 v39, v34, v35
    v_and_b32 v39, s66, v39
    s_add_u32 s62, s71, 344064
    buffer_store_dwordx4 v[36:39], v1, s[56:59], s62 offen offset:2048 sc1
    v_accvgpr_read_b32 v28, a216
    v_accvgpr_read_b32 v29, a217
    v_accvgpr_read_b32 v30, a218
    v_accvgpr_read_b32 v31, a219
    v_cvt_pk_bf16_f32 v93, v28, v29
    v_lshlrev_b32 v28, 16, v93
    v_and_b32 v29, 0xffff0000, v93
    v_add_f32 v28, v28, v68
    v_add_f32 v29, v29, v69
    v_cvt_pk_bf16_f32 v93, v28, v29
    v_lshlrev_b32 v28, 16, v93
    v_and_b32 v29, 0xffff0000, v93
    v_max_f32 v28, 0, v28
    v_max_f32 v29, 0, v29
    v_mul_f32 v28, v28, v28
    v_mul_f32 v29, v29, v29
    v_cvt_pk_bf16_f32 v40, v28, v29
    v_and_b32 v40, s66, v40
    v_cvt_pk_bf16_f32 v93, v30, v31
    v_lshlrev_b32 v30, 16, v93
    v_and_b32 v31, 0xffff0000, v93
    v_add_f32 v30, v30, v70
    v_add_f32 v31, v31, v71
    v_cvt_pk_bf16_f32 v93, v30, v31
    v_lshlrev_b32 v30, 16, v93
    v_and_b32 v31, 0xffff0000, v93
    v_max_f32 v30, 0, v30
    v_max_f32 v31, 0, v31
    v_mul_f32 v30, v30, v30
    v_mul_f32 v31, v31, v31
    v_cvt_pk_bf16_f32 v41, v30, v31
    v_and_b32 v41, s66, v41
    v_accvgpr_read_b32 v32, a248
    v_accvgpr_read_b32 v33, a249
    v_accvgpr_read_b32 v34, a250
    v_accvgpr_read_b32 v35, a251
    v_cvt_pk_bf16_f32 v93, v32, v33
    v_lshlrev_b32 v32, 16, v93
    v_and_b32 v33, 0xffff0000, v93
    v_add_f32 v32, v32, v72
    v_add_f32 v33, v33, v73
    v_cvt_pk_bf16_f32 v93, v32, v33
    v_lshlrev_b32 v32, 16, v93
    v_and_b32 v33, 0xffff0000, v93
    v_max_f32 v32, 0, v32
    v_max_f32 v33, 0, v33
    v_mul_f32 v32, v32, v32
    v_mul_f32 v33, v33, v33
    v_cvt_pk_bf16_f32 v42, v32, v33
    v_and_b32 v42, s66, v42
    v_cvt_pk_bf16_f32 v93, v34, v35
    v_lshlrev_b32 v34, 16, v93
    v_and_b32 v35, 0xffff0000, v93
    v_add_f32 v34, v34, v74
    v_add_f32 v35, v35, v75
    v_cvt_pk_bf16_f32 v93, v34, v35
    v_lshlrev_b32 v34, 16, v93
    v_and_b32 v35, 0xffff0000, v93
    v_max_f32 v34, 0, v34
    v_max_f32 v35, 0, v35
    v_mul_f32 v34, v34, v34
    v_mul_f32 v35, v35, v35
    v_cvt_pk_bf16_f32 v43, v34, v35
    v_and_b32 v43, s66, v43
    s_add_u32 s62, s71, 344064
    buffer_store_dwordx4 v[40:43], v1, s[56:59], s62 offen offset:3072 sc1
    v_accvgpr_read_b32 v28, a28
    v_accvgpr_read_b32 v29, a29
    v_accvgpr_read_b32 v30, a30
    v_accvgpr_read_b32 v31, a31
    v_cvt_pk_bf16_f32 v93, v28, v29
    v_lshlrev_b32 v28, 16, v93
    v_and_b32 v29, 0xffff0000, v93
    v_add_f32 v28, v28, v44
    v_add_f32 v29, v29, v45
    v_cvt_pk_bf16_f32 v93, v28, v29
    v_lshlrev_b32 v28, 16, v93
    v_and_b32 v29, 0xffff0000, v93
    v_max_f32 v28, 0, v28
    v_max_f32 v29, 0, v29
    v_mul_f32 v28, v28, v28
    v_mul_f32 v29, v29, v29
    v_cvt_pk_bf16_f32 v36, v28, v29
    v_cvt_pk_bf16_f32 v93, v30, v31
    v_lshlrev_b32 v30, 16, v93
    v_and_b32 v31, 0xffff0000, v93
    v_add_f32 v30, v30, v46
    v_add_f32 v31, v31, v47
    v_cvt_pk_bf16_f32 v93, v30, v31
    v_lshlrev_b32 v30, 16, v93
    v_and_b32 v31, 0xffff0000, v93
    v_max_f32 v30, 0, v30
    v_max_f32 v31, 0, v31
    v_mul_f32 v30, v30, v30
    v_mul_f32 v31, v31, v31
    v_cvt_pk_bf16_f32 v37, v30, v31
    v_accvgpr_read_b32 v32, a60
    v_accvgpr_read_b32 v33, a61
    v_accvgpr_read_b32 v34, a62
    v_accvgpr_read_b32 v35, a63
    v_cvt_pk_bf16_f32 v93, v32, v33
    v_lshlrev_b32 v32, 16, v93
    v_and_b32 v33, 0xffff0000, v93
    v_add_f32 v32, v32, v48
    v_add_f32 v33, v33, v49
    v_cvt_pk_bf16_f32 v93, v32, v33
    v_lshlrev_b32 v32, 16, v93
    v_and_b32 v33, 0xffff0000, v93
    v_max_f32 v32, 0, v32
    v_max_f32 v33, 0, v33
    v_mul_f32 v32, v32, v32
    v_mul_f32 v33, v33, v33
    v_cvt_pk_bf16_f32 v38, v32, v33
    v_cvt_pk_bf16_f32 v93, v34, v35
    v_lshlrev_b32 v34, 16, v93
    v_and_b32 v35, 0xffff0000, v93
    v_add_f32 v34, v34, v50
    v_add_f32 v35, v35, v51
    v_cvt_pk_bf16_f32 v93, v34, v35
    v_lshlrev_b32 v34, 16, v93
    v_and_b32 v35, 0xffff0000, v93
    v_max_f32 v34, 0, v34
    v_max_f32 v35, 0, v35
    v_mul_f32 v34, v34, v34
    v_mul_f32 v35, v35, v35
    v_cvt_pk_bf16_f32 v39, v34, v35
    s_add_u32 s62, s71, 401408
    buffer_store_dwordx4 v[36:39], v1, s[56:59], s62 offen sc1
    v_accvgpr_read_b32 v28, a92
    v_accvgpr_read_b32 v29, a93
    v_accvgpr_read_b32 v30, a94
    v_accvgpr_read_b32 v31, a95
    v_cvt_pk_bf16_f32 v93, v28, v29
    v_lshlrev_b32 v28, 16, v93
    v_and_b32 v29, 0xffff0000, v93
    v_add_f32 v28, v28, v52
    v_add_f32 v29, v29, v53
    v_cvt_pk_bf16_f32 v93, v28, v29
    v_lshlrev_b32 v28, 16, v93
    v_and_b32 v29, 0xffff0000, v93
    v_max_f32 v28, 0, v28
    v_max_f32 v29, 0, v29
    v_mul_f32 v28, v28, v28
    v_mul_f32 v29, v29, v29
    v_cvt_pk_bf16_f32 v40, v28, v29
    v_cvt_pk_bf16_f32 v93, v30, v31
    v_lshlrev_b32 v30, 16, v93
    v_and_b32 v31, 0xffff0000, v93
    v_add_f32 v30, v30, v54
    v_add_f32 v31, v31, v55
    v_cvt_pk_bf16_f32 v93, v30, v31
    v_lshlrev_b32 v30, 16, v93
    v_and_b32 v31, 0xffff0000, v93
    v_max_f32 v30, 0, v30
    v_max_f32 v31, 0, v31
    v_mul_f32 v30, v30, v30
    v_mul_f32 v31, v31, v31
    v_cvt_pk_bf16_f32 v41, v30, v31
    v_accvgpr_read_b32 v32, a124
    v_accvgpr_read_b32 v33, a125
    v_accvgpr_read_b32 v34, a126
    v_accvgpr_read_b32 v35, a127
    v_cvt_pk_bf16_f32 v93, v32, v33
    v_lshlrev_b32 v32, 16, v93
    v_and_b32 v33, 0xffff0000, v93
    v_add_f32 v32, v32, v56
    v_add_f32 v33, v33, v57
    v_cvt_pk_bf16_f32 v93, v32, v33
    v_lshlrev_b32 v32, 16, v93
    v_and_b32 v33, 0xffff0000, v93
    v_max_f32 v32, 0, v32
    v_max_f32 v33, 0, v33
    v_mul_f32 v32, v32, v32
    v_mul_f32 v33, v33, v33
    v_cvt_pk_bf16_f32 v42, v32, v33
    v_cvt_pk_bf16_f32 v93, v34, v35
    v_lshlrev_b32 v34, 16, v93
    v_and_b32 v35, 0xffff0000, v93
    v_add_f32 v34, v34, v58
    v_add_f32 v35, v35, v59
    v_cvt_pk_bf16_f32 v93, v34, v35
    v_lshlrev_b32 v34, 16, v93
    v_and_b32 v35, 0xffff0000, v93
    v_max_f32 v34, 0, v34
    v_max_f32 v35, 0, v35
    v_mul_f32 v34, v34, v34
    v_mul_f32 v35, v35, v35
    v_cvt_pk_bf16_f32 v43, v34, v35
    s_add_u32 s62, s71, 401408
    buffer_store_dwordx4 v[40:43], v1, s[56:59], s62 offen offset:1024 sc1
    v_accvgpr_read_b32 v28, a156
    v_accvgpr_read_b32 v29, a157
    v_accvgpr_read_b32 v30, a158
    v_accvgpr_read_b32 v31, a159
    v_cvt_pk_bf16_f32 v93, v28, v29
    v_lshlrev_b32 v28, 16, v93
    v_and_b32 v29, 0xffff0000, v93
    v_add_f32 v28, v28, v60
    v_add_f32 v29, v29, v61
    v_cvt_pk_bf16_f32 v93, v28, v29
    v_lshlrev_b32 v28, 16, v93
    v_and_b32 v29, 0xffff0000, v93
    v_max_f32 v28, 0, v28
    v_max_f32 v29, 0, v29
    v_mul_f32 v28, v28, v28
    v_mul_f32 v29, v29, v29
    v_cvt_pk_bf16_f32 v36, v28, v29
    v_and_b32 v36, s66, v36
    v_cvt_pk_bf16_f32 v93, v30, v31
    v_lshlrev_b32 v30, 16, v93
    v_and_b32 v31, 0xffff0000, v93
    v_add_f32 v30, v30, v62
    v_add_f32 v31, v31, v63
    v_cvt_pk_bf16_f32 v93, v30, v31
    v_lshlrev_b32 v30, 16, v93
    v_and_b32 v31, 0xffff0000, v93
    v_max_f32 v30, 0, v30
    v_max_f32 v31, 0, v31
    v_mul_f32 v30, v30, v30
    v_mul_f32 v31, v31, v31
    v_cvt_pk_bf16_f32 v37, v30, v31
    v_and_b32 v37, s66, v37
    v_accvgpr_read_b32 v32, a188
    v_accvgpr_read_b32 v33, a189
    v_accvgpr_read_b32 v34, a190
    v_accvgpr_read_b32 v35, a191
    v_cvt_pk_bf16_f32 v93, v32, v33
    v_lshlrev_b32 v32, 16, v93
    v_and_b32 v33, 0xffff0000, v93
    v_add_f32 v32, v32, v64
    v_add_f32 v33, v33, v65
    v_cvt_pk_bf16_f32 v93, v32, v33
    v_lshlrev_b32 v32, 16, v93
    v_and_b32 v33, 0xffff0000, v93
    v_max_f32 v32, 0, v32
    v_max_f32 v33, 0, v33
    v_mul_f32 v32, v32, v32
    v_mul_f32 v33, v33, v33
    v_cvt_pk_bf16_f32 v38, v32, v33
    v_and_b32 v38, s66, v38
    v_cvt_pk_bf16_f32 v93, v34, v35
    v_lshlrev_b32 v34, 16, v93
    v_and_b32 v35, 0xffff0000, v93
    v_add_f32 v34, v34, v66
    v_add_f32 v35, v35, v67
    v_cvt_pk_bf16_f32 v93, v34, v35
    v_lshlrev_b32 v34, 16, v93
    v_and_b32 v35, 0xffff0000, v93
    v_max_f32 v34, 0, v34
    v_max_f32 v35, 0, v35
    v_mul_f32 v34, v34, v34
    v_mul_f32 v35, v35, v35
    v_cvt_pk_bf16_f32 v39, v34, v35
    v_and_b32 v39, s66, v39
    s_add_u32 s62, s71, 401408
    buffer_store_dwordx4 v[36:39], v1, s[56:59], s62 offen offset:2048 sc1
    v_accvgpr_read_b32 v28, a220
    v_accvgpr_read_b32 v29, a221
    v_accvgpr_read_b32 v30, a222
    v_accvgpr_read_b32 v31, a223
    v_cvt_pk_bf16_f32 v93, v28, v29
    v_lshlrev_b32 v28, 16, v93
    v_and_b32 v29, 0xffff0000, v93
    v_add_f32 v28, v28, v68
    v_add_f32 v29, v29, v69
    v_cvt_pk_bf16_f32 v93, v28, v29
    v_lshlrev_b32 v28, 16, v93
    v_and_b32 v29, 0xffff0000, v93
    v_max_f32 v28, 0, v28
    v_max_f32 v29, 0, v29
    v_mul_f32 v28, v28, v28
    v_mul_f32 v29, v29, v29
    v_cvt_pk_bf16_f32 v40, v28, v29
    v_and_b32 v40, s66, v40
    v_cvt_pk_bf16_f32 v93, v30, v31
    v_lshlrev_b32 v30, 16, v93
    v_and_b32 v31, 0xffff0000, v93
    v_add_f32 v30, v30, v70
    v_add_f32 v31, v31, v71
    v_cvt_pk_bf16_f32 v93, v30, v31
    v_lshlrev_b32 v30, 16, v93
    v_and_b32 v31, 0xffff0000, v93
    v_max_f32 v30, 0, v30
    v_max_f32 v31, 0, v31
    v_mul_f32 v30, v30, v30
    v_mul_f32 v31, v31, v31
    v_cvt_pk_bf16_f32 v41, v30, v31
    v_and_b32 v41, s66, v41
    v_accvgpr_read_b32 v32, a252
    v_accvgpr_read_b32 v33, a253
    v_accvgpr_read_b32 v34, a254
    v_accvgpr_read_b32 v35, a255
    v_cvt_pk_bf16_f32 v93, v32, v33
    v_lshlrev_b32 v32, 16, v93
    v_and_b32 v33, 0xffff0000, v93
    v_add_f32 v32, v32, v72
    v_add_f32 v33, v33, v73
    v_cvt_pk_bf16_f32 v93, v32, v33
    v_lshlrev_b32 v32, 16, v93
    v_and_b32 v33, 0xffff0000, v93
    v_max_f32 v32, 0, v32
    v_max_f32 v33, 0, v33
    v_mul_f32 v32, v32, v32
    v_mul_f32 v33, v33, v33
    v_cvt_pk_bf16_f32 v42, v32, v33
    v_and_b32 v42, s66, v42
    v_cvt_pk_bf16_f32 v93, v34, v35
    v_lshlrev_b32 v34, 16, v93
    v_and_b32 v35, 0xffff0000, v93
    v_add_f32 v34, v34, v74
    v_add_f32 v35, v35, v75
    v_cvt_pk_bf16_f32 v93, v34, v35
    v_lshlrev_b32 v34, 16, v93
    v_and_b32 v35, 0xffff0000, v93
    v_max_f32 v34, 0, v34
    v_max_f32 v35, 0, v35
    v_mul_f32 v34, v34, v34
    v_mul_f32 v35, v35, v35
    v_cvt_pk_bf16_f32 v43, v34, v35
    v_and_b32 v43, s66, v43
    s_add_u32 s62, s71, 401408
    buffer_store_dwordx4 v[40:43], v1, s[56:59], s62 offen offset:3072 sc1
L_f1skip8:
    s_lshl_b32 s65, s72, 7
    s_add_u32 s65, s65, 94372864
    s_waitcnt vmcnt(0)
    s_barrier
    s_cmp_lg_u32 s61, 0
    s_cbranch_scc1 L_sig10
    v_mov_b32 v12, 131072
    v_mov_b32 v13, 0
    s_mov_b64 exec, 1
    buffer_atomic_add v12, v13, s[56:59], s65 offen sc1
    s_mov_b64 exec, -1
L_sig10:
    s_branch L_next
L_phB:
    v_mov_b32 v12, 1
    v_mov_b32 v13, 94372096
    v_cmp_eq_u32 vcc, 0, v0
    s_and_saveexec_b64 s[4:5], vcc
    s_cbranch_execz L_ba7873
    buffer_atomic_add v12, v13, s[56:59], 0 offen sc0 sc1
    s_waitcnt vmcnt(0)
    v_mov_b32 v13, 163832
    ds_write_b32 v13, v12
L_ba7873:
    s_mov_b64 exec, s[4:5]
    s_waitcnt lgkmcnt(0)
    s_barrier
    v_mov_b32 v13, 163832
    ds_read_b32 v12, v13
    s_waitcnt lgkmcnt(0)
    v_readfirstlane_b32 s60, v12
    s_barrier
    s_cmp_lt_u32 s60, 1188
    s_cbranch_scc0 L_end
    s_mul_hi_u32 s76, s60, 0x0e38e38f
    s_mul_i32 s63, s76, 18
    s_sub_u32 s62, s60, s63
    s_cmp_ge_u32 s62, 8
    s_cbranch_scc1 L_tfin
    s_cmp_ge_u32 s76, 64
    s_cbranch_scc1 L_next
    s_lshl_b32 s63, s62, 2
    s_add_u32 s77, s63, s61
    s_lshr_b32 s72, s76, 2
    s_lshl_b32 s65, s72, 7
    s_add_u32 s65, s65, 94372864
    s_cmp_lg_u32 s61, 0
    s_cbranch_scc1 L_wf12d
    v_mov_b32 v13, 0
L_wf12:
    buffer_load_dword v12, v13, s[56:59], s65 offen sc1
    s_waitcnt vmcnt(0)
    v_lshrrev_b32 v12, 11, v12
    v_and_b32 v12, 63, v12
    v_cmp_le_u32 vcc, 8, v12
    s_cbranch_vccnz L_wf12d
    s_sleep 16
    s_branch L_wf12
L_wf12d:
    s_barrier
    s_cmp_lg_u32 s61, 0
    s_cbranch_scc1 L_wf13d
    v_mov_b32 v13, 0
L_wf13:
    buffer_load_dword v12, v13, s[56:59], s65 offen sc1
    s_waitcnt vmcnt(0)
    v_lshrrev_b32 v12, 5, v12
    v_and_b32 v12, 63, v12
    v_cmp_le_u32 vcc, 16, v12
    s_cbranch_vccnz L_wf13d
    s_sleep 16
    s_branch L_wf13
L_wf13d:
    s_barrier
    s_lshl_b32 s62, s76, 5
    s_add_u32 s62, s62, s77
    s_lshl_b32 s63, s62, 13
    s_add_u32 s66, s63, 37748736
    s_add_u32 s67, s63, 37752832
    buffer_load_dwordx4 v[28:31], v1, s[56:59], s66 offen sc1
    buffer_load_dwordx4 v[32:35], v1, s[56:59], s66 offen offset:1024 sc1
    buffer_load_dwordx4 v[36:39], v1, s[56:59], s66 offen offset:2048 sc1
    buffer_load_dwordx4 v[40:43], v1, s[56:59], s66 offen offset:3072 sc1
    buffer_load_dwordx4 v[44:47], v1, s[56:59], s67 offen sc1
    buffer_load_dwordx4 v[48:51], v1, s[56:59], s67 offen offset:1024 sc1
    buffer_load_dwordx4 v[52:55], v1, s[56:59], s67 offen offset:2048 sc1
    buffer_load_dwordx4 v[56:59], v1, s[56:59], s67 offen offset:3072 sc1
    s_add_u32 s66, s63, 4194304
    s_add_u32 s67, s63, 4198400
    buffer_load_dwordx4 v[60:63], v1, s[56:59], s66 offen sc1
    buffer_load_dwordx4 v[64:67], v1, s[56:59], s66 offen offset:1024 sc1
    buffer_load_dwordx4 v[68:71], v1, s[56:59], s66 offen offset:2048 sc1
    buffer_load_dwordx4 v[72:75], v1, s[56:59], s66 offen offset:3072 sc1
    buffer_load_dwordx4 v[76:79], v1, s[56:59], s67 offen sc1
    buffer_load_dwordx4 v[80:83], v1, s[56:59], s67 offen offset:1024 sc1
    buffer_load_dwordx4 v[84:87], v1, s[56:59], s67 offen offset:2048 sc1
    buffer_load_dwordx4 v[88:91], v1, s[56:59], s67 offen offset:3072 sc1
    s_add_u32 s66, s63, 20971520
    s_add_u32 s67, s63, 20975616
    buffer_load_dwordx4 v[92:95], v1, s[56:59], s66 offen sc1
    buffer_load_dwordx4 v[96:99], v1, s[56:59], s66 offen offset:1024 sc1
    buffer_load_dwordx4 v[100:103], v1, s[56:59], s66 offen offset:2048 sc1
    buffer_load_dwordx4 v[104:107], v1, s[56:59], s66 offen offset:3072 sc1
    buffer_load_dwordx4 v[108:111], v1, s[56:59], s67 offen sc1
    buffer_load_dwordx4 v[112:115], v1, s[56:59], s67 offen offset:1024 sc1
    buffer_load_dwordx4 v[116:119], v1, s[56:59], s67 offen offset:2048 sc1
    buffer_load_dwordx4 v[120:123], v1, s[56:59], s67 offen offset:3072 sc1
    v_mov_b32 v14, 0
    s_add_u32 s66, s76, 1
    s_mov_b32 s67, 94372224
    s_cmp_lg_u32 s61, 0
    s_cbranch_scc1 L_atw11d
L_atw11:
    buffer_load_dwordx2 v[12:13], v14, s[56:59], s67 offen sc1
    s_waitcnt vmcnt(0)
    v_cmp_le_i32 s[90:91], s66, v12
    v_cmp_le_u32 vcc, 32, v13
    s_or_b64 vcc, vcc, s[90:91]
    s_cbranch_vccnz L_atw11d
    s_sleep 8
    s_branch L_atw11
L_atw11d:
    s_barrier
    s_lshl_b32 s63, s62, 12
    s_add_u32 s63, s63, 79822848
    s_add_u32 m0, s74, 0
    s_nop 0
    buffer_load_dwordx4 v1, s[56:59], s63 offen sc1 lds
    s_add_u32 m0, s74, 0
    s_nop 0
    buffer_load_dwordx4 v1, s[56:59], s63 offen offset:1024 sc1 lds
    v_and_b32 v15, 1, v25
    v_lshlrev_b32 v16, 4, v26
    v_lshl_add_u32 v16, v15, 3, v16
    buffer_load_dwordx2 v[140:141], v16, s[56:59], s63 offen offset:2048 sc1
    buffer_load_dwordx2 v[142:143], v16, s[56:59], s63 offen offset:2304 sc1
    buffer_load_dwordx2 v[144:145], v16, s[56:59], s63 offen offset:2560 sc1
    buffer_load_dwordx2 v[146:147], v16, s[56:59], s63 offen offset:2816 sc1
    buffer_load_dwordx2 v[148:149], v16, s[56:59], s63 offen offset:3072 sc1
    buffer_load_dwordx2 v[150:151], v16, s[56:59], s63 offen offset:3328 sc1
    buffer_load_dwordx2 v[152:153], v16, s[56:59], s63 offen offset:3584 sc1
    buffer_load_dwordx2 v[154:155], v16, s[56:59], s63 offen offset:3840 sc1
    v_lshrrev_b32 v17, 2, v24
    v_lshlrev_b32 v17, 4, v17
    v_and_b32 v18, 1, v24
    v_lshl_add_u32 v17, v18, 3, v17
    v_add_u32 v17, s74, v17
    s_waitcnt vmcnt(0)
    ds_read_b64_tr_b16 v[124:125], v17
    ds_read_b64_tr_b16 v[126:127], v17 offset:256
    ds_read_b64_tr_b16 v[128:129], v17 offset:512
    ds_read_b64_tr_b16 v[130:131], v17 offset:768
    ds_read_b64_tr_b16 v[132:133], v17 offset:1024
    ds_read_b64_tr_b16 v[134:135], v17 offset:1280
    ds_read_b64_tr_b16 v[136:137], v17 offset:1536
    ds_read_b64_tr_b16 v[138:139], v17 offset:1792
    v_lshl_add_u32 v18, v25, 2, 0
    v_cmp_gt_u32 s[80:81], v18, v26
    v_lshl_add_u32 v18, v25, 2, 1
    v_cmp_gt_u32 s[82:83], v18, v26
    v_lshl_add_u32 v18, v25, 2, 2
    v_cmp_gt_u32 s[84:85], v18, v26
    v_lshl_add_u32 v18, v25, 2, 3
    v_cmp_gt_u32 s[86:87], v18, v26
    v_cmp_le_u32 s[88:89], 2, v25
    v_mov_b32 v19, 0xce6e6b28
    s_waitcnt lgkmcnt(6)
    v_mfma_f32_16x16x32_bf16 v[156:159], v[124:127], v[28:31], 0
    s_waitcnt lgkmcnt(4)
    v_mfma_f32_16x16x32_bf16 v[156:159], v[128:131], v[32:35], v[156:159]
    s_waitcnt lgkmcnt(2)
    v_mfma_f32_16x16x32_bf16 v[156:159], v[132:135], v[36:39], v[156:159]
    s_waitcnt lgkmcnt(0)
    v_mfma_f32_16x16x32_bf16 v[156:159], v[136:139], v[40:43], v[156:159]
    v_mfma_f32_16x16x32_bf16 v[160:163], v[60:63], v[28:31], 0
    v_mfma_f32_16x16x32_bf16 v[160:163], v[64:67], v[32:35], v[160:163]
    v_mfma_f32_16x16x32_bf16 v[160:163], v[68:71], v[36:39], v[160:163]
    v_mfma_f32_16x16x32_bf16 v[160:163], v[72:75], v[40:43], v[160:163]
    v_mfma_f32_16x16x32_bf16 v[164:167], v[124:127], v[44:47], 0
    v_mfma_f32_16x16x32_bf16 v[164:167], v[128:131], v[48:51], v[164:167]
    v_mfma_f32_16x16x32_bf16 v[164:167], v[132:135], v[52:55], v[164:167]
    v_mfma_f32_16x16x32_bf16 v[164:167], v[136:139], v[56:59], v[164:167]
    v_mfma_f32_16x16x32_bf16 v[168:171], v[60:63], v[44:47], 0
    v_mfma_f32_16x16x32_bf16 v[168:171], v[64:67], v[48:51], v[168:171]
    v_mfma_f32_16x16x32_bf16 v[168:171], v[68:71], v[52:55], v[168:171]
    v_mfma_f32_16x16x32_bf16 v[168:171], v[72:75], v[56:59], v[168:171]
    v_mfma_f32_16x16x32_bf16 v[172:175], v[76:79], v[44:47], 0
    v_mfma_f32_16x16x32_bf16 v[172:175], v[80:83], v[48:51], v[172:175]
    v_mfma_f32_16x16x32_bf16 v[172:175], v[84:87], v[52:55], v[172:175]
    v_mfma_f32_16x16x32_bf16 v[172:175], v[88:91], v[56:59], v[172:175]
    s_mov_b32 s66, 0x3db504f3
    s_mov_b32 s67, 0x3fb8aa3b
    v_cvt_pk_bf16_f32 v20, v156, v157
    v_lshlrev_b32 v156, 16, v20
    v_and_b32 v157, 0xffff0000, v20
    v_mul_f32 v156, s66, v156
    v_mul_f32 v157, s66, v157
    v_cvt_pk_bf16_f32 v20, v156, v157
    v_lshlrev_b32 v156, 16, v20
    v_and_b32 v157, 0xffff0000, v20
    v_cvt_pk_bf16_f32 v20, v158, v159
    v_lshlrev_b32 v158, 16, v20
    v_and_b32 v159, 0xffff0000, v20
    v_mul_f32 v158, s66, v158
    v_mul_f32 v159, s66, v159
    v_cvt_pk_bf16_f32 v20, v158, v159
    v_lshlrev_b32 v158, 16, v20
    v_and_b32 v159, 0xffff0000, v20
    v_cndmask_b32 v156, v156, v19, s[88:89]
    v_cndmask_b32 v157, v157, v19, s[88:89]
    v_cndmask_b32 v158, v158, v19, s[88:89]
    v_cndmask_b32 v159, v159, v19, s[88:89]
    v_cvt_pk_bf16_f32 v20, v160, v161
    v_lshlrev_b32 v160, 16, v20
    v_and_b32 v161, 0xffff0000, v20
    v_mul_f32 v160, s66, v160
    v_mul_f32 v161, s66, v161
    v_cvt_pk_bf16_f32 v20, v160, v161
    v_lshlrev_b32 v160, 16, v20
    v_and_b32 v161, 0xffff0000, v20
    v_cvt_pk_bf16_f32 v20, v162, v163
    v_lshlrev_b32 v162, 16, v20
    v_and_b32 v163, 0xffff0000, v20
    v_mul_f32 v162, s66, v162
    v_mul_f32 v163, s66, v163
    v_cvt_pk_bf16_f32 v20, v162, v163
    v_lshlrev_b32 v162, 16, v20
    v_and_b32 v163, 0xffff0000, v20
    v_cndmask_b32 v160, v160, v19, s[80:81]
    v_cndmask_b32 v161, v161, v19, s[82:83]
    v_cndmask_b32 v162, v162, v19, s[84:85]
    v_cndmask_b32 v163, v163, v19, s[86:87]
    v_max_f32 v21, v156, v157
    v_max3_f32 v21, v21, v158, v159
    v_max3_f32 v21, v21, v160, v161
    v_max3_f32 v21, v21, v162, v163
    v_mov_b32 v23, v21
    s_nop 1
    v_permlane32_swap_b32 v21, v23
    v_max_f32 v21, v21, v23
    v_mov_b32 v23, v21
    s_nop 1
    v_permlane16_swap_b32 v21, v23
    v_max_f32 v21, v21, v23
    v_sub_f32 v156, v156, v21
    v_mul_f32 v156, s67, v156
    v_exp_f32 v156, v156
    v_sub_f32 v157, v157, v21
    v_mul_f32 v157, s67, v157
    v_exp_f32 v157, v157
    v_sub_f32 v158, v158, v21
    v_mul_f32 v158, s67, v158
    v_exp_f32 v158, v158
    v_sub_f32 v159, v159, v21
    v_mul_f32 v159, s67, v159
    v_exp_f32 v159, v159
    v_sub_f32 v160, v160, v21
    v_mul_f32 v160, s67, v160
    v_exp_f32 v160, v160
    v_sub_f32 v161, v161, v21
    v_mul_f32 v161, s67, v161
    v_exp_f32 v161, v161
    v_sub_f32 v162, v162, v21
    v_mul_f32 v162, s67, v162
    v_exp_f32 v162, v162
    v_sub_f32 v163, v163, v21
    v_mul_f32 v163, s67, v163
    v_exp_f32 v163, v163
    v_cndmask_b32 v156, v156, 0, s[88:89]
    v_cndmask_b32 v157, v157, 0, s[88:89]
    v_cndmask_b32 v158, v158, 0, s[88:89]
    v_cndmask_b32 v159, v159, 0, s[88:89]
    v_add_f32 v22, v156, v157
    v_add_f32 v22, v22, v158
    v_add_f32 v22, v22, v159
    v_add_f32 v22, v22, v160
    v_add_f32 v22, v22, v161
    v_add_f32 v22, v22, v162
    v_add_f32 v22, v22, v163
    v_mov_b32 v23, v22
    s_nop 1
    v_permlane32_swap_b32 v22, v23
    v_add_f32 v22, v22, v23
    v_mov_b32 v23, v22
    s_nop 1
    v_permlane16_swap_b32 v22, v23
    v_add_f32 v22, v22, v23
    v_rcp_f32 v22, v22
    s_nop 0
    v_mul_f32 v156, v156, v22
    v_mul_f32 v157, v157, v22
    v_mul_f32 v158, v158, v22
    v_mul_f32 v159, v159, v22
    v_mul_f32 v160, v160, v22
    v_mul_f32 v161, v161, v22
    v_mul_f32 v162, v162, v22
    v_mul_f32 v163, v163, v22
    v_cvt_pk_bf16_f32 v176, v160, v161
    v_cvt_pk_bf16_f32 v177, v162, v163
    v_mov_b32 v178, 0
    v_mov_b32 v179, 0
    v_cvt_pk_bf16_f32 v180, v156, v157
    v_cvt_pk_bf16_f32 v181, v158, v159
    v_cvt_pk_bf16_f32 v20, v164, v165
    v_lshlrev_b32 v164, 16, v20
    v_and_b32 v165, 0xffff0000, v20
    v_mul_f32 v164, s66, v164
    v_mul_f32 v165, s66, v165
    v_cvt_pk_bf16_f32 v20, v164, v165
    v_lshlrev_b32 v164, 16, v20
    v_and_b32 v165, 0xffff0000, v20
    v_cvt_pk_bf16_f32 v20, v166, v167
    v_lshlrev_b32 v166, 16, v20
    v_and_b32 v167, 0xffff0000, v20
    v_mul_f32 v166, s66, v166
    v_mul_f32 v167, s66, v167
    v_cvt_pk_bf16_f32 v20, v166, v167
    v_lshlrev_b32 v166, 16, v20
    v_and_b32 v167, 0xffff0000, v20
    v_cndmask_b32 v164, v164, v19, s[88:89]
    v_cndmask_b32 v165, v165, v19, s[88:89]
    v_cndmask_b32 v166, v166, v19, s[88:89]
    v_cndmask_b32 v167, v167, v19, s[88:89]
    v_cvt_pk_bf16_f32 v20, v168, v169
    v_lshlrev_b32 v168, 16, v20
    v_and_b32 v169, 0xffff0000, v20
    v_mul_f32 v168, s66, v168
    v_mul_f32 v169, s66, v169
    v_cvt_pk_bf16_f32 v20, v168, v169
    v_lshlrev_b32 v168, 16, v20
    v_and_b32 v169, 0xffff0000, v20
    v_cvt_pk_bf16_f32 v20, v170, v171
    v_lshlrev_b32 v170, 16, v20
    v_and_b32 v171, 0xffff0000, v20
    v_mul_f32 v170, s66, v170
    v_mul_f32 v171, s66, v171
    v_cvt_pk_bf16_f32 v20, v170, v171
    v_lshlrev_b32 v170, 16, v20
    v_and_b32 v171, 0xffff0000, v20
    v_cvt_pk_bf16_f32 v20, v172, v173
    v_lshlrev_b32 v172, 16, v20
    v_and_b32 v173, 0xffff0000, v20
    v_mul_f32 v172, s66, v172
    v_mul_f32 v173, s66, v173
    v_cvt_pk_bf16_f32 v20, v172, v173
    v_lshlrev_b32 v172, 16, v20
    v_and_b32 v173, 0xffff0000, v20
    v_cvt_pk_bf16_f32 v20, v174, v175
    v_lshlrev_b32 v174, 16, v20
    v_and_b32 v175, 0xffff0000, v20
    v_mul_f32 v174, s66, v174
    v_mul_f32 v175, s66, v175
    v_cvt_pk_bf16_f32 v20, v174, v175
    v_lshlrev_b32 v174, 16, v20
    v_and_b32 v175, 0xffff0000, v20
    v_cndmask_b32 v172, v172, v19, s[80:81]
    v_cndmask_b32 v173, v173, v19, s[82:83]
    v_cndmask_b32 v174, v174, v19, s[84:85]
    v_cndmask_b32 v175, v175, v19, s[86:87]
    v_max_f32 v21, v164, v165
    v_max3_f32 v21, v21, v166, v167
    v_max3_f32 v21, v21, v168, v169
    v_max3_f32 v21, v21, v170, v171
    v_max3_f32 v21, v21, v172, v173
    v_max3_f32 v21, v21, v174, v175
    v_mov_b32 v23, v21
    s_nop 1
    v_permlane32_swap_b32 v21, v23
    v_max_f32 v21, v21, v23
    v_mov_b32 v23, v21
    s_nop 1
    v_permlane16_swap_b32 v21, v23
    v_max_f32 v21, v21, v23
    v_sub_f32 v164, v164, v21
    v_mul_f32 v164, s67, v164
    v_exp_f32 v164, v164
    v_sub_f32 v165, v165, v21
    v_mul_f32 v165, s67, v165
    v_exp_f32 v165, v165
    v_sub_f32 v166, v166, v21
    v_mul_f32 v166, s67, v166
    v_exp_f32 v166, v166
    v_sub_f32 v167, v167, v21
    v_mul_f32 v167, s67, v167
    v_exp_f32 v167, v167
    v_sub_f32 v168, v168, v21
    v_mul_f32 v168, s67, v168
    v_exp_f32 v168, v168
    v_sub_f32 v169, v169, v21
    v_mul_f32 v169, s67, v169
    v_exp_f32 v169, v169
    v_sub_f32 v170, v170, v21
    v_mul_f32 v170, s67, v170
    v_exp_f32 v170, v170
    v_sub_f32 v171, v171, v21
    v_mul_f32 v171, s67, v171
    v_exp_f32 v171, v171
    v_sub_f32 v172, v172, v21
    v_mul_f32 v172, s67, v172
    v_exp_f32 v172, v172
    v_sub_f32 v173, v173, v21
    v_mul_f32 v173, s67, v173
    v_exp_f32 v173, v173
    v_sub_f32 v174, v174, v21
    v_mul_f32 v174, s67, v174
    v_exp_f32 v174, v174
    v_sub_f32 v175, v175, v21
    v_mul_f32 v175, s67, v175
    v_exp_f32 v175, v175
    v_cndmask_b32 v164, v164, 0, s[88:89]
    v_cndmask_b32 v165, v165, 0, s[88:89]
    v_cndmask_b32 v166, v166, 0, s[88:89]
    v_cndmask_b32 v167, v167, 0, s[88:89]
    v_add_f32 v22, v164, v165
    v_add_f32 v22, v22, v166
    v_add_f32 v22, v22, v167
    v_add_f32 v22, v22, v168
    v_add_f32 v22, v22, v169
    v_add_f32 v22, v22, v170
    v_add_f32 v22, v22, v171
    v_add_f32 v22, v22, v172
    v_add_f32 v22, v22, v173
    v_add_f32 v22, v22, v174
    v_add_f32 v22, v22, v175
    v_mov_b32 v23, v22
    s_nop 1
    v_permlane32_swap_b32 v22, v23
    v_add_f32 v22, v22, v23
    v_mov_b32 v23, v22
    s_nop 1
    v_permlane16_swap_b32 v22, v23
    v_add_f32 v22, v22, v23
    v_rcp_f32 v22, v22
    s_nop 0
    v_mul_f32 v164, v164, v22
    v_mul_f32 v165, v165, v22
    v_mul_f32 v166, v166, v22
    v_mul_f32 v167, v167, v22
    v_mul_f32 v168, v168, v22
    v_mul_f32 v169, v169, v22
    v_mul_f32 v170, v170, v22
    v_mul_f32 v171, v171, v22
    v_mul_f32 v172, v172, v22
    v_mul_f32 v173, v173, v22
    v_mul_f32 v174, v174, v22
    v_mul_f32 v175, v175, v22
    v_cvt_pk_bf16_f32 v182, v168, v169
    v_cvt_pk_bf16_f32 v183, v170, v171
    v_cvt_pk_bf16_f32 v184, v172, v173
    v_cvt_pk_bf16_f32 v185, v174, v175
    v_cvt_pk_bf16_f32 v186, v164, v165
    v_cvt_pk_bf16_f32 v187, v166, v167
    s_lshl_b32 s62, s76, 1
    s_lshl_b32 s62, s62, 5
    s_add_u32 s62, s62, s77
    s_lshl_b32 s62, s62, 12
    s_add_u32 s71, s62, 62914560
    v_mfma_f32_16x16x32_bf16 v[60:63], v[92:95], v[176:179], 0
    v_mfma_f32_16x16x32_bf16 v[64:67], v[96:99], v[176:179], 0
    v_mfma_f32_16x16x32_bf16 v[68:71], v[100:103], v[176:179], 0
    v_mfma_f32_16x16x32_bf16 v[72:75], v[104:107], v[176:179], 0
    v_mfma_f32_16x16x32_bf16 v[76:79], v[108:111], v[176:179], 0
    v_mfma_f32_16x16x32_bf16 v[80:83], v[112:115], v[176:179], 0
    v_mfma_f32_16x16x32_bf16 v[84:87], v[116:119], v[176:179], 0
    v_mfma_f32_16x16x32_bf16 v[88:91], v[120:123], v[176:179], 0
    v_mfma_f32_16x16x16_bf16 v[60:63], v[140:141], v[180:181], v[60:63]
    v_mfma_f32_16x16x16_bf16 v[64:67], v[142:143], v[180:181], v[64:67]
    v_mfma_f32_16x16x16_bf16 v[68:71], v[144:145], v[180:181], v[68:71]
    v_mfma_f32_16x16x16_bf16 v[72:75], v[146:147], v[180:181], v[72:75]
    v_mfma_f32_16x16x16_bf16 v[76:79], v[148:149], v[180:181], v[76:79]
    v_mfma_f32_16x16x16_bf16 v[80:83], v[150:151], v[180:181], v[80:83]
    v_mfma_f32_16x16x16_bf16 v[84:87], v[152:153], v[180:181], v[84:87]
    v_mfma_f32_16x16x16_bf16 v[88:91], v[154:155], v[180:181], v[88:91]
    s_nop 0
    v_cvt_pk_bf16_f32 v28, v60, v61
    v_cvt_pk_bf16_f32 v29, v62, v63
    v_cvt_pk_bf16_f32 v30, v64, v65
    v_cvt_pk_bf16_f32 v31, v66, v67
    s_add_u32 s62, s71, 0
    buffer_store_dwordx4 v[28:31], v1, s[56:59], s62 offen sc1
    v_cvt_pk_bf16_f32 v32, v68, v69
    v_cvt_pk_bf16_f32 v33, v70, v71
    v_cvt_pk_bf16_f32 v34, v72, v73
    v_cvt_pk_bf16_f32 v35, v74, v75
    s_add_u32 s62, s71, 0
    buffer_store_dwordx4 v[32:35], v1, s[56:59], s62 offen offset:1024 sc1
    v_cvt_pk_bf16_f32 v36, v76, v77
    v_cvt_pk_bf16_f32 v37, v78, v79
    v_cvt_pk_bf16_f32 v38, v80, v81
    v_cvt_pk_bf16_f32 v39, v82, v83
    s_add_u32 s62, s71, 0
    buffer_store_dwordx4 v[36:39], v1, s[56:59], s62 offen offset:2048 sc1
    v_cvt_pk_bf16_f32 v40, v84, v85
    v_cvt_pk_bf16_f32 v41, v86, v87
    v_cvt_pk_bf16_f32 v42, v88, v89
    v_cvt_pk_bf16_f32 v43, v90, v91
    s_add_u32 s62, s71, 0
    buffer_store_dwordx4 v[40:43], v1, s[56:59], s62 offen offset:3072 sc1
    v_mfma_f32_16x16x32_bf16 v[188:191], v[92:95], v[182:185], 0
    v_mfma_f32_16x16x32_bf16 v[192:195], v[96:99], v[182:185], 0
    v_mfma_f32_16x16x32_bf16 v[196:199], v[100:103], v[182:185], 0
    v_mfma_f32_16x16x32_bf16 v[200:203], v[104:107], v[182:185], 0
    v_mfma_f32_16x16x32_bf16 v[204:207], v[108:111], v[182:185], 0
    v_mfma_f32_16x16x32_bf16 v[208:211], v[112:115], v[182:185], 0
    v_mfma_f32_16x16x32_bf16 v[212:215], v[116:119], v[182:185], 0
    v_mfma_f32_16x16x32_bf16 v[216:219], v[120:123], v[182:185], 0
    v_mfma_f32_16x16x16_bf16 v[188:191], v[140:141], v[186:187], v[188:191]
    v_mfma_f32_16x16x16_bf16 v[192:195], v[142:143], v[186:187], v[192:195]
    v_mfma_f32_16x16x16_bf16 v[196:199], v[144:145], v[186:187], v[196:199]
    v_mfma_f32_16x16x16_bf16 v[200:203], v[146:147], v[186:187], v[200:203]
    v_mfma_f32_16x16x16_bf16 v[204:207], v[148:149], v[186:187], v[204:207]
    v_mfma_f32_16x16x16_bf16 v[208:211], v[150:151], v[186:187], v[208:211]
    v_mfma_f32_16x16x16_bf16 v[212:215], v[152:153], v[186:187], v[212:215]
    v_mfma_f32_16x16x16_bf16 v[216:219], v[154:155], v[186:187], v[216:219]
    s_nop 0
    v_cvt_pk_bf16_f32 v44, v188, v189
    v_cvt_pk_bf16_f32 v45, v190, v191
    v_cvt_pk_bf16_f32 v46, v192, v193
    v_cvt_pk_bf16_f32 v47, v194, v195
    s_add_u32 s62, s71, 131072
    buffer_store_dwordx4 v[44:47], v1, s[56:59], s62 offen sc1
    v_cvt_pk_bf16_f32 v48, v196, v197
    v_cvt_pk_bf16_f32 v49, v198, v199
    v_cvt_pk_bf16_f32 v50, v200, v201
    v_cvt_pk_bf16_f32 v51, v202, v203
    s_add_u32 s62, s71, 131072
    buffer_store_dwordx4 v[48:51], v1, s[56:59], s62 offen offset:1024 sc1
    v_cvt_pk_bf16_f32 v52, v204, v205
    v_cvt_pk_bf16_f32 v53, v206, v207
    v_cvt_pk_bf16_f32 v54, v208, v209
    v_cvt_pk_bf16_f32 v55, v210, v211
    s_add_u32 s62, s71, 131072
    buffer_store_dwordx4 v[52:55], v1, s[56:59], s62 offen offset:2048 sc1
    v_cvt_pk_bf16_f32 v56, v212, v213
    v_cvt_pk_bf16_f32 v57, v214, v215
    v_cvt_pk_bf16_f32 v58, v216, v217
    v_cvt_pk_bf16_f32 v59, v218, v219
    s_add_u32 s62, s71, 131072
    buffer_store_dwordx4 v[56:59], v1, s[56:59], s62 offen offset:3072 sc1
    s_lshl_b32 s62, s76, 7
    s_add_u32 s65, s62, 94375936
    s_waitcnt vmcnt(0)
    s_barrier
    s_cmp_lg_u32 s61, 0
    s_cbranch_scc1 L_sig14
    v_mov_b32 v12, 1
    v_mov_b32 v13, 0
    s_mov_b64 exec, 1
    buffer_atomic_add v12, v13, s[56:59], s65 offen sc1
    s_mov_b64 exec, -1
L_sig14:
    s_branch L_next
L_tfin:
    s_cmp_lt_u32 s76, 2
    s_cbranch_scc1 L_next
    s_sub_u32 s76, s76, 2
    s_sub_u32 s77, s62, 8
    s_movk_i32 s62, 1280
    v_lshrrev_b32 v12, 3, v24
    v_mul_lo_u32 v12, v12, s62
    v_and_b32 v13, 7, v24
    v_lshlrev_b32 v14, 1, v25
    v_xor_b32 v13, v13, v14
    v_lshl_add_u32 v2, v13, 4, v12
    v_lshrrev_b32 v14, 2, v24
    v_and_b32 v15, 3, v24
    v_bfe_u32 v16, v24, 3, 2
    v_lshlrev_b32 v17, 7, v14
    v_and_b32 v18, 1, v15
    v_lshl_add_u32 v17, v18, 4, v17
    v_add_u32 v17, s74, v17
    v_lshrrev_b32 v15, 1, v15
    v_add_u32 v18, 0, v15
    v_xor_b32 v18, v18, v16
    v_lshl_add_u32 v18, v18, 5, v17
    v_add_u32 v4, 0, v18
    v_add_u32 v18, 0, v15
    v_xor_b32 v18, v18, v16
    v_lshl_add_u32 v18, v18, 5, v17
    v_add_u32 v5, 8, v18
    v_add_u32 v18, 2, v15
    v_xor_b32 v18, v18, v16
    v_lshl_add_u32 v18, v18, 5, v17
    v_add_u32 v6, 0, v18
    v_add_u32 v18, 2, v15
    v_xor_b32 v18, v18, v16
    v_lshl_add_u32 v18, v18, 5, v17
    v_add_u32 v7, 8, v18
    s_lshr_b32 s72, s76, 2
    s_lshl_b32 s65, s72, 7
    s_add_u32 s65, s65, 94372864
    s_cmp_lg_u32 s61, 0
    s_cbranch_scc1 L_wf15d
    v_mov_b32 v13, 0
L_wf15:
    buffer_load_dword v12, v13, s[56:59], s65 offen sc1
    s_waitcnt vmcnt(0)
    v_lshrrev_b32 v12, 17, v12
    v_and_b32 v12, 15, v12
    v_cmp_le_u32 vcc, 4, v12
    s_cbranch_vccnz L_wf15d
    s_sleep 16
    s_branch L_wf15
L_wf15d:
    s_barrier
    s_lshl_b32 s66, s61, 4
    s_cmp_eq_u32 s61, 3
    s_cselect_b32 s66, 44, s66
    s_cmp_ge_u32 s61, 2
    s_cselect_b32 s64, 12, 16
    s_mul_i32 s68, s66, 40960
    s_lshl_b32 s62, s77, 7
    s_add_u32 s68, s68, s62
    s_mul_i32 s69, s76, 114688
    s_lshl_b32 s62, s66, 10
    s_add_u32 s69, s69, s62
    s_add_u32 s69, s69, 54525952
    s_mov_b32 s79, 57344
    v_accvgpr_write_b32 a0, 0
    v_accvgpr_write_b32 a1, 0
    v_accvgpr_write_b32 a2, 0
    v_accvgpr_write_b32 a3, 0
    v_accvgpr_write_b32 a4, 0
    v_accvgpr_write_b32 a5, 0
    v_accvgpr_write_b32 a6, 0
    v_accvgpr_write_b32 a7, 0
    v_accvgpr_write_b32 a8, 0
    v_accvgpr_write_b32 a9, 0
    v_accvgpr_write_b32 a10, 0
    v_accvgpr_write_b32 a11, 0
    v_accvgpr_write_b32 a12, 0
    v_accvgpr_write_b32 a13, 0
    v_accvgpr_write_b32 a14, 0
    v_accvgpr_write_b32 a15, 0
    v_accvgpr_write_b32 a16, 0
    v_accvgpr_write_b32 a17, 0
    v_accvgpr_write_b32 a18, 0
    v_accvgpr_write_b32 a19, 0
    v_accvgpr_write_b32 a20, 0
    v_accvgpr_write_b32 a21, 0
    v_accvgpr_write_b32 a22, 0
    v_accvgpr_write_b32 a23, 0
    v_accvgpr_write_b32 a24, 0
    v_accvgpr_write_b32 a25, 0
    v_accvgpr_write_b32 a26, 0
    v_accvgpr_write_b32 a27, 0
    v_accvgpr_write_b32 a28, 0
    v_accvgpr_write_b32 a29, 0
    v_accvgpr_write_b32 a30, 0
    v_accvgpr_write_b32 a31, 0
    s_add_u32 m0, s74, 0
    s_add_u32 s62, s68, 0
    buffer_load_dwordx4 v2, s[40:43], s62 offen lds
    s_add_u32 m0, s74, 1024
    s_add_u32 s62, s68, 10240
    buffer_load_dwordx4 v2, s[40:43], s62 offen lds
    s_add_u32 m0, s74, 2048
    s_add_u32 s62, s68, 20480
    buffer_load_dwordx4 v2, s[40:43], s62 offen lds
    s_add_u32 m0, s74, 3072
    s_add_u32 s62, s68, 30720
    buffer_load_dwordx4 v2, s[40:43], s62 offen lds
    s_add_u32 s68, s68, 40960
    s_mov_b32 s63, s69
    buffer_load_dwordx4 v[92:95], v1, s[56:59], s63 offen sc1
    s_add_u32 s63, s63, s79
    buffer_load_dwordx4 v[96:99], v1, s[56:59], s63 offen sc1
    s_add_u32 s69, s69, 1024
    s_add_u32 m0, s74, 8192
    s_add_u32 s62, s68, 0
    buffer_load_dwordx4 v2, s[40:43], s62 offen lds
    s_add_u32 m0, s74, 9216
    s_add_u32 s62, s68, 10240
    buffer_load_dwordx4 v2, s[40:43], s62 offen lds
    s_add_u32 m0, s74, 10240
    s_add_u32 s62, s68, 20480
    buffer_load_dwordx4 v2, s[40:43], s62 offen lds
    s_add_u32 m0, s74, 11264
    s_add_u32 s62, s68, 30720
    buffer_load_dwordx4 v2, s[40:43], s62 offen lds
    s_add_u32 s68, s68, 40960
    s_mov_b32 s63, s69
    buffer_load_dwordx4 v[124:127], v1, s[56:59], s63 offen sc1
    s_add_u32 s63, s63, s79
    buffer_load_dwordx4 v[128:131], v1, s[56:59], s63 offen sc1
    s_add_u32 s69, s69, 1024
    s_add_u32 m0, s74, 16384
    s_add_u32 s62, s68, 0
    buffer_load_dwordx4 v2, s[40:43], s62 offen lds
    s_add_u32 m0, s74, 17408
    s_add_u32 s62, s68, 10240
    buffer_load_dwordx4 v2, s[40:43], s62 offen lds
    s_add_u32 m0, s74, 18432
    s_add_u32 s62, s68, 20480
    buffer_load_dwordx4 v2, s[40:43], s62 offen lds
    s_add_u32 m0, s74, 19456
    s_add_u32 s62, s68, 30720
    buffer_load_dwordx4 v2, s[40:43], s62 offen lds
    s_add_u32 s68, s68, 40960
    s_waitcnt vmcnt(12)
    ds_read_b64_tr_b16 v[28:29], v4
    ds_read_b64_tr_b16 v[30:31], v4 offset:2048
    ds_read_b64_tr_b16 v[32:33], v5
    ds_read_b64_tr_b16 v[34:35], v5 offset:2048
    ds_read_b64_tr_b16 v[36:37], v6
    ds_read_b64_tr_b16 v[38:39], v6 offset:2048
    ds_read_b64_tr_b16 v[40:41], v7
    ds_read_b64_tr_b16 v[42:43], v7 offset:2048
    s_mov_b32 s70, 0
L_g2_loop:
    s_waitcnt vmcnt(6) lgkmcnt(0)
    v_mfma_f32_16x16x32_bf16 a[0:3], v[28:31], v[92:95], a[0:3]
    ds_read_b64_tr_b16 v[60:61], v4 offset:8192
    ds_read_b64_tr_b16 v[62:63], v4 offset:10240
    ds_read_b64_tr_b16 v[64:65], v5 offset:8192
    ds_read_b64_tr_b16 v[66:67], v5 offset:10240
    ds_read_b64_tr_b16 v[68:69], v6 offset:8192
    v_mfma_f32_16x16x32_bf16 a[4:7], v[28:31], v[96:99], a[4:7]
    ds_read_b64_tr_b16 v[70:71], v6 offset:10240
    ds_read_b64_tr_b16 v[72:73], v7 offset:8192
    ds_read_b64_tr_b16 v[74:75], v7 offset:10240
    s_mov_b32 s63, s69
    buffer_load_dwordx4 v[156:159], v1, s[56:59], s63 offen sc1
    v_mfma_f32_16x16x32_bf16 a[8:11], v[32:35], v[92:95], a[8:11]
    s_add_u32 s63, s63, s79
    buffer_load_dwordx4 v[160:163], v1, s[56:59], s63 offen sc1
    s_add_u32 s69, s69, 1024
    s_add_u32 m0, s74, 24576
    s_add_u32 s62, s68, 0
    v_mfma_f32_16x16x32_bf16 a[12:15], v[32:35], v[96:99], a[12:15]
    buffer_load_dwordx4 v2, s[40:43], s62 offen lds
    s_add_u32 m0, s74, 25600
    s_add_u32 s62, s68, 10240
    buffer_load_dwordx4 v2, s[40:43], s62 offen lds
    s_add_u32 m0, s74, 26624
    v_mfma_f32_16x16x32_bf16 a[16:19], v[36:39], v[92:95], a[16:19]
    s_add_u32 s62, s68, 20480
    buffer_load_dwordx4 v2, s[40:43], s62 offen lds
    s_add_u32 m0, s74, 27648
    s_add_u32 s62, s68, 30720
    buffer_load_dwordx4 v2, s[40:43], s62 offen lds
    v_mfma_f32_16x16x32_bf16 a[20:23], v[36:39], v[96:99], a[20:23]
    s_add_u32 s68, s68, 40960
    v_mfma_f32_16x16x32_bf16 a[24:27], v[40:43], v[92:95], a[24:27]
    v_mfma_f32_16x16x32_bf16 a[28:31], v[40:43], v[96:99], a[28:31]
    s_waitcnt vmcnt(6) lgkmcnt(0)
    v_mfma_f32_16x16x32_bf16 a[0:3], v[60:63], v[124:127], a[0:3]
    ds_read_b64_tr_b16 v[28:29], v4 offset:16384
    ds_read_b64_tr_b16 v[30:31], v4 offset:18432
    ds_read_b64_tr_b16 v[32:33], v5 offset:16384
    ds_read_b64_tr_b16 v[34:35], v5 offset:18432
    ds_read_b64_tr_b16 v[36:37], v6 offset:16384
    v_mfma_f32_16x16x32_bf16 a[4:7], v[60:63], v[128:131], a[4:7]
    ds_read_b64_tr_b16 v[38:39], v6 offset:18432
    ds_read_b64_tr_b16 v[40:41], v7 offset:16384
    ds_read_b64_tr_b16 v[42:43], v7 offset:18432
    s_mov_b32 s63, s69
    buffer_load_dwordx4 v[188:191], v1, s[56:59], s63 offen sc1
    v_mfma_f32_16x16x32_bf16 a[8:11], v[64:67], v[124:127], a[8:11]
    s_add_u32 s63, s63, s79
    buffer_load_dwordx4 v[192:195], v1, s[56:59], s63 offen sc1
    s_add_u32 s69, s69, 1024
    s_add_u32 m0, s74, 0
    s_add_u32 s62, s68, 0
    v_mfma_f32_16x16x32_bf16 a[12:15], v[64:67], v[128:131], a[12:15]
    buffer_load_dwordx4 v2, s[40:43], s62 offen lds
    s_add_u32 m0, s74, 1024
    s_add_u32 s62, s68, 10240
    buffer_load_dwordx4 v2, s[40:43], s62 offen lds
    s_add_u32 m0, s74, 2048
    v_mfma_f32_16x16x32_bf16 a[16:19], v[68:71], v[124:127], a[16:19]
    s_add_u32 s62, s68, 20480
    buffer_load_dwordx4 v2, s[40:43], s62 offen lds
    s_add_u32 m0, s74, 3072
    s_add_u32 s62, s68, 30720
    buffer_load_dwordx4 v2, s[40:43], s62 offen lds
    v_mfma_f32_16x16x32_bf16 a[20:23], v[68:71], v[128:131], a[20:23]
    s_add_u32 s68, s68, 40960
    v_mfma_f32_16x16x32_bf16 a[24:27], v[72:75], v[124:127], a[24:27]
    v_mfma_f32_16x16x32_bf16 a[28:31], v[72:75], v[128:131], a[28:31]
    s_waitcnt vmcnt(6) lgkmcnt(0)
    v_mfma_f32_16x16x32_bf16 a[0:3], v[28:31], v[156:159], a[0:3]
    ds_read_b64_tr_b16 v[60:61], v4 offset:24576
    ds_read_b64_tr_b16 v[62:63], v4 offset:26624
    ds_read_b64_tr_b16 v[64:65], v5 offset:24576
    ds_read_b64_tr_b16 v[66:67], v5 offset:26624
    ds_read_b64_tr_b16 v[68:69], v6 offset:24576
    v_mfma_f32_16x16x32_bf16 a[4:7], v[28:31], v[160:163], a[4:7]
    ds_read_b64_tr_b16 v[70:71], v6 offset:26624
    ds_read_b64_tr_b16 v[72:73], v7 offset:24576
    ds_read_b64_tr_b16 v[74:75], v7 offset:26624
    s_mov_b32 s63, s69
    buffer_load_dwordx4 v[92:95], v1, s[56:59], s63 offen sc1
    v_mfma_f32_16x16x32_bf16 a[8:11], v[32:35], v[156:159], a[8:11]
    s_add_u32 s63, s63, s79
    buffer_load_dwordx4 v[96:99], v1, s[56:59], s63 offen sc1
    s_add_u32 s69, s69, 1024
    s_add_u32 m0, s74, 8192
    s_add_u32 s62, s68, 0
    v_mfma_f32_16x16x32_bf16 a[12:15], v[32:35], v[160:163], a[12:15]
    buffer_load_dwordx4 v2, s[40:43], s62 offen lds
    s_add_u32 m0, s74, 9216
    s_add_u32 s62, s68, 10240
    buffer_load_dwordx4 v2, s[40:43], s62 offen lds
    s_add_u32 m0, s74, 10240
    v_mfma_f32_16x16x32_bf16 a[16:19], v[36:39], v[156:159], a[16:19]
    s_add_u32 s62, s68, 20480
    buffer_load_dwordx4 v2, s[40:43], s62 offen lds
    s_add_u32 m0, s74, 11264
    s_add_u32 s62, s68, 30720
    buffer_load_dwordx4 v2, s[40:43], s62 offen lds
    v_mfma_f32_16x16x32_bf16 a[20:23], v[36:39], v[160:163], a[20:23]
    s_add_u32 s68, s68, 40960
    v_mfma_f32_16x16x32_bf16 a[24:27], v[40:43], v[156:159], a[24:27]
    v_mfma_f32_16x16x32_bf16 a[28:31], v[40:43], v[160:163], a[28:31]
    s_waitcnt vmcnt(6) lgkmcnt(0)
    v_mfma_f32_16x16x32_bf16 a[0:3], v[60:63], v[188:191], a[0:3]
    ds_read_b64_tr_b16 v[28:29], v4
    ds_read_b64_tr_b16 v[30:31], v4 offset:2048
    ds_read_b64_tr_b16 v[32:33], v5
    ds_read_b64_tr_b16 v[34:35], v5 offset:2048
    ds_read_b64_tr_b16 v[36:37], v6
    v_mfma_f32_16x16x32_bf16 a[4:7], v[60:63], v[192:195], a[4:7]
    ds_read_b64_tr_b16 v[38:39], v6 offset:2048
    ds_read_b64_tr_b16 v[40:41], v7
    ds_read_b64_tr_b16 v[42:43], v7 offset:2048
    s_mov_b32 s63, s69
    buffer_load_dwordx4 v[124:127], v1, s[56:59], s63 offen sc1
    v_mfma_f32_16x16x32_bf16 a[8:11], v[64:67], v[188:191], a[8:11]
    s_add_u32 s63, s63, s79
    buffer_load_dwordx4 v[128:131], v1, s[56:59], s63 offen sc1
    s_add_u32 s69, s69, 1024
    s_add_u32 m0, s74, 16384
    s_add_u32 s62, s68, 0
    v_mfma_f32_16x16x32_bf16 a[12:15], v[64:67], v[192:195], a[12:15]
    buffer_load_dwordx4 v2, s[40:43], s62 offen lds
    s_add_u32 m0, s74, 17408
    s_add_u32 s62, s68, 10240
    buffer_load_dwordx4 v2, s[40:43], s62 offen lds
    s_add_u32 m0, s74, 18432
    v_mfma_f32_16x16x32_bf16 a[16:19], v[68:71], v[188:191], a[16:19]
    s_add_u32 s62, s68, 20480
    buffer_load_dwordx4 v2, s[40:43], s62 offen lds
    s_add_u32 m0, s74, 19456
    s_add_u32 s62, s68, 30720
    buffer_load_dwordx4 v2, s[40:43], s62 offen lds
    v_mfma_f32_16x16x32_bf16 a[20:23], v[68:71], v[192:195], a[20:23]
    s_add_u32 s68, s68, 40960
    v_mfma_f32_16x16x32_bf16 a[24:27], v[72:75], v[188:191], a[24:27]
    v_mfma_f32_16x16x32_bf16 a[28:31], v[72:75], v[192:195], a[28:31]
    s_add_u32 s70, s70, 4
    s_cmp_lt_u32 s70, s64
    s_cbranch_scc1 L_g2_loop
    s_waitcnt vmcnt(0) lgkmcnt(0)
    s_nop 7
    s_nop 7
    v_accvgpr_read_b32 v14, a0
    v_accvgpr_write_b32 a32, v14
    v_accvgpr_read_b32 v14, a1
    v_accvgpr_write_b32 a33, v14
    v_accvgpr_read_b32 v14, a2
    v_accvgpr_write_b32 a34, v14
    v_accvgpr_read_b32 v14, a3
    v_accvgpr_write_b32 a35, v14
    v_accvgpr_read_b32 v14, a4
    v_accvgpr_write_b32 a36, v14
    v_accvgpr_read_b32 v14, a5
    v_accvgpr_write_b32 a37, v14
    v_accvgpr_read_b32 v14, a6
    v_accvgpr_write_b32 a38, v14
    v_accvgpr_read_b32 v14, a7
    v_accvgpr_write_b32 a39, v14
    v_accvgpr_read_b32 v14, a8
    v_accvgpr_write_b32 a40, v14
    v_accvgpr_read_b32 v14, a9
    v_accvgpr_write_b32 a41, v14
    v_accvgpr_read_b32 v14, a10
    v_accvgpr_write_b32 a42, v14
    v_accvgpr_read_b32 v14, a11
    v_accvgpr_write_b32 a43, v14
    v_accvgpr_read_b32 v14, a12
    v_accvgpr_write_b32 a44, v14
    v_accvgpr_read_b32 v14, a13
    v_accvgpr_write_b32 a45, v14
    v_accvgpr_read_b32 v14, a14
    v_accvgpr_write_b32 a46, v14
    v_accvgpr_read_b32 v14, a15
    v_accvgpr_write_b32 a47, v14
    v_accvgpr_read_b32 v14, a16
    v_accvgpr_write_b32 a48, v14
    v_accvgpr_read_b32 v14, a17
    v_accvgpr_write_b32 a49, v14
    v_accvgpr_read_b32 v14, a18
    v_accvgpr_write_b32 a50, v14
    v_accvgpr_read_b32 v14, a19
    v_accvgpr_write_b32 a51, v14
    v_accvgpr_read_b32 v14, a20
    v_accvgpr_write_b32 a52, v14
    v_accvgpr_read_b32 v14, a21
    v_accvgpr_write_b32 a53, v14
    v_accvgpr_read_b32 v14, a22
    v_accvgpr_write_b32 a54, v14
    v_accvgpr_read_b32 v14, a23
    v_accvgpr_write_b32 a55, v14
    v_accvgpr_read_b32 v14, a24
    v_accvgpr_write_b32 a56, v14
    v_accvgpr_read_b32 v14, a25
    v_accvgpr_write_b32 a57, v14
    v_accvgpr_read_b32 v14, a26
    v_accvgpr_write_b32 a58, v14
    v_accvgpr_read_b32 v14, a27
    v_accvgpr_write_b32 a59, v14
    v_accvgpr_read_b32 v14, a28
    v_accvgpr_write_b32 a60, v14
    v_accvgpr_read_b32 v14, a29
    v_accvgpr_write_b32 a61, v14
    v_accvgpr_read_b32 v14, a30
    v_accvgpr_write_b32 a62, v14
    v_accvgpr_read_b32 v14, a31
    v_accvgpr_write_b32 a63, v14
    s_lshl_b32 s62, s76, 7
    s_add_u32 s65, s62, 94375936
    s_mul_i32 s68, s61, 1310720
    s_lshl_b32 s62, s77, 7
    s_add_u32 s68, s68, s62
    s_lshl_b32 s69, s76, 18
    s_lshl_b32 s62, s61, 15
    s_add_u32 s69, s69, s62
    s_add_u32 s69, s69, 62914560
    s_mov_b32 s79, 131072
    s_mov_b32 s64, 32
    v_accvgpr_write_b32 a0, 0
    v_accvgpr_write_b32 a1, 0
    v_accvgpr_write_b32 a2, 0
    v_accvgpr_write_b32 a3, 0
    v_accvgpr_write_b32 a4, 0
    v_accvgpr_write_b32 a5, 0
    v_accvgpr_write_b32 a6, 0
    v_accvgpr_write_b32 a7, 0
    v_accvgpr_write_b32 a8, 0
    v_accvgpr_write_b32 a9, 0
    v_accvgpr_write_b32 a10, 0
    v_accvgpr_write_b32 a11, 0
    v_accvgpr_write_b32 a12, 0
    v_accvgpr_write_b32 a13, 0
    v_accvgpr_write_b32 a14, 0
    v_accvgpr_write_b32 a15, 0
    v_accvgpr_write_b32 a16, 0
    v_accvgpr_write_b32 a17, 0
    v_accvgpr_write_b32 a18, 0
    v_accvgpr_write_b32 a19, 0
    v_accvgpr_write_b32 a20, 0
    v_accvgpr_write_b32 a21, 0
    v_accvgpr_write_b32 a22, 0
    v_accvgpr_write_b32 a23, 0
    v_accvgpr_write_b32 a24, 0
    v_accvgpr_write_b32 a25, 0
    v_accvgpr_write_b32 a26, 0
    v_accvgpr_write_b32 a27, 0
    v_accvgpr_write_b32 a28, 0
    v_accvgpr_write_b32 a29, 0
    v_accvgpr_write_b32 a30, 0
    v_accvgpr_write_b32 a31, 0
    s_add_u32 m0, s74, 0
    s_add_u32 s62, s68, 0
    buffer_load_dwordx4 v2, s[28:31], s62 offen lds
    s_add_u32 m0, s74, 1024
    s_add_u32 s62, s68, 10240
    buffer_load_dwordx4 v2, s[28:31], s62 offen lds
    s_add_u32 m0, s74, 2048
    s_add_u32 s62, s68, 20480
    buffer_load_dwordx4 v2, s[28:31], s62 offen lds
    s_add_u32 m0, s74, 3072
    s_add_u32 s62, s68, 30720
    buffer_load_dwordx4 v2, s[28:31], s62 offen lds
    s_add_u32 m0, s74, 4096
    s_add_u32 s62, s68, 40960
    buffer_load_dwordx4 v2, s[28:31], s62 offen lds
    s_add_u32 m0, s74, 5120
    s_add_u32 s62, s68, 51200
    buffer_load_dwordx4 v2, s[28:31], s62 offen lds
    s_add_u32 m0, s74, 6144
    s_add_u32 s62, s68, 61440
    buffer_load_dwordx4 v2, s[28:31], s62 offen lds
    s_add_u32 m0, s74, 7168
    s_add_u32 s62, s68, 71680
    buffer_load_dwordx4 v2, s[28:31], s62 offen lds
    s_add_u32 m0, s74, 8192
    s_add_u32 s62, s68, 81920
    buffer_load_dwordx4 v2, s[28:31], s62 offen lds
    s_add_u32 m0, s74, 9216
    s_add_u32 s62, s68, 92160
    buffer_load_dwordx4 v2, s[28:31], s62 offen lds
    s_add_u32 m0, s74, 10240
    s_add_u32 s62, s68, 102400
    buffer_load_dwordx4 v2, s[28:31], s62 offen lds
    s_add_u32 m0, s74, 11264
    s_add_u32 s62, s68, 112640
    buffer_load_dwordx4 v2, s[28:31], s62 offen lds
    s_add_u32 m0, s74, 12288
    s_add_u32 s62, s68, 122880
    buffer_load_dwordx4 v2, s[28:31], s62 offen lds
    s_add_u32 m0, s74, 13312
    s_add_u32 s62, s68, 133120
    buffer_load_dwordx4 v2, s[28:31], s62 offen lds
    s_add_u32 m0, s74, 14336
    s_add_u32 s62, s68, 143360
    buffer_load_dwordx4 v2, s[28:31], s62 offen lds
    s_add_u32 m0, s74, 15360
    s_add_u32 s62, s68, 153600
    buffer_load_dwordx4 v2, s[28:31], s62 offen lds
    s_add_u32 m0, s74, 16384
    s_add_u32 s62, s68, 163840
    buffer_load_dwordx4 v2, s[28:31], s62 offen lds
    s_add_u32 m0, s74, 17408
    s_add_u32 s62, s68, 174080
    buffer_load_dwordx4 v2, s[28:31], s62 offen lds
    s_add_u32 m0, s74, 18432
    s_add_u32 s62, s68, 184320
    buffer_load_dwordx4 v2, s[28:31], s62 offen lds
    s_add_u32 m0, s74, 19456
    s_add_u32 s62, s68, 194560
    buffer_load_dwordx4 v2, s[28:31], s62 offen lds
    s_add_u32 m0, s74, 20480
    s_add_u32 s62, s68, 204800
    buffer_load_dwordx4 v2, s[28:31], s62 offen lds
    s_add_u32 m0, s74, 21504
    s_add_u32 s62, s68, 215040
    buffer_load_dwordx4 v2, s[28:31], s62 offen lds
    s_add_u32 m0, s74, 22528
    s_add_u32 s62, s68, 225280
    buffer_load_dwordx4 v2, s[28:31], s62 offen lds
    s_add_u32 m0, s74, 23552
    s_add_u32 s62, s68, 235520
    buffer_load_dwordx4 v2, s[28:31], s62 offen lds
    s_add_u32 m0, s74, 24576
    s_add_u32 s62, s68, 245760
    buffer_load_dwordx4 v2, s[28:31], s62 offen lds
    s_add_u32 m0, s74, 25600
    s_add_u32 s62, s68, 256000
    buffer_load_dwordx4 v2, s[28:31], s62 offen lds
    s_add_u32 m0, s74, 26624
    s_add_u32 s62, s68, 266240
    buffer_load_dwordx4 v2, s[28:31], s62 offen lds
    s_add_u32 m0, s74, 27648
    s_add_u32 s62, s68, 276480
    buffer_load_dwordx4 v2, s[28:31], s62 offen lds
    s_waitcnt vmcnt(0)
    s_cmp_lg_u32 s61, 0
    s_cbranch_scc1 L_wf16d
    v_mov_b32 v13, 0
L_wf16:
    buffer_load_dword v12, v13, s[56:59], s65 offen sc1
    s_waitcnt vmcnt(0)
    v_lshrrev_b32 v12, 0, v12
    v_and_b32 v12, 15, v12
    v_cmp_le_u32 vcc, 8, v12
    s_cbranch_vccnz L_wf16d
    s_sleep 4
    s_branch L_wf16
L_wf16d:
    s_barrier
    s_add_u32 s63, s69, 0
    buffer_load_dwordx4 v[92:95], v1, s[56:59], s63 offen sc1
    s_add_u32 s63, s69, 131072
    buffer_load_dwordx4 v[96:99], v1, s[56:59], s63 offen sc1
    s_add_u32 s63, s69, 1024
    buffer_load_dwordx4 v[100:103], v1, s[56:59], s63 offen sc1
    s_add_u32 s63, s69, 132096
    buffer_load_dwordx4 v[104:107], v1, s[56:59], s63 offen sc1
    s_add_u32 s63, s69, 2048
    buffer_load_dwordx4 v[108:111], v1, s[56:59], s63 offen sc1
    s_add_u32 s63, s69, 133120
    buffer_load_dwordx4 v[112:115], v1, s[56:59], s63 offen sc1
    s_add_u32 s63, s69, 3072
    buffer_load_dwordx4 v[116:119], v1, s[56:59], s63 offen sc1
    s_add_u32 s63, s69, 134144
    buffer_load_dwordx4 v[120:123], v1, s[56:59], s63 offen sc1
    s_add_u32 s63, s69, 4096
    buffer_load_dwordx4 v[124:127], v1, s[56:59], s63 offen sc1
    s_add_u32 s63, s69, 135168
    buffer_load_dwordx4 v[128:131], v1, s[56:59], s63 offen sc1
    s_add_u32 s63, s69, 5120
    buffer_load_dwordx4 v[132:135], v1, s[56:59], s63 offen sc1
    s_add_u32 s63, s69, 136192
    buffer_load_dwordx4 v[136:139], v1, s[56:59], s63 offen sc1
    s_add_u32 s63, s69, 6144
    buffer_load_dwordx4 v[140:143], v1, s[56:59], s63 offen sc1
    s_add_u32 s63, s69, 137216
    buffer_load_dwordx4 v[144:147], v1, s[56:59], s63 offen sc1
    s_add_u32 s63, s69, 7168
    buffer_load_dwordx4 v[148:151], v1, s[56:59], s63 offen sc1
    s_add_u32 s63, s69, 138240
    buffer_load_dwordx4 v[152:155], v1, s[56:59], s63 offen sc1
    s_add_u32 s63, s69, 8192
    buffer_load_dwordx4 v[156:159], v1, s[56:59], s63 offen sc1
    s_add_u32 s63, s69, 139264
    buffer_load_dwordx4 v[160:163], v1, s[56:59], s63 offen sc1
    s_add_u32 s63, s69, 9216
    buffer_load_dwordx4 v[164:167], v1, s[56:59], s63 offen sc1
    s_add_u32 s63, s69, 140288
    buffer_load_dwordx4 v[168:171], v1, s[56:59], s63 offen sc1
    s_add_u32 s63, s69, 10240
    buffer_load_dwordx4 v[172:175], v1, s[56:59], s63 offen sc1
    s_add_u32 s63, s69, 141312
    buffer_load_dwordx4 v[176:179], v1, s[56:59], s63 offen sc1
    s_add_u32 s63, s69, 11264
    buffer_load_dwordx4 v[180:183], v1, s[56:59], s63 offen sc1
    s_add_u32 s63, s69, 142336
    buffer_load_dwordx4 v[184:187], v1, s[56:59], s63 offen sc1
    ds_read_b64_tr_b16 v[28:29], v4
    ds_read_b64_tr_b16 v[30:31], v4 offset:2048
    ds_read_b64_tr_b16 v[32:33], v5
    ds_read_b64_tr_b16 v[34:35], v5 offset:2048
    ds_read_b64_tr_b16 v[36:37], v6
    ds_read_b64_tr_b16 v[38:39], v6 offset:2048
    ds_read_b64_tr_b16 v[40:41], v7
    ds_read_b64_tr_b16 v[42:43], v7 offset:2048
    ds_read_b64_tr_b16 v[60:61], v4 offset:4096
    ds_read_b64_tr_b16 v[62:63], v4 offset:6144
    ds_read_b64_tr_b16 v[64:65], v5 offset:4096
    ds_read_b64_tr_b16 v[66:67], v5 offset:6144
    ds_read_b64_tr_b16 v[68:69], v6 offset:4096
    ds_read_b64_tr_b16 v[70:71], v6 offset:6144
    ds_read_b64_tr_b16 v[72:73], v7 offset:4096
    ds_read_b64_tr_b16 v[74:75], v7 offset:6144
    s_waitcnt vmcnt(23) lgkmcnt(14)
    v_mfma_f32_16x16x32_bf16 a[0:3], v[28:31], v[92:95], a[0:3]
    s_waitcnt vmcnt(22)
    v_mfma_f32_16x16x32_bf16 a[4:7], v[28:31], v[96:99], a[4:7]
    s_waitcnt lgkmcnt(12)
    v_mfma_f32_16x16x32_bf16 a[8:11], v[32:35], v[92:95], a[8:11]
    v_mfma_f32_16x16x32_bf16 a[12:15], v[32:35], v[96:99], a[12:15]
    s_waitcnt lgkmcnt(10)
    v_mfma_f32_16x16x32_bf16 a[16:19], v[36:39], v[92:95], a[16:19]
    v_mfma_f32_16x16x32_bf16 a[20:23], v[36:39], v[96:99], a[20:23]
    s_waitcnt lgkmcnt(8)
    v_mfma_f32_16x16x32_bf16 a[24:27], v[40:43], v[92:95], a[24:27]
    v_mfma_f32_16x16x32_bf16 a[28:31], v[40:43], v[96:99], a[28:31]
    s_add_u32 s63, s69, 12288
    buffer_load_dwordx4 v[188:191], v1, s[56:59], s63 offen sc1
    s_add_u32 s63, s69, 143360
    buffer_load_dwordx4 v[192:195], v1, s[56:59], s63 offen sc1
    s_add_u32 m0, s74, 28672
    s_add_u32 s62, s68, 286720
    buffer_load_dwordx4 v2, s[28:31], s62 offen lds
    s_add_u32 m0, s74, 29696
    s_add_u32 s62, s68, 296960
    buffer_load_dwordx4 v2, s[28:31], s62 offen lds
    s_add_u32 m0, s74, 30720
    s_add_u32 s62, s68, 307200
    buffer_load_dwordx4 v2, s[28:31], s62 offen lds
    s_add_u32 m0, s74, 31744
    s_add_u32 s62, s68, 317440
    buffer_load_dwordx4 v2, s[28:31], s62 offen lds
    ds_read_b64_tr_b16 v[28:29], v4 offset:8192
    ds_read_b64_tr_b16 v[30:31], v4 offset:10240
    ds_read_b64_tr_b16 v[32:33], v5 offset:8192
    ds_read_b64_tr_b16 v[34:35], v5 offset:10240
    ds_read_b64_tr_b16 v[36:37], v6 offset:8192
    ds_read_b64_tr_b16 v[38:39], v6 offset:10240
    ds_read_b64_tr_b16 v[40:41], v7 offset:8192
    ds_read_b64_tr_b16 v[42:43], v7 offset:10240
    s_waitcnt vmcnt(27) lgkmcnt(14)
    v_mfma_f32_16x16x32_bf16 a[0:3], v[60:63], v[100:103], a[0:3]
    s_waitcnt vmcnt(26)
    v_mfma_f32_16x16x32_bf16 a[4:7], v[60:63], v[104:107], a[4:7]
    s_waitcnt lgkmcnt(12)
    v_mfma_f32_16x16x32_bf16 a[8:11], v[64:67], v[100:103], a[8:11]
    v_mfma_f32_16x16x32_bf16 a[12:15], v[64:67], v[104:107], a[12:15]
    s_waitcnt lgkmcnt(10)
    v_mfma_f32_16x16x32_bf16 a[16:19], v[68:71], v[100:103], a[16:19]
    v_mfma_f32_16x16x32_bf16 a[20:23], v[68:71], v[104:107], a[20:23]
    s_waitcnt lgkmcnt(8)
    v_mfma_f32_16x16x32_bf16 a[24:27], v[72:75], v[100:103], a[24:27]
    v_mfma_f32_16x16x32_bf16 a[28:31], v[72:75], v[104:107], a[28:31]
    s_add_u32 s63, s69, 13312
    buffer_load_dwordx4 v[196:199], v1, s[56:59], s63 offen sc1
    s_add_u32 s63, s69, 144384
    buffer_load_dwordx4 v[200:203], v1, s[56:59], s63 offen sc1
    s_add_u32 m0, s74, 0
    s_add_u32 s62, s68, 327680
    buffer_load_dwordx4 v2, s[28:31], s62 offen lds
    s_add_u32 m0, s74, 1024
    s_add_u32 s62, s68, 337920
    buffer_load_dwordx4 v2, s[28:31], s62 offen lds
    s_add_u32 m0, s74, 2048
    s_add_u32 s62, s68, 348160
    buffer_load_dwordx4 v2, s[28:31], s62 offen lds
    s_add_u32 m0, s74, 3072
    s_add_u32 s62, s68, 358400
    buffer_load_dwordx4 v2, s[28:31], s62 offen lds
    ds_read_b64_tr_b16 v[60:61], v4 offset:12288
    ds_read_b64_tr_b16 v[62:63], v4 offset:14336
    ds_read_b64_tr_b16 v[64:65], v5 offset:12288
    ds_read_b64_tr_b16 v[66:67], v5 offset:14336
    ds_read_b64_tr_b16 v[68:69], v6 offset:12288
    ds_read_b64_tr_b16 v[70:71], v6 offset:14336
    ds_read_b64_tr_b16 v[72:73], v7 offset:12288
    ds_read_b64_tr_b16 v[74:75], v7 offset:14336
    s_waitcnt vmcnt(31) lgkmcnt(14)
    v_mfma_f32_16x16x32_bf16 a[0:3], v[28:31], v[108:111], a[0:3]
    s_waitcnt vmcnt(30)
    v_mfma_f32_16x16x32_bf16 a[4:7], v[28:31], v[112:115], a[4:7]
    s_waitcnt lgkmcnt(12)
    v_mfma_f32_16x16x32_bf16 a[8:11], v[32:35], v[108:111], a[8:11]
    v_mfma_f32_16x16x32_bf16 a[12:15], v[32:35], v[112:115], a[12:15]
    s_waitcnt lgkmcnt(10)
    v_mfma_f32_16x16x32_bf16 a[16:19], v[36:39], v[108:111], a[16:19]
    v_mfma_f32_16x16x32_bf16 a[20:23], v[36:39], v[112:115], a[20:23]
    s_waitcnt lgkmcnt(8)
    v_mfma_f32_16x16x32_bf16 a[24:27], v[40:43], v[108:111], a[24:27]
    v_mfma_f32_16x16x32_bf16 a[28:31], v[40:43], v[112:115], a[28:31]
    s_add_u32 s63, s69, 14336
    buffer_load_dwordx4 v[204:207], v1, s[56:59], s63 offen sc1
    s_add_u32 s63, s69, 145408
    buffer_load_dwordx4 v[208:211], v1, s[56:59], s63 offen sc1
    s_add_u32 m0, s74, 4096
    s_add_u32 s62, s68, 368640
    buffer_load_dwordx4 v2, s[28:31], s62 offen lds
    s_add_u32 m0, s74, 5120
    s_add_u32 s62, s68, 378880
    buffer_load_dwordx4 v2, s[28:31], s62 offen lds
    s_add_u32 m0, s74, 6144
    s_add_u32 s62, s68, 389120
    buffer_load_dwordx4 v2, s[28:31], s62 offen lds
    s_add_u32 m0, s74, 7168
    s_add_u32 s62, s68, 399360
    buffer_load_dwordx4 v2, s[28:31], s62 offen lds
    ds_read_b64_tr_b16 v[28:29], v4 offset:16384
    ds_read_b64_tr_b16 v[30:31], v4 offset:18432
    ds_read_b64_tr_b16 v[32:33], v5 offset:16384
    ds_read_b64_tr_b16 v[34:35], v5 offset:18432
    ds_read_b64_tr_b16 v[36:37], v6 offset:16384
    ds_read_b64_tr_b16 v[38:39], v6 offset:18432
    ds_read_b64_tr_b16 v[40:41], v7 offset:16384
    ds_read_b64_tr_b16 v[42:43], v7 offset:18432
    s_waitcnt vmcnt(35) lgkmcnt(14)
    v_mfma_f32_16x16x32_bf16 a[0:3], v[60:63], v[116:119], a[0:3]
    s_waitcnt vmcnt(34)
    v_mfma_f32_16x16x32_bf16 a[4:7], v[60:63], v[120:123], a[4:7]
    s_waitcnt lgkmcnt(12)
    v_mfma_f32_16x16x32_bf16 a[8:11], v[64:67], v[116:119], a[8:11]
    v_mfma_f32_16x16x32_bf16 a[12:15], v[64:67], v[120:123], a[12:15]
    s_waitcnt lgkmcnt(10)
    v_mfma_f32_16x16x32_bf16 a[16:19], v[68:71], v[116:119], a[16:19]
    v_mfma_f32_16x16x32_bf16 a[20:23], v[68:71], v[120:123], a[20:23]
    s_waitcnt lgkmcnt(8)
    v_mfma_f32_16x16x32_bf16 a[24:27], v[72:75], v[116:119], a[24:27]
    v_mfma_f32_16x16x32_bf16 a[28:31], v[72:75], v[120:123], a[28:31]
    s_add_u32 s63, s69, 15360
    buffer_load_dwordx4 v[212:215], v1, s[56:59], s63 offen sc1
    s_add_u32 s63, s69, 146432
    buffer_load_dwordx4 v[216:219], v1, s[56:59], s63 offen sc1
    s_add_u32 m0, s74, 8192
    s_add_u32 s62, s68, 409600
    buffer_load_dwordx4 v2, s[28:31], s62 offen lds
    s_add_u32 m0, s74, 9216
    s_add_u32 s62, s68, 419840
    buffer_load_dwordx4 v2, s[28:31], s62 offen lds
    s_add_u32 m0, s74, 10240
    s_add_u32 s62, s68, 430080
    buffer_load_dwordx4 v2, s[28:31], s62 offen lds
    s_add_u32 m0, s74, 11264
    s_add_u32 s62, s68, 440320
    buffer_load_dwordx4 v2, s[28:31], s62 offen lds
    ds_read_b64_tr_b16 v[60:61], v4 offset:20480
    ds_read_b64_tr_b16 v[62:63], v4 offset:22528
    ds_read_b64_tr_b16 v[64:65], v5 offset:20480
    ds_read_b64_tr_b16 v[66:67], v5 offset:22528
    ds_read_b64_tr_b16 v[68:69], v6 offset:20480
    ds_read_b64_tr_b16 v[70:71], v6 offset:22528
    ds_read_b64_tr_b16 v[72:73], v7 offset:20480
    ds_read_b64_tr_b16 v[74:75], v7 offset:22528
    s_waitcnt vmcnt(39) lgkmcnt(14)
    v_mfma_f32_16x16x32_bf16 a[0:3], v[28:31], v[124:127], a[0:3]
    s_waitcnt vmcnt(38)
    v_mfma_f32_16x16x32_bf16 a[4:7], v[28:31], v[128:131], a[4:7]
    s_waitcnt lgkmcnt(12)
    v_mfma_f32_16x16x32_bf16 a[8:11], v[32:35], v[124:127], a[8:11]
    v_mfma_f32_16x16x32_bf16 a[12:15], v[32:35], v[128:131], a[12:15]
    s_waitcnt lgkmcnt(10)
    v_mfma_f32_16x16x32_bf16 a[16:19], v[36:39], v[124:127], a[16:19]
    v_mfma_f32_16x16x32_bf16 a[20:23], v[36:39], v[128:131], a[20:23]
    s_waitcnt lgkmcnt(8)
    v_mfma_f32_16x16x32_bf16 a[24:27], v[40:43], v[124:127], a[24:27]
    v_mfma_f32_16x16x32_bf16 a[28:31], v[40:43], v[128:131], a[28:31]
    s_add_u32 s63, s69, 16384
    buffer_load_dwordx4 v[92:95], v1, s[56:59], s63 offen sc1
    s_add_u32 s63, s69, 147456
    buffer_load_dwordx4 v[96:99], v1, s[56:59], s63 offen sc1
    s_add_u32 m0, s74, 12288
    s_add_u32 s62, s68, 450560
    buffer_load_dwordx4 v2, s[28:31], s62 offen lds
    s_add_u32 m0, s74, 13312
    s_add_u32 s62, s68, 460800
    buffer_load_dwordx4 v2, s[28:31], s62 offen lds
    s_add_u32 m0, s74, 14336
    s_add_u32 s62, s68, 471040
    buffer_load_dwordx4 v2, s[28:31], s62 offen lds
    s_add_u32 m0, s74, 15360
    s_add_u32 s62, s68, 481280
    buffer_load_dwordx4 v2, s[28:31], s62 offen lds
    ds_read_b64_tr_b16 v[28:29], v4 offset:24576
    ds_read_b64_tr_b16 v[30:31], v4 offset:26624
    ds_read_b64_tr_b16 v[32:33], v5 offset:24576
    ds_read_b64_tr_b16 v[34:35], v5 offset:26624
    ds_read_b64_tr_b16 v[36:37], v6 offset:24576
    ds_read_b64_tr_b16 v[38:39], v6 offset:26624
    ds_read_b64_tr_b16 v[40:41], v7 offset:24576
    ds_read_b64_tr_b16 v[42:43], v7 offset:26624
    s_waitcnt vmcnt(43) lgkmcnt(14)
    v_mfma_f32_16x16x32_bf16 a[0:3], v[60:63], v[132:135], a[0:3]
    s_waitcnt vmcnt(42)
    v_mfma_f32_16x16x32_bf16 a[4:7], v[60:63], v[136:139], a[4:7]
    s_waitcnt lgkmcnt(12)
    v_mfma_f32_16x16x32_bf16 a[8:11], v[64:67], v[132:135], a[8:11]
    v_mfma_f32_16x16x32_bf16 a[12:15], v[64:67], v[136:139], a[12:15]
    s_waitcnt lgkmcnt(10)
    v_mfma_f32_16x16x32_bf16 a[16:19], v[68:71], v[132:135], a[16:19]
    v_mfma_f32_16x16x32_bf16 a[20:23], v[68:71], v[136:139], a[20:23]
    s_waitcnt lgkmcnt(8)
    v_mfma_f32_16x16x32_bf16 a[24:27], v[72:75], v[132:135], a[24:27]
    v_mfma_f32_16x16x32_bf16 a[28:31], v[72:75], v[136:139], a[28:31]
    s_add_u32 s63, s69, 17408
    buffer_load_dwordx4 v[100:103], v1, s[56:59], s63 offen sc1
    s_add_u32 s63, s69, 148480
    buffer_load_dwordx4 v[104:107], v1, s[56:59], s63 offen sc1
    s_add_u32 m0, s74, 16384
    s_add_u32 s62, s68, 491520
    buffer_load_dwordx4 v2, s[28:31], s62 offen lds
    s_add_u32 m0, s74, 17408
    s_add_u32 s62, s68, 501760
    buffer_load_dwordx4 v2, s[28:31], s62 offen lds
    s_add_u32 m0, s74, 18432
    s_add_u32 s62, s68, 512000
    buffer_load_dwordx4 v2, s[28:31], s62 offen lds
    s_add_u32 m0, s74, 19456
    s_add_u32 s62, s68, 522240
    buffer_load_dwordx4 v2, s[28:31], s62 offen lds
    s_waitcnt vmcnt(30)
    ds_read_b64_tr_b16 v[60:61], v4 offset:28672
    ds_read_b64_tr_b16 v[62:63], v4 offset:30720
    ds_read_b64_tr_b16 v[64:65], v5 offset:28672
    ds_read_b64_tr_b16 v[66:67], v5 offset:30720
    ds_read_b64_tr_b16 v[68:69], v6 offset:28672
    ds_read_b64_tr_b16 v[70:71], v6 offset:30720
    ds_read_b64_tr_b16 v[72:73], v7 offset:28672
    ds_read_b64_tr_b16 v[74:75], v7 offset:30720
    s_waitcnt lgkmcnt(14)
    v_mfma_f32_16x16x32_bf16 a[0:3], v[28:31], v[140:143], a[0:3]
    v_mfma_f32_16x16x32_bf16 a[4:7], v[28:31], v[144:147], a[4:7]
    s_waitcnt lgkmcnt(12)
    v_mfma_f32_16x16x32_bf16 a[8:11], v[32:35], v[140:143], a[8:11]
    v_mfma_f32_16x16x32_bf16 a[12:15], v[32:35], v[144:147], a[12:15]
    s_waitcnt lgkmcnt(10)
    v_mfma_f32_16x16x32_bf16 a[16:19], v[36:39], v[140:143], a[16:19]
    v_mfma_f32_16x16x32_bf16 a[20:23], v[36:39], v[144:147], a[20:23]
    s_waitcnt lgkmcnt(8)
    v_mfma_f32_16x16x32_bf16 a[24:27], v[40:43], v[140:143], a[24:27]
    v_mfma_f32_16x16x32_bf16 a[28:31], v[40:43], v[144:147], a[28:31]
    s_add_u32 s63, s69, 18432
    buffer_load_dwordx4 v[108:111], v1, s[56:59], s63 offen sc1
    s_add_u32 s63, s69, 149504
    buffer_load_dwordx4 v[112:115], v1, s[56:59], s63 offen sc1
    s_add_u32 m0, s74, 20480
    s_add_u32 s62, s68, 532480
    buffer_load_dwordx4 v2, s[28:31], s62 offen lds
    s_add_u32 m0, s74, 21504
    s_add_u32 s62, s68, 542720
    buffer_load_dwordx4 v2, s[28:31], s62 offen lds
    s_add_u32 m0, s74, 22528
    s_add_u32 s62, s68, 552960
    buffer_load_dwordx4 v2, s[28:31], s62 offen lds
    s_add_u32 m0, s74, 23552
    s_add_u32 s62, s68, 563200
    buffer_load_dwordx4 v2, s[28:31], s62 offen lds
    s_waitcnt vmcnt(30)
    ds_read_b64_tr_b16 v[28:29], v4
    ds_read_b64_tr_b16 v[30:31], v4 offset:2048
    ds_read_b64_tr_b16 v[32:33], v5
    ds_read_b64_tr_b16 v[34:35], v5 offset:2048
    ds_read_b64_tr_b16 v[36:37], v6
    ds_read_b64_tr_b16 v[38:39], v6 offset:2048
    ds_read_b64_tr_b16 v[40:41], v7
    ds_read_b64_tr_b16 v[42:43], v7 offset:2048
    s_waitcnt lgkmcnt(14)
    v_mfma_f32_16x16x32_bf16 a[0:3], v[60:63], v[148:151], a[0:3]
    v_mfma_f32_16x16x32_bf16 a[4:7], v[60:63], v[152:155], a[4:7]
    s_waitcnt lgkmcnt(12)
    v_mfma_f32_16x16x32_bf16 a[8:11], v[64:67], v[148:151], a[8:11]
    v_mfma_f32_16x16x32_bf16 a[12:15], v[64:67], v[152:155], a[12:15]
    s_waitcnt lgkmcnt(10)
    v_mfma_f32_16x16x32_bf16 a[16:19], v[68:71], v[148:151], a[16:19]
    v_mfma_f32_16x16x32_bf16 a[20:23], v[68:71], v[152:155], a[20:23]
    s_waitcnt lgkmcnt(8)
    v_mfma_f32_16x16x32_bf16 a[24:27], v[72:75], v[148:151], a[24:27]
    v_mfma_f32_16x16x32_bf16 a[28:31], v[72:75], v[152:155], a[28:31]
    s_add_u32 s63, s69, 19456
    buffer_load_dwordx4 v[116:119], v1, s[56:59], s63 offen sc1
    s_add_u32 s63, s69, 150528
    buffer_load_dwordx4 v[120:123], v1, s[56:59], s63 offen sc1
    s_add_u32 m0, s74, 24576
    s_add_u32 s62, s68, 573440
    buffer_load_dwordx4 v2, s[28:31], s62 offen lds
    s_add_u32 m0, s74, 25600
    s_add_u32 s62, s68, 583680
    buffer_load_dwordx4 v2, s[28:31], s62 offen lds
    s_add_u32 m0, s74, 26624
    s_add_u32 s62, s68, 593920
    buffer_load_dwordx4 v2, s[28:31], s62 offen lds
    s_add_u32 m0, s74, 27648
    s_add_u32 s62, s68, 604160
    buffer_load_dwordx4 v2, s[28:31], s62 offen lds
    s_waitcnt vmcnt(30)
    ds_read_b64_tr_b16 v[60:61], v4 offset:4096
    ds_read_b64_tr_b16 v[62:63], v4 offset:6144
    ds_read_b64_tr_b16 v[64:65], v5 offset:4096
    ds_read_b64_tr_b16 v[66:67], v5 offset:6144
    ds_read_b64_tr_b16 v[68:69], v6 offset:4096
    ds_read_b64_tr_b16 v[70:71], v6 offset:6144
    ds_read_b64_tr_b16 v[72:73], v7 offset:4096
    ds_read_b64_tr_b16 v[74:75], v7 offset:6144
    s_waitcnt lgkmcnt(14)
    v_mfma_f32_16x16x32_bf16 a[0:3], v[28:31], v[156:159], a[0:3]
    v_mfma_f32_16x16x32_bf16 a[4:7], v[28:31], v[160:163], a[4:7]
    s_waitcnt lgkmcnt(12)
    v_mfma_f32_16x16x32_bf16 a[8:11], v[32:35], v[156:159], a[8:11]
    v_mfma_f32_16x16x32_bf16 a[12:15], v[32:35], v[160:163], a[12:15]
    s_waitcnt lgkmcnt(10)
    v_mfma_f32_16x16x32_bf16 a[16:19], v[36:39], v[156:159], a[16:19]
    v_mfma_f32_16x16x32_bf16 a[20:23], v[36:39], v[160:163], a[20:23]
    s_waitcnt lgkmcnt(8)
    v_mfma_f32_16x16x32_bf16 a[24:27], v[40:43], v[156:159], a[24:27]
    v_mfma_f32_16x16x32_bf16 a[28:31], v[40:43], v[160:163], a[28:31]
    s_add_u32 s63, s69, 20480
    buffer_load_dwordx4 v[124:127], v1, s[56:59], s63 offen sc1
    s_add_u32 s63, s69, 151552
    buffer_load_dwordx4 v[128:131], v1, s[56:59], s63 offen sc1
    s_add_u32 m0, s74, 28672
    s_add_u32 s62, s68, 614400
    buffer_load_dwordx4 v2, s[28:31], s62 offen lds
    s_add_u32 m0, s74, 29696
    s_add_u32 s62, s68, 624640
    buffer_load_dwordx4 v2, s[28:31], s62 offen lds
    s_add_u32 m0, s74, 30720
    s_add_u32 s62, s68, 634880
    buffer_load_dwordx4 v2, s[28:31], s62 offen lds
    s_add_u32 m0, s74, 31744
    s_add_u32 s62, s68, 645120
    buffer_load_dwordx4 v2, s[28:31], s62 offen lds
    s_waitcnt vmcnt(30)
    ds_read_b64_tr_b16 v[28:29], v4 offset:8192
    ds_read_b64_tr_b16 v[30:31], v4 offset:10240
    ds_read_b64_tr_b16 v[32:33], v5 offset:8192
    ds_read_b64_tr_b16 v[34:35], v5 offset:10240
    ds_read_b64_tr_b16 v[36:37], v6 offset:8192
    ds_read_b64_tr_b16 v[38:39], v6 offset:10240
    ds_read_b64_tr_b16 v[40:41], v7 offset:8192
    ds_read_b64_tr_b16 v[42:43], v7 offset:10240
    s_waitcnt lgkmcnt(14)
    v_mfma_f32_16x16x32_bf16 a[0:3], v[60:63], v[164:167], a[0:3]
    v_mfma_f32_16x16x32_bf16 a[4:7], v[60:63], v[168:171], a[4:7]
    s_waitcnt lgkmcnt(12)
    v_mfma_f32_16x16x32_bf16 a[8:11], v[64:67], v[164:167], a[8:11]
    v_mfma_f32_16x16x32_bf16 a[12:15], v[64:67], v[168:171], a[12:15]
    s_waitcnt lgkmcnt(10)
    v_mfma_f32_16x16x32_bf16 a[16:19], v[68:71], v[164:167], a[16:19]
    v_mfma_f32_16x16x32_bf16 a[20:23], v[68:71], v[168:171], a[20:23]
    s_waitcnt lgkmcnt(8)
    v_mfma_f32_16x16x32_bf16 a[24:27], v[72:75], v[164:167], a[24:27]
    v_mfma_f32_16x16x32_bf16 a[28:31], v[72:75], v[168:171], a[28:31]
    s_add_u32 s63, s69, 21504
    buffer_load_dwordx4 v[132:135], v1, s[56:59], s63 offen sc1
    s_add_u32 s63, s69, 152576
    buffer_load_dwordx4 v[136:139], v1, s[56:59], s63 offen sc1
    s_add_u32 m0, s74, 0
    s_add_u32 s62, s68, 655360
    buffer_load_dwordx4 v2, s[28:31], s62 offen lds
    s_add_u32 m0, s74, 1024
    s_add_u32 s62, s68, 665600
    buffer_load_dwordx4 v2, s[28:31], s62 offen lds
    s_add_u32 m0, s74, 2048
    s_add_u32 s62, s68, 675840
    buffer_load_dwordx4 v2, s[28:31], s62 offen lds
    s_add_u32 m0, s74, 3072
    s_add_u32 s62, s68, 686080
    buffer_load_dwordx4 v2, s[28:31], s62 offen lds
    s_waitcnt vmcnt(30)
    ds_read_b64_tr_b16 v[60:61], v4 offset:12288
    ds_read_b64_tr_b16 v[62:63], v4 offset:14336
    ds_read_b64_tr_b16 v[64:65], v5 offset:12288
    ds_read_b64_tr_b16 v[66:67], v5 offset:14336
    ds_read_b64_tr_b16 v[68:69], v6 offset:12288
    ds_read_b64_tr_b16 v[70:71], v6 offset:14336
    ds_read_b64_tr_b16 v[72:73], v7 offset:12288
    ds_read_b64_tr_b16 v[74:75], v7 offset:14336
    s_waitcnt lgkmcnt(14)
    v_mfma_f32_16x16x32_bf16 a[0:3], v[28:31], v[172:175], a[0:3]
    v_mfma_f32_16x16x32_bf16 a[4:7], v[28:31], v[176:179], a[4:7]
    s_waitcnt lgkmcnt(12)
    v_mfma_f32_16x16x32_bf16 a[8:11], v[32:35], v[172:175], a[8:11]
    v_mfma_f32_16x16x32_bf16 a[12:15], v[32:35], v[176:179], a[12:15]
    s_waitcnt lgkmcnt(10)
    v_mfma_f32_16x16x32_bf16 a[16:19], v[36:39], v[172:175], a[16:19]
    v_mfma_f32_16x16x32_bf16 a[20:23], v[36:39], v[176:179], a[20:23]
    s_waitcnt lgkmcnt(8)
    v_mfma_f32_16x16x32_bf16 a[24:27], v[40:43], v[172:175], a[24:27]
    v_mfma_f32_16x16x32_bf16 a[28:31], v[40:43], v[176:179], a[28:31]
    s_add_u32 s63, s69, 22528
    buffer_load_dwordx4 v[140:143], v1, s[56:59], s63 offen sc1
    s_add_u32 s63, s69, 153600
    buffer_load_dwordx4 v[144:147], v1, s[56:59], s63 offen sc1
    s_add_u32 m0, s74, 4096
    s_add_u32 s62, s68, 696320
    buffer_load_dwordx4 v2, s[28:31], s62 offen lds
    s_add_u32 m0, s74, 5120
    s_add_u32 s62, s68, 706560
    buffer_load_dwordx4 v2, s[28:31], s62 offen lds
    s_add_u32 m0, s74, 6144
    s_add_u32 s62, s68, 716800
    buffer_load_dwordx4 v2, s[28:31], s62 offen lds
    s_add_u32 m0, s74, 7168
    s_add_u32 s62, s68, 727040
    buffer_load_dwordx4 v2, s[28:31], s62 offen lds
    s_waitcnt vmcnt(30)
    ds_read_b64_tr_b16 v[28:29], v4 offset:16384
    ds_read_b64_tr_b16 v[30:31], v4 offset:18432
    ds_read_b64_tr_b16 v[32:33], v5 offset:16384
    ds_read_b64_tr_b16 v[34:35], v5 offset:18432
    ds_read_b64_tr_b16 v[36:37], v6 offset:16384
    ds_read_b64_tr_b16 v[38:39], v6 offset:18432
    ds_read_b64_tr_b16 v[40:41], v7 offset:16384
    ds_read_b64_tr_b16 v[42:43], v7 offset:18432
    s_waitcnt lgkmcnt(14)
    v_mfma_f32_16x16x32_bf16 a[0:3], v[60:63], v[180:183], a[0:3]
    v_mfma_f32_16x16x32_bf16 a[4:7], v[60:63], v[184:187], a[4:7]
    s_waitcnt lgkmcnt(12)
    v_mfma_f32_16x16x32_bf16 a[8:11], v[64:67], v[180:183], a[8:11]
    v_mfma_f32_16x16x32_bf16 a[12:15], v[64:67], v[184:187], a[12:15]
    s_waitcnt lgkmcnt(10)
    v_mfma_f32_16x16x32_bf16 a[16:19], v[68:71], v[180:183], a[16:19]
    v_mfma_f32_16x16x32_bf16 a[20:23], v[68:71], v[184:187], a[20:23]
    s_waitcnt lgkmcnt(8)
    v_mfma_f32_16x16x32_bf16 a[24:27], v[72:75], v[180:183], a[24:27]
    v_mfma_f32_16x16x32_bf16 a[28:31], v[72:75], v[184:187], a[28:31]
    s_add_u32 s63, s69, 23552
    buffer_load_dwordx4 v[148:151], v1, s[56:59], s63 offen sc1
    s_add_u32 s63, s69, 154624
    buffer_load_dwordx4 v[152:155], v1, s[56:59], s63 offen sc1
    s_add_u32 m0, s74, 8192
    s_add_u32 s62, s68, 737280
    buffer_load_dwordx4 v2, s[28:31], s62 offen lds
    s_add_u32 m0, s74, 9216
    s_add_u32 s62, s68, 747520
    buffer_load_dwordx4 v2, s[28:31], s62 offen lds
    s_add_u32 m0, s74, 10240
    s_add_u32 s62, s68, 757760
    buffer_load_dwordx4 v2, s[28:31], s62 offen lds
    s_add_u32 m0, s74, 11264
    s_add_u32 s62, s68, 768000
    buffer_load_dwordx4 v2, s[28:31], s62 offen lds
    s_waitcnt vmcnt(30)
    ds_read_b64_tr_b16 v[60:61], v4 offset:20480
    ds_read_b64_tr_b16 v[62:63], v4 offset:22528
    ds_read_b64_tr_b16 v[64:65], v5 offset:20480
    ds_read_b64_tr_b16 v[66:67], v5 offset:22528
    ds_read_b64_tr_b16 v[68:69], v6 offset:20480
    ds_read_b64_tr_b16 v[70:71], v6 offset:22528
    ds_read_b64_tr_b16 v[72:73], v7 offset:20480
    ds_read_b64_tr_b16 v[74:75], v7 offset:22528
    s_waitcnt lgkmcnt(14)
    v_mfma_f32_16x16x32_bf16 a[0:3], v[28:31], v[188:191], a[0:3]
    v_mfma_f32_16x16x32_bf16 a[4:7], v[28:31], v[192:195], a[4:7]
    s_waitcnt lgkmcnt(12)
    v_mfma_f32_16x16x32_bf16 a[8:11], v[32:35], v[188:191], a[8:11]
    v_mfma_f32_16x16x32_bf16 a[12:15], v[32:35], v[192:195], a[12:15]
    s_waitcnt lgkmcnt(10)
    v_mfma_f32_16x16x32_bf16 a[16:19], v[36:39], v[188:191], a[16:19]
    v_mfma_f32_16x16x32_bf16 a[20:23], v[36:39], v[192:195], a[20:23]
    s_waitcnt lgkmcnt(8)
    v_mfma_f32_16x16x32_bf16 a[24:27], v[40:43], v[188:191], a[24:27]
    v_mfma_f32_16x16x32_bf16 a[28:31], v[40:43], v[192:195], a[28:31]
    s_add_u32 s63, s69, 24576
    buffer_load_dwordx4 v[156:159], v1, s[56:59], s63 offen sc1
    s_add_u32 s63, s69, 155648
    buffer_load_dwordx4 v[160:163], v1, s[56:59], s63 offen sc1
    s_add_u32 m0, s74, 12288
    s_add_u32 s62, s68, 778240
    buffer_load_dwordx4 v2, s[28:31], s62 offen lds
    s_add_u32 m0, s74, 13312
    s_add_u32 s62, s68, 788480
    buffer_load_dwordx4 v2, s[28:31], s62 offen lds
    s_add_u32 m0, s74, 14336
    s_add_u32 s62, s68, 798720
    buffer_load_dwordx4 v2, s[28:31], s62 offen lds
    s_add_u32 m0, s74, 15360
    s_add_u32 s62, s68, 808960
    buffer_load_dwordx4 v2, s[28:31], s62 offen lds
    s_waitcnt vmcnt(30)
    ds_read_b64_tr_b16 v[28:29], v4 offset:24576
    ds_read_b64_tr_b16 v[30:31], v4 offset:26624
    ds_read_b64_tr_b16 v[32:33], v5 offset:24576
    ds_read_b64_tr_b16 v[34:35], v5 offset:26624
    ds_read_b64_tr_b16 v[36:37], v6 offset:24576
    ds_read_b64_tr_b16 v[38:39], v6 offset:26624
    ds_read_b64_tr_b16 v[40:41], v7 offset:24576
    ds_read_b64_tr_b16 v[42:43], v7 offset:26624
    s_waitcnt lgkmcnt(14)
    v_mfma_f32_16x16x32_bf16 a[0:3], v[60:63], v[196:199], a[0:3]
    v_mfma_f32_16x16x32_bf16 a[4:7], v[60:63], v[200:203], a[4:7]
    s_waitcnt lgkmcnt(12)
    v_mfma_f32_16x16x32_bf16 a[8:11], v[64:67], v[196:199], a[8:11]
    v_mfma_f32_16x16x32_bf16 a[12:15], v[64:67], v[200:203], a[12:15]
    s_waitcnt lgkmcnt(10)
    v_mfma_f32_16x16x32_bf16 a[16:19], v[68:71], v[196:199], a[16:19]
    v_mfma_f32_16x16x32_bf16 a[20:23], v[68:71], v[200:203], a[20:23]
    s_waitcnt lgkmcnt(8)
    v_mfma_f32_16x16x32_bf16 a[24:27], v[72:75], v[196:199], a[24:27]
    v_mfma_f32_16x16x32_bf16 a[28:31], v[72:75], v[200:203], a[28:31]
    s_add_u32 s63, s69, 25600
    buffer_load_dwordx4 v[164:167], v1, s[56:59], s63 offen sc1
    s_add_u32 s63, s69, 156672
    buffer_load_dwordx4 v[168:171], v1, s[56:59], s63 offen sc1
    s_add_u32 m0, s74, 16384
    s_add_u32 s62, s68, 819200
    buffer_load_dwordx4 v2, s[28:31], s62 offen lds
    s_add_u32 m0, s74, 17408
    s_add_u32 s62, s68, 829440
    buffer_load_dwordx4 v2, s[28:31], s62 offen lds
    s_add_u32 m0, s74, 18432
    s_add_u32 s62, s68, 839680
    buffer_load_dwordx4 v2, s[28:31], s62 offen lds
    s_add_u32 m0, s74, 19456
    s_add_u32 s62, s68, 849920
    buffer_load_dwordx4 v2, s[28:31], s62 offen lds
    s_waitcnt vmcnt(30)
    ds_read_b64_tr_b16 v[60:61], v4 offset:28672
    ds_read_b64_tr_b16 v[62:63], v4 offset:30720
    ds_read_b64_tr_b16 v[64:65], v5 offset:28672
    ds_read_b64_tr_b16 v[66:67], v5 offset:30720
    ds_read_b64_tr_b16 v[68:69], v6 offset:28672
    ds_read_b64_tr_b16 v[70:71], v6 offset:30720
    ds_read_b64_tr_b16 v[72:73], v7 offset:28672
    ds_read_b64_tr_b16 v[74:75], v7 offset:30720
    s_waitcnt lgkmcnt(14)
    v_mfma_f32_16x16x32_bf16 a[0:3], v[28:31], v[204:207], a[0:3]
    v_mfma_f32_16x16x32_bf16 a[4:7], v[28:31], v[208:211], a[4:7]
    s_waitcnt lgkmcnt(12)
    v_mfma_f32_16x16x32_bf16 a[8:11], v[32:35], v[204:207], a[8:11]
    v_mfma_f32_16x16x32_bf16 a[12:15], v[32:35], v[208:211], a[12:15]
    s_waitcnt lgkmcnt(10)
    v_mfma_f32_16x16x32_bf16 a[16:19], v[36:39], v[204:207], a[16:19]
    v_mfma_f32_16x16x32_bf16 a[20:23], v[36:39], v[208:211], a[20:23]
    s_waitcnt lgkmcnt(8)
    v_mfma_f32_16x16x32_bf16 a[24:27], v[40:43], v[204:207], a[24:27]
    v_mfma_f32_16x16x32_bf16 a[28:31], v[40:43], v[208:211], a[28:31]
    s_add_u32 s63, s69, 26624
    buffer_load_dwordx4 v[172:175], v1, s[56:59], s63 offen sc1
    s_add_u32 s63, s69, 157696
    buffer_load_dwordx4 v[176:179], v1, s[56:59], s63 offen sc1
    s_add_u32 m0, s74, 20480
    s_add_u32 s62, s68, 860160
    buffer_load_dwordx4 v2, s[28:31], s62 offen lds
    s_add_u32 m0, s74, 21504
    s_add_u32 s62, s68, 870400
    buffer_load_dwordx4 v2, s[28:31], s62 offen lds
    s_add_u32 m0, s74, 22528
    s_add_u32 s62, s68, 880640
    buffer_load_dwordx4 v2, s[28:31], s62 offen lds
    s_add_u32 m0, s74, 23552
    s_add_u32 s62, s68, 890880
    buffer_load_dwordx4 v2, s[28:31], s62 offen lds
    s_waitcnt vmcnt(30)
    ds_read_b64_tr_b16 v[28:29], v4
    ds_read_b64_tr_b16 v[30:31], v4 offset:2048
    ds_read_b64_tr_b16 v[32:33], v5
    ds_read_b64_tr_b16 v[34:35], v5 offset:2048
    ds_read_b64_tr_b16 v[36:37], v6
    ds_read_b64_tr_b16 v[38:39], v6 offset:2048
    ds_read_b64_tr_b16 v[40:41], v7
    ds_read_b64_tr_b16 v[42:43], v7 offset:2048
    s_waitcnt lgkmcnt(14)
    v_mfma_f32_16x16x32_bf16 a[0:3], v[60:63], v[212:215], a[0:3]
    v_mfma_f32_16x16x32_bf16 a[4:7], v[60:63], v[216:219], a[4:7]
    s_waitcnt lgkmcnt(12)
    v_mfma_f32_16x16x32_bf16 a[8:11], v[64:67], v[212:215], a[8:11]
    v_mfma_f32_16x16x32_bf16 a[12:15], v[64:67], v[216:219], a[12:15]
    s_waitcnt lgkmcnt(10)
    v_mfma_f32_16x16x32_bf16 a[16:19], v[68:71], v[212:215], a[16:19]
    v_mfma_f32_16x16x32_bf16 a[20:23], v[68:71], v[216:219], a[20:23]
    s_waitcnt lgkmcnt(8)
    v_mfma_f32_16x16x32_bf16 a[24:27], v[72:75], v[212:215], a[24:27]
    v_mfma_f32_16x16x32_bf16 a[28:31], v[72:75], v[216:219], a[28:31]
    s_add_u32 s63, s69, 27648
    buffer_load_dwordx4 v[180:183], v1, s[56:59], s63 offen sc1
    s_add_u32 s63, s69, 158720
    buffer_load_dwordx4 v[184:187], v1, s[56:59], s63 offen sc1
    s_add_u32 m0, s74, 24576
    s_add_u32 s62, s68, 901120
    buffer_load_dwordx4 v2, s[28:31], s62 offen lds
    s_add_u32 m0, s74, 25600
    s_add_u32 s62, s68, 911360
    buffer_load_dwordx4 v2, s[28:31], s62 offen lds
    s_add_u32 m0, s74, 26624
    s_add_u32 s62, s68, 921600
    buffer_load_dwordx4 v2, s[28:31], s62 offen lds
    s_add_u32 m0, s74, 27648
    s_add_u32 s62, s68, 931840
    buffer_load_dwordx4 v2, s[28:31], s62 offen lds
    s_waitcnt vmcnt(30)
    ds_read_b64_tr_b16 v[60:61], v4 offset:4096
    ds_read_b64_tr_b16 v[62:63], v4 offset:6144
    ds_read_b64_tr_b16 v[64:65], v5 offset:4096
    ds_read_b64_tr_b16 v[66:67], v5 offset:6144
    ds_read_b64_tr_b16 v[68:69], v6 offset:4096
    ds_read_b64_tr_b16 v[70:71], v6 offset:6144
    ds_read_b64_tr_b16 v[72:73], v7 offset:4096
    ds_read_b64_tr_b16 v[74:75], v7 offset:6144
    s_waitcnt lgkmcnt(14)
    v_mfma_f32_16x16x32_bf16 a[0:3], v[28:31], v[92:95], a[0:3]
    v_mfma_f32_16x16x32_bf16 a[4:7], v[28:31], v[96:99], a[4:7]
    s_waitcnt lgkmcnt(12)
    v_mfma_f32_16x16x32_bf16 a[8:11], v[32:35], v[92:95], a[8:11]
    v_mfma_f32_16x16x32_bf16 a[12:15], v[32:35], v[96:99], a[12:15]
    s_waitcnt lgkmcnt(10)
    v_mfma_f32_16x16x32_bf16 a[16:19], v[36:39], v[92:95], a[16:19]
    v_mfma_f32_16x16x32_bf16 a[20:23], v[36:39], v[96:99], a[20:23]
    s_waitcnt lgkmcnt(8)
    v_mfma_f32_16x16x32_bf16 a[24:27], v[40:43], v[92:95], a[24:27]
    v_mfma_f32_16x16x32_bf16 a[28:31], v[40:43], v[96:99], a[28:31]
    s_add_u32 s63, s69, 28672
    buffer_load_dwordx4 v[188:191], v1, s[56:59], s63 offen sc1
    s_add_u32 s63, s69, 159744
    buffer_load_dwordx4 v[192:195], v1, s[56:59], s63 offen sc1
    s_add_u32 m0, s74, 28672
    s_add_u32 s62, s68, 942080
    buffer_load_dwordx4 v2, s[28:31], s62 offen lds
    s_add_u32 m0, s74, 29696
    s_add_u32 s62, s68, 952320
    buffer_load_dwordx4 v2, s[28:31], s62 offen lds
    s_add_u32 m0, s74, 30720
    s_add_u32 s62, s68, 962560
    buffer_load_dwordx4 v2, s[28:31], s62 offen lds
    s_add_u32 m0, s74, 31744
    s_add_u32 s62, s68, 972800
    buffer_load_dwordx4 v2, s[28:31], s62 offen lds
    s_waitcnt vmcnt(30)
    ds_read_b64_tr_b16 v[28:29], v4 offset:8192
    ds_read_b64_tr_b16 v[30:31], v4 offset:10240
    ds_read_b64_tr_b16 v[32:33], v5 offset:8192
    ds_read_b64_tr_b16 v[34:35], v5 offset:10240
    ds_read_b64_tr_b16 v[36:37], v6 offset:8192
    ds_read_b64_tr_b16 v[38:39], v6 offset:10240
    ds_read_b64_tr_b16 v[40:41], v7 offset:8192
    ds_read_b64_tr_b16 v[42:43], v7 offset:10240
    s_waitcnt lgkmcnt(14)
    v_mfma_f32_16x16x32_bf16 a[0:3], v[60:63], v[100:103], a[0:3]
    v_mfma_f32_16x16x32_bf16 a[4:7], v[60:63], v[104:107], a[4:7]
    s_waitcnt lgkmcnt(12)
    v_mfma_f32_16x16x32_bf16 a[8:11], v[64:67], v[100:103], a[8:11]
    v_mfma_f32_16x16x32_bf16 a[12:15], v[64:67], v[104:107], a[12:15]
    s_waitcnt lgkmcnt(10)
    v_mfma_f32_16x16x32_bf16 a[16:19], v[68:71], v[100:103], a[16:19]
    v_mfma_f32_16x16x32_bf16 a[20:23], v[68:71], v[104:107], a[20:23]
    s_waitcnt lgkmcnt(8)
    v_mfma_f32_16x16x32_bf16 a[24:27], v[72:75], v[100:103], a[24:27]
    v_mfma_f32_16x16x32_bf16 a[28:31], v[72:75], v[104:107], a[28:31]
    s_add_u32 s63, s69, 29696
    buffer_load_dwordx4 v[196:199], v1, s[56:59], s63 offen sc1
    s_add_u32 s63, s69, 160768
    buffer_load_dwordx4 v[200:203], v1, s[56:59], s63 offen sc1
    s_add_u32 m0, s74, 0
    s_add_u32 s62, s68, 983040
    buffer_load_dwordx4 v2, s[28:31], s62 offen lds
    s_add_u32 m0, s74, 1024
    s_add_u32 s62, s68, 993280
    buffer_load_dwordx4 v2, s[28:31], s62 offen lds
    s_add_u32 m0, s74, 2048
    s_add_u32 s62, s68, 1003520
    buffer_load_dwordx4 v2, s[28:31], s62 offen lds
    s_add_u32 m0, s74, 3072
    s_add_u32 s62, s68, 1013760
    buffer_load_dwordx4 v2, s[28:31], s62 offen lds
    s_waitcnt vmcnt(30)
    ds_read_b64_tr_b16 v[60:61], v4 offset:12288
    ds_read_b64_tr_b16 v[62:63], v4 offset:14336
    ds_read_b64_tr_b16 v[64:65], v5 offset:12288
    ds_read_b64_tr_b16 v[66:67], v5 offset:14336
    ds_read_b64_tr_b16 v[68:69], v6 offset:12288
    ds_read_b64_tr_b16 v[70:71], v6 offset:14336
    ds_read_b64_tr_b16 v[72:73], v7 offset:12288
    ds_read_b64_tr_b16 v[74:75], v7 offset:14336
    s_waitcnt lgkmcnt(14)
    v_mfma_f32_16x16x32_bf16 a[0:3], v[28:31], v[108:111], a[0:3]
    v_mfma_f32_16x16x32_bf16 a[4:7], v[28:31], v[112:115], a[4:7]
    s_waitcnt lgkmcnt(12)
    v_mfma_f32_16x16x32_bf16 a[8:11], v[32:35], v[108:111], a[8:11]
    v_mfma_f32_16x16x32_bf16 a[12:15], v[32:35], v[112:115], a[12:15]
    s_waitcnt lgkmcnt(10)
    v_mfma_f32_16x16x32_bf16 a[16:19], v[36:39], v[108:111], a[16:19]
    v_mfma_f32_16x16x32_bf16 a[20:23], v[36:39], v[112:115], a[20:23]
    s_waitcnt lgkmcnt(8)
    v_mfma_f32_16x16x32_bf16 a[24:27], v[40:43], v[108:111], a[24:27]
    v_mfma_f32_16x16x32_bf16 a[28:31], v[40:43], v[112:115], a[28:31]
    s_add_u32 s63, s69, 30720
    buffer_load_dwordx4 v[204:207], v1, s[56:59], s63 offen sc1
    s_add_u32 s63, s69, 161792
    buffer_load_dwordx4 v[208:211], v1, s[56:59], s63 offen sc1
    s_add_u32 m0, s74, 4096
    s_add_u32 s62, s68, 1024000
    buffer_load_dwordx4 v2, s[28:31], s62 offen lds
    s_add_u32 m0, s74, 5120
    s_add_u32 s62, s68, 1034240
    buffer_load_dwordx4 v2, s[28:31], s62 offen lds
    s_add_u32 m0, s74, 6144
    s_add_u32 s62, s68, 1044480
    buffer_load_dwordx4 v2, s[28:31], s62 offen lds
    s_add_u32 m0, s74, 7168
    s_add_u32 s62, s68, 1054720
    buffer_load_dwordx4 v2, s[28:31], s62 offen lds
    s_waitcnt vmcnt(30)
    ds_read_b64_tr_b16 v[28:29], v4 offset:16384
    ds_read_b64_tr_b16 v[30:31], v4 offset:18432
    ds_read_b64_tr_b16 v[32:33], v5 offset:16384
    ds_read_b64_tr_b16 v[34:35], v5 offset:18432
    ds_read_b64_tr_b16 v[36:37], v6 offset:16384
    ds_read_b64_tr_b16 v[38:39], v6 offset:18432
    ds_read_b64_tr_b16 v[40:41], v7 offset:16384
    ds_read_b64_tr_b16 v[42:43], v7 offset:18432
    s_waitcnt lgkmcnt(14)
    v_mfma_f32_16x16x32_bf16 a[0:3], v[60:63], v[116:119], a[0:3]
    v_mfma_f32_16x16x32_bf16 a[4:7], v[60:63], v[120:123], a[4:7]
    s_waitcnt lgkmcnt(12)
    v_mfma_f32_16x16x32_bf16 a[8:11], v[64:67], v[116:119], a[8:11]
    v_mfma_f32_16x16x32_bf16 a[12:15], v[64:67], v[120:123], a[12:15]
    s_waitcnt lgkmcnt(10)
    v_mfma_f32_16x16x32_bf16 a[16:19], v[68:71], v[116:119], a[16:19]
    v_mfma_f32_16x16x32_bf16 a[20:23], v[68:71], v[120:123], a[20:23]
    s_waitcnt lgkmcnt(8)
    v_mfma_f32_16x16x32_bf16 a[24:27], v[72:75], v[116:119], a[24:27]
    v_mfma_f32_16x16x32_bf16 a[28:31], v[72:75], v[120:123], a[28:31]
    s_add_u32 s63, s69, 31744
    buffer_load_dwordx4 v[212:215], v1, s[56:59], s63 offen sc1
    s_add_u32 s63, s69, 162816
    buffer_load_dwordx4 v[216:219], v1, s[56:59], s63 offen sc1
    s_add_u32 m0, s74, 8192
    s_add_u32 s62, s68, 1064960
    buffer_load_dwordx4 v2, s[28:31], s62 offen lds
    s_add_u32 m0, s74, 9216
    s_add_u32 s62, s68, 1075200
    buffer_load_dwordx4 v2, s[28:31], s62 offen lds
    s_add_u32 m0, s74, 10240
    s_add_u32 s62, s68, 1085440
    buffer_load_dwordx4 v2, s[28:31], s62 offen lds
    s_add_u32 m0, s74, 11264
    s_add_u32 s62, s68, 1095680
    buffer_load_dwordx4 v2, s[28:31], s62 offen lds
    s_waitcnt vmcnt(30)
    ds_read_b64_tr_b16 v[60:61], v4 offset:20480
    ds_read_b64_tr_b16 v[62:63], v4 offset:22528
    ds_read_b64_tr_b16 v[64:65], v5 offset:20480
    ds_read_b64_tr_b16 v[66:67], v5 offset:22528
    ds_read_b64_tr_b16 v[68:69], v6 offset:20480
    ds_read_b64_tr_b16 v[70:71], v6 offset:22528
    ds_read_b64_tr_b16 v[72:73], v7 offset:20480
    ds_read_b64_tr_b16 v[74:75], v7 offset:22528
    s_waitcnt lgkmcnt(14)
    v_mfma_f32_16x16x32_bf16 a[0:3], v[28:31], v[124:127], a[0:3]
    v_mfma_f32_16x16x32_bf16 a[4:7], v[28:31], v[128:131], a[4:7]
    s_waitcnt lgkmcnt(12)
    v_mfma_f32_16x16x32_bf16 a[8:11], v[32:35], v[124:127], a[8:11]
    v_mfma_f32_16x16x32_bf16 a[12:15], v[32:35], v[128:131], a[12:15]
    s_waitcnt lgkmcnt(10)
    v_mfma_f32_16x16x32_bf16 a[16:19], v[36:39], v[124:127], a[16:19]
    v_mfma_f32_16x16x32_bf16 a[20:23], v[36:39], v[128:131], a[20:23]
    s_waitcnt lgkmcnt(8)
    v_mfma_f32_16x16x32_bf16 a[24:27], v[40:43], v[124:127], a[24:27]
    v_mfma_f32_16x16x32_bf16 a[28:31], v[40:43], v[128:131], a[28:31]
    s_add_u32 m0, s74, 12288
    s_add_u32 s62, s68, 1105920
    buffer_load_dwordx4 v2, s[28:31], s62 offen lds
    s_add_u32 m0, s74, 13312
    s_add_u32 s62, s68, 1116160
    buffer_load_dwordx4 v2, s[28:31], s62 offen lds
    s_add_u32 m0, s74, 14336
    s_add_u32 s62, s68, 1126400
    buffer_load_dwordx4 v2, s[28:31], s62 offen lds
    s_add_u32 m0, s74, 15360
    s_add_u32 s62, s68, 1136640
    buffer_load_dwordx4 v2, s[28:31], s62 offen lds
    s_waitcnt vmcnt(28)
    ds_read_b64_tr_b16 v[28:29], v4 offset:24576
    ds_read_b64_tr_b16 v[30:31], v4 offset:26624
    ds_read_b64_tr_b16 v[32:33], v5 offset:24576
    ds_read_b64_tr_b16 v[34:35], v5 offset:26624
    ds_read_b64_tr_b16 v[36:37], v6 offset:24576
    ds_read_b64_tr_b16 v[38:39], v6 offset:26624
    ds_read_b64_tr_b16 v[40:41], v7 offset:24576
    ds_read_b64_tr_b16 v[42:43], v7 offset:26624
    s_waitcnt lgkmcnt(14)
    v_mfma_f32_16x16x32_bf16 a[0:3], v[60:63], v[132:135], a[0:3]
    v_mfma_f32_16x16x32_bf16 a[4:7], v[60:63], v[136:139], a[4:7]
    s_waitcnt lgkmcnt(12)
    v_mfma_f32_16x16x32_bf16 a[8:11], v[64:67], v[132:135], a[8:11]
    v_mfma_f32_16x16x32_bf16 a[12:15], v[64:67], v[136:139], a[12:15]
    s_waitcnt lgkmcnt(10)
    v_mfma_f32_16x16x32_bf16 a[16:19], v[68:71], v[132:135], a[16:19]
    v_mfma_f32_16x16x32_bf16 a[20:23], v[68:71], v[136:139], a[20:23]
    s_waitcnt lgkmcnt(8)
    v_mfma_f32_16x16x32_bf16 a[24:27], v[72:75], v[132:135], a[24:27]
    v_mfma_f32_16x16x32_bf16 a[28:31], v[72:75], v[136:139], a[28:31]
    s_add_u32 m0, s74, 16384
    s_add_u32 s62, s68, 1146880
    buffer_load_dwordx4 v2, s[28:31], s62 offen lds
    s_add_u32 m0, s74, 17408
    s_add_u32 s62, s68, 1157120
    buffer_load_dwordx4 v2, s[28:31], s62 offen lds
    s_add_u32 m0, s74, 18432
    s_add_u32 s62, s68, 1167360
    buffer_load_dwordx4 v2, s[28:31], s62 offen lds
    s_add_u32 m0, s74, 19456
    s_add_u32 s62, s68, 1177600
    buffer_load_dwordx4 v2, s[28:31], s62 offen lds
    s_waitcnt vmcnt(26)
    ds_read_b64_tr_b16 v[60:61], v4 offset:28672
    ds_read_b64_tr_b16 v[62:63], v4 offset:30720
    ds_read_b64_tr_b16 v[64:65], v5 offset:28672
    ds_read_b64_tr_b16 v[66:67], v5 offset:30720
    ds_read_b64_tr_b16 v[68:69], v6 offset:28672
    ds_read_b64_tr_b16 v[70:71], v6 offset:30720
    ds_read_b64_tr_b16 v[72:73], v7 offset:28672
    ds_read_b64_tr_b16 v[74:75], v7 offset:30720
    s_waitcnt lgkmcnt(14)
    v_mfma_f32_16x16x32_bf16 a[0:3], v[28:31], v[140:143], a[0:3]
    v_mfma_f32_16x16x32_bf16 a[4:7], v[28:31], v[144:147], a[4:7]
    s_waitcnt lgkmcnt(12)
    v_mfma_f32_16x16x32_bf16 a[8:11], v[32:35], v[140:143], a[8:11]
    v_mfma_f32_16x16x32_bf16 a[12:15], v[32:35], v[144:147], a[12:15]
    s_waitcnt lgkmcnt(10)
    v_mfma_f32_16x16x32_bf16 a[16:19], v[36:39], v[140:143], a[16:19]
    v_mfma_f32_16x16x32_bf16 a[20:23], v[36:39], v[144:147], a[20:23]
    s_waitcnt lgkmcnt(8)
    v_mfma_f32_16x16x32_bf16 a[24:27], v[40:43], v[140:143], a[24:27]
    v_mfma_f32_16x16x32_bf16 a[28:31], v[40:43], v[144:147], a[28:31]
    s_add_u32 m0, s74, 20480
    s_add_u32 s62, s68, 1187840
    buffer_load_dwordx4 v2, s[28:31], s62 offen lds
    s_add_u32 m0, s74, 21504
    s_add_u32 s62, s68, 1198080
    buffer_load_dwordx4 v2, s[28:31], s62 offen lds
    s_add_u32 m0, s74, 22528
    s_add_u32 s62, s68, 1208320
    buffer_load_dwordx4 v2, s[28:31], s62 offen lds
    s_add_u32 m0, s74, 23552
    s_add_u32 s62, s68, 1218560
    buffer_load_dwordx4 v2, s[28:31], s62 offen lds
    s_waitcnt vmcnt(24)
    ds_read_b64_tr_b16 v[28:29], v4
    ds_read_b64_tr_b16 v[30:31], v4 offset:2048
    ds_read_b64_tr_b16 v[32:33], v5
    ds_read_b64_tr_b16 v[34:35], v5 offset:2048
    ds_read_b64_tr_b16 v[36:37], v6
    ds_read_b64_tr_b16 v[38:39], v6 offset:2048
    ds_read_b64_tr_b16 v[40:41], v7
    ds_read_b64_tr_b16 v[42:43], v7 offset:2048
    s_waitcnt lgkmcnt(14)
    v_mfma_f32_16x16x32_bf16 a[0:3], v[60:63], v[148:151], a[0:3]
    v_mfma_f32_16x16x32_bf16 a[4:7], v[60:63], v[152:155], a[4:7]
    s_waitcnt lgkmcnt(12)
    v_mfma_f32_16x16x32_bf16 a[8:11], v[64:67], v[148:151], a[8:11]
    v_mfma_f32_16x16x32_bf16 a[12:15], v[64:67], v[152:155], a[12:15]
    s_waitcnt lgkmcnt(10)
    v_mfma_f32_16x16x32_bf16 a[16:19], v[68:71], v[148:151], a[16:19]
    v_mfma_f32_16x16x32_bf16 a[20:23], v[68:71], v[152:155], a[20:23]
    s_waitcnt lgkmcnt(8)
    v_mfma_f32_16x16x32_bf16 a[24:27], v[72:75], v[148:151], a[24:27]
    v_mfma_f32_16x16x32_bf16 a[28:31], v[72:75], v[152:155], a[28:31]
    s_add_u32 m0, s74, 24576
    s_add_u32 s62, s68, 1228800
    buffer_load_dwordx4 v2, s[28:31], s62 offen lds
    s_add_u32 m0, s74, 25600
    s_add_u32 s62, s68, 1239040
    buffer_load_dwordx4 v2, s[28:31], s62 offen lds
    s_add_u32 m0, s74, 26624
    s_add_u32 s62, s68, 1249280
    buffer_load_dwordx4 v2, s[28:31], s62 offen lds
    s_add_u32 m0, s74, 27648
    s_add_u32 s62, s68, 1259520
    buffer_load_dwordx4 v2, s[28:31], s62 offen lds
    s_waitcnt vmcnt(22)
    ds_read_b64_tr_b16 v[60:61], v4 offset:4096
    ds_read_b64_tr_b16 v[62:63], v4 offset:6144
    ds_read_b64_tr_b16 v[64:65], v5 offset:4096
    ds_read_b64_tr_b16 v[66:67], v5 offset:6144
    ds_read_b64_tr_b16 v[68:69], v6 offset:4096
    ds_read_b64_tr_b16 v[70:71], v6 offset:6144
    ds_read_b64_tr_b16 v[72:73], v7 offset:4096
    ds_read_b64_tr_b16 v[74:75], v7 offset:6144
    s_waitcnt lgkmcnt(14)
    v_mfma_f32_16x16x32_bf16 a[0:3], v[28:31], v[156:159], a[0:3]
    v_mfma_f32_16x16x32_bf16 a[4:7], v[28:31], v[160:163], a[4:7]
    s_waitcnt lgkmcnt(12)
    v_mfma_f32_16x16x32_bf16 a[8:11], v[32:35], v[156:159], a[8:11]
    v_mfma_f32_16x16x32_bf16 a[12:15], v[32:35], v[160:163], a[12:15]
    s_waitcnt lgkmcnt(10)
    v_mfma_f32_16x16x32_bf16 a[16:19], v[36:39], v[156:159], a[16:19]
    v_mfma_f32_16x16x32_bf16 a[20:23], v[36:39], v[160:163], a[20:23]
    s_waitcnt lgkmcnt(8)
    v_mfma_f32_16x16x32_bf16 a[24:27], v[40:43], v[156:159], a[24:27]
    v_mfma_f32_16x16x32_bf16 a[28:31], v[40:43], v[160:163], a[28:31]
    s_add_u32 m0, s74, 28672
    s_add_u32 s62, s68, 1269760
    buffer_load_dwordx4 v2, s[28:31], s62 offen lds
    s_add_u32 m0, s74, 29696
    s_add_u32 s62, s68, 1280000
    buffer_load_dwordx4 v2, s[28:31], s62 offen lds
    s_add_u32 m0, s74, 30720
    s_add_u32 s62, s68, 1290240
    buffer_load_dwordx4 v2, s[28:31], s62 offen lds
    s_add_u32 m0, s74, 31744
    s_add_u32 s62, s68, 1300480
    buffer_load_dwordx4 v2, s[28:31], s62 offen lds
    s_waitcnt vmcnt(20)
    ds_read_b64_tr_b16 v[28:29], v4 offset:8192
    ds_read_b64_tr_b16 v[30:31], v4 offset:10240
    ds_read_b64_tr_b16 v[32:33], v5 offset:8192
    ds_read_b64_tr_b16 v[34:35], v5 offset:10240
    ds_read_b64_tr_b16 v[36:37], v6 offset:8192
    ds_read_b64_tr_b16 v[38:39], v6 offset:10240
    ds_read_b64_tr_b16 v[40:41], v7 offset:8192
    ds_read_b64_tr_b16 v[42:43], v7 offset:10240
    s_waitcnt lgkmcnt(14)
    v_mfma_f32_16x16x32_bf16 a[0:3], v[60:63], v[164:167], a[0:3]
    v_mfma_f32_16x16x32_bf16 a[4:7], v[60:63], v[168:171], a[4:7]
    s_waitcnt lgkmcnt(12)
    v_mfma_f32_16x16x32_bf16 a[8:11], v[64:67], v[164:167], a[8:11]
    v_mfma_f32_16x16x32_bf16 a[12:15], v[64:67], v[168:171], a[12:15]
    s_waitcnt lgkmcnt(10)
    v_mfma_f32_16x16x32_bf16 a[16:19], v[68:71], v[164:167], a[16:19]
    v_mfma_f32_16x16x32_bf16 a[20:23], v[68:71], v[168:171], a[20:23]
    s_waitcnt lgkmcnt(8)
    v_mfma_f32_16x16x32_bf16 a[24:27], v[72:75], v[164:167], a[24:27]
    v_mfma_f32_16x16x32_bf16 a[28:31], v[72:75], v[168:171], a[28:31]
    s_waitcnt vmcnt(16)
    ds_read_b64_tr_b16 v[60:61], v4 offset:12288
    ds_read_b64_tr_b16 v[62:63], v4 offset:14336
    ds_read_b64_tr_b16 v[64:65], v5 offset:12288
    ds_read_b64_tr_b16 v[66:67], v5 offset:14336
    ds_read_b64_tr_b16 v[68:69], v6 offset:12288
    ds_read_b64_tr_b16 v[70:71], v6 offset:14336
    ds_read_b64_tr_b16 v[72:73], v7 offset:12288
    ds_read_b64_tr_b16 v[74:75], v7 offset:14336
    s_waitcnt lgkmcnt(14)
    v_mfma_f32_16x16x32_bf16 a[0:3], v[28:31], v[172:175], a[0:3]
    v_mfma_f32_16x16x32_bf16 a[4:7], v[28:31], v[176:179], a[4:7]
    s_waitcnt lgkmcnt(12)
    v_mfma_f32_16x16x32_bf16 a[8:11], v[32:35], v[172:175], a[8:11]
    v_mfma_f32_16x16x32_bf16 a[12:15], v[32:35], v[176:179], a[12:15]
    s_waitcnt lgkmcnt(10)
    v_mfma_f32_16x16x32_bf16 a[16:19], v[36:39], v[172:175], a[16:19]
    v_mfma_f32_16x16x32_bf16 a[20:23], v[36:39], v[176:179], a[20:23]
    s_waitcnt lgkmcnt(8)
    v_mfma_f32_16x16x32_bf16 a[24:27], v[40:43], v[172:175], a[24:27]
    v_mfma_f32_16x16x32_bf16 a[28:31], v[40:43], v[176:179], a[28:31]
    s_waitcnt vmcnt(12)
    ds_read_b64_tr_b16 v[28:29], v4 offset:16384
    ds_read_b64_tr_b16 v[30:31], v4 offset:18432
    ds_read_b64_tr_b16 v[32:33], v5 offset:16384
    ds_read_b64_tr_b16 v[34:35], v5 offset:18432
    ds_read_b64_tr_b16 v[36:37], v6 offset:16384
    ds_read_b64_tr_b16 v[38:39], v6 offset:18432
    ds_read_b64_tr_b16 v[40:41], v7 offset:16384
    ds_read_b64_tr_b16 v[42:43], v7 offset:18432
    s_waitcnt lgkmcnt(14)
    v_mfma_f32_16x16x32_bf16 a[0:3], v[60:63], v[180:183], a[0:3]
    v_mfma_f32_16x16x32_bf16 a[4:7], v[60:63], v[184:187], a[4:7]
    s_waitcnt lgkmcnt(12)
    v_mfma_f32_16x16x32_bf16 a[8:11], v[64:67], v[180:183], a[8:11]
    v_mfma_f32_16x16x32_bf16 a[12:15], v[64:67], v[184:187], a[12:15]
    s_waitcnt lgkmcnt(10)
    v_mfma_f32_16x16x32_bf16 a[16:19], v[68:71], v[180:183], a[16:19]
    v_mfma_f32_16x16x32_bf16 a[20:23], v[68:71], v[184:187], a[20:23]
    s_waitcnt lgkmcnt(8)
    v_mfma_f32_16x16x32_bf16 a[24:27], v[72:75], v[180:183], a[24:27]
    v_mfma_f32_16x16x32_bf16 a[28:31], v[72:75], v[184:187], a[28:31]
    s_waitcnt vmcnt(8)
    ds_read_b64_tr_b16 v[60:61], v4 offset:20480
    ds_read_b64_tr_b16 v[62:63], v4 offset:22528
    ds_read_b64_tr_b16 v[64:65], v5 offset:20480
    ds_read_b64_tr_b16 v[66:67], v5 offset:22528
    ds_read_b64_tr_b16 v[68:69], v6 offset:20480
    ds_read_b64_tr_b16 v[70:71], v6 offset:22528
    ds_read_b64_tr_b16 v[72:73], v7 offset:20480
    ds_read_b64_tr_b16 v[74:75], v7 offset:22528
    s_waitcnt lgkmcnt(14)
    v_mfma_f32_16x16x32_bf16 a[0:3], v[28:31], v[188:191], a[0:3]
    v_mfma_f32_16x16x32_bf16 a[4:7], v[28:31], v[192:195], a[4:7]
    s_waitcnt lgkmcnt(12)
    v_mfma_f32_16x16x32_bf16 a[8:11], v[32:35], v[188:191], a[8:11]
    v_mfma_f32_16x16x32_bf16 a[12:15], v[32:35], v[192:195], a[12:15]
    s_waitcnt lgkmcnt(10)
    v_mfma_f32_16x16x32_bf16 a[16:19], v[36:39], v[188:191], a[16:19]
    v_mfma_f32_16x16x32_bf16 a[20:23], v[36:39], v[192:195], a[20:23]
    s_waitcnt lgkmcnt(8)
    v_mfma_f32_16x16x32_bf16 a[24:27], v[40:43], v[188:191], a[24:27]
    v_mfma_f32_16x16x32_bf16 a[28:31], v[40:43], v[192:195], a[28:31]
    s_waitcnt vmcnt(4)
    ds_read_b64_tr_b16 v[28:29], v4 offset:24576
    ds_read_b64_tr_b16 v[30:31], v4 offset:26624
    ds_read_b64_tr_b16 v[32:33], v5 offset:24576
    ds_read_b64_tr_b16 v[34:35], v5 offset:26624
    ds_read_b64_tr_b16 v[36:37], v6 offset:24576
    ds_read_b64_tr_b16 v[38:39], v6 offset:26624
    ds_read_b64_tr_b16 v[40:41], v7 offset:24576
    ds_read_b64_tr_b16 v[42:43], v7 offset:26624
    s_waitcnt lgkmcnt(14)
    v_mfma_f32_16x16x32_bf16 a[0:3], v[60:63], v[196:199], a[0:3]
    v_mfma_f32_16x16x32_bf16 a[4:7], v[60:63], v[200:203], a[4:7]
    s_waitcnt lgkmcnt(12)
    v_mfma_f32_16x16x32_bf16 a[8:11], v[64:67], v[196:199], a[8:11]
    v_mfma_f32_16x16x32_bf16 a[12:15], v[64:67], v[200:203], a[12:15]
    s_waitcnt lgkmcnt(10)
    v_mfma_f32_16x16x32_bf16 a[16:19], v[68:71], v[196:199], a[16:19]
    v_mfma_f32_16x16x32_bf16 a[20:23], v[68:71], v[200:203], a[20:23]
    s_waitcnt lgkmcnt(8)
    v_mfma_f32_16x16x32_bf16 a[24:27], v[72:75], v[196:199], a[24:27]
    v_mfma_f32_16x16x32_bf16 a[28:31], v[72:75], v[200:203], a[28:31]
    s_waitcnt vmcnt(0)
    ds_read_b64_tr_b16 v[60:61], v4 offset:28672
    ds_read_b64_tr_b16 v[62:63], v4 offset:30720
    ds_read_b64_tr_b16 v[64:65], v5 offset:28672
    ds_read_b64_tr_b16 v[66:67], v5 offset:30720
    ds_read_b64_tr_b16 v[68:69], v6 offset:28672
    ds_read_b64_tr_b16 v[70:71], v6 offset:30720
    ds_read_b64_tr_b16 v[72:73], v7 offset:28672
    ds_read_b64_tr_b16 v[74:75], v7 offset:30720
    s_waitcnt lgkmcnt(14)
    v_mfma_f32_16x16x32_bf16 a[0:3], v[28:31], v[204:207], a[0:3]
    v_mfma_f32_16x16x32_bf16 a[4:7], v[28:31], v[208:211], a[4:7]
    s_waitcnt lgkmcnt(12)
    v_mfma_f32_16x16x32_bf16 a[8:11], v[32:35], v[204:207], a[8:11]
    v_mfma_f32_16x16x32_bf16 a[12:15], v[32:35], v[208:211], a[12:15]
    s_waitcnt lgkmcnt(10)
    v_mfma_f32_16x16x32_bf16 a[16:19], v[36:39], v[204:207], a[16:19]
    v_mfma_f32_16x16x32_bf16 a[20:23], v[36:39], v[208:211], a[20:23]
    s_waitcnt lgkmcnt(8)
    v_mfma_f32_16x16x32_bf16 a[24:27], v[40:43], v[204:207], a[24:27]
    v_mfma_f32_16x16x32_bf16 a[28:31], v[40:43], v[208:211], a[28:31]
    s_waitcnt lgkmcnt(6)
    v_mfma_f32_16x16x32_bf16 a[0:3], v[60:63], v[212:215], a[0:3]
    v_mfma_f32_16x16x32_bf16 a[4:7], v[60:63], v[216:219], a[4:7]
    s_waitcnt lgkmcnt(4)
    v_mfma_f32_16x16x32_bf16 a[8:11], v[64:67], v[212:215], a[8:11]
    v_mfma_f32_16x16x32_bf16 a[12:15], v[64:67], v[216:219], a[12:15]
    s_waitcnt lgkmcnt(2)
    v_mfma_f32_16x16x32_bf16 a[16:19], v[68:71], v[212:215], a[16:19]
    v_mfma_f32_16x16x32_bf16 a[20:23], v[68:71], v[216:219], a[20:23]
    s_waitcnt lgkmcnt(0)
    v_mfma_f32_16x16x32_bf16 a[24:27], v[72:75], v[212:215], a[24:27]
    v_mfma_f32_16x16x32_bf16 a[28:31], v[72:75], v[216:219], a[28:31]
    s_waitcnt vmcnt(0) lgkmcnt(0)
    s_nop 7
    s_nop 7
    v_add_u32 v14, s74, v1
    ds_write_b128 v14, a[0:3]
    ds_write_b128 v14, a[4:7] offset:1024
    ds_write_b128 v14, a[8:11] offset:2048
    ds_write_b128 v14, a[12:15] offset:3072
    ds_write_b128 v14, a[16:19] offset:4096
    ds_write_b128 v14, a[20:23] offset:5120
    ds_write_b128 v14, a[24:27] offset:6144
    ds_write_b128 v14, a[28:31] offset:7168
    ds_write_b128 v14, a[32:35] offset:8192
    ds_write_b128 v14, a[36:39] offset:9216
    ds_write_b128 v14, a[40:43] offset:10240
    ds_write_b128 v14, a[44:47] offset:11264
    ds_write_b128 v14, a[48:51] offset:12288
    ds_write_b128 v14, a[52:55] offset:13312
    ds_write_b128 v14, a[56:59] offset:14336
    ds_write_b128 v14, a[60:63] offset:15360
    s_lshr_b32 s73, s61, 1
    s_and_b32 s75, s61, 1
    s_lshl_b32 s62, s73, 12
    s_lshl_b32 s63, s75, 10
    s_add_u32 s62, s62, s63
    v_add_u32 v14, s62, v1
    v_add_u32 v17, 65536, v14
    s_movk_i32 s62, 1280
    v_mul_lo_u32 v15, v26, s62
    v_lshl_add_u32 v15, v25, 4, v15
    s_lshl_b32 s63, s76, 5
    s_lshl_b32 s62, s75, 4
    s_add_u32 s63, s63, s62
    s_mul_i32 s66, s63, 1280
    s_lshl_b32 s62, s77, 7
    s_lshl_b32 s63, s73, 6
    s_add_u32 s62, s62, s63
    s_add_u32 s66, s66, s62
    buffer_load_dwordx4 v[28:31], v15, s[8:11], s66 offen
    v_lshlrev_b32 v16, 4, v25
    buffer_load_dwordx4 v[36:39], v16, s[44:47], s62 offen
    s_waitcnt lgkmcnt(0)
    s_barrier
    ds_read_b128 v[64:67], v14
    ds_read_b128 v[68:71], v14 offset:32768
    ds_read_b128 v[72:75], v17
    ds_read_b128 v[76:79], v17 offset:32768
    ds_read_b128 v[80:83], v14 offset:2048
    ds_read_b128 v[84:87], v14 offset:34816
    ds_read_b128 v[88:91], v17 offset:2048
    ds_read_b128 v[92:95], v17 offset:34816
    ds_read_b128 v[96:99], v14 offset:8192
    ds_read_b128 v[100:103], v14 offset:40960
    ds_read_b128 v[104:107], v17 offset:8192
    ds_read_b128 v[108:111], v17 offset:40960
    ds_read_b128 v[112:115], v14 offset:10240
    ds_read_b128 v[116:119], v14 offset:43008
    ds_read_b128 v[120:123], v17 offset:10240
    ds_read_b128 v[124:127], v17 offset:43008
    s_waitcnt vmcnt(0)
    v_lshlrev_b32 v40, 16, v36
    v_and_b32 v41, 0xffff0000, v36
    v_lshlrev_b32 v42, 16, v37
    v_and_b32 v43, 0xffff0000, v37
    v_lshlrev_b32 v44, 16, v38
    v_and_b32 v45, 0xffff0000, v38
    v_lshlrev_b32 v46, 16, v39
    v_and_b32 v47, 0xffff0000, v39
    s_waitcnt lgkmcnt(14)
    v_add_f32 v48, v64, v68
    s_waitcnt lgkmcnt(12)
    v_add_f32 v72, v72, v76
    v_add_f32 v48, v48, v72
    v_add_f32 v49, v65, v69
    v_add_f32 v73, v73, v77
    v_add_f32 v49, v49, v73
    v_add_f32 v50, v66, v70
    v_add_f32 v74, v74, v78
    v_add_f32 v50, v50, v74
    v_add_f32 v51, v67, v71
    v_add_f32 v75, v75, v79
    v_add_f32 v51, v51, v75
    s_waitcnt lgkmcnt(10)
    v_add_f32 v52, v80, v84
    s_waitcnt lgkmcnt(8)
    v_add_f32 v88, v88, v92
    v_add_f32 v52, v52, v88
    v_add_f32 v53, v81, v85
    v_add_f32 v89, v89, v93
    v_add_f32 v53, v53, v89
    v_add_f32 v54, v82, v86
    v_add_f32 v90, v90, v94
    v_add_f32 v54, v54, v90
    v_add_f32 v55, v83, v87
    v_add_f32 v91, v91, v95
    v_add_f32 v55, v55, v91
    s_waitcnt lgkmcnt(6)
    v_add_f32 v56, v96, v100
    s_waitcnt lgkmcnt(4)
    v_add_f32 v104, v104, v108
    v_add_f32 v56, v56, v104
    v_add_f32 v57, v97, v101
    v_add_f32 v105, v105, v109
    v_add_f32 v57, v57, v105
    v_add_f32 v58, v98, v102
    v_add_f32 v106, v106, v110
    v_add_f32 v58, v58, v106
    v_add_f32 v59, v99, v103
    v_add_f32 v107, v107, v111
    v_add_f32 v59, v59, v107
    s_waitcnt lgkmcnt(2)
    v_add_f32 v60, v112, v116
    s_waitcnt lgkmcnt(0)
    v_add_f32 v120, v120, v124
    v_add_f32 v60, v60, v120
    v_add_f32 v61, v113, v117
    v_add_f32 v121, v121, v125
    v_add_f32 v61, v61, v121
    v_add_f32 v62, v114, v118
    v_add_f32 v122, v122, v126
    v_add_f32 v62, v62, v122
    v_add_f32 v63, v115, v119
    v_add_f32 v123, v123, v127
    v_add_f32 v63, v63, v123
    s_mov_b32 s62, 0xbfb8aa3b
    v_cvt_pk_bf16_f32 v132, v48, v49
    v_lshlrev_b32 v48, 16, v132
    v_and_b32 v49, 0xffff0000, v132
    v_cvt_pk_bf16_f32 v132, v56, v57
    v_lshlrev_b32 v56, 16, v132
    v_and_b32 v57, 0xffff0000, v132
    v_add_f32 v56, v56, v40
    v_add_f32 v57, v57, v41
    v_cvt_pk_bf16_f32 v132, v56, v57
    v_lshlrev_b32 v56, 16, v132
    v_and_b32 v57, 0xffff0000, v132
    v_mul_f32 v133, s62, v56
    v_exp_f32 v133, v133
    s_nop 0
    v_add_f32 v133, 1.0, v133
    v_rcp_f32 v133, v133
    s_nop 0
    v_mul_f32 v56, v56, v133
    v_mul_f32 v134, s62, v57
    v_exp_f32 v134, v134
    s_nop 0
    v_add_f32 v134, 1.0, v134
    v_rcp_f32 v134, v134
    s_nop 0
    v_mul_f32 v57, v57, v134
    v_cvt_pk_bf16_f32 v132, v56, v57
    v_lshlrev_b32 v56, 16, v132
    v_and_b32 v57, 0xffff0000, v132
    v_mul_f32 v48, v48, v56
    v_mul_f32 v49, v49, v57
    v_cvt_pk_bf16_f32 v132, v48, v49
    v_lshlrev_b32 v48, 16, v132
    v_and_b32 v49, 0xffff0000, v132
    v_lshlrev_b32 v135, 16, v28
    v_and_b32 v136, 0xffff0000, v28
    v_add_f32 v48, v48, v135
    v_add_f32 v49, v49, v136
    v_cvt_pk_bf16_f32 v128, v48, v49
    v_cvt_pk_bf16_f32 v132, v50, v51
    v_lshlrev_b32 v50, 16, v132
    v_and_b32 v51, 0xffff0000, v132
    v_cvt_pk_bf16_f32 v132, v58, v59
    v_lshlrev_b32 v58, 16, v132
    v_and_b32 v59, 0xffff0000, v132
    v_add_f32 v58, v58, v42
    v_add_f32 v59, v59, v43
    v_cvt_pk_bf16_f32 v132, v58, v59
    v_lshlrev_b32 v58, 16, v132
    v_and_b32 v59, 0xffff0000, v132
    v_mul_f32 v133, s62, v58
    v_exp_f32 v133, v133
    s_nop 0
    v_add_f32 v133, 1.0, v133
    v_rcp_f32 v133, v133
    s_nop 0
    v_mul_f32 v58, v58, v133
    v_mul_f32 v134, s62, v59
    v_exp_f32 v134, v134
    s_nop 0
    v_add_f32 v134, 1.0, v134
    v_rcp_f32 v134, v134
    s_nop 0
    v_mul_f32 v59, v59, v134
    v_cvt_pk_bf16_f32 v132, v58, v59
    v_lshlrev_b32 v58, 16, v132
    v_and_b32 v59, 0xffff0000, v132
    v_mul_f32 v50, v50, v58
    v_mul_f32 v51, v51, v59
    v_cvt_pk_bf16_f32 v132, v50, v51
    v_lshlrev_b32 v50, 16, v132
    v_and_b32 v51, 0xffff0000, v132
    v_lshlrev_b32 v135, 16, v29
    v_and_b32 v136, 0xffff0000, v29
    v_add_f32 v50, v50, v135
    v_add_f32 v51, v51, v136
    v_cvt_pk_bf16_f32 v129, v50, v51
    v_cvt_pk_bf16_f32 v132, v52, v53
    v_lshlrev_b32 v52, 16, v132
    v_and_b32 v53, 0xffff0000, v132
    v_cvt_pk_bf16_f32 v132, v60, v61
    v_lshlrev_b32 v60, 16, v132
    v_and_b32 v61, 0xffff0000, v132
    v_add_f32 v60, v60, v44
    v_add_f32 v61, v61, v45
    v_cvt_pk_bf16_f32 v132, v60, v61
    v_lshlrev_b32 v60, 16, v132
    v_and_b32 v61, 0xffff0000, v132
    v_mul_f32 v133, s62, v60
    v_exp_f32 v133, v133
    s_nop 0
    v_add_f32 v133, 1.0, v133
    v_rcp_f32 v133, v133
    s_nop 0
    v_mul_f32 v60, v60, v133
    v_mul_f32 v134, s62, v61
    v_exp_f32 v134, v134
    s_nop 0
    v_add_f32 v134, 1.0, v134
    v_rcp_f32 v134, v134
    s_nop 0
    v_mul_f32 v61, v61, v134
    v_cvt_pk_bf16_f32 v132, v60, v61
    v_lshlrev_b32 v60, 16, v132
    v_and_b32 v61, 0xffff0000, v132
    v_mul_f32 v52, v52, v60
    v_mul_f32 v53, v53, v61
    v_cvt_pk_bf16_f32 v132, v52, v53
    v_lshlrev_b32 v52, 16, v132
    v_and_b32 v53, 0xffff0000, v132
    v_lshlrev_b32 v135, 16, v30
    v_and_b32 v136, 0xffff0000, v30
    v_add_f32 v52, v52, v135
    v_add_f32 v53, v53, v136
    v_cvt_pk_bf16_f32 v130, v52, v53
    v_cvt_pk_bf16_f32 v132, v54, v55
    v_lshlrev_b32 v54, 16, v132
    v_and_b32 v55, 0xffff0000, v132
    v_cvt_pk_bf16_f32 v132, v62, v63
    v_lshlrev_b32 v62, 16, v132
    v_and_b32 v63, 0xffff0000, v132
    v_add_f32 v62, v62, v46
    v_add_f32 v63, v63, v47
    v_cvt_pk_bf16_f32 v132, v62, v63
    v_lshlrev_b32 v62, 16, v132
    v_and_b32 v63, 0xffff0000, v132
    v_mul_f32 v133, s62, v62
    v_exp_f32 v133, v133
    s_nop 0
    v_add_f32 v133, 1.0, v133
    v_rcp_f32 v133, v133
    s_nop 0
    v_mul_f32 v62, v62, v133
    v_mul_f32 v134, s62, v63
    v_exp_f32 v134, v134
    s_nop 0
    v_add_f32 v134, 1.0, v134
    v_rcp_f32 v134, v134
    s_nop 0
    v_mul_f32 v63, v63, v134
    v_cvt_pk_bf16_f32 v132, v62, v63
    v_lshlrev_b32 v62, 16, v132
    v_and_b32 v63, 0xffff0000, v132
    v_mul_f32 v54, v54, v62
    v_mul_f32 v55, v55, v63
    v_cvt_pk_bf16_f32 v132, v54, v55
    v_lshlrev_b32 v54, 16, v132
    v_and_b32 v55, 0xffff0000, v132
    v_lshlrev_b32 v135, 16, v31
    v_and_b32 v136, 0xffff0000, v31
    v_add_f32 v54, v54, v135
    v_add_f32 v55, v55, v136
    v_cvt_pk_bf16_f32 v131, v54, v55
    buffer_store_dwordx4 v[128:131], v15, s[48:51], s66 offen
    s_waitcnt lgkmcnt(0)
    s_barrier
    v_and_b32 v24, 63, v0
    v_lshrrev_b32 v12, 6, v0
    s_nop 0
    v_readfirstlane_b32 s61, v12
    v_lshlrev_b32 v1, 4, v24
    v_lshrrev_b32 v25, 4, v24
    v_and_b32 v26, 15, v24
    s_lshl_b32 s74, s61, 15
    v_lshrrev_b32 v12, 2, v24
    v_and_b32 v13, 7, v12
    v_and_b32 v14, 3, v24
    v_lshlrev_b32 v12, 8, v12
    v_lshl_add_u32 v12, v13, 5, v12
    v_lshl_add_u32 v12, v14, 3, v12
    v_xor_b32 v13, 0, v12
    v_add_u32 v4, s74, v13
    v_xor_b32 v13, 32, v12
    v_add_u32 v5, s74, v13
    v_xor_b32 v13, 64, v12
    v_add_u32 v6, s74, v13
    v_xor_b32 v13, 96, v12
    v_add_u32 v7, s74, v13
    v_xor_b32 v13, 128, v12
    v_add_u32 v8, s74, v13
    v_xor_b32 v13, 160, v12
    v_add_u32 v9, s74, v13
    v_xor_b32 v13, 192, v12
    v_add_u32 v10, s74, v13
    v_xor_b32 v13, 224, v12
    v_add_u32 v11, s74, v13
    s_branch L_next
L_chain:
    v_and_b32 v12, 63, v0
    v_lshrrev_b32 v15, 6, v0
    s_nop 0
    v_readfirstlane_b32 s61, v15
    v_lshrrev_b32 v13, 4, v12
    v_and_b32 v14, 15, v12
    v_lshlrev_b32 v10, 4, v12
    s_lshl_b32 s86, s61, 15
    v_add_u32 v1, s86, v10
    v_and_b32 v15, 7, v12
    v_xor_b32 v15, v15, v13
    v_lshl_add_u32 v15, v13, 3, v15
    v_lshlrev_b32 v15, 4, v15
    v_add_u32 v2, 131072, v15
    v_add_u32 v3, 131072, v10
    v_lshrrev_b32 v15, 2, v12
    v_lshlrev_b32 v15, 4, v15
    v_and_b32 v16, 1, v12
    v_lshl_add_u32 v15, v16, 3, v15
    v_add_u32 v4, 157696, v15
    v_and_b32 v19, 1, v13
    v_lshrrev_b32 v20, 1, v13
    v_lshlrev_b32 v15, 4, v14
    v_lshl_add_u32 v15, v19, 3, v15
    v_add_u32 v5, 161792, v15
    v_lshl_add_u32 v15, v20, 8, v15
    s_lshl_b32 s86, s61, 9
    s_add_u32 s86, s86, 157696
    v_add_u32 v6, s86, v15
    v_lshrrev_b32 v18, 1, v0
    v_and_b32 v21, 1, v0
    v_bfe_u32 v22, v18, 2, 2
    v_lshlrev_b32 v15, 2, v21
    v_xor_b32 v15, v15, v22
    v_lshl_add_u32 v15, v22, 3, v15
    v_lshlrev_b32 v15, 4, v15
    v_lshrrev_b32 v16, 4, v18
    v_lshl_add_u32 v16, v16, 9, v15
    v_and_b32 v17, 3, v18
    v_lshl_add_u32 v16, v17, 2, v16
    v_add_u32 v7, 131072, v16
    v_lshrrev_b32 v15, 3, v14
    v_lshl_add_u32 v15, v20, 1, v15
    v_lshlrev_b32 v15, 12, v15
    v_and_b32 v16, 7, v14
    v_lshl_add_u32 v15, v16, 4, v15
    v_lshl_add_u32 v8, v19, 3, v15
    v_cmp_le_u32 s[82:83], 8, v14
    v_mov_b32 v15, 0x4444
    v_mov_b32 v16, 0xeeee
    v_cndmask_b32 v11, v15, v16, s[82:83]
    v_cmp_le_u32 vcc, 1, v20
    v_mov_b32 v15, 0x10000
    v_mov_b32 v16, 0xf149f2ca
    v_cndmask_b32 v9, v15, v16, vcc
    s_add_u32 s65, s60, 48
    s_cmp_eq_u32 s61, 0
    s_cselect_b32 s65, s60, s65
    s_add_u32 s86, s60, 32
    s_cmp_lt_u32 s60, 16
    s_cselect_b32 s86, s86, 99
    s_cmp_eq_u32 s61, 2
    s_cselect_b32 s65, s86, s65
    s_cmp_eq_u32 s61, 3
    s_cselect_b32 s65, 99, s65
    s_lshl_b32 s66, s65, 12
    s_add_u32 s66, s66, 88604672
    s_lshl_b32 s67, s65, 8
    s_add_u32 s67, s67, 89128960
    s_mul_i32 s86, s61, 49152
    s_lshl_b32 s87, s60, 7
    s_add_u32 s86, s86, s87
    s_add_u32 s68, s86, 88604672
    s_add_u32 s69, s68, 16384
    s_add_u32 s70, s69, 16384
    s_mul_i32 s86, s61, 32768
    s_add_u32 s86, s86, s87
    s_add_u32 s71, s86, 88801280
    s_add_u32 s72, s71, 16384
    s_lshl_b32 s86, s61, 10
    s_add_u32 s73, s86, 89128960
    s_add_u32 s74, s86, 89133056
    s_add_u32 s75, s86, 89137152
    s_add_u32 s76, s86, 89141248
    s_add_u32 s77, s86, 89145344
    s_lshl_b32 s87, s61, 9
    s_add_u32 s94, s87, 159744
    s_lshl_b32 s86, s60, 2
    s_add_u32 s86, s86, s61
    s_lshl_b32 s86, s86, 15
    s_add_u32 s78, s86, 90177536
    s_add_u32 s32, s78, 0
    s_add_u32 s33, s78, 4096
    s_add_u32 s34, s78, 8192
    s_add_u32 s35, s78, 12288
    s_add_u32 s36, s78, 16384
    s_add_u32 s37, s78, 20480
    s_lshl_b32 s86, s60, 13
    s_add_u32 s79, s86, 4194304
    s_add_u32 s81, s86, 20971520
    s_lshl_b32 s86, s60, 12
    s_lshl_b32 s87, s61, 9
    s_add_u32 s86, s86, s87
    s_add_u32 s80, s86, 79691776
    s_mov_b32 s90, 0x3e0293ee
    s_mov_b32 s91, 0x3e0293ee
    s_lshl_b32 s40, s61, 11
    s_mov_b32 s62, 0
    s_mov_b32 s85, 0x10001
    s_mov_b32 s84, 1
    s_mov_b32 s95, 0x07060302
    s_mov_b32 s63, 2
    s_mov_b32 s64, 1
    v_mov_b32 v12, 1
    v_mov_b32 v13, 1
    buffer_store_dwordx2 v[12:13], v8, s[56:59], s68 offen sc1
    buffer_store_dwordx2 v[12:13], v8, s[56:59], s69 offen sc1
    buffer_store_dwordx2 v[12:13], v8, s[56:59], s70 offen sc1
    buffer_store_dwordx2 v[12:13], v8, s[56:59], s71 offen sc1
    buffer_store_dwordx2 v[12:13], v8, s[56:59], s72 offen sc1
    s_cmp_ge_u32 s65, 80
    s_cbranch_scc1 L_ci_skip
    v_mov_b32 v16, 2
    v_mov_b32 v17, 2
    v_mov_b32 v18, 2
    v_mov_b32 v19, 2
    v_and_b32 v39, 4095, v8
    v_lshlrev_b32 v39, 1, v39
    buffer_store_dwordx4 v[16:19], v39, s[56:59], s67 offen sc1
L_ci_skip:
    s_waitcnt vmcnt(0)
    s_barrier
    s_lshl_b32 s86, 1, s3
    v_mov_b32 v12, s86
    v_mov_b32 v13, 94371972
    v_mov_b32 v14, 1
    v_mov_b32 v15, 94371968
    s_cmp_lg_u32 s61, 0
    s_cbranch_scc1 L_ch0
    s_mov_b64 exec, 1
    buffer_atomic_or v12, v13, s[56:59], 0 offen sc1
    s_waitcnt vmcnt(0)
    buffer_atomic_add v14, v15, s[56:59], 0 offen sc1
    s_mov_b64 exec, -1
L_ch0:
    v_and_b32 v17, 63, v0
    v_lshrrev_b32 v18, 4, v17
    v_bfe_u32 v19, v17, 2, 2
    v_and_b32 v20, 3, v17
    v_lshrrev_b32 v21, 2, v17
    v_lshlrev_b32 v22, 4, v20
    v_lshl_add_u32 v12, v21, 13, v22
    s_movk_i32 s86, 1280
    v_mul_lo_u32 v21, v21, s86
    v_add_u32 v13, v21, v22
    s_lshl_b32 s86, s61, 15
    v_and_b32 v23, 1, v19
    v_lshrrev_b32 v24, 1, v19
    v_and_b32 v25, 1, v18
    v_lshrrev_b32 v26, 1, v18
    v_lshlrev_b32 v27, 3, v20
    v_lshl_add_u32 v27, v24, 5, v27
    v_add_u32 v27, s86, v27
    v_lshlrev_b32 v21, 5, v23
    v_lshl_add_u32 v21, v26, 2, v21
    v_lshl_add_u32 v21, v25, 1, v21
    v_lshl_add_u32 v14, v21, 6, v27
    v_lshl_add_u32 v21, v25, 4, v23
    v_lshl_add_u32 v21, v26, 2, v21
    v_lshl_add_u32 v16, v21, 6, v27
    s_lshl_b32 s88, s60, 8
    s_lshl_b32 s87, s61, 6
    s_add_u32 s88, s88, s87
    s_mul_i32 s89, s60, 163840
    s_mul_i32 s87, s61, 192
    s_add_u32 s44, s89, s87
    s_lshl_b32 s87, s61, 7
    s_add_u32 s45, s89, s87
    s_lshl_b32 s92, s61, 15
    s_add_u32 m0, s92, 0
    s_add_u32 s93, s88, 0
    buffer_load_dwordx4 v12, s[16:19], s93 offen lds
    s_add_u32 m0, s92, 1024
    s_add_u32 s93, s88, 131072
    buffer_load_dwordx4 v12, s[16:19], s93 offen lds
    s_add_u32 m0, s92, 2048
    s_add_u32 s93, s88, 1048576
    buffer_load_dwordx4 v12, s[16:19], s93 offen lds
    s_add_u32 m0, s92, 3072
    s_add_u32 s93, s88, 1179648
    buffer_load_dwordx4 v12, s[16:19], s93 offen lds
    s_add_u32 m0, s92, 4096
    s_add_u32 s93, s88, 524288
    buffer_load_dwordx4 v12, s[16:19], s93 offen lds
    s_add_u32 m0, s92, 5120
    s_add_u32 s93, s88, 655360
    buffer_load_dwordx4 v12, s[16:19], s93 offen lds
    s_add_u32 m0, s92, 6144
    s_add_u32 s93, s88, 1572864
    buffer_load_dwordx4 v12, s[16:19], s93 offen lds
    s_add_u32 m0, s92, 7168
    s_add_u32 s93, s88, 1703936
    buffer_load_dwordx4 v12, s[16:19], s93 offen lds
    s_add_u32 m0, s92, 8192
    s_add_u32 s93, s88, 2097152
    buffer_load_dwordx4 v12, s[16:19], s93 offen lds
    s_add_u32 m0, s92, 9216
    s_add_u32 s93, s88, 2228224
    buffer_load_dwordx4 v12, s[16:19], s93 offen lds
    s_add_u32 m0, s92, 10240
    s_add_u32 s93, s88, 2359296
    buffer_load_dwordx4 v12, s[16:19], s93 offen lds
    s_add_u32 m0, s92, 11264
    s_add_u32 s93, s88, 2490368
    buffer_load_dwordx4 v12, s[16:19], s93 offen lds
    s_add_u32 m0, s92, 12288
    s_add_u32 s93, s88, 3145728
    buffer_load_dwordx4 v12, s[16:19], s93 offen lds
    s_add_u32 m0, s92, 13312
    s_add_u32 s93, s88, 3276800
    buffer_load_dwordx4 v12, s[16:19], s93 offen lds
    s_add_u32 m0, s92, 14336
    s_add_u32 s93, s88, 4194304
    buffer_load_dwordx4 v12, s[16:19], s93 offen lds
    s_add_u32 m0, s92, 15360
    s_add_u32 s93, s88, 4325376
    buffer_load_dwordx4 v12, s[16:19], s93 offen lds
    s_add_u32 m0, s92, 16384
    s_add_u32 s93, s88, 3670016
    buffer_load_dwordx4 v12, s[16:19], s93 offen lds
    s_add_u32 m0, s92, 17408
    s_add_u32 s93, s88, 3801088
    buffer_load_dwordx4 v12, s[16:19], s93 offen lds
    s_add_u32 m0, s92, 18432
    s_add_u32 s93, s88, 4718592
    buffer_load_dwordx4 v12, s[16:19], s93 offen lds
    s_add_u32 m0, s92, 19456
    s_add_u32 s93, s88, 4849664
    buffer_load_dwordx4 v12, s[16:19], s93 offen lds
    s_add_u32 m0, s92, 20480
    s_add_u32 s93, s44, 0
    buffer_load_dwordx4 v13, s[28:31], s93 offen lds
    s_add_u32 m0, s92, 21504
    s_add_u32 s93, s44, 20480
    buffer_load_dwordx4 v13, s[28:31], s93 offen lds
    s_add_u32 m0, s92, 22528
    s_add_u32 s93, s44, 40960
    buffer_load_dwordx4 v13, s[28:31], s93 offen lds
    s_add_u32 m0, s92, 23552
    s_add_u32 s93, s44, 61440
    buffer_load_dwordx4 v13, s[28:31], s93 offen lds
    s_add_u32 m0, s92, 24576
    s_add_u32 s93, s44, 81920
    buffer_load_dwordx4 v13, s[28:31], s93 offen lds
    s_add_u32 m0, s92, 25600
    s_add_u32 s93, s44, 102400
    buffer_load_dwordx4 v13, s[28:31], s93 offen lds
    s_add_u32 m0, s92, 26624
    s_add_u32 s93, s44, 122880
    buffer_load_dwordx4 v13, s[28:31], s93 offen lds
    s_add_u32 m0, s92, 27648
    s_add_u32 s93, s44, 143360
    buffer_load_dwordx4 v13, s[28:31], s93 offen lds
    s_waitcnt vmcnt(24)
    ds_read_b64_tr_b16 v[96:97], v14
    ds_read_b64_tr_b16 v[98:99], v14 offset:64
    ds_read_b64_tr_b16 v[100:101], v14 offset:512
    ds_read_b64_tr_b16 v[102:103], v14 offset:576
    ds_read_b64_tr_b16 v[104:105], v14 offset:1024
    ds_read_b64_tr_b16 v[106:107], v14 offset:1088
    ds_read_b64_tr_b16 v[108:109], v14 offset:1536
    ds_read_b64_tr_b16 v[110:111], v14 offset:1600
    s_waitcnt lgkmcnt(0)
    s_add_u32 m0, s92, 28672
    s_add_u32 s93, s44, 81984
    buffer_load_dwordx4 v13, s[28:31], s93 offen lds
    s_add_u32 m0, s92, 29696
    s_add_u32 s93, s44, 102464
    buffer_load_dwordx4 v13, s[28:31], s93 offen lds
    s_add_u32 m0, s92, 30720
    s_add_u32 s93, s44, 122944
    buffer_load_dwordx4 v13, s[28:31], s93 offen lds
    s_add_u32 m0, s92, 31744
    s_add_u32 s93, s44, 143424
    buffer_load_dwordx4 v13, s[28:31], s93 offen lds
    s_waitcnt vmcnt(24)
    ds_read_b64_tr_b16 v[128:129], v14 offset:4096
    ds_read_b64_tr_b16 v[130:131], v14 offset:4160
    ds_read_b64_tr_b16 v[132:133], v14 offset:4608
    ds_read_b64_tr_b16 v[134:135], v14 offset:4672
    ds_read_b64_tr_b16 v[136:137], v14 offset:5120
    ds_read_b64_tr_b16 v[138:139], v14 offset:5184
    ds_read_b64_tr_b16 v[140:141], v14 offset:5632
    ds_read_b64_tr_b16 v[142:143], v14 offset:5696
    s_waitcnt lgkmcnt(0)
    s_add_u32 m0, s92, 0
    s_add_u32 s93, s44, 82048
    buffer_load_dwordx4 v13, s[28:31], s93 offen lds
    s_add_u32 m0, s92, 1024
    s_add_u32 s93, s44, 102528
    buffer_load_dwordx4 v13, s[28:31], s93 offen lds
    s_add_u32 m0, s92, 2048
    s_add_u32 s93, s44, 123008
    buffer_load_dwordx4 v13, s[28:31], s93 offen lds
    s_add_u32 m0, s92, 3072
    s_add_u32 s93, s44, 143488
    buffer_load_dwordx4 v13, s[28:31], s93 offen lds
    s_waitcnt vmcnt(24)
    ds_read_b64_tr_b16 v[160:161], v16 offset:8192
    ds_read_b64_tr_b16 v[162:163], v16 offset:8320
    ds_read_b64_tr_b16 v[164:165], v16 offset:8704
    ds_read_b64_tr_b16 v[166:167], v16 offset:8832
    ds_read_b64_tr_b16 v[168:169], v16 offset:10240
    ds_read_b64_tr_b16 v[170:171], v16 offset:10368
    ds_read_b64_tr_b16 v[172:173], v16 offset:10752
    ds_read_b64_tr_b16 v[174:175], v16 offset:10880
    s_waitcnt lgkmcnt(0)
    s_add_u32 m0, s92, 4096
    s_add_u32 s93, s45, 82688
    buffer_load_dwordx4 v13, s[28:31], s93 offen lds
    s_add_u32 m0, s92, 5120
    s_add_u32 s93, s45, 103168
    buffer_load_dwordx4 v13, s[28:31], s93 offen lds
    s_add_u32 m0, s92, 6144
    s_add_u32 s93, s45, 123648
    buffer_load_dwordx4 v13, s[28:31], s93 offen lds
    s_add_u32 m0, s92, 7168
    s_add_u32 s93, s45, 144128
    buffer_load_dwordx4 v13, s[28:31], s93 offen lds
    s_waitcnt vmcnt(24)
    ds_read_b64_tr_b16 v[208:209], v14 offset:12288
    ds_read_b64_tr_b16 v[210:211], v14 offset:12352
    ds_read_b64_tr_b16 v[212:213], v14 offset:12800
    ds_read_b64_tr_b16 v[214:215], v14 offset:12864
    ds_read_b64_tr_b16 v[216:217], v14 offset:13312
    ds_read_b64_tr_b16 v[218:219], v14 offset:13376
    ds_read_b64_tr_b16 v[220:221], v14 offset:13824
    ds_read_b64_tr_b16 v[222:223], v14 offset:13888
    s_waitcnt lgkmcnt(0)
    s_add_u32 m0, s92, 8192
    s_add_u32 s93, s45, 832
    buffer_load_dwordx4 v13, s[28:31], s93 offen lds
    s_add_u32 m0, s92, 9216
    s_add_u32 s93, s45, 21312
    buffer_load_dwordx4 v13, s[28:31], s93 offen lds
    s_add_u32 m0, s92, 10240
    s_add_u32 s93, s45, 41792
    buffer_load_dwordx4 v13, s[28:31], s93 offen lds
    s_add_u32 m0, s92, 11264
    s_add_u32 s93, s45, 62272
    buffer_load_dwordx4 v13, s[28:31], s93 offen lds
    s_waitcnt vmcnt(24)
    ds_read_b64_tr_b16 a[0:1], v14 offset:16384
    ds_read_b64_tr_b16 a[2:3], v14 offset:16448
    ds_read_b64_tr_b16 a[4:5], v14 offset:16896
    ds_read_b64_tr_b16 a[6:7], v14 offset:16960
    ds_read_b64_tr_b16 a[8:9], v14 offset:17408
    ds_read_b64_tr_b16 a[10:11], v14 offset:17472
    ds_read_b64_tr_b16 a[12:13], v14 offset:17920
    ds_read_b64_tr_b16 a[14:15], v14 offset:17984
    s_waitcnt lgkmcnt(0)
    s_add_u32 m0, s92, 12288
    s_add_u32 s93, s45, 82752
    buffer_load_dwordx4 v13, s[28:31], s93 offen lds
    s_add_u32 m0, s92, 13312
    s_add_u32 s93, s45, 103232
    buffer_load_dwordx4 v13, s[28:31], s93 offen lds
    s_add_u32 m0, s92, 14336
    s_add_u32 s93, s45, 123712
    buffer_load_dwordx4 v13, s[28:31], s93 offen lds
    s_add_u32 m0, s92, 15360
    s_add_u32 s93, s45, 144192
    buffer_load_dwordx4 v13, s[28:31], s93 offen lds
    s_waitcnt vmcnt(24)
    ds_read_b64_tr_b16 a[168:169], v16 offset:20480
    ds_read_b64_tr_b16 a[170:171], v16 offset:20608
    ds_read_b64_tr_b16 a[172:173], v16 offset:20992
    ds_read_b64_tr_b16 a[174:175], v16 offset:21120
    ds_read_b64_tr_b16 a[176:177], v16 offset:22528
    ds_read_b64_tr_b16 a[178:179], v16 offset:22656
    ds_read_b64_tr_b16 a[180:181], v16 offset:23040
    ds_read_b64_tr_b16 a[182:183], v16 offset:23168
    s_waitcnt lgkmcnt(0)
    s_add_u32 m0, s92, 16384
    s_add_u32 s93, s88, 0
    buffer_load_dwordx4 v12, s[20:23], s93 offen lds
    s_add_u32 m0, s92, 17408
    s_add_u32 s93, s88, 131072
    buffer_load_dwordx4 v12, s[20:23], s93 offen lds
    s_add_u32 m0, s92, 18432
    s_add_u32 s93, s88, 1048576
    buffer_load_dwordx4 v12, s[20:23], s93 offen lds
    s_add_u32 m0, s92, 19456
    s_add_u32 s93, s88, 1179648
    buffer_load_dwordx4 v12, s[20:23], s93 offen lds
    s_waitcnt vmcnt(24)
    ds_read_b64_tr_b16 a[184:185], v16 offset:24576
    ds_read_b64_tr_b16 a[186:187], v16 offset:24704
    ds_read_b64_tr_b16 a[188:189], v16 offset:25088
    ds_read_b64_tr_b16 a[190:191], v16 offset:25216
    ds_read_b64_tr_b16 a[192:193], v16 offset:26624
    ds_read_b64_tr_b16 a[194:195], v16 offset:26752
    ds_read_b64_tr_b16 a[196:197], v16 offset:27136
    ds_read_b64_tr_b16 a[198:199], v16 offset:27264
    s_waitcnt lgkmcnt(0)
    s_add_u32 m0, s92, 20480
    s_add_u32 s93, s88, 262144
    buffer_load_dwordx4 v12, s[20:23], s93 offen lds
    s_add_u32 m0, s92, 21504
    s_add_u32 s93, s88, 393216
    buffer_load_dwordx4 v12, s[20:23], s93 offen lds
    s_add_u32 m0, s92, 22528
    s_add_u32 s93, s88, 1310720
    buffer_load_dwordx4 v12, s[20:23], s93 offen lds
    s_add_u32 m0, s92, 23552
    s_add_u32 s93, s88, 1441792
    buffer_load_dwordx4 v12, s[20:23], s93 offen lds
    s_waitcnt vmcnt(24)
    ds_read_b64_tr_b16 a[200:201], v16 offset:28672
    ds_read_b64_tr_b16 a[202:203], v16 offset:28800
    ds_read_b64_tr_b16 a[204:205], v16 offset:29184
    ds_read_b64_tr_b16 a[206:207], v16 offset:29312
    ds_read_b64_tr_b16 a[208:209], v16 offset:30720
    ds_read_b64_tr_b16 a[210:211], v16 offset:30848
    ds_read_b64_tr_b16 a[212:213], v16 offset:31232
    ds_read_b64_tr_b16 a[214:215], v16 offset:31360
    s_waitcnt lgkmcnt(0)
    s_add_u32 m0, s92, 24576
    s_add_u32 s93, s88, 524288
    buffer_load_dwordx4 v12, s[20:23], s93 offen lds
    s_add_u32 m0, s92, 25600
    s_add_u32 s93, s88, 655360
    buffer_load_dwordx4 v12, s[20:23], s93 offen lds
    s_add_u32 m0, s92, 26624
    s_add_u32 s93, s88, 1572864
    buffer_load_dwordx4 v12, s[20:23], s93 offen lds
    s_add_u32 m0, s92, 27648
    s_add_u32 s93, s88, 1703936
    buffer_load_dwordx4 v12, s[20:23], s93 offen lds
    s_waitcnt vmcnt(24)
    ds_read_b64_tr_b16 a[216:217], v16
    ds_read_b64_tr_b16 a[218:219], v16 offset:128
    ds_read_b64_tr_b16 a[220:221], v16 offset:512
    ds_read_b64_tr_b16 a[222:223], v16 offset:640
    ds_read_b64_tr_b16 a[224:225], v16 offset:2048
    ds_read_b64_tr_b16 a[226:227], v16 offset:2176
    ds_read_b64_tr_b16 a[228:229], v16 offset:2560
    ds_read_b64_tr_b16 a[230:231], v16 offset:2688
    s_waitcnt lgkmcnt(0)
    s_add_u32 m0, s92, 28672
    s_add_u32 s93, s88, 786432
    buffer_load_dwordx4 v12, s[20:23], s93 offen lds
    s_add_u32 m0, s92, 29696
    s_add_u32 s93, s88, 917504
    buffer_load_dwordx4 v12, s[20:23], s93 offen lds
    s_add_u32 m0, s92, 30720
    s_add_u32 s93, s88, 1835008
    buffer_load_dwordx4 v12, s[20:23], s93 offen lds
    s_add_u32 m0, s92, 31744
    s_add_u32 s93, s88, 1966080
    buffer_load_dwordx4 v12, s[20:23], s93 offen lds
    s_waitcnt vmcnt(24)
    ds_read_b64_tr_b16 a[232:233], v16 offset:4096
    ds_read_b64_tr_b16 a[234:235], v16 offset:4224
    ds_read_b64_tr_b16 a[236:237], v16 offset:4608
    ds_read_b64_tr_b16 a[238:239], v16 offset:4736
    ds_read_b64_tr_b16 a[240:241], v16 offset:6144
    ds_read_b64_tr_b16 a[242:243], v16 offset:6272
    ds_read_b64_tr_b16 a[244:245], v16 offset:6656
    ds_read_b64_tr_b16 a[246:247], v16 offset:6784
    s_waitcnt lgkmcnt(0)
    s_add_u32 m0, s92, 0
    s_add_u32 s93, s88, 2097152
    buffer_load_dwordx4 v12, s[20:23], s93 offen lds
    s_add_u32 m0, s92, 1024
    s_add_u32 s93, s88, 2228224
    buffer_load_dwordx4 v12, s[20:23], s93 offen lds
    s_add_u32 m0, s92, 2048
    s_add_u32 s93, s88, 2359296
    buffer_load_dwordx4 v12, s[20:23], s93 offen lds
    s_add_u32 m0, s92, 3072
    s_add_u32 s93, s88, 2490368
    buffer_load_dwordx4 v12, s[20:23], s93 offen lds
    s_waitcnt vmcnt(24)
    ds_read_b64_tr_b16 a[248:249], v16 offset:8192
    ds_read_b64_tr_b16 a[250:251], v16 offset:8320
    ds_read_b64_tr_b16 a[252:253], v16 offset:8704
    ds_read_b64_tr_b16 a[254:255], v16 offset:8832
    ds_read_b64_tr_b16 v[36:37], v16 offset:10240
    ds_read_b64_tr_b16 v[38:39], v16 offset:10368
    ds_read_b64_tr_b16 v[40:41], v16 offset:10752
    ds_read_b64_tr_b16 v[42:43], v16 offset:10880
    s_waitcnt lgkmcnt(0)
    s_add_u32 s93, s78, 18432
    buffer_store_dwordx4 v[36:39], v10, s[56:59], s93 offen
    s_add_u32 s93, s78, 19456
    buffer_store_dwordx4 v[40:43], v10, s[56:59], s93 offen
    s_add_u32 m0, s92, 4096
    s_add_u32 s93, s88, 2621440
    buffer_load_dwordx4 v12, s[20:23], s93 offen lds
    s_add_u32 m0, s92, 5120
    s_add_u32 s93, s88, 2752512
    buffer_load_dwordx4 v12, s[20:23], s93 offen lds
    s_add_u32 m0, s92, 6144
    s_add_u32 s93, s88, 2883584
    buffer_load_dwordx4 v12, s[20:23], s93 offen lds
    s_add_u32 m0, s92, 7168
    s_add_u32 s93, s88, 3014656
    buffer_load_dwordx4 v12, s[20:23], s93 offen lds
    s_waitcnt vmcnt(26)
    ds_read_b64_tr_b16 v[44:45], v16 offset:12288
    ds_read_b64_tr_b16 v[46:47], v16 offset:12416
    ds_read_b64_tr_b16 v[48:49], v16 offset:12800
    ds_read_b64_tr_b16 v[50:51], v16 offset:12928
    ds_read_b64_tr_b16 v[52:53], v16 offset:14336
    ds_read_b64_tr_b16 v[54:55], v16 offset:14464
    ds_read_b64_tr_b16 v[56:57], v16 offset:14848
    ds_read_b64_tr_b16 v[58:59], v16 offset:14976
    s_waitcnt lgkmcnt(0)
    s_add_u32 s93, s78, 20480
    buffer_store_dwordx4 v[44:47], v10, s[56:59], s93 offen
    s_add_u32 s93, s78, 21504
    buffer_store_dwordx4 v[48:51], v10, s[56:59], s93 offen
    s_add_u32 s93, s78, 22528
    buffer_store_dwordx4 v[52:55], v10, s[56:59], s93 offen
    s_add_u32 s93, s78, 23552
    buffer_store_dwordx4 v[56:59], v10, s[56:59], s93 offen
    s_add_u32 m0, s92, 8192
    s_add_u32 s93, s88, 3145728
    buffer_load_dwordx4 v12, s[20:23], s93 offen lds
    s_add_u32 m0, s92, 9216
    s_add_u32 s93, s88, 3276800
    buffer_load_dwordx4 v12, s[20:23], s93 offen lds
    s_add_u32 m0, s92, 10240
    s_add_u32 s93, s88, 4194304
    buffer_load_dwordx4 v12, s[20:23], s93 offen lds
    s_add_u32 m0, s92, 11264
    s_add_u32 s93, s88, 4325376
    buffer_load_dwordx4 v12, s[20:23], s93 offen lds
    s_waitcnt vmcnt(30)
    ds_read_b64_tr_b16 v[112:113], v14 offset:16384
    ds_read_b64_tr_b16 v[114:115], v14 offset:16448
    ds_read_b64_tr_b16 v[116:117], v14 offset:16896
    ds_read_b64_tr_b16 v[118:119], v14 offset:16960
    ds_read_b64_tr_b16 v[120:121], v14 offset:17408
    ds_read_b64_tr_b16 v[122:123], v14 offset:17472
    ds_read_b64_tr_b16 v[124:125], v14 offset:17920
    ds_read_b64_tr_b16 v[126:127], v14 offset:17984
    s_waitcnt lgkmcnt(0)
    s_add_u32 m0, s92, 12288
    s_add_u32 s93, s88, 3407872
    buffer_load_dwordx4 v12, s[20:23], s93 offen lds
    s_add_u32 m0, s92, 13312
    s_add_u32 s93, s88, 3538944
    buffer_load_dwordx4 v12, s[20:23], s93 offen lds
    s_add_u32 m0, s92, 14336
    s_add_u32 s93, s88, 4456448
    buffer_load_dwordx4 v12, s[20:23], s93 offen lds
    s_add_u32 m0, s92, 15360
    s_add_u32 s93, s88, 4587520
    buffer_load_dwordx4 v12, s[20:23], s93 offen lds
    s_waitcnt vmcnt(30)
    ds_read_b64_tr_b16 v[44:45], v14 offset:20480
    ds_read_b64_tr_b16 v[46:47], v14 offset:20544
    ds_read_b64_tr_b16 v[48:49], v14 offset:20992
    ds_read_b64_tr_b16 v[50:51], v14 offset:21056
    ds_read_b64_tr_b16 v[52:53], v14 offset:21504
    ds_read_b64_tr_b16 v[54:55], v14 offset:21568
    ds_read_b64_tr_b16 v[56:57], v14 offset:22016
    ds_read_b64_tr_b16 v[58:59], v14 offset:22080
    s_waitcnt lgkmcnt(0)
    s_add_u32 s93, s78, 0
    buffer_store_dwordx4 v[44:47], v10, s[56:59], s93 offen
    s_add_u32 s93, s78, 1024
    buffer_store_dwordx4 v[48:51], v10, s[56:59], s93 offen
    s_add_u32 s93, s78, 2048
    buffer_store_dwordx4 v[52:55], v10, s[56:59], s93 offen
    s_add_u32 s93, s78, 3072
    buffer_store_dwordx4 v[56:59], v10, s[56:59], s93 offen
    s_add_u32 m0, s92, 16384
    s_add_u32 s93, s88, 3670016
    buffer_load_dwordx4 v12, s[20:23], s93 offen lds
    s_add_u32 m0, s92, 17408
    s_add_u32 s93, s88, 3801088
    buffer_load_dwordx4 v12, s[20:23], s93 offen lds
    s_add_u32 m0, s92, 18432
    s_add_u32 s93, s88, 4718592
    buffer_load_dwordx4 v12, s[20:23], s93 offen lds
    s_add_u32 m0, s92, 19456
    s_add_u32 s93, s88, 4849664
    buffer_load_dwordx4 v12, s[20:23], s93 offen lds
    s_waitcnt vmcnt(34)
    ds_read_b64_tr_b16 v[28:29], v14 offset:24576
    ds_read_b64_tr_b16 v[30:31], v14 offset:24640
    ds_read_b64_tr_b16 v[32:33], v14 offset:25088
    ds_read_b64_tr_b16 v[34:35], v14 offset:25152
    ds_read_b64_tr_b16 v[36:37], v14 offset:25600
    ds_read_b64_tr_b16 v[38:39], v14 offset:25664
    ds_read_b64_tr_b16 v[40:41], v14 offset:26112
    ds_read_b64_tr_b16 v[42:43], v14 offset:26176
    s_waitcnt lgkmcnt(0)
    s_add_u32 s93, s78, 4096
    buffer_store_dwordx4 v[28:31], v10, s[56:59], s93 offen
    s_add_u32 s93, s78, 5120
    buffer_store_dwordx4 v[32:35], v10, s[56:59], s93 offen
    s_add_u32 s93, s78, 6144
    buffer_store_dwordx4 v[36:39], v10, s[56:59], s93 offen
    s_add_u32 s93, s78, 7168
    buffer_store_dwordx4 v[40:43], v10, s[56:59], s93 offen
    s_add_u32 m0, s92, 20480
    s_add_u32 s93, s88, 3932160
    buffer_load_dwordx4 v12, s[20:23], s93 offen lds
    s_add_u32 m0, s92, 21504
    s_add_u32 s93, s88, 4063232
    buffer_load_dwordx4 v12, s[20:23], s93 offen lds
    s_add_u32 m0, s92, 22528
    s_add_u32 s93, s88, 4980736
    buffer_load_dwordx4 v12, s[20:23], s93 offen lds
    s_add_u32 m0, s92, 23552
    s_add_u32 s93, s88, 5111808
    buffer_load_dwordx4 v12, s[20:23], s93 offen lds
    s_waitcnt vmcnt(38)
    ds_read_b64_tr_b16 v[144:145], v14 offset:28672
    ds_read_b64_tr_b16 v[146:147], v14 offset:28736
    ds_read_b64_tr_b16 v[148:149], v14 offset:29184
    ds_read_b64_tr_b16 v[150:151], v14 offset:29248
    ds_read_b64_tr_b16 v[152:153], v14 offset:29696
    ds_read_b64_tr_b16 v[154:155], v14 offset:29760
    ds_read_b64_tr_b16 v[156:157], v14 offset:30208
    ds_read_b64_tr_b16 v[158:159], v14 offset:30272
    s_waitcnt lgkmcnt(0)
    s_add_u32 m0, s92, 24576
    s_add_u32 s93, s88, 0
    buffer_load_dwordx4 v12, s[24:27], s93 offen lds
    s_add_u32 m0, s92, 25600
    s_add_u32 s93, s88, 131072
    buffer_load_dwordx4 v12, s[24:27], s93 offen lds
    s_add_u32 m0, s92, 26624
    s_add_u32 s93, s88, 1048576
    buffer_load_dwordx4 v12, s[24:27], s93 offen lds
    s_add_u32 m0, s92, 27648
    s_add_u32 s93, s88, 1179648
    buffer_load_dwordx4 v12, s[24:27], s93 offen lds
    s_waitcnt vmcnt(38)
    ds_read_b64_tr_b16 v[176:177], v16
    ds_read_b64_tr_b16 v[178:179], v16 offset:128
    ds_read_b64_tr_b16 v[180:181], v16 offset:512
    ds_read_b64_tr_b16 v[182:183], v16 offset:640
    ds_read_b64_tr_b16 v[184:185], v16 offset:2048
    ds_read_b64_tr_b16 v[186:187], v16 offset:2176
    ds_read_b64_tr_b16 v[188:189], v16 offset:2560
    ds_read_b64_tr_b16 v[190:191], v16 offset:2688
    s_waitcnt lgkmcnt(0)
    s_add_u32 m0, s92, 28672
    s_add_u32 s93, s88, 262144
    buffer_load_dwordx4 v12, s[24:27], s93 offen lds
    s_add_u32 m0, s92, 29696
    s_add_u32 s93, s88, 393216
    buffer_load_dwordx4 v12, s[24:27], s93 offen lds
    s_add_u32 m0, s92, 30720
    s_add_u32 s93, s88, 1310720
    buffer_load_dwordx4 v12, s[24:27], s93 offen lds
    s_add_u32 m0, s92, 31744
    s_add_u32 s93, s88, 1441792
    buffer_load_dwordx4 v12, s[24:27], s93 offen lds
    s_waitcnt vmcnt(36)
    ds_read_b64_tr_b16 v[192:193], v16 offset:4096
    ds_read_b64_tr_b16 v[194:195], v16 offset:4224
    ds_read_b64_tr_b16 v[196:197], v16 offset:4608
    ds_read_b64_tr_b16 v[198:199], v16 offset:4736
    ds_read_b64_tr_b16 v[200:201], v16 offset:6144
    ds_read_b64_tr_b16 v[202:203], v16 offset:6272
    ds_read_b64_tr_b16 v[204:205], v16 offset:6656
    ds_read_b64_tr_b16 v[206:207], v16 offset:6784
    s_waitcnt lgkmcnt(0)
    s_add_u32 m0, s92, 0
    s_add_u32 s93, s88, 524288
    buffer_load_dwordx4 v12, s[24:27], s93 offen lds
    s_add_u32 m0, s92, 1024
    s_add_u32 s93, s88, 655360
    buffer_load_dwordx4 v12, s[24:27], s93 offen lds
    s_add_u32 m0, s92, 2048
    s_add_u32 s93, s88, 1572864
    buffer_load_dwordx4 v12, s[24:27], s93 offen lds
    s_add_u32 m0, s92, 3072
    s_add_u32 s93, s88, 1703936
    buffer_load_dwordx4 v12, s[24:27], s93 offen lds
    s_waitcnt vmcnt(32)
    ds_read_b64_tr_b16 v[224:225], v14 offset:8192
    ds_read_b64_tr_b16 v[226:227], v14 offset:8256
    ds_read_b64_tr_b16 v[228:229], v14 offset:8704
    ds_read_b64_tr_b16 v[230:231], v14 offset:8768
    ds_read_b64_tr_b16 v[232:233], v14 offset:9216
    ds_read_b64_tr_b16 v[234:235], v14 offset:9280
    ds_read_b64_tr_b16 v[236:237], v14 offset:9728
    ds_read_b64_tr_b16 v[238:239], v14 offset:9792
    s_waitcnt lgkmcnt(0)
    s_add_u32 m0, s92, 4096
    s_add_u32 s93, s88, 786432
    buffer_load_dwordx4 v12, s[24:27], s93 offen lds
    s_add_u32 m0, s92, 5120
    s_add_u32 s93, s88, 917504
    buffer_load_dwordx4 v12, s[24:27], s93 offen lds
    s_add_u32 m0, s92, 6144
    s_add_u32 s93, s88, 1835008
    buffer_load_dwordx4 v12, s[24:27], s93 offen lds
    s_add_u32 m0, s92, 7168
    s_add_u32 s93, s88, 1966080
    buffer_load_dwordx4 v12, s[24:27], s93 offen lds
    s_waitcnt vmcnt(32)
    ds_read_b64_tr_b16 v[240:241], v14 offset:12288
    ds_read_b64_tr_b16 v[242:243], v14 offset:12352
    ds_read_b64_tr_b16 v[244:245], v14 offset:12800
    ds_read_b64_tr_b16 v[246:247], v14 offset:12864
    ds_read_b64_tr_b16 v[248:249], v14 offset:13312
    ds_read_b64_tr_b16 v[250:251], v14 offset:13376
    ds_read_b64_tr_b16 v[252:253], v14 offset:13824
    ds_read_b64_tr_b16 v[254:255], v14 offset:13888
    s_waitcnt lgkmcnt(0)
    s_add_u32 m0, s92, 8192
    s_add_u32 s93, s88, 2097152
    buffer_load_dwordx4 v12, s[24:27], s93 offen lds
    s_add_u32 m0, s92, 9216
    s_add_u32 s93, s88, 2228224
    buffer_load_dwordx4 v12, s[24:27], s93 offen lds
    s_add_u32 m0, s92, 10240
    s_add_u32 s93, s88, 2359296
    buffer_load_dwordx4 v12, s[24:27], s93 offen lds
    s_add_u32 m0, s92, 11264
    s_add_u32 s93, s88, 2490368
    buffer_load_dwordx4 v12, s[24:27], s93 offen lds
    s_waitcnt vmcnt(28)
    ds_read_b64_tr_b16 v[28:29], v14 offset:16384
    ds_read_b64_tr_b16 v[30:31], v14 offset:16448
    ds_read_b64_tr_b16 v[32:33], v14 offset:16896
    ds_read_b64_tr_b16 v[34:35], v14 offset:16960
    ds_read_b64_tr_b16 v[36:37], v14 offset:17408
    ds_read_b64_tr_b16 v[38:39], v14 offset:17472
    ds_read_b64_tr_b16 v[40:41], v14 offset:17920
    ds_read_b64_tr_b16 v[42:43], v14 offset:17984
    s_waitcnt lgkmcnt(0)
    s_add_u32 s93, s78, 8192
    buffer_store_dwordx4 v[28:31], v10, s[56:59], s93 offen
    s_add_u32 s93, s78, 9216
    buffer_store_dwordx4 v[32:35], v10, s[56:59], s93 offen
    s_add_u32 s93, s78, 10240
    buffer_store_dwordx4 v[36:39], v10, s[56:59], s93 offen
    s_add_u32 s93, s78, 11264
    buffer_store_dwordx4 v[40:43], v10, s[56:59], s93 offen
    s_add_u32 m0, s92, 12288
    s_add_u32 s93, s88, 2621440
    buffer_load_dwordx4 v12, s[24:27], s93 offen lds
    s_add_u32 m0, s92, 13312
    s_add_u32 s93, s88, 2752512
    buffer_load_dwordx4 v12, s[24:27], s93 offen lds
    s_add_u32 m0, s92, 14336
    s_add_u32 s93, s88, 2883584
    buffer_load_dwordx4 v12, s[24:27], s93 offen lds
    s_add_u32 m0, s92, 15360
    s_add_u32 s93, s88, 3014656
    buffer_load_dwordx4 v12, s[24:27], s93 offen lds
    s_waitcnt vmcnt(28)
    ds_read_b64_tr_b16 v[44:45], v14 offset:20480
    ds_read_b64_tr_b16 v[46:47], v14 offset:20544
    ds_read_b64_tr_b16 v[48:49], v14 offset:20992
    ds_read_b64_tr_b16 v[50:51], v14 offset:21056
    ds_read_b64_tr_b16 v[52:53], v14 offset:21504
    ds_read_b64_tr_b16 v[54:55], v14 offset:21568
    ds_read_b64_tr_b16 v[56:57], v14 offset:22016
    ds_read_b64_tr_b16 v[58:59], v14 offset:22080
    s_waitcnt lgkmcnt(0)
    s_add_u32 s93, s78, 12288
    buffer_store_dwordx4 v[44:47], v10, s[56:59], s93 offen
    s_add_u32 s93, s78, 13312
    buffer_store_dwordx4 v[48:51], v10, s[56:59], s93 offen
    s_add_u32 s93, s78, 14336
    buffer_store_dwordx4 v[52:55], v10, s[56:59], s93 offen
    s_add_u32 s93, s78, 15360
    buffer_store_dwordx4 v[56:59], v10, s[56:59], s93 offen
    s_add_u32 m0, s92, 16384
    s_add_u32 s93, s88, 3145728
    buffer_load_dwordx4 v12, s[24:27], s93 offen lds
    s_add_u32 m0, s92, 17408
    s_add_u32 s93, s88, 3276800
    buffer_load_dwordx4 v12, s[24:27], s93 offen lds
    s_add_u32 m0, s92, 18432
    s_add_u32 s93, s88, 4194304
    buffer_load_dwordx4 v12, s[24:27], s93 offen lds
    s_add_u32 m0, s92, 19456
    s_add_u32 s93, s88, 4325376
    buffer_load_dwordx4 v12, s[24:27], s93 offen lds
    s_waitcnt vmcnt(32)
    ds_read_b64_tr_b16 a[16:17], v14 offset:24576
    ds_read_b64_tr_b16 a[18:19], v14 offset:24640
    ds_read_b64_tr_b16 a[20:21], v14 offset:25088
    ds_read_b64_tr_b16 a[22:23], v14 offset:25152
    ds_read_b64_tr_b16 a[24:25], v14 offset:25600
    ds_read_b64_tr_b16 a[26:27], v14 offset:25664
    ds_read_b64_tr_b16 a[28:29], v14 offset:26112
    ds_read_b64_tr_b16 a[30:31], v14 offset:26176
    s_waitcnt lgkmcnt(0)
    s_add_u32 m0, s92, 20480
    s_add_u32 s93, s88, 3407872
    buffer_load_dwordx4 v12, s[24:27], s93 offen lds
    s_add_u32 m0, s92, 21504
    s_add_u32 s93, s88, 3538944
    buffer_load_dwordx4 v12, s[24:27], s93 offen lds
    s_add_u32 m0, s92, 22528
    s_add_u32 s93, s88, 4456448
    buffer_load_dwordx4 v12, s[24:27], s93 offen lds
    s_add_u32 m0, s92, 23552
    s_add_u32 s93, s88, 4587520
    buffer_load_dwordx4 v12, s[24:27], s93 offen lds
    s_waitcnt vmcnt(32)
    ds_read_b64_tr_b16 a[32:33], v14 offset:28672
    ds_read_b64_tr_b16 a[34:35], v14 offset:28736
    ds_read_b64_tr_b16 a[36:37], v14 offset:29184
    ds_read_b64_tr_b16 a[38:39], v14 offset:29248
    ds_read_b64_tr_b16 a[40:41], v14 offset:29696
    ds_read_b64_tr_b16 a[42:43], v14 offset:29760
    ds_read_b64_tr_b16 a[44:45], v14 offset:30208
    ds_read_b64_tr_b16 a[46:47], v14 offset:30272
    s_waitcnt lgkmcnt(0)
    s_add_u32 m0, s92, 24576
    s_add_u32 s93, s88, 3670016
    buffer_load_dwordx4 v12, s[24:27], s93 offen lds
    s_add_u32 m0, s92, 25600
    s_add_u32 s93, s88, 3801088
    buffer_load_dwordx4 v12, s[24:27], s93 offen lds
    s_add_u32 m0, s92, 26624
    s_add_u32 s93, s88, 4718592
    buffer_load_dwordx4 v12, s[24:27], s93 offen lds
    s_add_u32 m0, s92, 27648
    s_add_u32 s93, s88, 4849664
    buffer_load_dwordx4 v12, s[24:27], s93 offen lds
    s_waitcnt vmcnt(32)
    ds_read_b64_tr_b16 a[48:49], v14
    ds_read_b64_tr_b16 a[50:51], v14 offset:64
    ds_read_b64_tr_b16 a[52:53], v14 offset:512
    ds_read_b64_tr_b16 a[54:55], v14 offset:576
    ds_read_b64_tr_b16 a[56:57], v14 offset:1024
    ds_read_b64_tr_b16 a[58:59], v14 offset:1088
    ds_read_b64_tr_b16 a[60:61], v14 offset:1536
    ds_read_b64_tr_b16 a[62:63], v14 offset:1600
    s_waitcnt lgkmcnt(0)
    s_add_u32 m0, s92, 28672
    s_add_u32 s93, s88, 3932160
    buffer_load_dwordx4 v12, s[24:27], s93 offen lds
    s_add_u32 m0, s92, 29696
    s_add_u32 s93, s88, 4063232
    buffer_load_dwordx4 v12, s[24:27], s93 offen lds
    s_add_u32 m0, s92, 30720
    s_add_u32 s93, s88, 4980736
    buffer_load_dwordx4 v12, s[24:27], s93 offen lds
    s_add_u32 m0, s92, 31744
    s_add_u32 s93, s88, 5111808
    buffer_load_dwordx4 v12, s[24:27], s93 offen lds
    s_waitcnt vmcnt(32)
    ds_read_b64_tr_b16 a[64:65], v14 offset:4096
    ds_read_b64_tr_b16 a[66:67], v14 offset:4160
    ds_read_b64_tr_b16 a[68:69], v14 offset:4608
    ds_read_b64_tr_b16 a[70:71], v14 offset:4672
    ds_read_b64_tr_b16 a[72:73], v14 offset:5120
    ds_read_b64_tr_b16 a[74:75], v14 offset:5184
    ds_read_b64_tr_b16 a[76:77], v14 offset:5632
    ds_read_b64_tr_b16 a[78:79], v14 offset:5696
    s_waitcnt lgkmcnt(0)
    s_add_u32 m0, s92, 0
    s_add_u32 s93, s88, 262144
    buffer_load_dwordx4 v12, s[16:19], s93 offen lds
    s_add_u32 m0, s92, 1024
    s_add_u32 s93, s88, 393216
    buffer_load_dwordx4 v12, s[16:19], s93 offen lds
    s_add_u32 m0, s92, 2048
    s_add_u32 s93, s88, 1310720
    buffer_load_dwordx4 v12, s[16:19], s93 offen lds
    s_add_u32 m0, s92, 3072
    s_add_u32 s93, s88, 1441792
    buffer_load_dwordx4 v12, s[16:19], s93 offen lds
    s_waitcnt vmcnt(32)
    ds_read_b64_tr_b16 a[80:81], v16 offset:8192
    ds_read_b64_tr_b16 a[82:83], v16 offset:8320
    ds_read_b64_tr_b16 a[84:85], v16 offset:8704
    ds_read_b64_tr_b16 a[86:87], v16 offset:8832
    ds_read_b64_tr_b16 a[88:89], v16 offset:10240
    ds_read_b64_tr_b16 a[90:91], v16 offset:10368
    ds_read_b64_tr_b16 a[92:93], v16 offset:10752
    ds_read_b64_tr_b16 a[94:95], v16 offset:10880
    s_waitcnt lgkmcnt(0)
    s_add_u32 m0, s92, 4096
    s_add_u32 s93, s88, 786432
    buffer_load_dwordx4 v12, s[16:19], s93 offen lds
    s_add_u32 m0, s92, 5120
    s_add_u32 s93, s88, 917504
    buffer_load_dwordx4 v12, s[16:19], s93 offen lds
    s_add_u32 m0, s92, 6144
    s_add_u32 s93, s88, 1835008
    buffer_load_dwordx4 v12, s[16:19], s93 offen lds
    s_add_u32 m0, s92, 7168
    s_add_u32 s93, s88, 1966080
    buffer_load_dwordx4 v12, s[16:19], s93 offen lds
    s_waitcnt vmcnt(28)
    ds_read_b64_tr_b16 a[96:97], v16 offset:12288
    ds_read_b64_tr_b16 a[98:99], v16 offset:12416
    ds_read_b64_tr_b16 a[100:101], v16 offset:12800
    ds_read_b64_tr_b16 a[102:103], v16 offset:12928
    ds_read_b64_tr_b16 a[104:105], v16 offset:14336
    ds_read_b64_tr_b16 a[106:107], v16 offset:14464
    ds_read_b64_tr_b16 a[108:109], v16 offset:14848
    ds_read_b64_tr_b16 a[110:111], v16 offset:14976
    s_waitcnt lgkmcnt(0)
    s_add_u32 m0, s92, 8192
    s_add_u32 s93, s88, 2621440
    buffer_load_dwordx4 v12, s[16:19], s93 offen lds
    s_add_u32 m0, s92, 9216
    s_add_u32 s93, s88, 2752512
    buffer_load_dwordx4 v12, s[16:19], s93 offen lds
    s_add_u32 m0, s92, 10240
    s_add_u32 s93, s88, 2883584
    buffer_load_dwordx4 v12, s[16:19], s93 offen lds
    s_add_u32 m0, s92, 11264
    s_add_u32 s93, s88, 3014656
    buffer_load_dwordx4 v12, s[16:19], s93 offen lds
    s_waitcnt vmcnt(24)
    ds_read_b64_tr_b16 a[112:113], v14 offset:16384
    ds_read_b64_tr_b16 a[114:115], v14 offset:16448
    ds_read_b64_tr_b16 a[116:117], v14 offset:16896
    ds_read_b64_tr_b16 a[118:119], v14 offset:16960
    ds_read_b64_tr_b16 a[120:121], v14 offset:17408
    ds_read_b64_tr_b16 a[122:123], v14 offset:17472
    ds_read_b64_tr_b16 a[124:125], v14 offset:17920
    ds_read_b64_tr_b16 a[126:127], v14 offset:17984
    s_waitcnt lgkmcnt(0)
    s_add_u32 m0, s92, 12288
    s_add_u32 s93, s88, 3407872
    buffer_load_dwordx4 v12, s[16:19], s93 offen lds
    s_add_u32 m0, s92, 13312
    s_add_u32 s93, s88, 3538944
    buffer_load_dwordx4 v12, s[16:19], s93 offen lds
    s_add_u32 m0, s92, 14336
    s_add_u32 s93, s88, 4456448
    buffer_load_dwordx4 v12, s[16:19], s93 offen lds
    s_add_u32 m0, s92, 15360
    s_add_u32 s93, s88, 4587520
    buffer_load_dwordx4 v12, s[16:19], s93 offen lds
    s_waitcnt vmcnt(24)
    ds_read_b64_tr_b16 a[128:129], v14 offset:20480
    ds_read_b64_tr_b16 a[130:131], v14 offset:20544
    ds_read_b64_tr_b16 a[132:133], v14 offset:20992
    ds_read_b64_tr_b16 a[134:135], v14 offset:21056
    ds_read_b64_tr_b16 a[136:137], v14 offset:21504
    ds_read_b64_tr_b16 a[138:139], v14 offset:21568
    ds_read_b64_tr_b16 a[140:141], v14 offset:22016
    ds_read_b64_tr_b16 a[142:143], v14 offset:22080
    s_waitcnt lgkmcnt(0)
    s_add_u32 m0, s92, 16384
    s_add_u32 s93, s88, 3932160
    buffer_load_dwordx4 v12, s[16:19], s93 offen lds
    s_add_u32 m0, s92, 17408
    s_add_u32 s93, s88, 4063232
    buffer_load_dwordx4 v12, s[16:19], s93 offen lds
    s_add_u32 m0, s92, 18432
    s_add_u32 s93, s88, 4980736
    buffer_load_dwordx4 v12, s[16:19], s93 offen lds
    s_add_u32 m0, s92, 19456
    s_add_u32 s93, s88, 5111808
    buffer_load_dwordx4 v12, s[16:19], s93 offen lds
    s_waitcnt vmcnt(24)
    ds_read_b64_tr_b16 a[144:145], v14 offset:24576
    ds_read_b64_tr_b16 a[146:147], v14 offset:24640
    ds_read_b64_tr_b16 a[148:149], v14 offset:25088
    ds_read_b64_tr_b16 a[150:151], v14 offset:25152
    ds_read_b64_tr_b16 a[152:153], v14 offset:25600
    ds_read_b64_tr_b16 a[154:155], v14 offset:25664
    ds_read_b64_tr_b16 a[156:157], v14 offset:26112
    ds_read_b64_tr_b16 a[158:159], v14 offset:26176
    s_waitcnt lgkmcnt(0)
    s_add_u32 m0, s92, 20480
    s_add_u32 s93, s44, 64
    buffer_load_dwordx4 v13, s[28:31], s93 offen lds
    s_add_u32 m0, s92, 21504
    s_add_u32 s93, s44, 20544
    buffer_load_dwordx4 v13, s[28:31], s93 offen lds
    s_add_u32 m0, s92, 22528
    s_add_u32 s93, s44, 41024
    buffer_load_dwordx4 v13, s[28:31], s93 offen lds
    s_add_u32 m0, s92, 23552
    s_add_u32 s93, s44, 61504
    buffer_load_dwordx4 v13, s[28:31], s93 offen lds
    s_waitcnt vmcnt(24)
    ds_read_b64_tr_b16 a[160:161], v14 offset:28672
    ds_read_b64_tr_b16 a[162:163], v14 offset:28736
    ds_read_b64_tr_b16 a[164:165], v14 offset:29184
    ds_read_b64_tr_b16 a[166:167], v14 offset:29248
    ds_read_b64_tr_b16 v[52:53], v14 offset:29696
    ds_read_b64_tr_b16 v[54:55], v14 offset:29760
    ds_read_b64_tr_b16 v[56:57], v14 offset:30208
    ds_read_b64_tr_b16 v[58:59], v14 offset:30272
    s_waitcnt lgkmcnt(0)
    s_add_u32 s93, s78, 16384
    buffer_store_dwordx4 v[52:55], v10, s[56:59], s93 offen
    s_add_u32 s93, s78, 17408
    buffer_store_dwordx4 v[56:59], v10, s[56:59], s93 offen
    s_add_u32 m0, s92, 24576
    s_add_u32 s93, s44, 128
    buffer_load_dwordx4 v13, s[28:31], s93 offen lds
    s_add_u32 m0, s92, 25600
    s_add_u32 s93, s44, 20608
    buffer_load_dwordx4 v13, s[28:31], s93 offen lds
    s_add_u32 m0, s92, 26624
    s_add_u32 s93, s44, 41088
    buffer_load_dwordx4 v13, s[28:31], s93 offen lds
    s_add_u32 m0, s92, 27648
    s_add_u32 s93, s44, 61568
    buffer_load_dwordx4 v13, s[28:31], s93 offen lds
    s_waitcnt vmcnt(26)
    ds_read_b64_tr_b16 v[28:29], v14
    ds_read_b64_tr_b16 v[30:31], v14 offset:64
    ds_read_b64_tr_b16 v[32:33], v14 offset:512
    ds_read_b64_tr_b16 v[34:35], v14 offset:576
    ds_read_b64_tr_b16 v[36:37], v14 offset:1024
    ds_read_b64_tr_b16 v[38:39], v14 offset:1088
    ds_read_b64_tr_b16 v[40:41], v14 offset:1536
    ds_read_b64_tr_b16 v[42:43], v14 offset:1600
    s_waitcnt lgkmcnt(0)
    ds_write_b128 v1, v[28:31]
    ds_write_b128 v1, v[32:35] offset:1024
    ds_write_b128 v1, v[36:39] offset:2048
    ds_write_b128 v1, v[40:43] offset:3072
    s_add_u32 m0, s92, 28672
    s_add_u32 s93, s45, 768
    buffer_load_dwordx4 v13, s[28:31], s93 offen lds
    s_add_u32 m0, s92, 29696
    s_add_u32 s93, s45, 21248
    buffer_load_dwordx4 v13, s[28:31], s93 offen lds
    s_add_u32 m0, s92, 30720
    s_add_u32 s93, s45, 41728
    buffer_load_dwordx4 v13, s[28:31], s93 offen lds
    s_add_u32 m0, s92, 31744
    s_add_u32 s93, s45, 62208
    buffer_load_dwordx4 v13, s[28:31], s93 offen lds
    s_waitcnt vmcnt(26)
    ds_read_b64_tr_b16 v[44:45], v14 offset:4096
    ds_read_b64_tr_b16 v[46:47], v14 offset:4160
    ds_read_b64_tr_b16 v[48:49], v14 offset:4608
    ds_read_b64_tr_b16 v[50:51], v14 offset:4672
    ds_read_b64_tr_b16 v[52:53], v14 offset:5120
    ds_read_b64_tr_b16 v[54:55], v14 offset:5184
    ds_read_b64_tr_b16 v[56:57], v14 offset:5632
    ds_read_b64_tr_b16 v[58:59], v14 offset:5696
    s_waitcnt lgkmcnt(0)
    ds_write_b128 v1, v[44:47] offset:4096
    ds_write_b128 v1, v[48:51] offset:5120
    ds_write_b128 v1, v[52:55] offset:6144
    ds_write_b128 v1, v[56:59] offset:7168
    s_waitcnt vmcnt(22)
    ds_read_b64_tr_b16 v[28:29], v16 offset:8192
    ds_read_b64_tr_b16 v[30:31], v16 offset:8320
    ds_read_b64_tr_b16 v[32:33], v16 offset:8704
    ds_read_b64_tr_b16 v[34:35], v16 offset:8832
    ds_read_b64_tr_b16 v[36:37], v16 offset:10240
    ds_read_b64_tr_b16 v[38:39], v16 offset:10368
    ds_read_b64_tr_b16 v[40:41], v16 offset:10752
    ds_read_b64_tr_b16 v[42:43], v16 offset:10880
    s_waitcnt lgkmcnt(0)
    ds_write_b128 v1, v[28:31] offset:8192
    ds_write_b128 v1, v[32:35] offset:9216
    ds_write_b128 v1, v[36:39] offset:10240
    ds_write_b128 v1, v[40:43] offset:11264
    s_waitcnt vmcnt(18)
    ds_read_b64_tr_b16 v[44:45], v14 offset:12288
    ds_read_b64_tr_b16 v[46:47], v14 offset:12352
    ds_read_b64_tr_b16 v[48:49], v14 offset:12800
    ds_read_b64_tr_b16 v[50:51], v14 offset:12864
    ds_read_b64_tr_b16 v[52:53], v14 offset:13312
    ds_read_b64_tr_b16 v[54:55], v14 offset:13376
    ds_read_b64_tr_b16 v[56:57], v14 offset:13824
    ds_read_b64_tr_b16 v[58:59], v14 offset:13888
    s_waitcnt lgkmcnt(0)
    ds_write_b128 v1, v[44:47] offset:12288
    ds_write_b128 v1, v[48:51] offset:13312
    ds_write_b128 v1, v[52:55] offset:14336
    ds_write_b128 v1, v[56:59] offset:15360
    s_waitcnt vmcnt(14)
    ds_read_b64_tr_b16 v[28:29], v14 offset:16384
    ds_read_b64_tr_b16 v[30:31], v14 offset:16448
    ds_read_b64_tr_b16 v[32:33], v14 offset:16896
    ds_read_b64_tr_b16 v[34:35], v14 offset:16960
    ds_read_b64_tr_b16 v[36:37], v14 offset:17408
    ds_read_b64_tr_b16 v[38:39], v14 offset:17472
    ds_read_b64_tr_b16 v[40:41], v14 offset:17920
    ds_read_b64_tr_b16 v[42:43], v14 offset:17984
    s_waitcnt lgkmcnt(0)
    ds_write_b128 v1, v[28:31] offset:16384
    ds_write_b128 v1, v[32:35] offset:17408
    ds_write_b128 v1, v[36:39] offset:18432
    ds_write_b128 v1, v[40:43] offset:19456
    s_waitcnt vmcnt(10)
    ds_read_b64_tr_b16 v[44:45], v16 offset:20480
    ds_read_b64_tr_b16 v[46:47], v16 offset:20608
    ds_read_b64_tr_b16 v[48:49], v16 offset:20992
    ds_read_b64_tr_b16 v[50:51], v16 offset:21120
    ds_read_b64_tr_b16 v[52:53], v16 offset:22528
    ds_read_b64_tr_b16 v[54:55], v16 offset:22656
    ds_read_b64_tr_b16 v[56:57], v16 offset:23040
    ds_read_b64_tr_b16 v[58:59], v16 offset:23168
    s_waitcnt lgkmcnt(0)
    ds_write_b128 v1, v[44:47] offset:20480
    ds_write_b128 v1, v[48:51] offset:21504
    ds_write_b128 v1, v[52:55] offset:22528
    ds_write_b128 v1, v[56:59] offset:23552
    s_waitcnt vmcnt(4)
    ds_read_b64_tr_b16 v[28:29], v16 offset:24576
    ds_read_b64_tr_b16 v[30:31], v16 offset:24704
    ds_read_b64_tr_b16 v[32:33], v16 offset:25088
    ds_read_b64_tr_b16 v[34:35], v16 offset:25216
    ds_read_b64_tr_b16 v[36:37], v16 offset:26624
    ds_read_b64_tr_b16 v[38:39], v16 offset:26752
    ds_read_b64_tr_b16 v[40:41], v16 offset:27136
    ds_read_b64_tr_b16 v[42:43], v16 offset:27264
    s_waitcnt lgkmcnt(0)
    ds_write_b128 v1, v[28:31] offset:24576
    ds_write_b128 v1, v[32:35] offset:25600
    ds_write_b128 v1, v[36:39] offset:26624
    ds_write_b128 v1, v[40:43] offset:27648
    s_waitcnt vmcnt(0)
    ds_read_b64_tr_b16 v[44:45], v16 offset:28672
    ds_read_b64_tr_b16 v[46:47], v16 offset:28800
    ds_read_b64_tr_b16 v[48:49], v16 offset:29184
    ds_read_b64_tr_b16 v[50:51], v16 offset:29312
    ds_read_b64_tr_b16 v[52:53], v16 offset:30720
    ds_read_b64_tr_b16 v[54:55], v16 offset:30848
    ds_read_b64_tr_b16 v[56:57], v16 offset:31232
    ds_read_b64_tr_b16 v[58:59], v16 offset:31360
    s_waitcnt lgkmcnt(0)
    ds_write_b128 v1, v[44:47] offset:28672
    ds_write_b128 v1, v[48:51] offset:29696
    ds_write_b128 v1, v[52:55] offset:30720
    ds_write_b128 v1, v[56:59] offset:31744
    s_waitcnt vmcnt(0) lgkmcnt(0)
    s_mov_b32 s47, 0
    s_mov_b32 s86, 0
    s_mov_b32 s87, 94372864
    v_and_b32 v53, 240, v10
    v_lshlrev_b32 v53, 3, v53
L_kvw1:
    s_bitcmp1_b32 s47, s86
    s_cbranch_scc1 L_kvw1d
    buffer_load_dword v52, v53, s[56:59], s87 offen sc1
    s_waitcnt vmcnt(0)
    v_bfe_u32 v52, v52, 5, 6
    v_cmp_le_u32 vcc, 16, v52
    s_and_b32 s47, vcc_lo, 65535
    s_bitcmp1_b32 s47, s86
    s_cbranch_scc1 L_kvw1d
    s_sleep 4
    s_branch L_kvw1
L_kvw1d:
    v_mov_b32 v16, 94371968
L_arr:
    buffer_load_dwordx2 v[12:13], v16, s[56:59], 0 offen sc1
    s_waitcnt vmcnt(0)
    v_cmp_gt_u32 vcc, 32, v12
    s_cbranch_vccnz L_arr
    v_readfirstlane_b32 s6, v13
    s_lshl_b32 s86, s60, 2
    s_add_u32 s86, s86, s61
    s_lshl_b32 s87, s86, 7
    s_add_u32 s87, s87, 94404608
    s_cmp_eq_u32 s86, 3
    s_cselect_b32 s46, 94372224, s87
    v_lshrrev_b32 v76, 1, v0
    v_and_b32 v77, 1, v0
    s_movk_i32 s86, 5120
    v_mul_lo_u32 v78, v77, s86
    v_lshl_add_u32 v78, v76, 1, v78
    v_mov_b32 v12, 0
    v_mov_b32 v13, 0
    v_mov_b32 v14, 0
    v_mov_b32 v15, 0
    v_mov_b32 v16, 0
    v_mov_b32 v17, 0
    v_mov_b32 v18, 0
    v_mov_b32 v19, 0
    v_mov_b32 v20, 0
    v_mov_b32 v21, 0
    v_mov_b32 v22, 0
    v_mov_b32 v23, 0
    v_mov_b32 v88, 0
    v_mov_b32 v89, 0
    v_mov_b32 v90, 0
    v_mov_b32 v91, 0
    v_mov_b32 v92, 0
    v_mov_b32 v93, 0
    v_mov_b32 v94, 0
    v_mov_b32 v95, 0
    s_movk_i32 s87, 0
    buffer_load_short_d16_hi v12, v78, s[12:15], s87 offen
    buffer_load_short_d16_hi v16, v78, s[12:15], s87 offen offset:256
    buffer_load_short_d16_hi v20, v78, s[12:15], s87 offen offset:512
    buffer_load_short_d16_hi v88, v78, s[12:15], s87 offen offset:768
    buffer_load_short_d16_hi v92, v78, s[12:15], s87 offen offset:1024
    s_movk_i32 s87, 1280
    buffer_load_short_d16_hi v13, v78, s[12:15], s87 offen
    buffer_load_short_d16_hi v17, v78, s[12:15], s87 offen offset:256
    buffer_load_short_d16_hi v21, v78, s[12:15], s87 offen offset:512
    buffer_load_short_d16_hi v89, v78, s[12:15], s87 offen offset:768
    buffer_load_short_d16_hi v93, v78, s[12:15], s87 offen offset:1024
    s_movk_i32 s87, 2560
    buffer_load_short_d16_hi v14, v78, s[12:15], s87 offen
    buffer_load_short_d16_hi v18, v78, s[12:15], s87 offen offset:256
    buffer_load_short_d16_hi v22, v78, s[12:15], s87 offen offset:512
    buffer_load_short_d16_hi v90, v78, s[12:15], s87 offen offset:768
    buffer_load_short_d16_hi v94, v78, s[12:15], s87 offen offset:1024
    s_movk_i32 s87, 3840
    buffer_load_short_d16_hi v15, v78, s[12:15], s87 offen
    buffer_load_short_d16_hi v19, v78, s[12:15], s87 offen offset:256
    buffer_load_short_d16_hi v23, v78, s[12:15], s87 offen offset:512
    buffer_load_short_d16_hi v91, v78, s[12:15], s87 offen offset:768
    buffer_load_short_d16_hi v95, v78, s[12:15], s87 offen offset:1024
    buffer_load_dwordx4 v[56:59], v10, s[56:59], s32 offen
    buffer_load_dwordx4 v[60:63], v10, s[56:59], s32 offen offset:1024
    buffer_load_dwordx4 v[64:67], v10, s[56:59], s32 offen offset:2048
    buffer_load_dwordx4 v[68:71], v10, s[56:59], s32 offen offset:3072
    buffer_load_dwordx4 v[72:75], v10, s[56:59], s33 offen
    buffer_load_dwordx4 v[76:79], v10, s[56:59], s33 offen offset:1024
    buffer_load_dwordx4 v[80:83], v10, s[56:59], s33 offen offset:2048
    buffer_load_dwordx4 v[84:87], v10, s[56:59], s33 offen offset:3072
    s_waitcnt vmcnt(0)
    v_subrev_u32 v48, 131072, v7
    v_and_b32 v44, 496, v48
    v_bfe_u32 v49, v48, 2, 2
    v_lshl_add_u32 v44, v49, 1, v44
    v_bfe_u32 v49, v48, 9, 1
    v_lshl_add_u32 v44, v49, 3, v44
    v_lshrrev_b32 v49, 10, v48
    v_lshl_add_u32 v44, v49, 9, v44
    v_add_u32 v44, 135168, v44
    v_xor_b32 v41, 16, v7
    v_xor_b32 v45, 16, v44
    v_xor_b32 v42, 32, v7
    v_xor_b32 v46, 32, v44
    v_xor_b32 v43, 48, v7
    v_xor_b32 v47, 48, v44
    v_perm_b32 v32, v16, v12, s95
    ds_write_b32 v7, v32
    ds_write_b16_d16_hi v44, v20
    v_perm_b32 v33, v17, v13, s95
    ds_write_b32 v41, v33
    ds_write_b16_d16_hi v45, v21
    v_perm_b32 v34, v18, v14, s95
    ds_write_b32 v42, v34
    ds_write_b16_d16_hi v46, v22
    v_perm_b32 v35, v19, v15, s95
    ds_write_b32 v43, v35
    ds_write_b16_d16_hi v47, v23
    s_add_u32 m0, s40, 141312
    s_add_u32 s87, s79, s40
    buffer_load_dwordx4 v10, s[56:59], s87 offen sc1 lds
    buffer_load_dwordx4 v10, s[56:59], s87 offen offset:1024 sc1 lds
    s_add_u32 m0, s40, 149504
    s_add_u32 s87, s81, s40
    buffer_load_dwordx4 v10, s[56:59], s87 offen sc1 lds
    buffer_load_dwordx4 v10, s[56:59], s87 offen offset:1024 sc1 lds
    s_sub_u32 s86, s62, 2
    v_mov_b32 v36, s86
    v_mov_b32 v37, 0
    s_mov_b64 exec, 1
    buffer_store_dword v36, v37, s[56:59], s46 offen sc1
    s_mov_b64 exec, -1
    s_bcnt1_i32_b32 s86, s6
    s_cmp_lg_u32 s86, 1
    s_cbranch_scc1 L_slow
L_f_top:
    v_mov_b64 v[12:13], 0
    v_mov_b64 v[14:15], 0
    v_mov_b64 v[16:17], 0
    v_mov_b64 v[18:19], 0
    v_mov_b64 v[20:21], 0
    v_mov_b64 v[22:23], 0
    s_waitcnt lgkmcnt(0)
    s_barrier
    ds_read_b128 v[24:27], v2
    ds_read_b128 v[28:31], v2 offset:512
    ds_read_b128 v[32:35], v2 offset:1024
    ds_read_b128 v[36:39], v2 offset:1536
    ds_read_b128 v[40:43], v1
    ds_read_b128 v[44:47], v1 offset:1024
    ds_read_b128 v[48:51], v1 offset:2048
    ds_read_b128 v[52:55], v1 offset:3072
    s_waitcnt lgkmcnt(7)
    v_smfmac_f32_16x16x64_bf16 v[12:15], v[24:27], v[96:103], v11
    v_smfmac_f32_16x16x64_bf16 v[16:19], v[24:27], v[112:119], v11
    v_smfmac_f32_16x16x64_bf16 v[20:23], v[24:27], a[16:23], v11
    ds_read_b128 v[24:27], v2 offset:2048
    s_waitcnt lgkmcnt(7)
    v_smfmac_f32_16x16x64_bf16 v[12:15], v[28:31], v[104:111], v11
    v_smfmac_f32_16x16x64_bf16 v[16:19], v[28:31], v[120:127], v11
    v_smfmac_f32_16x16x64_bf16 v[20:23], v[28:31], a[24:31], v11
    ds_read_b128 v[28:31], v2 offset:2560
    s_waitcnt lgkmcnt(4)
    v_smfmac_f32_16x16x64_bf16 v[12:15], v[32:35], v[40:47], v11
    ds_read_b128 v[40:43], v1 offset:4096
    ds_read_b128 v[44:47], v1 offset:5120
    v_smfmac_f32_16x16x64_bf16 v[16:19], v[32:35], v[56:63], v11
    buffer_load_dwordx4 v[56:59], v10, s[56:59], s34 offen
    buffer_load_dwordx4 v[60:63], v10, s[56:59], s34 offen offset:1024
    v_smfmac_f32_16x16x64_bf16 v[20:23], v[32:35], a[32:39], v11
    ds_read_b128 v[32:35], v2 offset:3072
    s_waitcnt lgkmcnt(5)
    v_smfmac_f32_16x16x64_bf16 v[12:15], v[36:39], v[48:55], v11
    ds_read_b128 v[48:51], v1 offset:6144
    ds_read_b128 v[52:55], v1 offset:7168
    v_smfmac_f32_16x16x64_bf16 v[16:19], v[36:39], v[64:71], v11
    buffer_load_dwordx4 v[64:67], v10, s[56:59], s34 offen offset:2048
    buffer_load_dwordx4 v[68:71], v10, s[56:59], s34 offen offset:3072
    v_smfmac_f32_16x16x64_bf16 v[20:23], v[36:39], a[40:47], v11
    ds_read_b128 v[36:39], v2 offset:3584
    s_waitcnt lgkmcnt(7)
    v_smfmac_f32_16x16x64_bf16 v[12:15], v[24:27], v[128:135], v11
    v_smfmac_f32_16x16x64_bf16 v[16:19], v[24:27], v[72:79], v11
    buffer_load_dwordx4 v[72:75], v10, s[56:59], s35 offen
    buffer_load_dwordx4 v[76:79], v10, s[56:59], s35 offen offset:1024
    v_smfmac_f32_16x16x64_bf16 v[20:23], v[24:27], a[48:55], v11
    ds_read_b128 v[24:27], v2 offset:4096
    s_waitcnt lgkmcnt(7)
    v_smfmac_f32_16x16x64_bf16 v[12:15], v[28:31], v[136:143], v11
    v_smfmac_f32_16x16x64_bf16 v[16:19], v[28:31], v[80:87], v11
    buffer_load_dwordx4 v[80:83], v10, s[56:59], s35 offen offset:2048
    buffer_load_dwordx4 v[84:87], v10, s[56:59], s35 offen offset:3072
    v_smfmac_f32_16x16x64_bf16 v[20:23], v[28:31], a[56:63], v11
    ds_read_b128 v[28:31], v2 offset:4608
    s_waitcnt lgkmcnt(5)
    v_smfmac_f32_16x16x64_bf16 v[12:15], v[32:35], v[40:47], v11
    ds_read_b128 v[40:43], v1 offset:8192
    ds_read_b128 v[44:47], v1 offset:9216
    v_smfmac_f32_16x16x64_bf16 v[16:19], v[32:35], v[144:151], v11
    s_waitcnt vmcnt(13)
    v_or_b32 v0, v88, v92
    v_and_b32 v0, s64, v0
    v_cmp_ne_u32 vcc, 0, v0
    s_cbranch_vccnz L_f_agb
L_f_agbok:
    v_perm_b32 v88, v92, v88, s95
    v_perm_b32 v89, v93, v89, s95
    v_perm_b32 v90, v94, v90, s95
    v_perm_b32 v91, v95, v91, s95
    ds_write_b32 v7, v88 offset:6144
    v_xor_b32 v93, 16, v7
    ds_write_b32 v93, v89 offset:6144
    v_xor_b32 v94, 32, v7
    ds_write_b32 v94, v90 offset:6144
    v_xor_b32 v95, 48, v7
    ds_write_b32 v95, v91 offset:6144
    v_smfmac_f32_16x16x64_bf16 v[20:23], v[32:35], a[64:71], v11
    ds_read_b128 v[32:35], v2 offset:5120
    s_waitcnt lgkmcnt(9)
    v_smfmac_f32_16x16x64_bf16 v[12:15], v[36:39], v[48:55], v11
    ds_read_b128 v[48:51], v1 offset:10240
    ds_read_b128 v[52:55], v1 offset:11264
    v_smfmac_f32_16x16x64_bf16 v[16:19], v[36:39], v[152:159], v11
    v_smfmac_f32_16x16x64_bf16 v[20:23], v[36:39], a[72:79], v11
    s_waitcnt lgkmcnt(0)
    s_barrier
    buffer_load_dwordx4 v[88:91], v10, s[56:59], s36 offen
    buffer_load_dwordx4 v[92:95], v10, s[56:59], s36 offen offset:1024
    ds_read_b128 v[36:39], v2 offset:5632
    v_smfmac_f32_16x16x64_bf16 v[12:15], v[24:27], v[160:167], v11
    v_smfmac_f32_16x16x64_bf16 v[16:19], v[24:27], v[176:183], v11
    v_smfmac_f32_16x16x64_bf16 v[20:23], v[24:27], a[80:87], v11
    ds_read_b128 v[24:27], v2 offset:6144
    v_smfmac_f32_16x16x64_bf16 v[12:15], v[28:31], v[168:175], v11
    v_smfmac_f32_16x16x64_bf16 v[16:19], v[28:31], v[184:191], v11
    v_smfmac_f32_16x16x64_bf16 v[20:23], v[28:31], a[88:95], v11
    ds_read_b128 v[28:31], v2 offset:6656
    v_smfmac_f32_16x16x64_bf16 v[12:15], v[32:35], v[40:47], v11
    ds_read_b128 v[40:43], v1 offset:12288
    ds_read_b128 v[44:47], v1 offset:13312
    v_smfmac_f32_16x16x64_bf16 v[16:19], v[32:35], v[192:199], v11
    v_smfmac_f32_16x16x64_bf16 v[20:23], v[32:35], a[96:103], v11
    ds_read_b128 v[32:35], v2 offset:7168
    s_waitcnt lgkmcnt(5)
    v_smfmac_f32_16x16x64_bf16 v[12:15], v[36:39], v[48:55], v11
    ds_read_b128 v[48:51], v1 offset:14336
    ds_read_b128 v[52:55], v1 offset:15360
    v_smfmac_f32_16x16x64_bf16 v[16:19], v[36:39], v[200:207], v11
    v_smfmac_f32_16x16x64_bf16 v[20:23], v[36:39], a[104:111], v11
    ds_read_b128 v[36:39], v2 offset:7680
    s_waitcnt lgkmcnt(7)
    v_smfmac_f32_16x16x64_bf16 v[12:15], v[24:27], v[208:215], v11
    v_smfmac_f32_16x16x64_bf16 v[16:19], v[24:27], v[224:231], v11
    v_smfmac_f32_16x16x64_bf16 v[20:23], v[24:27], a[112:119], v11
    ds_read_b128 v[24:27], v2 offset:8192
    s_waitcnt lgkmcnt(7)
    v_smfmac_f32_16x16x64_bf16 v[12:15], v[28:31], v[216:223], v11
    v_smfmac_f32_16x16x64_bf16 v[16:19], v[28:31], v[232:239], v11
    v_smfmac_f32_16x16x64_bf16 v[20:23], v[28:31], a[120:127], v11
    ds_read_b128 v[28:31], v2 offset:8704
    s_waitcnt lgkmcnt(5)
    v_smfmac_f32_16x16x64_bf16 v[12:15], v[32:35], v[40:47], v11
    ds_read_b128 v[40:43], v1 offset:16384
    ds_read_b128 v[44:47], v1 offset:17408
    v_smfmac_f32_16x16x64_bf16 v[16:19], v[32:35], v[240:247], v11
    v_smfmac_f32_16x16x64_bf16 v[20:23], v[32:35], a[128:135], v11
    ds_read_b128 v[32:35], v2 offset:9216
    s_waitcnt lgkmcnt(5)
    v_smfmac_f32_16x16x64_bf16 v[12:15], v[36:39], v[48:55], v11
    ds_read_b128 v[48:51], v1 offset:18432
    ds_read_b128 v[52:55], v1 offset:19456
    v_smfmac_f32_16x16x64_bf16 v[16:19], v[36:39], v[248:255], v11
    v_smfmac_f32_16x16x64_bf16 v[20:23], v[36:39], a[136:143], v11
    ds_read_b128 v[36:39], v2 offset:9728
    s_waitcnt lgkmcnt(7)
    v_smfmac_f32_16x16x64_bf16 v[12:15], v[24:27], a[0:7], v11
    s_waitcnt vmcnt(8)
    v_smfmac_f32_16x16x64_bf16 v[16:19], v[24:27], v[56:63], v11
    s_waitcnt lgkmcnt(6)
    v_smfmac_f32_16x16x64_bf16 v[12:15], v[28:31], a[8:15], v11
    s_waitcnt vmcnt(6)
    v_smfmac_f32_16x16x64_bf16 v[16:19], v[28:31], v[64:71], v11
    s_waitcnt lgkmcnt(3)
    v_smfmac_f32_16x16x64_bf16 v[12:15], v[32:35], v[40:47], v11
    s_waitcnt vmcnt(4)
    v_smfmac_f32_16x16x64_bf16 v[16:19], v[32:35], v[72:79], v11
    s_waitcnt lgkmcnt(0)
    v_smfmac_f32_16x16x64_bf16 v[12:15], v[36:39], v[48:55], v11
    s_waitcnt vmcnt(2)
    v_smfmac_f32_16x16x64_bf16 v[16:19], v[36:39], v[80:87], v11
    v_and_b32 v0, 496, v10
    v_and_b32 v72, 512, v10
    v_lshl_add_u32 v0, v72, 2, v0
    v_add_u32 v72, s94, v0
    ds_read_b128 v[72:75], v72
    v_smfmac_f32_16x16x64_bf16 v[20:23], v[24:27], a[144:151], v11
    s_barrier
    ds_read_b128 v[40:43], v3 offset:10240
    ds_read_b128 v[44:47], v3 offset:14336
    v_cvt_pk_bf16_f32 v12, v12, v13
    v_cvt_pk_bf16_f32 v13, v14, v15
    v_cvt_pk_bf16_f32 v16, v16, v17
    v_cvt_pk_bf16_f32 v17, v18, v19
    s_waitcnt lgkmcnt(2)
    buffer_store_dwordx4 v[72:75], v0, s[56:59], s80 offen sc1
    ds_write_b64 v6, v[12:13]
    ds_write_b64 v6, v[16:17] offset:2048
    s_add_u32 s80, s80, 131072
    ds_read_b128 v[48:51], v3 offset:11264
    ds_read_b128 v[52:55], v3 offset:15360
    ds_read_b128 v[56:59], v3 offset:12288
    ds_read_b128 v[60:63], v3 offset:16384
    s_waitcnt lgkmcnt(4)
    s_barrier
    ds_read_b64_tr_b16 v[12:13], v4
    ds_read_b64_tr_b16 v[14:15], v4 offset:256
    ds_read_b64_tr_b16 v[16:17], v4 offset:512
    ds_read_b64_tr_b16 v[18:19], v4 offset:768
    ds_read_b64_tr_b16 v[24:25], v4 offset:2048
    ds_read_b64_tr_b16 v[26:27], v4 offset:2304
    v_smfmac_f32_16x16x64_bf16 v[20:23], v[28:31], a[152:159], v11
    ds_read_b64_tr_b16 v[72:73], v4 offset:1024
    ds_read_b64_tr_b16 v[74:75], v4 offset:1280
    ds_read_b64_tr_b16 v[28:29], v4 offset:2560
    ds_read_b64_tr_b16 v[30:31], v4 offset:2816
    ds_read_b128 v[64:67], v3 offset:13312
    ds_read_b128 v[68:71], v3 offset:17408
    v_smfmac_f32_16x16x64_bf16 v[20:23], v[32:35], a[160:167], v11
    ds_read_b64_tr_b16 v[76:77], v4 offset:1536
    ds_read_b64_tr_b16 v[78:79], v4 offset:1792
    ds_read_b64_tr_b16 v[32:33], v4 offset:3072
    ds_read_b64_tr_b16 v[34:35], v4 offset:3328
    s_waitcnt vmcnt(1)
    v_smfmac_f32_16x16x64_bf16 v[20:23], v[36:39], v[88:95], v11
    ds_read_b64_tr_b16 v[36:37], v4 offset:3584
    ds_read_b64_tr_b16 v[38:39], v4 offset:3840
    ds_read_b128 v[88:91], v3 offset:25600
    s_waitcnt lgkmcnt(15)
    v_mfma_f32_16x16x32_bf16 v[80:83], v[40:43], v[12:15], 0
    v_mov_b32 v40, v9
    v_mov_b32 v41, v9
    v_mov_b32 v42, v9
    v_mov_b32 v43, v9
    v_mfma_f32_16x16x32_bf16 v[84:87], v[44:47], v[12:15], 0
    ds_read_b128 v[44:47], v3 offset:18432
    v_mfma_f32_16x16x32_bf16 v[80:83], v[48:51], v[16:19], v[80:83]
    ds_read_b128 v[48:51], v3 offset:19456
    v_cvt_pk_bf16_f32 v20, v20, v21
    v_cvt_pk_bf16_f32 v21, v22, v23
    ds_write_b64 v6, v[20:21] offset:4096
    v_mfma_f32_16x16x32_bf16 v[84:87], v[52:55], v[16:19], v[84:87]
    ds_read_b128 v[52:55], v3 offset:20480
    s_waitcnt lgkmcnt(15)
    v_mfma_f32_16x16x32_bf16 v[80:83], v[56:59], v[72:75], v[80:83]
    ds_read_b128 v[56:59], v3 offset:21504
    v_mfma_f32_16x16x32_bf16 v[84:87], v[60:63], v[72:75], v[84:87]
    ds_read_b128 v[60:63], v3 offset:22528
    s_waitcnt lgkmcnt(11)
    v_mfma_f32_16x16x32_bf16 v[80:83], v[64:67], v[76:79], v[80:83]
    ds_read_b128 v[64:67], v3 offset:23552
    v_mfma_f32_16x16x32_bf16 v[84:87], v[68:71], v[76:79], v[84:87]
    ds_read_b128 v[68:71], v3 offset:24576
    v_mfma_f32_16x16x32_bf16 v[40:43], v[24:27], v[12:15], v[40:43]
    v_mfma_f32_16x16x32_bf16 v[40:43], v[28:31], v[16:19], v[40:43]
    s_waitcnt lgkmcnt(11)
    v_mfma_f32_16x16x32_bf16 v[40:43], v[32:35], v[72:75], v[40:43]
    s_waitcnt lgkmcnt(9)
    v_mfma_f32_16x16x32_bf16 v[40:43], v[36:39], v[76:79], v[40:43]
    v_max3_f32 v92, v80, v81, v82
    v_max3_f32 v93, v83, v84, v85
    v_max3_f32 v92, v92, v86, v87
    s_waitcnt lgkmcnt(0)
    s_barrier
    s_cmp_eq_u32 s62, 63
    s_cbranch_scc1 L_f_last
    ds_read_b64 v[12:13], v5
    ds_read_b64 v[14:15], v5 offset:256
    ds_read_b64 v[16:17], v5 offset:512
    ds_read_b64 v[18:19], v5 offset:768
    v_max3_f32 v93, v93, v40, v41
    v_max3_f32 v92, v92, v42, v43
    v_max_f32 v92, v92, v93
    v_mov_b32 v93, v92
    buffer_load_dwordx4 v[24:27], v10, s[56:59], s36 offen offset:2048
    buffer_load_dwordx4 v[28:31], v10, s[56:59], s36 offen offset:3072
    v_permlane32_swap_b32 v92, v93
    v_max_f32 v92, v92, v93
    v_mov_b32 v93, v92
    buffer_load_dwordx4 v[32:35], v10, s[56:59], s37 offen
    buffer_load_dwordx4 v[36:39], v10, s[56:59], s37 offen offset:1024
    v_permlane16_swap_b32 v92, v93
    v_max_f32 v92, v92, v93
    v_mul_f32 v92, s90, v92
    v_pk_fma_f32 v[40:41], v[40:41], s[90:91], v[92:93] op_sel_hi:[1,1,0] neg_lo:[0,0,1] neg_hi:[0,0,1]
    v_pk_fma_f32 v[42:43], v[42:43], s[90:91], v[92:93] op_sel_hi:[1,1,0] neg_lo:[0,0,1] neg_hi:[0,0,1]
    v_pk_fma_f32 v[80:81], v[80:81], s[90:91], v[92:93] op_sel_hi:[1,1,0] neg_lo:[0,0,1] neg_hi:[0,0,1]
    v_pk_fma_f32 v[82:83], v[82:83], s[90:91], v[92:93] op_sel_hi:[1,1,0] neg_lo:[0,0,1] neg_hi:[0,0,1]
    v_pk_fma_f32 v[84:85], v[84:85], s[90:91], v[92:93] op_sel_hi:[1,1,0] neg_lo:[0,0,1] neg_hi:[0,0,1]
    v_pk_fma_f32 v[86:87], v[86:87], s[90:91], v[92:93] op_sel_hi:[1,1,0] neg_lo:[0,0,1] neg_hi:[0,0,1]
    v_exp_f32 v40, v40
    v_exp_f32 v41, v41
    v_exp_f32 v42, v42
    v_exp_f32 v43, v43
    v_exp_f32 v80, v80
    v_exp_f32 v81, v81
    v_exp_f32 v82, v82
    v_exp_f32 v83, v83
    v_exp_f32 v84, v84
    v_exp_f32 v85, v85
    v_exp_f32 v86, v86
    v_exp_f32 v87, v87
    v_pk_add_f32 v[20:21], v[40:41], v[42:43]
    v_pk_add_f32 v[20:21], v[20:21], v[80:81]
    v_pk_add_f32 v[20:21], v[20:21], v[82:83]
    v_pk_add_f32 v[20:21], v[20:21], v[84:85]
    v_pk_add_f32 v[20:21], v[20:21], v[86:87]
    v_add_f32 v20, v20, v21
    v_mov_b32 v93, v20
    buffer_load_dwordx4 v[72:75], v10, s[56:59], s37 offen offset:2048
    buffer_load_dwordx4 v[76:79], v10, s[56:59], s37 offen offset:3072
    v_permlane32_swap_b32 v20, v93
    v_add_f32 v20, v20, v93
    v_mov_b32 v93, v20
    s_nop 1
    v_permlane16_swap_b32 v20, v93
    v_add_f32 v20, v20, v93
    v_rcp_f32 v22, v20
    s_nop 0
    v_pk_mul_f32 v[80:81], v[80:81], v[22:23] op_sel_hi:[1,0]
    v_pk_mul_f32 v[82:83], v[82:83], v[22:23] op_sel_hi:[1,0]
    v_pk_mul_f32 v[84:85], v[84:85], v[22:23] op_sel_hi:[1,0]
    v_pk_mul_f32 v[86:87], v[86:87], v[22:23] op_sel_hi:[1,0]
    v_pk_mul_f32 v[40:41], v[40:41], v[22:23] op_sel_hi:[1,0]
    v_pk_mul_f32 v[42:43], v[42:43], v[22:23] op_sel_hi:[1,0]
    v_cvt_pk_bf16_f32 v20, v80, v81
    v_cvt_pk_bf16_f32 v21, v82, v83
    v_cvt_pk_bf16_f32 v22, v84, v85
    v_cvt_pk_bf16_f32 v23, v86, v87
    v_cvt_pk_bf16_f32 v92, v40, v41
    v_cvt_pk_bf16_f32 v93, v42, v43
    v_mfma_f32_16x16x32_bf16 v[80:83], v[44:47], v[20:23], 0
    ds_read_b64 v[44:45], v5 offset:1024
    ds_read_b64 v[46:47], v5 offset:1280
    v_mfma_f32_16x16x32_bf16 v[84:87], v[48:51], v[20:23], 0
    ds_read_b64 v[48:49], v5 offset:1536
    ds_read_b64 v[50:51], v5 offset:1792
    v_mfma_f32_16x16x32_bf16 v[40:43], v[52:55], v[20:23], 0
    v_mfma_f32_16x16x32_bf16 v[52:55], v[56:59], v[20:23], 0
    v_mfma_f32_16x16x32_bf16 v[56:59], v[60:63], v[20:23], 0
    v_mfma_f32_16x16x32_bf16 v[60:63], v[64:67], v[20:23], 0
    v_mfma_f32_16x16x32_bf16 v[64:67], v[68:71], v[20:23], 0
    v_mfma_f32_16x16x32_bf16 v[68:71], v[88:91], v[20:23], 0
    s_waitcnt lgkmcnt(7)
    v_mfma_f32_16x16x16_bf16 v[80:83], v[12:13], v[92:93], v[80:83]
    v_mov_b64 v[20:21], 0
    v_mov_b64 v[22:23], 0
    s_waitcnt lgkmcnt(6)
    v_mfma_f32_16x16x16_bf16 v[84:87], v[14:15], v[92:93], v[84:87]
    s_waitcnt lgkmcnt(5)
    v_mfma_f32_16x16x16_bf16 v[40:43], v[16:17], v[92:93], v[40:43]
    s_waitcnt lgkmcnt(4)
    v_mfma_f32_16x16x16_bf16 v[52:55], v[18:19], v[92:93], v[52:55]
    v_cvt_pk_bf16_f32 v80, v80, v81
    v_cvt_pk_bf16_f32 v81, v82, v83
    s_waitcnt lgkmcnt(3)
    v_mfma_f32_16x16x16_bf16 v[56:59], v[44:45], v[92:93], v[56:59]
    v_cvt_pk_bf16_f32 v82, v84, v85
    v_cvt_pk_bf16_f32 v83, v86, v87
    ds_read_b128 v[12:15], v1 offset:20480
    ds_read_b128 v[16:19], v1 offset:21504
    s_waitcnt lgkmcnt(4)
    v_mfma_f32_16x16x16_bf16 v[60:63], v[46:47], v[92:93], v[60:63]
    v_cvt_pk_bf16_f32 v40, v40, v41
    v_cvt_pk_bf16_f32 v41, v42, v43
    s_waitcnt lgkmcnt(3)
    v_mfma_f32_16x16x16_bf16 v[64:67], v[48:49], v[92:93], v[64:67]
    v_cvt_pk_bf16_f32 v42, v52, v53
    v_cvt_pk_bf16_f32 v43, v54, v55
    s_waitcnt lgkmcnt(2)
    v_mfma_f32_16x16x16_bf16 v[68:71], v[50:51], v[92:93], v[68:71]
    v_cvt_pk_bf16_f32 v56, v56, v57
    v_cvt_pk_bf16_f32 v57, v58, v59
    ds_read_b128 v[44:47], v1 offset:22528
    ds_read_b128 v[48:51], v1 offset:23552
    v_smfmac_f32_16x16x64_bf16 v[20:23], v[80:83], a[168:175], v11
    v_cvt_pk_bf16_f32 v58, v60, v61
    v_cvt_pk_bf16_f32 v59, v62, v63
    v_smfmac_f32_16x16x64_bf16 v[20:23], v[40:43], a[176:183], v11
    v_cvt_pk_bf16_f32 v64, v64, v65
    v_cvt_pk_bf16_f32 v65, v66, v67
    v_cvt_pk_bf16_f32 v66, v68, v69
    v_cvt_pk_bf16_f32 v67, v70, v71
    v_smfmac_f32_16x16x64_bf16 v[20:23], v[56:59], a[184:191], v11
    v_mov_b64 v[84:85], 0
    v_mov_b64 v[86:87], 0
    v_smfmac_f32_16x16x64_bf16 v[20:23], v[64:67], a[192:199], v11
    v_mov_b64 v[52:53], 0
    v_mov_b64 v[54:55], 0
    s_waitcnt lgkmcnt(2)
    v_smfmac_f32_16x16x64_bf16 v[84:87], v[80:83], v[12:19], v11
    ds_read_b128 v[12:15], v1 offset:24576
    ds_read_b128 v[16:19], v1 offset:25600
    v_mov_b64 v[60:61], 0
    v_mov_b64 v[62:63], 0
    s_waitcnt lgkmcnt(2)
    v_smfmac_f32_16x16x64_bf16 v[84:87], v[40:43], v[44:51], v11
    ds_read_b128 v[44:47], v1 offset:26624
    ds_read_b128 v[48:51], v1 offset:27648
    v_mov_b64 v[68:69], 0
    v_mov_b64 v[70:71], 0
    v_smfmac_f32_16x16x64_bf16 v[84:87], v[56:59], a[200:207], v11
    v_cvt_pk_bf16_f32 v20, v20, v21
    v_cvt_pk_bf16_f32 v21, v22, v23
    v_bfi_b32 v20, s85, v9, v20
    buffer_store_dwordx2 v[20:21], v8, s[56:59], s68 offen
    v_smfmac_f32_16x16x64_bf16 v[84:87], v[64:67], a[208:215], v11
    s_waitcnt lgkmcnt(2)
    v_smfmac_f32_16x16x64_bf16 v[52:55], v[80:83], v[12:19], v11
    ds_read_b128 v[12:15], v1 offset:28672
    ds_read_b128 v[16:19], v1 offset:29696
    s_waitcnt lgkmcnt(2)
    v_smfmac_f32_16x16x64_bf16 v[52:55], v[40:43], v[44:51], v11
    ds_read_b128 v[44:47], v1 offset:30720
    ds_read_b128 v[48:51], v1 offset:31744
    v_smfmac_f32_16x16x64_bf16 v[52:55], v[56:59], a[216:223], v11
    v_cvt_pk_bf16_f32 v84, v84, v85
    v_cvt_pk_bf16_f32 v85, v86, v87
    v_bfi_b32 v84, s85, v9, v84
    buffer_store_dwordx2 v[84:85], v8, s[56:59], s69 offen
    v_smfmac_f32_16x16x64_bf16 v[52:55], v[64:67], a[224:231], v11
    s_waitcnt lgkmcnt(2)
    v_smfmac_f32_16x16x64_bf16 v[60:63], v[80:83], v[12:19], v11
    s_waitcnt lgkmcnt(0)
    v_smfmac_f32_16x16x64_bf16 v[60:63], v[40:43], v[44:51], v11
    v_smfmac_f32_16x16x64_bf16 v[60:63], v[56:59], a[232:239], v11
    s_nop 2
    v_cvt_pk_bf16_f32 v52, v52, v53
    v_cvt_pk_bf16_f32 v53, v54, v55
    v_bfi_b32 v52, s85, v9, v52
    buffer_store_dwordx2 v[52:53], v8, s[56:59], s70 offen
    v_smfmac_f32_16x16x64_bf16 v[60:63], v[64:67], a[240:247], v11
    v_smfmac_f32_16x16x64_bf16 v[68:71], v[80:83], a[248:255], v11
    s_waitcnt vmcnt(7)
    v_smfmac_f32_16x16x64_bf16 v[68:71], v[40:43], v[24:31], v11
    s_waitcnt vmcnt(5)
    v_smfmac_f32_16x16x64_bf16 v[68:71], v[56:59], v[32:39], v11
    s_nop 2
    v_cvt_pk_bf16_f32 v60, v60, v61
    v_cvt_pk_bf16_f32 v61, v62, v63
    v_bfi_b32 v60, s85, v9, v60
    buffer_store_dwordx2 v[60:61], v8, s[56:59], s71 offen
    s_waitcnt vmcnt(4)
    v_smfmac_f32_16x16x64_bf16 v[68:71], v[64:67], v[72:79], v11
    s_nop 7
    v_cvt_pk_bf16_f32 v68, v68, v69
    v_cvt_pk_bf16_f32 v69, v70, v71
    v_bfi_b32 v68, s85, v9, v68
    buffer_store_dwordx2 v[68:69], v8, s[56:59], s72 offen
    s_add_u32 s62, s62, 1
    s_add_u32 s79, s79, 262144
    s_add_u32 s81, s81, 262144
    v_xor_b32 v9, s85, v9
    s_cmp_ge_u32 s65, 80
    s_cbranch_scc1 L_f_ag0
    v_and_b32 v39, 4095, v8
    v_lshlrev_b32 v39, 1, v39
    v_lshrrev_b32 v36, 4, v10
    v_and_b32 v36, 15, v36
    v_and_b32 v37, 1, v36
    v_lshlrev_b32 v37, 4, v37
    v_mov_b32 v38, 0x3f80
    v_lshlrev_b32 v37, v37, v38
    v_lshrrev_b32 v36, 1, v36
    v_cmp_eq_u32 vcc, 0, v36
    s_nop 1
    v_cndmask_b32 v32, 0, v37, vcc
    v_cmp_eq_u32 vcc, 1, v36
    s_nop 1
    v_cndmask_b32 v33, 0, v37, vcc
    v_cmp_eq_u32 vcc, 2, v36
    s_nop 1
    v_cndmask_b32 v34, 0, v37, vcc
    v_cmp_eq_u32 vcc, 3, v36
    s_nop 1
    v_cndmask_b32 v35, 0, v37, vcc
L_f_rs:
    buffer_load_dwordx4 v[12:15], v10, s[56:59], s66 offen sc1
    buffer_load_dwordx4 v[16:19], v10, s[56:59], s66 offen offset:1024 sc1
    buffer_load_dwordx4 v[20:23], v10, s[56:59], s66 offen offset:2048 sc1
    buffer_load_dwordx4 v[24:27], v10, s[56:59], s66 offen offset:3072 sc1
    s_waitcnt vmcnt(2)
    v_or3_b32 v50, v12, v14, v16
    s_waitcnt vmcnt(1)
    v_or3_b32 v50, v50, v18, v20
    s_waitcnt vmcnt(0)
    v_or3_b32 v50, v50, v22, v24
    v_or_b32 v50, v50, v26
    v_and_b32 v50, s84, v50
    v_cmp_ne_u32 vcc, 0, v50
    v_mfma_f32_16x16x32_bf16 v[28:31], v[32:35], v[12:15], 0
    v_mfma_f32_16x16x32_bf16 v[28:31], v[32:35], v[16:19], v[28:31]
    v_mfma_f32_16x16x32_bf16 v[28:31], v[32:35], v[20:23], v[28:31]
    v_mfma_f32_16x16x32_bf16 v[28:31], v[32:35], v[24:27], v[28:31]
    s_cbranch_vccnz L_f_rs
    s_nop 6
    v_add_f32 v28, v28, v28 row_ror:8 row_mask:0xf bank_mask:0xf
    v_add_f32 v29, v29, v29 row_ror:8 row_mask:0xf bank_mask:0xf
    v_add_f32 v30, v30, v30 row_ror:8 row_mask:0xf bank_mask:0xf
    v_add_f32 v31, v31, v31 row_ror:8 row_mask:0xf bank_mask:0xf
    v_cvt_pk_bf16_f32 v28, 0, v28
    v_cvt_pk_bf16_f32 v29, 0, v29
    v_cvt_pk_bf16_f32 v30, 0, v30
    v_cvt_pk_bf16_f32 v31, 0, v31
    v_or_b32 v28, s64, v28
    s_mov_b64 exec, 0x00ff00ff
    buffer_store_dwordx4 v[28:31], v39, s[56:59], s67 offen
    s_mov_b64 exec, -1
    s_mov_b32 s86, s63
    s_mov_b32 s63, s64
    s_mov_b32 s64, s86
    s_xor_b32 s84, s84, s85
    v_subrev_u32 v48, 131072, v7
    v_and_b32 v44, 496, v48
    v_bfe_u32 v49, v48, 2, 2
    v_lshl_add_u32 v44, v49, 1, v44
    v_bfe_u32 v49, v48, 9, 1
    v_lshl_add_u32 v44, v49, 3, v44
    v_lshrrev_b32 v49, 10, v48
    v_lshl_add_u32 v44, v49, 9, v44
    v_add_u32 v44, 135168, v44
    v_xor_b32 v41, 16, v7
    v_xor_b32 v45, 16, v44
    v_xor_b32 v42, 32, v7
    v_xor_b32 v46, 32, v44
    v_xor_b32 v43, 48, v7
    v_xor_b32 v47, 48, v44
    buffer_load_dwordx4 v[56:59], v10, s[56:59], s32 offen
    buffer_load_dwordx4 v[60:63], v10, s[56:59], s32 offen offset:1024
    buffer_load_dwordx4 v[64:67], v10, s[56:59], s32 offen offset:2048
    buffer_load_dwordx4 v[68:71], v10, s[56:59], s32 offen offset:3072
    buffer_load_dwordx4 v[72:75], v10, s[56:59], s33 offen
    buffer_load_dwordx4 v[76:79], v10, s[56:59], s33 offen offset:1024
    buffer_load_dwordx4 v[80:83], v10, s[56:59], s33 offen offset:2048
    buffer_load_dwordx4 v[84:87], v10, s[56:59], s33 offen offset:3072
    s_sleep 2
    s_branch L_f_ag
L_f_ag0:
    s_mov_b32 s86, s63
    s_mov_b32 s63, s64
    s_mov_b32 s64, s86
    s_xor_b32 s84, s84, s85
    v_subrev_u32 v48, 131072, v7
    v_and_b32 v44, 496, v48
    v_bfe_u32 v49, v48, 2, 2
    v_lshl_add_u32 v44, v49, 1, v44
    v_bfe_u32 v49, v48, 9, 1
    v_lshl_add_u32 v44, v49, 3, v44
    v_lshrrev_b32 v49, 10, v48
    v_lshl_add_u32 v44, v49, 9, v44
    v_add_u32 v44, 135168, v44
    v_xor_b32 v41, 16, v7
    v_xor_b32 v45, 16, v44
    v_xor_b32 v42, 32, v7
    v_xor_b32 v46, 32, v44
    v_xor_b32 v43, 48, v7
    v_xor_b32 v47, 48, v44
    s_cmp_lg_u32 s61, 3
    s_cbranch_scc1 L_pg2e
    s_add_u32 s86, s62, 1
    s_and_b32 s87, s86, 3
    s_cmp_lg_u32 s87, 0
    s_cbranch_scc1 L_kvw3d
    s_cmp_ge_u32 s86, 64
    s_cbranch_scc1 L_kvw3d
    s_lshr_b32 s86, s86, 2
    s_mov_b32 s87, 94372864
    v_and_b32 v53, 240, v10
    v_lshlrev_b32 v53, 3, v53
L_kvw3:
    s_bitcmp1_b32 s47, s86
    s_cbranch_scc1 L_kvw3d
    buffer_load_dword v52, v53, s[56:59], s87 offen sc1
    s_waitcnt vmcnt(0)
    v_bfe_u32 v52, v52, 5, 6
    v_cmp_le_u32 vcc, 16, v52
    s_and_b32 s47, vcc_lo, 65535
    s_bitcmp1_b32 s47, s86
    s_cbranch_scc1 L_kvw3d
    s_sleep 4
    s_branch L_kvw3
L_kvw3d:
L_pg2e:
    s_sleep 2
    buffer_load_dwordx4 v[56:59], v10, s[56:59], s32 offen
    buffer_load_dwordx4 v[60:63], v10, s[56:59], s32 offen offset:1024
    buffer_load_dwordx4 v[64:67], v10, s[56:59], s32 offen offset:2048
    buffer_load_dwordx4 v[68:71], v10, s[56:59], s32 offen offset:3072
    buffer_load_dwordx4 v[72:75], v10, s[56:59], s33 offen
    buffer_load_dwordx4 v[76:79], v10, s[56:59], s33 offen offset:1024
    buffer_load_dwordx4 v[80:83], v10, s[56:59], s33 offen offset:2048
    buffer_load_dwordx4 v[84:87], v10, s[56:59], s33 offen offset:3072
    s_sleep 13
L_f_ag:
    buffer_load_dwordx4 v[12:15], v10, s[56:59], s73 offen sc1
    buffer_load_dwordx4 v[16:19], v10, s[56:59], s74 offen sc1
    buffer_load_dwordx4 v[20:23], v10, s[56:59], s75 offen sc1
    s_waitcnt vmcnt(0)
    v_or3_b32 v52, v12, v16, v20
    v_and_b32 v52, s64, v52
    v_cmp_ne_u32 vcc, 0, v52
    s_cbranch_vccnz L_f_ag
    buffer_load_dwordx4 v[88:91], v10, s[56:59], s76 offen sc1
    buffer_load_dwordx4 v[92:95], v10, s[56:59], s77 offen sc1
    v_perm_b32 v32, v16, v12, s95
    ds_write_b32 v7, v32
    ds_write_b16_d16_hi v44, v20
    v_perm_b32 v33, v17, v13, s95
    ds_write_b32 v41, v33
    ds_write_b16_d16_hi v45, v21
    v_perm_b32 v34, v18, v14, s95
    ds_write_b32 v42, v34
    ds_write_b16_d16_hi v46, v22
    v_perm_b32 v35, v19, v15, s95
    ds_write_b32 v43, v35
    ds_write_b16_d16_hi v47, v23
    s_add_u32 m0, s40, 141312
    s_add_u32 s87, s79, s40
    buffer_load_dwordx4 v10, s[56:59], s87 offen sc1 lds
    buffer_load_dwordx4 v10, s[56:59], s87 offen offset:1024 sc1 lds
    s_add_u32 m0, s40, 149504
    s_add_u32 s87, s81, s40
    buffer_load_dwordx4 v10, s[56:59], s87 offen sc1 lds
    buffer_load_dwordx4 v10, s[56:59], s87 offen offset:1024 sc1 lds
    s_sub_u32 s86, s62, 2
    v_mov_b32 v36, s86
    v_mov_b32 v37, 0
    s_mov_b64 exec, 1
    buffer_store_dword v36, v37, s[56:59], s46 offen sc1
    s_mov_b64 exec, -1
    s_branch L_f_top
L_f_agb:
    buffer_load_dwordx4 v[88:91], v10, s[56:59], s76 offen sc1
    buffer_load_dwordx4 v[92:95], v10, s[56:59], s77 offen sc1
    s_waitcnt vmcnt(0)
    v_or_b32 v0, v88, v92
    v_and_b32 v0, s64, v0
    v_cmp_ne_u32 vcc, 0, v0
    s_cbranch_vccnz L_f_agb
    s_nop 4
    s_branch L_f_agbok
L_f_last:
    v_and_b32 v0, 496, v10
    v_and_b32 v88, 512, v10
    v_lshl_add_u32 v0, v88, 2, v0
    v_add_u32 v88, s94, v0
    ds_read_b128 v[88:91], v88
    s_waitcnt lgkmcnt(0)
    buffer_store_dwordx4 v[88:91], v0, s[56:59], s80 offen sc1
L_f_exit:
    s_branch L_chend
L_slow:
L_s_top:
    v_mov_b64 v[12:13], 0
    v_mov_b64 v[14:15], 0
    v_mov_b64 v[16:17], 0
    v_mov_b64 v[18:19], 0
    v_mov_b64 v[20:21], 0
    v_mov_b64 v[22:23], 0
    s_waitcnt lgkmcnt(0)
    s_barrier
    ds_read_b128 v[24:27], v2
    ds_read_b128 v[28:31], v2 offset:512
    ds_read_b128 v[32:35], v2 offset:1024
    ds_read_b128 v[36:39], v2 offset:1536
    ds_read_b128 v[40:43], v1
    ds_read_b128 v[44:47], v1 offset:1024
    ds_read_b128 v[48:51], v1 offset:2048
    ds_read_b128 v[52:55], v1 offset:3072
    s_waitcnt lgkmcnt(7)
    v_smfmac_f32_16x16x64_bf16 v[12:15], v[24:27], v[96:103], v11
    v_smfmac_f32_16x16x64_bf16 v[16:19], v[24:27], v[112:119], v11
    v_smfmac_f32_16x16x64_bf16 v[20:23], v[24:27], a[16:23], v11
    ds_read_b128 v[24:27], v2 offset:2048
    s_waitcnt lgkmcnt(7)
    v_smfmac_f32_16x16x64_bf16 v[12:15], v[28:31], v[104:111], v11
    v_smfmac_f32_16x16x64_bf16 v[16:19], v[28:31], v[120:127], v11
    v_smfmac_f32_16x16x64_bf16 v[20:23], v[28:31], a[24:31], v11
    ds_read_b128 v[28:31], v2 offset:2560
    s_waitcnt lgkmcnt(4)
    v_smfmac_f32_16x16x64_bf16 v[12:15], v[32:35], v[40:47], v11
    ds_read_b128 v[40:43], v1 offset:4096
    ds_read_b128 v[44:47], v1 offset:5120
    v_smfmac_f32_16x16x64_bf16 v[16:19], v[32:35], v[56:63], v11
    buffer_load_dwordx4 v[56:59], v10, s[56:59], s34 offen
    buffer_load_dwordx4 v[60:63], v10, s[56:59], s34 offen offset:1024
    v_smfmac_f32_16x16x64_bf16 v[20:23], v[32:35], a[32:39], v11
    ds_read_b128 v[32:35], v2 offset:3072
    s_waitcnt lgkmcnt(5)
    v_smfmac_f32_16x16x64_bf16 v[12:15], v[36:39], v[48:55], v11
    ds_read_b128 v[48:51], v1 offset:6144
    ds_read_b128 v[52:55], v1 offset:7168
    v_smfmac_f32_16x16x64_bf16 v[16:19], v[36:39], v[64:71], v11
    buffer_load_dwordx4 v[64:67], v10, s[56:59], s34 offen offset:2048
    buffer_load_dwordx4 v[68:71], v10, s[56:59], s34 offen offset:3072
    v_smfmac_f32_16x16x64_bf16 v[20:23], v[36:39], a[40:47], v11
    ds_read_b128 v[36:39], v2 offset:3584
    s_waitcnt lgkmcnt(7)
    v_smfmac_f32_16x16x64_bf16 v[12:15], v[24:27], v[128:135], v11
    v_smfmac_f32_16x16x64_bf16 v[16:19], v[24:27], v[72:79], v11
    buffer_load_dwordx4 v[72:75], v10, s[56:59], s35 offen
    buffer_load_dwordx4 v[76:79], v10, s[56:59], s35 offen offset:1024
    v_smfmac_f32_16x16x64_bf16 v[20:23], v[24:27], a[48:55], v11
    ds_read_b128 v[24:27], v2 offset:4096
    s_waitcnt lgkmcnt(7)
    v_smfmac_f32_16x16x64_bf16 v[12:15], v[28:31], v[136:143], v11
    v_smfmac_f32_16x16x64_bf16 v[16:19], v[28:31], v[80:87], v11
    buffer_load_dwordx4 v[80:83], v10, s[56:59], s35 offen offset:2048
    buffer_load_dwordx4 v[84:87], v10, s[56:59], s35 offen offset:3072
    v_smfmac_f32_16x16x64_bf16 v[20:23], v[28:31], a[56:63], v11
    ds_read_b128 v[28:31], v2 offset:4608
    s_waitcnt lgkmcnt(5)
    v_smfmac_f32_16x16x64_bf16 v[12:15], v[32:35], v[40:47], v11
    ds_read_b128 v[40:43], v1 offset:8192
    ds_read_b128 v[44:47], v1 offset:9216
    v_smfmac_f32_16x16x64_bf16 v[16:19], v[32:35], v[144:151], v11
    s_waitcnt vmcnt(13)
    v_or_b32 v0, v88, v92
    v_and_b32 v0, s64, v0
    v_cmp_ne_u32 vcc, 0, v0
    s_cbranch_vccnz L_s_agb
L_s_agbok:
    v_perm_b32 v88, v92, v88, s95
    v_perm_b32 v89, v93, v89, s95
    v_perm_b32 v90, v94, v90, s95
    v_perm_b32 v91, v95, v91, s95
    ds_write_b32 v7, v88 offset:6144
    v_xor_b32 v93, 16, v7
    ds_write_b32 v93, v89 offset:6144
    v_xor_b32 v94, 32, v7
    ds_write_b32 v94, v90 offset:6144
    v_xor_b32 v95, 48, v7
    ds_write_b32 v95, v91 offset:6144
    v_smfmac_f32_16x16x64_bf16 v[20:23], v[32:35], a[64:71], v11
    ds_read_b128 v[32:35], v2 offset:5120
    s_waitcnt lgkmcnt(9)
    v_smfmac_f32_16x16x64_bf16 v[12:15], v[36:39], v[48:55], v11
    ds_read_b128 v[48:51], v1 offset:10240
    ds_read_b128 v[52:55], v1 offset:11264
    v_smfmac_f32_16x16x64_bf16 v[16:19], v[36:39], v[152:159], v11
    v_smfmac_f32_16x16x64_bf16 v[20:23], v[36:39], a[72:79], v11
    s_waitcnt lgkmcnt(0)
    s_barrier
    buffer_load_dwordx4 v[88:91], v10, s[56:59], s36 offen
    buffer_load_dwordx4 v[92:95], v10, s[56:59], s36 offen offset:1024
    ds_read_b128 v[36:39], v2 offset:5632
    v_smfmac_f32_16x16x64_bf16 v[12:15], v[24:27], v[160:167], v11
    v_smfmac_f32_16x16x64_bf16 v[16:19], v[24:27], v[176:183], v11
    v_smfmac_f32_16x16x64_bf16 v[20:23], v[24:27], a[80:87], v11
    ds_read_b128 v[24:27], v2 offset:6144
    v_smfmac_f32_16x16x64_bf16 v[12:15], v[28:31], v[168:175], v11
    v_smfmac_f32_16x16x64_bf16 v[16:19], v[28:31], v[184:191], v11
    v_smfmac_f32_16x16x64_bf16 v[20:23], v[28:31], a[88:95], v11
    ds_read_b128 v[28:31], v2 offset:6656
    v_smfmac_f32_16x16x64_bf16 v[12:15], v[32:35], v[40:47], v11
    ds_read_b128 v[40:43], v1 offset:12288
    ds_read_b128 v[44:47], v1 offset:13312
    v_smfmac_f32_16x16x64_bf16 v[16:19], v[32:35], v[192:199], v11
    v_smfmac_f32_16x16x64_bf16 v[20:23], v[32:35], a[96:103], v11
    ds_read_b128 v[32:35], v2 offset:7168
    s_waitcnt lgkmcnt(5)
    v_smfmac_f32_16x16x64_bf16 v[12:15], v[36:39], v[48:55], v11
    ds_read_b128 v[48:51], v1 offset:14336
    ds_read_b128 v[52:55], v1 offset:15360
    v_smfmac_f32_16x16x64_bf16 v[16:19], v[36:39], v[200:207], v11
    v_smfmac_f32_16x16x64_bf16 v[20:23], v[36:39], a[104:111], v11
    ds_read_b128 v[36:39], v2 offset:7680
    s_waitcnt lgkmcnt(7)
    v_smfmac_f32_16x16x64_bf16 v[12:15], v[24:27], v[208:215], v11
    v_smfmac_f32_16x16x64_bf16 v[16:19], v[24:27], v[224:231], v11
    v_smfmac_f32_16x16x64_bf16 v[20:23], v[24:27], a[112:119], v11
    ds_read_b128 v[24:27], v2 offset:8192
    s_waitcnt lgkmcnt(7)
    v_smfmac_f32_16x16x64_bf16 v[12:15], v[28:31], v[216:223], v11
    v_smfmac_f32_16x16x64_bf16 v[16:19], v[28:31], v[232:239], v11
    v_smfmac_f32_16x16x64_bf16 v[20:23], v[28:31], a[120:127], v11
    ds_read_b128 v[28:31], v2 offset:8704
    s_waitcnt lgkmcnt(5)
    v_smfmac_f32_16x16x64_bf16 v[12:15], v[32:35], v[40:47], v11
    ds_read_b128 v[40:43], v1 offset:16384
    ds_read_b128 v[44:47], v1 offset:17408
    v_smfmac_f32_16x16x64_bf16 v[16:19], v[32:35], v[240:247], v11
    v_smfmac_f32_16x16x64_bf16 v[20:23], v[32:35], a[128:135], v11
    ds_read_b128 v[32:35], v2 offset:9216
    s_waitcnt lgkmcnt(5)
    v_smfmac_f32_16x16x64_bf16 v[12:15], v[36:39], v[48:55], v11
    ds_read_b128 v[48:51], v1 offset:18432
    ds_read_b128 v[52:55], v1 offset:19456
    v_smfmac_f32_16x16x64_bf16 v[16:19], v[36:39], v[248:255], v11
    v_smfmac_f32_16x16x64_bf16 v[20:23], v[36:39], a[136:143], v11
    ds_read_b128 v[36:39], v2 offset:9728
    s_waitcnt lgkmcnt(7)
    v_smfmac_f32_16x16x64_bf16 v[12:15], v[24:27], a[0:7], v11
    s_waitcnt vmcnt(8)
    v_smfmac_f32_16x16x64_bf16 v[16:19], v[24:27], v[56:63], v11
    s_waitcnt lgkmcnt(6)
    v_smfmac_f32_16x16x64_bf16 v[12:15], v[28:31], a[8:15], v11
    s_waitcnt vmcnt(6)
    v_smfmac_f32_16x16x64_bf16 v[16:19], v[28:31], v[64:71], v11
    s_waitcnt lgkmcnt(3)
    v_smfmac_f32_16x16x64_bf16 v[12:15], v[32:35], v[40:47], v11
    s_waitcnt vmcnt(4)
    v_smfmac_f32_16x16x64_bf16 v[16:19], v[32:35], v[72:79], v11
    s_waitcnt lgkmcnt(0)
    v_smfmac_f32_16x16x64_bf16 v[12:15], v[36:39], v[48:55], v11
    s_waitcnt vmcnt(2)
    v_smfmac_f32_16x16x64_bf16 v[16:19], v[36:39], v[80:87], v11
    v_and_b32 v0, 496, v10
    v_and_b32 v72, 512, v10
    v_lshl_add_u32 v0, v72, 2, v0
    v_add_u32 v72, s94, v0
    ds_read_b128 v[72:75], v72
    v_smfmac_f32_16x16x64_bf16 v[20:23], v[24:27], a[144:151], v11
    s_barrier
    ds_read_b128 v[40:43], v3 offset:10240
    ds_read_b128 v[44:47], v3 offset:14336
    v_cvt_pk_bf16_f32 v12, v12, v13
    v_cvt_pk_bf16_f32 v13, v14, v15
    v_cvt_pk_bf16_f32 v16, v16, v17
    v_cvt_pk_bf16_f32 v17, v18, v19
    s_waitcnt lgkmcnt(2)
    buffer_store_dwordx4 v[72:75], v0, s[56:59], s80 offen sc1
    ds_write_b64 v6, v[12:13]
    ds_write_b64 v6, v[16:17] offset:2048
    s_add_u32 s80, s80, 131072
    ds_read_b128 v[48:51], v3 offset:11264
    ds_read_b128 v[52:55], v3 offset:15360
    ds_read_b128 v[56:59], v3 offset:12288
    ds_read_b128 v[60:63], v3 offset:16384
    s_waitcnt lgkmcnt(4)
    s_barrier
    ds_read_b64_tr_b16 v[12:13], v4
    ds_read_b64_tr_b16 v[14:15], v4 offset:256
    ds_read_b64_tr_b16 v[16:17], v4 offset:512
    ds_read_b64_tr_b16 v[18:19], v4 offset:768
    ds_read_b64_tr_b16 v[24:25], v4 offset:2048
    ds_read_b64_tr_b16 v[26:27], v4 offset:2304
    v_smfmac_f32_16x16x64_bf16 v[20:23], v[28:31], a[152:159], v11
    ds_read_b64_tr_b16 v[72:73], v4 offset:1024
    ds_read_b64_tr_b16 v[74:75], v4 offset:1280
    ds_read_b64_tr_b16 v[28:29], v4 offset:2560
    ds_read_b64_tr_b16 v[30:31], v4 offset:2816
    ds_read_b128 v[64:67], v3 offset:13312
    ds_read_b128 v[68:71], v3 offset:17408
    v_smfmac_f32_16x16x64_bf16 v[20:23], v[32:35], a[160:167], v11
    ds_read_b64_tr_b16 v[76:77], v4 offset:1536
    ds_read_b64_tr_b16 v[78:79], v4 offset:1792
    ds_read_b64_tr_b16 v[32:33], v4 offset:3072
    ds_read_b64_tr_b16 v[34:35], v4 offset:3328
    s_waitcnt vmcnt(1)
    v_smfmac_f32_16x16x64_bf16 v[20:23], v[36:39], v[88:95], v11
    ds_read_b64_tr_b16 v[36:37], v4 offset:3584
    ds_read_b64_tr_b16 v[38:39], v4 offset:3840
    ds_read_b128 v[88:91], v3 offset:25600
    s_waitcnt lgkmcnt(15)
    v_mfma_f32_16x16x32_bf16 v[80:83], v[40:43], v[12:15], 0
    v_mov_b32 v40, v9
    v_mov_b32 v41, v9
    v_mov_b32 v42, v9
    v_mov_b32 v43, v9
    v_mfma_f32_16x16x32_bf16 v[84:87], v[44:47], v[12:15], 0
    ds_read_b128 v[44:47], v3 offset:18432
    v_mfma_f32_16x16x32_bf16 v[80:83], v[48:51], v[16:19], v[80:83]
    ds_read_b128 v[48:51], v3 offset:19456
    v_cvt_pk_bf16_f32 v20, v20, v21
    v_cvt_pk_bf16_f32 v21, v22, v23
    ds_write_b64 v6, v[20:21] offset:4096
    v_mfma_f32_16x16x32_bf16 v[84:87], v[52:55], v[16:19], v[84:87]
    ds_read_b128 v[52:55], v3 offset:20480
    s_waitcnt lgkmcnt(15)
    v_mfma_f32_16x16x32_bf16 v[80:83], v[56:59], v[72:75], v[80:83]
    ds_read_b128 v[56:59], v3 offset:21504
    v_mfma_f32_16x16x32_bf16 v[84:87], v[60:63], v[72:75], v[84:87]
    ds_read_b128 v[60:63], v3 offset:22528
    s_waitcnt lgkmcnt(11)
    v_mfma_f32_16x16x32_bf16 v[80:83], v[64:67], v[76:79], v[80:83]
    ds_read_b128 v[64:67], v3 offset:23552
    v_mfma_f32_16x16x32_bf16 v[84:87], v[68:71], v[76:79], v[84:87]
    ds_read_b128 v[68:71], v3 offset:24576
    v_mfma_f32_16x16x32_bf16 v[40:43], v[24:27], v[12:15], v[40:43]
    v_mfma_f32_16x16x32_bf16 v[40:43], v[28:31], v[16:19], v[40:43]
    s_waitcnt lgkmcnt(11)
    v_mfma_f32_16x16x32_bf16 v[40:43], v[32:35], v[72:75], v[40:43]
    s_waitcnt lgkmcnt(9)
    v_mfma_f32_16x16x32_bf16 v[40:43], v[36:39], v[76:79], v[40:43]
    v_max3_f32 v92, v80, v81, v82
    v_max3_f32 v93, v83, v84, v85
    v_max3_f32 v92, v92, v86, v87
    s_waitcnt lgkmcnt(0)
    s_barrier
    s_cmp_eq_u32 s62, 63
    s_cbranch_scc1 L_s_last
    ds_read_b64 v[12:13], v5
    ds_read_b64 v[14:15], v5 offset:256
    ds_read_b64 v[16:17], v5 offset:512
    ds_read_b64 v[18:19], v5 offset:768
    v_max3_f32 v93, v93, v40, v41
    v_max3_f32 v92, v92, v42, v43
    v_max_f32 v92, v92, v93
    v_mov_b32 v93, v92
    buffer_load_dwordx4 v[24:27], v10, s[56:59], s36 offen offset:2048
    buffer_load_dwordx4 v[28:31], v10, s[56:59], s36 offen offset:3072
    v_permlane32_swap_b32 v92, v93
    v_max_f32 v92, v92, v93
    v_mov_b32 v93, v92
    buffer_load_dwordx4 v[32:35], v10, s[56:59], s37 offen
    buffer_load_dwordx4 v[36:39], v10, s[56:59], s37 offen offset:1024
    v_permlane16_swap_b32 v92, v93
    v_max_f32 v92, v92, v93
    v_mul_f32 v92, s90, v92
    v_pk_fma_f32 v[40:41], v[40:41], s[90:91], v[92:93] op_sel_hi:[1,1,0] neg_lo:[0,0,1] neg_hi:[0,0,1]
    v_pk_fma_f32 v[42:43], v[42:43], s[90:91], v[92:93] op_sel_hi:[1,1,0] neg_lo:[0,0,1] neg_hi:[0,0,1]
    v_pk_fma_f32 v[80:81], v[80:81], s[90:91], v[92:93] op_sel_hi:[1,1,0] neg_lo:[0,0,1] neg_hi:[0,0,1]
    v_pk_fma_f32 v[82:83], v[82:83], s[90:91], v[92:93] op_sel_hi:[1,1,0] neg_lo:[0,0,1] neg_hi:[0,0,1]
    v_pk_fma_f32 v[84:85], v[84:85], s[90:91], v[92:93] op_sel_hi:[1,1,0] neg_lo:[0,0,1] neg_hi:[0,0,1]
    v_pk_fma_f32 v[86:87], v[86:87], s[90:91], v[92:93] op_sel_hi:[1,1,0] neg_lo:[0,0,1] neg_hi:[0,0,1]
    v_exp_f32 v40, v40
    v_exp_f32 v41, v41
    v_exp_f32 v42, v42
    v_exp_f32 v43, v43
    v_exp_f32 v80, v80
    v_exp_f32 v81, v81
    v_exp_f32 v82, v82
    v_exp_f32 v83, v83
    v_exp_f32 v84, v84
    v_exp_f32 v85, v85
    v_exp_f32 v86, v86
    v_exp_f32 v87, v87
    v_pk_add_f32 v[20:21], v[40:41], v[42:43]
    v_pk_add_f32 v[20:21], v[20:21], v[80:81]
    v_pk_add_f32 v[20:21], v[20:21], v[82:83]
    v_pk_add_f32 v[20:21], v[20:21], v[84:85]
    v_pk_add_f32 v[20:21], v[20:21], v[86:87]
    v_add_f32 v20, v20, v21
    v_mov_b32 v93, v20
    buffer_load_dwordx4 v[72:75], v10, s[56:59], s37 offen offset:2048
    buffer_load_dwordx4 v[76:79], v10, s[56:59], s37 offen offset:3072
    v_permlane32_swap_b32 v20, v93
    v_add_f32 v20, v20, v93
    v_mov_b32 v93, v20
    s_nop 1
    v_permlane16_swap_b32 v20, v93
    v_add_f32 v20, v20, v93
    v_rcp_f32 v22, v20
    s_nop 0
    v_pk_mul_f32 v[80:81], v[80:81], v[22:23] op_sel_hi:[1,0]
    v_pk_mul_f32 v[82:83], v[82:83], v[22:23] op_sel_hi:[1,0]
    v_pk_mul_f32 v[84:85], v[84:85], v[22:23] op_sel_hi:[1,0]
    v_pk_mul_f32 v[86:87], v[86:87], v[22:23] op_sel_hi:[1,0]
    v_pk_mul_f32 v[40:41], v[40:41], v[22:23] op_sel_hi:[1,0]
    v_pk_mul_f32 v[42:43], v[42:43], v[22:23] op_sel_hi:[1,0]
    v_cvt_pk_bf16_f32 v20, v80, v81
    v_cvt_pk_bf16_f32 v21, v82, v83
    v_cvt_pk_bf16_f32 v22, v84, v85
    v_cvt_pk_bf16_f32 v23, v86, v87
    v_cvt_pk_bf16_f32 v92, v40, v41
    v_cvt_pk_bf16_f32 v93, v42, v43
    v_mfma_f32_16x16x32_bf16 v[80:83], v[44:47], v[20:23], 0
    ds_read_b64 v[44:45], v5 offset:1024
    ds_read_b64 v[46:47], v5 offset:1280
    v_mfma_f32_16x16x32_bf16 v[84:87], v[48:51], v[20:23], 0
    ds_read_b64 v[48:49], v5 offset:1536
    ds_read_b64 v[50:51], v5 offset:1792
    v_mfma_f32_16x16x32_bf16 v[40:43], v[52:55], v[20:23], 0
    v_mfma_f32_16x16x32_bf16 v[52:55], v[56:59], v[20:23], 0
    v_mfma_f32_16x16x32_bf16 v[56:59], v[60:63], v[20:23], 0
    v_mfma_f32_16x16x32_bf16 v[60:63], v[64:67], v[20:23], 0
    v_mfma_f32_16x16x32_bf16 v[64:67], v[68:71], v[20:23], 0
    v_mfma_f32_16x16x32_bf16 v[68:71], v[88:91], v[20:23], 0
    s_waitcnt lgkmcnt(7)
    v_mfma_f32_16x16x16_bf16 v[80:83], v[12:13], v[92:93], v[80:83]
    v_mov_b64 v[20:21], 0
    v_mov_b64 v[22:23], 0
    s_waitcnt lgkmcnt(6)
    v_mfma_f32_16x16x16_bf16 v[84:87], v[14:15], v[92:93], v[84:87]
    s_waitcnt lgkmcnt(5)
    v_mfma_f32_16x16x16_bf16 v[40:43], v[16:17], v[92:93], v[40:43]
    s_waitcnt lgkmcnt(4)
    v_mfma_f32_16x16x16_bf16 v[52:55], v[18:19], v[92:93], v[52:55]
    v_cvt_pk_bf16_f32 v80, v80, v81
    v_cvt_pk_bf16_f32 v81, v82, v83
    s_waitcnt lgkmcnt(3)
    v_mfma_f32_16x16x16_bf16 v[56:59], v[44:45], v[92:93], v[56:59]
    v_cvt_pk_bf16_f32 v82, v84, v85
    v_cvt_pk_bf16_f32 v83, v86, v87
    ds_read_b128 v[12:15], v1 offset:20480
    ds_read_b128 v[16:19], v1 offset:21504
    s_waitcnt lgkmcnt(4)
    v_mfma_f32_16x16x16_bf16 v[60:63], v[46:47], v[92:93], v[60:63]
    v_cvt_pk_bf16_f32 v40, v40, v41
    v_cvt_pk_bf16_f32 v41, v42, v43
    s_waitcnt lgkmcnt(3)
    v_mfma_f32_16x16x16_bf16 v[64:67], v[48:49], v[92:93], v[64:67]
    v_cvt_pk_bf16_f32 v42, v52, v53
    v_cvt_pk_bf16_f32 v43, v54, v55
    s_waitcnt lgkmcnt(2)
    v_mfma_f32_16x16x16_bf16 v[68:71], v[50:51], v[92:93], v[68:71]
    v_cvt_pk_bf16_f32 v56, v56, v57
    v_cvt_pk_bf16_f32 v57, v58, v59
    ds_read_b128 v[44:47], v1 offset:22528
    ds_read_b128 v[48:51], v1 offset:23552
    v_smfmac_f32_16x16x64_bf16 v[20:23], v[80:83], a[168:175], v11
    v_cvt_pk_bf16_f32 v58, v60, v61
    v_cvt_pk_bf16_f32 v59, v62, v63
    v_smfmac_f32_16x16x64_bf16 v[20:23], v[40:43], a[176:183], v11
    v_cvt_pk_bf16_f32 v64, v64, v65
    v_cvt_pk_bf16_f32 v65, v66, v67
    v_cvt_pk_bf16_f32 v66, v68, v69
    v_cvt_pk_bf16_f32 v67, v70, v71
    v_smfmac_f32_16x16x64_bf16 v[20:23], v[56:59], a[184:191], v11
    v_mov_b64 v[84:85], 0
    v_mov_b64 v[86:87], 0
    v_smfmac_f32_16x16x64_bf16 v[20:23], v[64:67], a[192:199], v11
    v_mov_b64 v[52:53], 0
    v_mov_b64 v[54:55], 0
    s_waitcnt lgkmcnt(2)
    v_smfmac_f32_16x16x64_bf16 v[84:87], v[80:83], v[12:19], v11
    ds_read_b128 v[12:15], v1 offset:24576
    ds_read_b128 v[16:19], v1 offset:25600
    v_mov_b64 v[60:61], 0
    v_mov_b64 v[62:63], 0
    s_waitcnt lgkmcnt(2)
    v_smfmac_f32_16x16x64_bf16 v[84:87], v[40:43], v[44:51], v11
    ds_read_b128 v[44:47], v1 offset:26624
    ds_read_b128 v[48:51], v1 offset:27648
    v_mov_b64 v[68:69], 0
    v_mov_b64 v[70:71], 0
    v_smfmac_f32_16x16x64_bf16 v[84:87], v[56:59], a[200:207], v11
    v_cvt_pk_bf16_f32 v20, v20, v21
    v_cvt_pk_bf16_f32 v21, v22, v23
    v_bfi_b32 v20, s85, v9, v20
    buffer_store_dwordx2 v[20:21], v8, s[56:59], s68 offen sc1
    v_smfmac_f32_16x16x64_bf16 v[84:87], v[64:67], a[208:215], v11
    s_waitcnt lgkmcnt(2)
    v_smfmac_f32_16x16x64_bf16 v[52:55], v[80:83], v[12:19], v11
    ds_read_b128 v[12:15], v1 offset:28672
    ds_read_b128 v[16:19], v1 offset:29696
    s_waitcnt lgkmcnt(2)
    v_smfmac_f32_16x16x64_bf16 v[52:55], v[40:43], v[44:51], v11
    ds_read_b128 v[44:47], v1 offset:30720
    ds_read_b128 v[48:51], v1 offset:31744
    v_smfmac_f32_16x16x64_bf16 v[52:55], v[56:59], a[216:223], v11
    v_cvt_pk_bf16_f32 v84, v84, v85
    v_cvt_pk_bf16_f32 v85, v86, v87
    v_bfi_b32 v84, s85, v9, v84
    buffer_store_dwordx2 v[84:85], v8, s[56:59], s69 offen sc1
    v_smfmac_f32_16x16x64_bf16 v[52:55], v[64:67], a[224:231], v11
    s_waitcnt lgkmcnt(2)
    v_smfmac_f32_16x16x64_bf16 v[60:63], v[80:83], v[12:19], v11
    s_waitcnt lgkmcnt(0)
    v_smfmac_f32_16x16x64_bf16 v[60:63], v[40:43], v[44:51], v11
    v_smfmac_f32_16x16x64_bf16 v[60:63], v[56:59], a[232:239], v11
    s_nop 2
    v_cvt_pk_bf16_f32 v52, v52, v53
    v_cvt_pk_bf16_f32 v53, v54, v55
    v_bfi_b32 v52, s85, v9, v52
    buffer_store_dwordx2 v[52:53], v8, s[56:59], s70 offen sc1
    v_smfmac_f32_16x16x64_bf16 v[60:63], v[64:67], a[240:247], v11
    v_smfmac_f32_16x16x64_bf16 v[68:71], v[80:83], a[248:255], v11
    s_waitcnt vmcnt(7)
    v_smfmac_f32_16x16x64_bf16 v[68:71], v[40:43], v[24:31], v11
    s_waitcnt vmcnt(5)
    v_smfmac_f32_16x16x64_bf16 v[68:71], v[56:59], v[32:39], v11
    s_nop 2
    v_cvt_pk_bf16_f32 v60, v60, v61
    v_cvt_pk_bf16_f32 v61, v62, v63
    v_bfi_b32 v60, s85, v9, v60
    buffer_store_dwordx2 v[60:61], v8, s[56:59], s71 offen sc1
    s_waitcnt vmcnt(4)
    v_smfmac_f32_16x16x64_bf16 v[68:71], v[64:67], v[72:79], v11
    s_nop 7
    v_cvt_pk_bf16_f32 v68, v68, v69
    v_cvt_pk_bf16_f32 v69, v70, v71
    v_bfi_b32 v68, s85, v9, v68
    buffer_store_dwordx2 v[68:69], v8, s[56:59], s72 offen sc1
    s_add_u32 s62, s62, 1
    s_add_u32 s79, s79, 262144
    s_add_u32 s81, s81, 262144
    v_xor_b32 v9, s85, v9
    s_cmp_ge_u32 s65, 80
    s_cbranch_scc1 L_s_ag0
    v_and_b32 v39, 4095, v8
    v_lshlrev_b32 v39, 1, v39
    v_lshrrev_b32 v36, 4, v10
    v_and_b32 v36, 15, v36
    v_and_b32 v37, 1, v36
    v_lshlrev_b32 v37, 4, v37
    v_mov_b32 v38, 0x3f80
    v_lshlrev_b32 v37, v37, v38
    v_lshrrev_b32 v36, 1, v36
    v_cmp_eq_u32 vcc, 0, v36
    s_nop 1
    v_cndmask_b32 v32, 0, v37, vcc
    v_cmp_eq_u32 vcc, 1, v36
    s_nop 1
    v_cndmask_b32 v33, 0, v37, vcc
    v_cmp_eq_u32 vcc, 2, v36
    s_nop 1
    v_cndmask_b32 v34, 0, v37, vcc
    v_cmp_eq_u32 vcc, 3, v36
    s_nop 1
    v_cndmask_b32 v35, 0, v37, vcc
L_s_rs:
    buffer_load_dwordx4 v[12:15], v10, s[56:59], s66 offen sc1
    buffer_load_dwordx4 v[16:19], v10, s[56:59], s66 offen offset:1024 sc1
    buffer_load_dwordx4 v[20:23], v10, s[56:59], s66 offen offset:2048 sc1
    buffer_load_dwordx4 v[24:27], v10, s[56:59], s66 offen offset:3072 sc1
    s_waitcnt vmcnt(2)
    v_or3_b32 v50, v12, v14, v16
    s_waitcnt vmcnt(1)
    v_or3_b32 v50, v50, v18, v20
    s_waitcnt vmcnt(0)
    v_or3_b32 v50, v50, v22, v24
    v_or_b32 v50, v50, v26
    v_and_b32 v50, s84, v50
    v_cmp_ne_u32 vcc, 0, v50
    v_mfma_f32_16x16x32_bf16 v[28:31], v[32:35], v[12:15], 0
    v_mfma_f32_16x16x32_bf16 v[28:31], v[32:35], v[16:19], v[28:31]
    v_mfma_f32_16x16x32_bf16 v[28:31], v[32:35], v[20:23], v[28:31]
    v_mfma_f32_16x16x32_bf16 v[28:31], v[32:35], v[24:27], v[28:31]
    s_cbranch_vccnz L_s_rs
    s_nop 6
    v_add_f32 v28, v28, v28 row_ror:8 row_mask:0xf bank_mask:0xf
    v_add_f32 v29, v29, v29 row_ror:8 row_mask:0xf bank_mask:0xf
    v_add_f32 v30, v30, v30 row_ror:8 row_mask:0xf bank_mask:0xf
    v_add_f32 v31, v31, v31 row_ror:8 row_mask:0xf bank_mask:0xf
    v_cvt_pk_bf16_f32 v28, 0, v28
    v_cvt_pk_bf16_f32 v29, 0, v29
    v_cvt_pk_bf16_f32 v30, 0, v30
    v_cvt_pk_bf16_f32 v31, 0, v31
    v_or_b32 v28, s64, v28
    s_mov_b64 exec, 0x00ff00ff
    buffer_store_dwordx4 v[28:31], v39, s[56:59], s67 offen sc1
    s_mov_b64 exec, -1
    s_mov_b32 s86, s63
    s_mov_b32 s63, s64
    s_mov_b32 s64, s86
    s_xor_b32 s84, s84, s85
    v_subrev_u32 v48, 131072, v7
    v_and_b32 v44, 496, v48
    v_bfe_u32 v49, v48, 2, 2
    v_lshl_add_u32 v44, v49, 1, v44
    v_bfe_u32 v49, v48, 9, 1
    v_lshl_add_u32 v44, v49, 3, v44
    v_lshrrev_b32 v49, 10, v48
    v_lshl_add_u32 v44, v49, 9, v44
    v_add_u32 v44, 135168, v44
    v_xor_b32 v41, 16, v7
    v_xor_b32 v45, 16, v44
    v_xor_b32 v42, 32, v7
    v_xor_b32 v46, 32, v44
    v_xor_b32 v43, 48, v7
    v_xor_b32 v47, 48, v44
    buffer_load_dwordx4 v[56:59], v10, s[56:59], s32 offen
    buffer_load_dwordx4 v[60:63], v10, s[56:59], s32 offen offset:1024
    buffer_load_dwordx4 v[64:67], v10, s[56:59], s32 offen offset:2048
    buffer_load_dwordx4 v[68:71], v10, s[56:59], s32 offen offset:3072
    buffer_load_dwordx4 v[72:75], v10, s[56:59], s33 offen
    buffer_load_dwordx4 v[76:79], v10, s[56:59], s33 offen offset:1024
    buffer_load_dwordx4 v[80:83], v10, s[56:59], s33 offen offset:2048
    buffer_load_dwordx4 v[84:87], v10, s[56:59], s33 offen offset:3072
    s_sleep 2
    s_branch L_s_ag
L_s_ag0:
    s_mov_b32 s86, s63
    s_mov_b32 s63, s64
    s_mov_b32 s64, s86
    s_xor_b32 s84, s84, s85
    v_subrev_u32 v48, 131072, v7
    v_and_b32 v44, 496, v48
    v_bfe_u32 v49, v48, 2, 2
    v_lshl_add_u32 v44, v49, 1, v44
    v_bfe_u32 v49, v48, 9, 1
    v_lshl_add_u32 v44, v49, 3, v44
    v_lshrrev_b32 v49, 10, v48
    v_lshl_add_u32 v44, v49, 9, v44
    v_add_u32 v44, 135168, v44
    v_xor_b32 v41, 16, v7
    v_xor_b32 v45, 16, v44
    v_xor_b32 v42, 32, v7
    v_xor_b32 v46, 32, v44
    v_xor_b32 v43, 48, v7
    v_xor_b32 v47, 48, v44
    s_cmp_lg_u32 s61, 3
    s_cbranch_scc1 L_pg4e
    s_add_u32 s86, s62, 1
    s_and_b32 s87, s86, 3
    s_cmp_lg_u32 s87, 0
    s_cbranch_scc1 L_kvw5d
    s_cmp_ge_u32 s86, 64
    s_cbranch_scc1 L_kvw5d
    s_lshr_b32 s86, s86, 2
    s_mov_b32 s87, 94372864
    v_and_b32 v53, 240, v10
    v_lshlrev_b32 v53, 3, v53
L_kvw5:
    s_bitcmp1_b32 s47, s86
    s_cbranch_scc1 L_kvw5d
    buffer_load_dword v52, v53, s[56:59], s87 offen sc1
    s_waitcnt vmcnt(0)
    v_bfe_u32 v52, v52, 5, 6
    v_cmp_le_u32 vcc, 16, v52
    s_and_b32 s47, vcc_lo, 65535
    s_bitcmp1_b32 s47, s86
    s_cbranch_scc1 L_kvw5d
    s_sleep 4
    s_branch L_kvw5
L_kvw5d:
L_pg4e:
    s_sleep 2
    buffer_load_dwordx4 v[56:59], v10, s[56:59], s32 offen
    buffer_load_dwordx4 v[60:63], v10, s[56:59], s32 offen offset:1024
    buffer_load_dwordx4 v[64:67], v10, s[56:59], s32 offen offset:2048
    buffer_load_dwordx4 v[68:71], v10, s[56:59], s32 offen offset:3072
    buffer_load_dwordx4 v[72:75], v10, s[56:59], s33 offen
    buffer_load_dwordx4 v[76:79], v10, s[56:59], s33 offen offset:1024
    buffer_load_dwordx4 v[80:83], v10, s[56:59], s33 offen offset:2048
    buffer_load_dwordx4 v[84:87], v10, s[56:59], s33 offen offset:3072
    s_sleep 13
L_s_ag:
    buffer_load_dwordx4 v[12:15], v10, s[56:59], s73 offen sc1
    buffer_load_dwordx4 v[16:19], v10, s[56:59], s74 offen sc1
    buffer_load_dwordx4 v[20:23], v10, s[56:59], s75 offen sc1
    s_waitcnt vmcnt(0)
    v_or3_b32 v52, v12, v16, v20
    v_and_b32 v52, s64, v52
    v_cmp_ne_u32 vcc, 0, v52
    s_cbranch_vccnz L_s_ag
    buffer_load_dwordx4 v[88:91], v10, s[56:59], s76 offen sc1
    buffer_load_dwordx4 v[92:95], v10, s[56:59], s77 offen sc1
    v_perm_b32 v32, v16, v12, s95
    ds_write_b32 v7, v32
    ds_write_b16_d16_hi v44, v20
    v_perm_b32 v33, v17, v13, s95
    ds_write_b32 v41, v33
    ds_write_b16_d16_hi v45, v21
    v_perm_b32 v34, v18, v14, s95
    ds_write_b32 v42, v34
    ds_write_b16_d16_hi v46, v22
    v_perm_b32 v35, v19, v15, s95
    ds_write_b32 v43, v35
    ds_write_b16_d16_hi v47, v23
    s_add_u32 m0, s40, 141312
    s_add_u32 s87, s79, s40
    buffer_load_dwordx4 v10, s[56:59], s87 offen sc1 lds
    buffer_load_dwordx4 v10, s[56:59], s87 offen offset:1024 sc1 lds
    s_add_u32 m0, s40, 149504
    s_add_u32 s87, s81, s40
    buffer_load_dwordx4 v10, s[56:59], s87 offen sc1 lds
    buffer_load_dwordx4 v10, s[56:59], s87 offen offset:1024 sc1 lds
    s_sub_u32 s86, s62, 2
    v_mov_b32 v36, s86
    v_mov_b32 v37, 0
    s_mov_b64 exec, 1
    buffer_store_dword v36, v37, s[56:59], s46 offen sc1
    s_mov_b64 exec, -1
    s_branch L_s_top
L_s_agb:
    buffer_load_dwordx4 v[88:91], v10, s[56:59], s76 offen sc1
    buffer_load_dwordx4 v[92:95], v10, s[56:59], s77 offen sc1
    s_waitcnt vmcnt(0)
    v_or_b32 v0, v88, v92
    v_and_b32 v0, s64, v0
    v_cmp_ne_u32 vcc, 0, v0
    s_cbranch_vccnz L_s_agb
    s_nop 4
    s_branch L_s_agbok
L_s_last:
    v_and_b32 v0, 496, v10
    v_and_b32 v88, 512, v10
    v_lshl_add_u32 v0, v88, 2, v0
    v_add_u32 v88, s94, v0
    ds_read_b128 v[88:91], v88
    s_waitcnt lgkmcnt(0)
    buffer_store_dwordx4 v[88:91], v0, s[56:59], s80 offen sc1
L_s_exit:
L_chend:
    s_waitcnt vmcnt(0)
    s_barrier
    s_cmp_lg_u32 s61, 0
    s_cbranch_scc1 L_end
    v_mov_b32 v12, 1
    v_mov_b32 v13, 94372228
    s_mov_b64 exec, 1
    buffer_atomic_add v12, v13, s[56:59], 0 offen sc1
L_end:
    s_endpgm

.section .rodata,"a"
.p2align 6
.amdhsa_kernel recurrent_scan__memory_aug_recurrent_mem_tr__dense_activation_squared_relu__prompt_kernel
  .amdhsa_next_free_vgpr 512
  .amdhsa_next_free_sgpr 102
  .amdhsa_accum_offset 256
  .amdhsa_group_segment_fixed_size 0
  .amdhsa_kernarg_size 120
  .amdhsa_user_sgpr_count 2
  .amdhsa_user_sgpr_kernarg_segment_ptr 1
  .amdhsa_system_sgpr_workgroup_id_x 1
.end_amdhsa_kernel
```
